```python
import torch

def _softmax(x, axis=-1):
    return torch.softmax(x, dim=axis)
def _gelu(x):
    return torch.nn.functional.gelu(x, approximate="tanh")
def _silu(x):
    return torch.nn.functional.silu(x)
def _sigmoid(x):
    return torch.sigmoid(x)
def _layernorm(x, axis=-1, eps=1e-5):
    m = x.mean(dim=axis, keepdim=True)
    v = x.var(dim=axis, keepdim=True, unbiased=False)
    return (x - m) / torch.sqrt(v + eps)
def _scatter_add(tgt, idx, src, axis=0):
    return tgt.clone().index_add_(axis, idx, src)
def _segment_sum(src, seg, n):
    out = torch.zeros((n,) + src.shape[1:], dtype=src.dtype)
    return out.index_add_(0, seg, src)
def _pad(x, pw):
    flat = tuple(v for pair in reversed(pw) for v in pair)
    return torch.nn.functional.pad(x, flat)

kernel_name = 'parallel_sum__spectral_gfnet__dense_activation_mish__prompt'

def setup_inputs():

    _w = (lambda a: (lambda t: t.to(torch.bfloat16) if t.is_floating_point() else t)(torch.as_tensor(a)))
    def _A_setup():
        B, S, D = 1, 2048, 1024
        Df = D // 2 + 1
        return {
            "x": _w((lambda *s: torch.randn(*s, dtype=torch.bfloat16) * 0.05)(B, S, D)),
            "w_r": _w((lambda *s: torch.randn(*s, dtype=torch.bfloat16) * 0.8)(S, Df) * 0.02),
            "w_i": _w((lambda *s: torch.randn(*s, dtype=torch.bfloat16) * 0.8)(S, Df) * 0.02),
        }
    _A_in = _A_setup()

    def _B_setup():
        B, S, D, F = 1, 2048, 1024, 3584
        return {
            "x": _w((lambda *s: torch.randn(*s, dtype=torch.bfloat16) * 0.05)(B, S, D)),
            "w1": _w((lambda *s: torch.randn(*s, dtype=torch.bfloat16) * 0.8)(D, F) * (D ** -0.5)),
            "b1": _w((lambda *s: torch.randn(*s, dtype=torch.bfloat16) * 0.2)(F)),
            "w2": _w((lambda *s: torch.randn(*s, dtype=torch.bfloat16) * 0.1)(F, D) * (F ** -0.5)),
        }
    _B_in = _B_setup()

    return {
        "A_x": _A_in["x"],
        "A_w_r": _A_in["w_r"],
        "A_w_i": _A_in["w_i"],
        "B_x": _B_in["x"],
        "B_w1": _B_in["w1"],
        "B_b1": _B_in["b1"],
        "B_w2": _B_in["w2"],
    }

def reference(A_x, A_w_r, A_w_i, B_x, B_w1, B_b1, B_w2):
    def _A_ref(x, w_r, w_i):
        B, S, D = x.shape
        X = (lambda x, axes=(-2,-1): torch.fft.rfft2(x.float(), dim=axes))(x, axes=(-2, -1))
        W = w_r + 1j * w_i
        X = X * W
        y = (lambda x, s, axes=(-2,-1): torch.fft.irfft2(x, s=s, dim=axes).to(torch.bfloat16))(X, (S, D), axes=(-2, -1))
        return y

    def _B_ref(x, w1, b1, w2):
        h = torch.einsum("bsd,df->bsf", x, w1) + b1
        sp = torch.log1p(torch.exp(-torch.abs(h))) + torch.where(h > 0, h, torch.zeros_like(h))
        act = h * torch.tanh(sp)
        return torch.einsum("bsf,fd->bsd", act, w2)

    x = A_x
    xn = _layernorm(x, axis=-1)
    return x + _A_ref(xn, A_w_r, A_w_i) + _B_ref(xn, B_w1, B_b1, B_w2)
```

```asm
; @launch grid=(256,1,1) block=(512,1,1) lds=163840
.amdgcn_target "amdgcn-amd-amdhsa--gfx950"
.text
.globl parallel_sum__spectral_gfnet__dense_activation_mish__prompt_kernel
.p2align 8
.type parallel_sum__spectral_gfnet__dense_activation_mish__prompt_kernel,@function
parallel_sum__spectral_gfnet__dense_activation_mish__prompt_kernel:
    s_cmp_ge_u32 s2, 256
    s_cbranch_scc1 parallel_sum__spectral_gfnet__dense_activation_mish__prompt_kernel_end
    s_load_dwordx4 s[40:43], s[0:1], 0
    s_load_dwordx4 s[48:51], s[0:1], 32
    s_load_dwordx4 s[52:55], s[0:1], 64
    s_load_dwordx2 s[44:45], s[0:1], 16
    s_load_dwordx2 s[46:47], s[0:1], 48
    v_lshrrev_b32 v1, 6, v0
    v_and_b32 v2, 63, v0
    s_and_b32 s56, s2, 7
    s_lshr_b32 s57, s2, 3
    v_readfirstlane_b32 s3, v1
    s_and_b32 s58, s56, 2
    s_lshl_b32 s58, s58, 2
    s_and_b32 s59, s57, 7
    s_add_u32 s58, s58, s59
    s_and_b32 s59, s56, 1
    s_lshl_b32 s59, s59, 3
    s_and_b32 s60, s56, 4
    s_add_u32 s59, s59, s60
    s_lshr_b32 s60, s57, 3
    s_add_u32 s59, s59, s60
    v_lshlrev_b32 v3, 4, v2
    s_getpc_b64 s[60:61]
    s_add_u32 s60, s60, fft_tab@rel32@lo+4
    s_addc_u32 s61, s61, fft_tab@rel32@hi+12
    s_mov_b32 s12, s60
    s_mov_b32 s13, s61
    s_mov_b32 s14, 110592
    s_mov_b32 s15, 0x00020000
    s_cmp_lt_u32 s3, 4
    s_cbranch_scc1 parallel_sum__spectral_gfnet__dense_activation_mish__prompt_kernel_comp
    s_sub_u32 s60, s3, 4
    s_and_b32 s65, s57, 7
    s_lshl_b32 s65, s65, 1
    s_mov_b32 s61, 0
    s_cmp_eq_u32 s60, 3
    s_cbranch_scc1 parallel_sum__spectral_gfnet__dense_activation_mish__prompt_kernel_side
    s_cmp_lg_u32 s60, 0
    s_cbranch_scc1 parallel_sum__spectral_gfnet__dense_activation_mish__prompt_kernel_ldb
    s_lshl_b32 s62, s58, 17
    s_and_b32 s63, s2, 1
    s_lshl_b32 s63, s63, 16
    s_xor_b32 s64, s63, 65536
    v_add_u32 v4, 0, v2
    v_lshrrev_b32 v5, 3, v4
    v_and_b32 v6, 7, v4
    v_bfe_u32 v7, v4, 4, 3
    v_xor_b32 v6, v6, v7
    v_lshlrev_b32 v5, 11, v5
    v_lshl_add_u32 v5, v6, 4, v5
    v_add_u32 v5, s62, v5
    v_subrev_u32 v16, 0, v5
    v_add_u32 v4, 64, v2
    v_lshrrev_b32 v5, 3, v4
    v_and_b32 v6, 7, v4
    v_bfe_u32 v7, v4, 4, 3
    v_xor_b32 v6, v6, v7
    v_lshlrev_b32 v5, 11, v5
    v_lshl_add_u32 v5, v6, 4, v5
    v_add_u32 v5, s62, v5
    v_subrev_u32 v17, 1024, v5
    v_add_u32 v4, 128, v2
    v_lshrrev_b32 v5, 3, v4
    v_and_b32 v6, 7, v4
    v_bfe_u32 v7, v4, 4, 3
    v_xor_b32 v6, v6, v7
    v_lshlrev_b32 v5, 11, v5
    v_lshl_add_u32 v5, v6, 4, v5
    v_add_u32 v5, s62, v5
    v_subrev_u32 v18, 2048, v5
    v_add_u32 v4, 192, v2
    v_lshrrev_b32 v5, 3, v4
    v_and_b32 v6, 7, v4
    v_bfe_u32 v7, v4, 4, 3
    v_xor_b32 v6, v6, v7
    v_lshlrev_b32 v5, 11, v5
    v_lshl_add_u32 v5, v6, 4, v5
    v_add_u32 v5, s62, v5
    v_subrev_u32 v19, 3072, v5
    s_waitcnt lgkmcnt(0)
    s_mov_b32 s4, s40
    s_mov_b32 s5, s41
    s_mov_b32 s6, 4194304
    s_mov_b32 s7, 0x00020000
    s_barrier
    s_lshl_b32 s67, s65, 7
    s_mov_b32 m0, s61
    s_add_u32 s68, s67, s63
    buffer_load_dwordx4 v16, s[4:7], s68 offen offset:0 lds
    buffer_load_dwordx4 v17, s[4:7], s68 offen offset:1024 lds
    buffer_load_dwordx4 v18, s[4:7], s68 offen offset:2048 lds
    buffer_load_dwordx4 v19, s[4:7], s68 offen offset:3072 lds
    s_add_u32 m0, m0, 4096
    s_add_u32 s68, s68, 2097152
    buffer_load_dwordx4 v16, s[4:7], s68 offen offset:0 lds
    buffer_load_dwordx4 v17, s[4:7], s68 offen offset:1024 lds
    buffer_load_dwordx4 v18, s[4:7], s68 offen offset:2048 lds
    buffer_load_dwordx4 v19, s[4:7], s68 offen offset:3072 lds
    s_add_u32 m0, m0, 4096
    s_add_u32 s68, s67, s64
    buffer_load_dwordx4 v16, s[4:7], s68 offen offset:0 lds
    buffer_load_dwordx4 v17, s[4:7], s68 offen offset:1024 lds
    buffer_load_dwordx4 v18, s[4:7], s68 offen offset:2048 lds
    buffer_load_dwordx4 v19, s[4:7], s68 offen offset:3072 lds
    s_add_u32 m0, m0, 4096
    s_add_u32 s68, s68, 2097152
    buffer_load_dwordx4 v16, s[4:7], s68 offen offset:0 lds
    buffer_load_dwordx4 v17, s[4:7], s68 offen offset:1024 lds
    buffer_load_dwordx4 v18, s[4:7], s68 offen offset:2048 lds
    buffer_load_dwordx4 v19, s[4:7], s68 offen offset:3072 lds
    s_add_u32 s65, s65, 1
    s_and_b32 s65, s65, 15
    s_add_u32 s61, s61, 45568
    s_cmp_eq_u32 s61, 136704
    s_cselect_b32 s61, 0, s61
    s_lshl_b32 s67, s65, 7
    s_mov_b32 m0, s61
    s_add_u32 s68, s67, s63
    buffer_load_dwordx4 v16, s[4:7], s68 offen offset:0 lds
    buffer_load_dwordx4 v17, s[4:7], s68 offen offset:1024 lds
    buffer_load_dwordx4 v18, s[4:7], s68 offen offset:2048 lds
    buffer_load_dwordx4 v19, s[4:7], s68 offen offset:3072 lds
    s_add_u32 m0, m0, 4096
    s_add_u32 s68, s68, 2097152
    buffer_load_dwordx4 v16, s[4:7], s68 offen offset:0 lds
    buffer_load_dwordx4 v17, s[4:7], s68 offen offset:1024 lds
    buffer_load_dwordx4 v18, s[4:7], s68 offen offset:2048 lds
    buffer_load_dwordx4 v19, s[4:7], s68 offen offset:3072 lds
    s_add_u32 m0, m0, 4096
    s_add_u32 s68, s67, s64
    buffer_load_dwordx4 v16, s[4:7], s68 offen offset:0 lds
    buffer_load_dwordx4 v17, s[4:7], s68 offen offset:1024 lds
    buffer_load_dwordx4 v18, s[4:7], s68 offen offset:2048 lds
    buffer_load_dwordx4 v19, s[4:7], s68 offen offset:3072 lds
    s_add_u32 m0, m0, 4096
    s_add_u32 s68, s68, 2097152
    buffer_load_dwordx4 v16, s[4:7], s68 offen offset:0 lds
    buffer_load_dwordx4 v17, s[4:7], s68 offen offset:1024 lds
    buffer_load_dwordx4 v18, s[4:7], s68 offen offset:2048 lds
    buffer_load_dwordx4 v19, s[4:7], s68 offen offset:3072 lds
    s_add_u32 s65, s65, 1
    s_and_b32 s65, s65, 15
    s_add_u32 s61, s61, 45568
    s_cmp_eq_u32 s61, 136704
    s_cselect_b32 s61, 0, s61
    s_and_b32 s95, s2, 1
    s_and_b32 s96, s59, 7
    s_and_b32 s97, s60, 1
    s_lshl_b32 s43, s58, 1
    s_add_u32 s43, s43, s95
    s_and_b32 s43, s43, 7
    s_lshl_b32 s43, s43, 7
    v_xor_b32 v249, s43, v3
    s_lshl_b32 s98, s58, 6
    s_lshl_b32 s99, s95, 5
    s_add_u32 s98, s98, s99
    s_lshr_b32 s99, s60, 1
    s_lshl_b32 s99, s99, 4
    s_add_u32 s98, s98, s99
    s_lshl_b32 s98, s98, 11
    s_lshl_b32 s99, s96, 7
    s_add_u32 s98, s98, s99
    s_lshl_b32 s99, s97, 6
    s_add_u32 s98, s98, s99
    s_add_u32 s99, s98, 2097152
    v_lshrrev_b32 v4, 4, v2
    v_and_b32 v5, 15, v2
    v_lshlrev_b32 v6, 11, v5
    v_and_b32 v7, 1, v4
    v_lshl_add_u32 v6, v7, 5, v6
    v_lshrrev_b32 v7, 1, v4
    v_lshl_add_u32 v250, v7, 4, v6
    s_and_b32 s44, s57, 7
    s_lshl_b32 s43, s44, 1
    s_add_u32 s43, s43, 11
    v_add_u32 v6, s43, v2
    v_subrev_u32 v7, 14, v6
    v_min_u32 v6, v6, v7
    v_subrev_u32 v7, 14, v6
    v_min_u32 v6, v6, v7
    v_lshrrev_b32 v8, 1, v6
    v_and_b32 v9, 1, v6
    v_lshlrev_b32 v9, 2, v9
    s_sub_u32 s43, s44, 17
    v_add_u32 v6, s43, v2
    v_cmp_lt_u32 vcc, 16, v2
    v_subrev_u32 v7, 7, v6
    v_min_u32 v6, v6, v7
    v_cndmask_b32 v8, v8, v6, vcc
    v_cndmask_b32 v9, v9, 2, vcc
    v_cmp_le_u32 vcc, s96, v8
    v_add_u32 v6, 1, v8
    v_add_u32 v9, s97, v9
    v_cndmask_b32 v8, v8, v6, vcc
    s_lshl_b32 s43, s44, 1
    s_add_u32 s43, s43, s97
    v_cmp_lt_u32 vcc, 23, v2
    v_lshl_add_u32 v6, v2, 1, s43
    v_and_b32 v6, 7, v6
    v_cndmask_b32 v8, v8, v6, vcc
    v_cndmask_b32 v9, v9, 6, vcc
    v_lshlrev_b32 v6, 2, v2
    v_and_b32 v6, 4, v6
    v_cmp_gt_u32 vcc, 3, v2
    v_and_b32 v7, 2, v2
    v_add3_u32 v6, v6, v7, s97
    v_mov_b32 v7, s96
    v_cndmask_b32 v8, v8, v7, vcc
    v_cndmask_b32 v9, v9, v6, vcc
    v_mad_u32_u24 v8, v8, 7, v9
    s_lshl_b32 s43, s58, 2
    s_mul_i32 s43, s43, 112
    s_mul_i32 s44, s95, 56
    s_add_u32 s43, s43, s44
    s_lshl_b32 s43, s43, 10
    s_add_u32 s43, s43, 4190208
    v_lshl_add_u32 v248, v8, 10, s43
    s_mul_i32 s43, s95, 229376
    s_xor_b32 s44, s95, 1
    s_mul_i32 s44, s44, 229376
    v_add_u32 v6, s43, v3
    v_add_u32 v7, s44, v3
    v_add_u32 v240, 4096, v6
    v_add_u32 v241, 117760, v6
    v_add_u32 v242, 7342080, v6
    v_add_u32 v243, 7455744, v6
    v_add_u32 v244, 4096, v7
    v_add_u32 v245, 117760, v7
    v_add_u32 v246, 7342080, v7
    v_add_u32 v247, 7455744, v7
    s_mov_b32 s66, 0
parallel_sum__spectral_gfnet__dense_activation_mish__prompt_kernel_la:
    s_waitcnt vmcnt(16)
    s_barrier
    s_lshl_b32 s67, s65, 7
    s_mov_b32 m0, s61
    s_add_u32 s68, s67, s63
    buffer_load_dwordx4 v16, s[4:7], s68 offen offset:0 lds
    buffer_load_dwordx4 v17, s[4:7], s68 offen offset:1024 lds
    buffer_load_dwordx4 v18, s[4:7], s68 offen offset:2048 lds
    buffer_load_dwordx4 v19, s[4:7], s68 offen offset:3072 lds
    s_add_u32 m0, m0, 4096
    s_add_u32 s68, s68, 2097152
    buffer_load_dwordx4 v16, s[4:7], s68 offen offset:0 lds
    buffer_load_dwordx4 v17, s[4:7], s68 offen offset:1024 lds
    buffer_load_dwordx4 v18, s[4:7], s68 offen offset:2048 lds
    buffer_load_dwordx4 v19, s[4:7], s68 offen offset:3072 lds
    s_add_u32 m0, m0, 4096
    s_add_u32 s68, s67, s64
    buffer_load_dwordx4 v16, s[4:7], s68 offen offset:0 lds
    buffer_load_dwordx4 v17, s[4:7], s68 offen offset:1024 lds
    buffer_load_dwordx4 v18, s[4:7], s68 offen offset:2048 lds
    buffer_load_dwordx4 v19, s[4:7], s68 offen offset:3072 lds
    s_add_u32 m0, m0, 4096
    s_add_u32 s68, s68, 2097152
    buffer_load_dwordx4 v16, s[4:7], s68 offen offset:0 lds
    buffer_load_dwordx4 v17, s[4:7], s68 offen offset:1024 lds
    buffer_load_dwordx4 v18, s[4:7], s68 offen offset:2048 lds
    buffer_load_dwordx4 v19, s[4:7], s68 offen offset:3072 lds
    s_add_u32 s65, s65, 1
    s_and_b32 s65, s65, 15
    s_add_u32 s61, s61, 45568
    s_cmp_eq_u32 s61, 136704
    s_cselect_b32 s61, 0, s61
    s_add_u32 s66, s66, 1
    s_cmp_lt_u32 s66, 14
    s_cbranch_scc1 parallel_sum__spectral_gfnet__dense_activation_mish__prompt_kernel_la
    s_branch parallel_sum__spectral_gfnet__dense_activation_mish__prompt_kernel_join
parallel_sum__spectral_gfnet__dense_activation_mish__prompt_kernel_ldb:
    v_cmp_lt_u32 vcc, 27, v2
    v_subrev_u32 v4, 28, v2
    s_sub_u32 s64, s60, 1
    s_mul_i32 s62, s59, 448
    s_mul_i32 s63, s64, 229376
    s_add_u32 s62, s62, s63
    v_cndmask_b32 v4, v2, v4, vcc
    v_mov_b32 v5, s62
    v_add_u32 v6, 7168, v5
    v_cndmask_b32 v5, v5, v6, vcc
    v_lshl_add_u32 v6, v4, 4, v5
    v_xor_b32 v4, 2, v4
    v_lshl_add_u32 v7, v4, 4, v5
    v_cmp_lt_u32 vcc, 55, v2
    v_mov_b32 v4, 0x40000000
    s_mul_i32 s63, s64, 14592
    v_cndmask_b32 v6, v6, v4, vcc
    v_cndmask_b32 v7, v7, v4, vcc
    s_add_u32 s63, s63, 16384
    v_add_u32 v16, 0, v6
    v_add_u32 v17, 13440, v6
    v_add_u32 v18, 26880, v6
    v_add_u32 v19, 40320, v6
    v_add_u32 v20, 57344, v7
    v_add_u32 v21, 70784, v7
    v_add_u32 v22, 84224, v7
    v_add_u32 v23, 97664, v7
    s_waitcnt lgkmcnt(0)
    s_mov_b32 s8, s48
    s_mov_b32 s9, s49
    s_mov_b32 s10, 7340032
    s_mov_b32 s11, 0x00020000
    s_barrier
    s_add_u32 m0, s61, s63
    s_mul_i32 s68, s65, 458752
    buffer_load_dwordx4 v16, s[8:11], s68 offen offset:0  lds
    buffer_load_dwordx4 v17, s[8:11], s68 offen offset:896  lds
    buffer_load_dwordx4 v18, s[8:11], s68 offen offset:1792  lds
    buffer_load_dwordx4 v19, s[8:11], s68 offen offset:2688  lds
    s_add_u32 m0, m0, 3584
    s_nop 0
    buffer_load_dwordx4 v20, s[8:11], s68 offen offset:0  lds
    buffer_load_dwordx4 v21, s[8:11], s68 offen offset:896  lds
    buffer_load_dwordx4 v22, s[8:11], s68 offen offset:1792  lds
    buffer_load_dwordx4 v23, s[8:11], s68 offen offset:2688  lds
    s_add_u32 m0, m0, 3712
    s_add_u32 s68, s68, 114688
    buffer_load_dwordx4 v16, s[8:11], s68 offen offset:0  lds
    buffer_load_dwordx4 v17, s[8:11], s68 offen offset:896  lds
    buffer_load_dwordx4 v18, s[8:11], s68 offen offset:1792  lds
    buffer_load_dwordx4 v19, s[8:11], s68 offen offset:2688  lds
    s_add_u32 m0, m0, 3584
    s_nop 0
    buffer_load_dwordx4 v20, s[8:11], s68 offen offset:0  lds
    buffer_load_dwordx4 v21, s[8:11], s68 offen offset:896  lds
    buffer_load_dwordx4 v22, s[8:11], s68 offen offset:1792  lds
    buffer_load_dwordx4 v23, s[8:11], s68 offen offset:2688  lds
    s_add_u32 s65, s65, 1
    s_and_b32 s65, s65, 15
    s_add_u32 s61, s61, 45568
    s_cmp_eq_u32 s61, 136704
    s_cselect_b32 s61, 0, s61
    s_add_u32 m0, s61, s63
    s_mul_i32 s68, s65, 458752
    buffer_load_dwordx4 v16, s[8:11], s68 offen offset:0  lds
    buffer_load_dwordx4 v17, s[8:11], s68 offen offset:896  lds
    buffer_load_dwordx4 v18, s[8:11], s68 offen offset:1792  lds
    buffer_load_dwordx4 v19, s[8:11], s68 offen offset:2688  lds
    s_add_u32 m0, m0, 3584
    s_nop 0
    buffer_load_dwordx4 v20, s[8:11], s68 offen offset:0  lds
    buffer_load_dwordx4 v21, s[8:11], s68 offen offset:896  lds
    buffer_load_dwordx4 v22, s[8:11], s68 offen offset:1792  lds
    buffer_load_dwordx4 v23, s[8:11], s68 offen offset:2688  lds
    s_add_u32 m0, m0, 3712
    s_add_u32 s68, s68, 114688
    buffer_load_dwordx4 v16, s[8:11], s68 offen offset:0  lds
    buffer_load_dwordx4 v17, s[8:11], s68 offen offset:896  lds
    buffer_load_dwordx4 v18, s[8:11], s68 offen offset:1792  lds
    buffer_load_dwordx4 v19, s[8:11], s68 offen offset:2688  lds
    s_add_u32 m0, m0, 3584
    s_nop 0
    buffer_load_dwordx4 v20, s[8:11], s68 offen offset:0  lds
    buffer_load_dwordx4 v21, s[8:11], s68 offen offset:896  lds
    buffer_load_dwordx4 v22, s[8:11], s68 offen offset:1792  lds
    buffer_load_dwordx4 v23, s[8:11], s68 offen offset:2688  lds
    s_add_u32 s65, s65, 1
    s_and_b32 s65, s65, 15
    s_add_u32 s61, s61, 45568
    s_cmp_eq_u32 s61, 136704
    s_cselect_b32 s61, 0, s61
    s_and_b32 s95, s2, 1
    s_and_b32 s96, s59, 7
    s_and_b32 s97, s60, 1
    s_lshl_b32 s43, s58, 1
    s_add_u32 s43, s43, s95
    s_and_b32 s43, s43, 7
    s_lshl_b32 s43, s43, 7
    v_xor_b32 v249, s43, v3
    s_lshl_b32 s98, s58, 6
    s_lshl_b32 s99, s95, 5
    s_add_u32 s98, s98, s99
    s_lshr_b32 s99, s60, 1
    s_lshl_b32 s99, s99, 4
    s_add_u32 s98, s98, s99
    s_lshl_b32 s98, s98, 11
    s_lshl_b32 s99, s96, 7
    s_add_u32 s98, s98, s99
    s_lshl_b32 s99, s97, 6
    s_add_u32 s98, s98, s99
    s_add_u32 s99, s98, 2097152
    v_lshrrev_b32 v4, 4, v2
    v_and_b32 v5, 15, v2
    v_lshlrev_b32 v6, 11, v5
    v_and_b32 v7, 1, v4
    v_lshl_add_u32 v6, v7, 5, v6
    v_lshrrev_b32 v7, 1, v4
    v_lshl_add_u32 v250, v7, 4, v6
    s_and_b32 s44, s57, 7
    s_lshl_b32 s43, s44, 1
    s_add_u32 s43, s43, 11
    v_add_u32 v6, s43, v2
    v_subrev_u32 v7, 14, v6
    v_min_u32 v6, v6, v7
    v_subrev_u32 v7, 14, v6
    v_min_u32 v6, v6, v7
    v_lshrrev_b32 v8, 1, v6
    v_and_b32 v9, 1, v6
    v_lshlrev_b32 v9, 2, v9
    s_sub_u32 s43, s44, 17
    v_add_u32 v6, s43, v2
    v_cmp_lt_u32 vcc, 16, v2
    v_subrev_u32 v7, 7, v6
    v_min_u32 v6, v6, v7
    v_cndmask_b32 v8, v8, v6, vcc
    v_cndmask_b32 v9, v9, 2, vcc
    v_cmp_le_u32 vcc, s96, v8
    v_add_u32 v6, 1, v8
    v_add_u32 v9, s97, v9
    v_cndmask_b32 v8, v8, v6, vcc
    s_lshl_b32 s43, s44, 1
    s_add_u32 s43, s43, s97
    v_cmp_lt_u32 vcc, 23, v2
    v_lshl_add_u32 v6, v2, 1, s43
    v_and_b32 v6, 7, v6
    v_cndmask_b32 v8, v8, v6, vcc
    v_cndmask_b32 v9, v9, 6, vcc
    v_lshlrev_b32 v6, 2, v2
    v_and_b32 v6, 4, v6
    v_cmp_gt_u32 vcc, 3, v2
    v_and_b32 v7, 2, v2
    v_add3_u32 v6, v6, v7, s97
    v_mov_b32 v7, s96
    v_cndmask_b32 v8, v8, v7, vcc
    v_cndmask_b32 v9, v9, v6, vcc
    v_mad_u32_u24 v8, v8, 7, v9
    s_cmp_lt_u32 s60, 2
    s_cbranch_scc0 parallel_sum__spectral_gfnet__dense_activation_mish__prompt_kernel_vb_lb
    s_lshl_b32 s43, s58, 2
    s_mul_i32 s43, s43, 112
    s_mul_i32 s44, s95, 56
    s_add_u32 s43, s43, s44
    s_lshl_b32 s43, s43, 10
    s_add_u32 s43, s43, 4190208
    v_lshl_add_u32 v248, v8, 10, s43
    s_mul_i32 s43, s95, 229376
    s_xor_b32 s44, s95, 1
    s_mul_i32 s44, s44, 229376
    v_add_u32 v6, s43, v3
    v_add_u32 v7, s44, v3
    v_add_u32 v240, 4096, v6
    v_add_u32 v241, 117760, v6
    v_add_u32 v242, 7342080, v6
    v_add_u32 v243, 7455744, v6
    v_add_u32 v244, 4096, v7
    v_add_u32 v245, 117760, v7
    v_add_u32 v246, 7342080, v7
    v_add_u32 v247, 7455744, v7
    s_branch parallel_sum__spectral_gfnet__dense_activation_mish__prompt_kernel_vc_lb
parallel_sum__spectral_gfnet__dense_activation_mish__prompt_kernel_vb_lb:
    s_mul_i32 s43, s95, 3670016
    v_lshl_add_u32 v248, v8, 16, s43
    s_lshl_b32 s43, s96, 7
    v_add_u32 v6, 0, v4
    v_lshlrev_b32 v7, 1, v6
    v_xor_b32 v7, v7, v5
    v_and_b32 v8, 7, v7
    v_lshrrev_b32 v7, 3, v7
    v_lshlrev_b32 v6, 11, v6
    v_lshl_add_u32 v6, v8, 4, v6
    v_lshl_add_u32 v6, v7, 10, v6
    v_add_u32 v6, s43, v6
    v_subrev_u32 v240, 0, v6
    v_add_u32 v242, 14336, v240
    v_add_u32 v244, 32768, v240
    v_add_u32 v246, 47104, v240
    v_add_u32 v6, 4, v4
    v_lshlrev_b32 v7, 1, v6
    v_xor_b32 v7, v7, v5
    v_and_b32 v8, 7, v7
    v_lshrrev_b32 v7, 3, v7
    v_lshlrev_b32 v6, 11, v6
    v_lshl_add_u32 v6, v8, 4, v6
    v_lshl_add_u32 v6, v7, 10, v6
    v_add_u32 v6, s43, v6
    v_subrev_u32 v241, 1024, v6
    v_add_u32 v243, 14336, v241
    v_add_u32 v245, 32768, v241
    v_add_u32 v247, 47104, v241
parallel_sum__spectral_gfnet__dense_activation_mish__prompt_kernel_vc_lb:
    s_mov_b32 s66, 0
parallel_sum__spectral_gfnet__dense_activation_mish__prompt_kernel_lb:
    s_waitcnt vmcnt(16)
    s_barrier
    s_add_u32 m0, s61, s63
    s_mul_i32 s68, s65, 458752
    buffer_load_dwordx4 v16, s[8:11], s68 offen offset:0  lds
    buffer_load_dwordx4 v17, s[8:11], s68 offen offset:896  lds
    buffer_load_dwordx4 v18, s[8:11], s68 offen offset:1792  lds
    buffer_load_dwordx4 v19, s[8:11], s68 offen offset:2688  lds
    s_add_u32 m0, m0, 3584
    s_nop 0
    buffer_load_dwordx4 v20, s[8:11], s68 offen offset:0  lds
    buffer_load_dwordx4 v21, s[8:11], s68 offen offset:896  lds
    buffer_load_dwordx4 v22, s[8:11], s68 offen offset:1792  lds
    buffer_load_dwordx4 v23, s[8:11], s68 offen offset:2688  lds
    s_add_u32 m0, m0, 3712
    s_add_u32 s68, s68, 114688
    buffer_load_dwordx4 v16, s[8:11], s68 offen offset:0  lds
    buffer_load_dwordx4 v17, s[8:11], s68 offen offset:896  lds
    buffer_load_dwordx4 v18, s[8:11], s68 offen offset:1792  lds
    buffer_load_dwordx4 v19, s[8:11], s68 offen offset:2688  lds
    s_add_u32 m0, m0, 3584
    s_nop 0
    buffer_load_dwordx4 v20, s[8:11], s68 offen offset:0  lds
    buffer_load_dwordx4 v21, s[8:11], s68 offen offset:896  lds
    buffer_load_dwordx4 v22, s[8:11], s68 offen offset:1792  lds
    buffer_load_dwordx4 v23, s[8:11], s68 offen offset:2688  lds
    s_add_u32 s65, s65, 1
    s_and_b32 s65, s65, 15
    s_add_u32 s61, s61, 45568
    s_cmp_eq_u32 s61, 136704
    s_cselect_b32 s61, 0, s61
    s_add_u32 s66, s66, 1
    s_cmp_lt_u32 s66, 14
    s_cbranch_scc1 parallel_sum__spectral_gfnet__dense_activation_mish__prompt_kernel_lb
    s_branch parallel_sum__spectral_gfnet__dense_activation_mish__prompt_kernel_join
parallel_sum__spectral_gfnet__dense_activation_mish__prompt_kernel_side:
    s_getpc_b64 s[88:89]
parallel_sum__spectral_gfnet__dense_activation_mish__prompt_kernel_pc:
    s_sub_u32 s88, s88, parallel_sum__spectral_gfnet__dense_activation_mish__prompt_kernel_pc-parallel_sum__spectral_gfnet__dense_activation_mish__prompt_kernel
    s_subb_u32 s89, s89, 0
    s_mov_b32 s90, parallel_sum__spectral_gfnet__dense_activation_mish__prompt_kernel_last-parallel_sum__spectral_gfnet__dense_activation_mish__prompt_kernel
    s_mov_b32 s91, 0x00020000
    v_lshlrev_b32 v16, 7, v2
    s_mul_i32 s68, s57, 52
    s_lshr_b32 s68, s68, 8
    s_mul_i32 s68, s68, 5
    s_sub_u32 s68, s57, s68
    s_lshl_b32 s68, s68, 13
    buffer_load_dword v35, v16, s[88:91], s68 offen
    v_mov_b32 v4, 163776
    v_mov_b32 v8, 0
    v_mov_b32 v9, 0
    v_mov_b32 v10, 0
    v_mov_b32 v11, 0
    ds_write_b128 v4, v[8:11]
    ds_write_b128 v4, v[8:11] offset:16
    v_and_b32 v4, 3, v2
    v_lshlrev_b32 v4, 4, v4
    v_add_u32 v4, 161472, v4
    ds_write_b128 v4, v[8:11]
    v_lshlrev_b32 v14, 2, v2
    v_lshlrev_b32 v12, 6, v2
    s_lshl_b32 s61, s57, 1
    s_lshl_b32 s62, s56, 8
    s_add_u32 s61, s61, s62
    s_mul_i32 s61, s61, 1026
    s_waitcnt lgkmcnt(0)
    s_mov_b32 s20, s42
    s_mov_b32 s21, s43
    s_mov_b32 s22, 2101248
    s_mov_b32 s23, 0x00020000
    s_mov_b32 s24, s44
    s_mov_b32 s25, s45
    s_mov_b32 s26, 2101248
    s_mov_b32 s27, 0x00020000
    s_barrier
    s_mov_b32 s16, s54
    s_mov_b32 s17, s55
    s_mov_b32 s18, 67108864
    s_mov_b32 s19, 0x00020000
    s_mov_b32 s28, s52
    s_mov_b32 s29, s53
    s_mov_b32 s30, 256
    s_mov_b32 s31, 0x00020000
    s_mov_b32 s32, s46
    s_mov_b32 s33, s47
    s_mov_b32 s34, 7340032
    s_mov_b32 s35, 0x00020000
    s_lshr_b32 s62, s2, 5
    s_lshl_b32 s62, s62, 6
    s_and_b32 s63, s2, 31
    s_lshl_b32 s63, s63, 4
    v_and_b32 v4, 15, v2
    v_add_u32 v4, s62, v4
    v_lshrrev_b32 v5, 4, v2
    v_lshl_add_u32 v5, v5, 2, s63
    s_mov_b32 s64, 0x3a800000
    v_add_u32 v6, 0, v5
    v_bfe_u32 v7, v6, 3, 5
    v_and_b32 v8, 7, v6
    v_lshrrev_b32 v9, 8, v6
    v_lshl_add_u32 v8, v8, 1, v9
    v_and_b32 v9, 16, v7
    v_or_b32 v9, v9, v8
    v_cmp_eq_u32 vcc, 0, v9
    v_lshl_add_u32 v9, v7, 5, v8
    v_add_u32 v7, 16, v9
    v_cndmask_b32 v9, v9, v7, vcc
    v_mul_u32_u24 v10, v9, v4
    v_cmp_eq_u32 vcc, 512, v9
    v_lshlrev_b32 v9, 4, v9
    v_mov_b32 v11, 1.0
    v_cndmask_b32 v11, v11, 0.5, vcc
    v_and_b32 v7, 1023, v10
    v_cvt_f32_u32 v7, v7
    v_mul_f32 v7, s64, v7
    v_cos_f32 v8, v7
    v_sin_f32 v7, v7
    v_add_u32 v10, v10, v9
    v_mul_f32 v8, v8, v11
    v_cvt_pk_bf16_f32 v160, v8, -v7
    v_and_b32 v7, 1023, v10
    v_cvt_f32_u32 v7, v7
    v_mul_f32 v7, s64, v7
    v_cos_f32 v8, v7
    v_sin_f32 v7, v7
    v_add_u32 v10, v10, v9
    v_mul_f32 v8, v8, v11
    v_cvt_pk_bf16_f32 v164, v8, -v7
    v_and_b32 v7, 1023, v10
    v_cvt_f32_u32 v7, v7
    v_mul_f32 v7, s64, v7
    v_cos_f32 v8, v7
    v_sin_f32 v7, v7
    v_add_u32 v10, v10, v9
    v_mul_f32 v8, v8, v11
    v_cvt_pk_bf16_f32 v168, v8, -v7
    v_and_b32 v7, 1023, v10
    v_cvt_f32_u32 v7, v7
    v_mul_f32 v7, s64, v7
    v_cos_f32 v8, v7
    v_sin_f32 v7, v7
    v_add_u32 v10, v10, v9
    v_mul_f32 v8, v8, v11
    v_cvt_pk_bf16_f32 v172, v8, -v7
    v_add_u32 v6, 1, v5
    v_bfe_u32 v7, v6, 3, 5
    v_and_b32 v8, 7, v6
    v_lshrrev_b32 v9, 8, v6
    v_lshl_add_u32 v8, v8, 1, v9
    v_and_b32 v9, 16, v7
    v_or_b32 v9, v9, v8
    v_cmp_eq_u32 vcc, 0, v9
    v_lshl_add_u32 v9, v7, 5, v8
    v_add_u32 v7, 16, v9
    v_cndmask_b32 v9, v9, v7, vcc
    v_mul_u32_u24 v10, v9, v4
    v_cmp_eq_u32 vcc, 512, v9
    v_lshlrev_b32 v9, 4, v9
    v_mov_b32 v11, 1.0
    v_cndmask_b32 v11, v11, 0.5, vcc
    v_and_b32 v7, 1023, v10
    v_cvt_f32_u32 v7, v7
    v_mul_f32 v7, s64, v7
    v_cos_f32 v8, v7
    v_sin_f32 v7, v7
    v_add_u32 v10, v10, v9
    v_mul_f32 v8, v8, v11
    v_cvt_pk_bf16_f32 v161, v8, -v7
    v_and_b32 v7, 1023, v10
    v_cvt_f32_u32 v7, v7
    v_mul_f32 v7, s64, v7
    v_cos_f32 v8, v7
    v_sin_f32 v7, v7
    v_add_u32 v10, v10, v9
    v_mul_f32 v8, v8, v11
    v_cvt_pk_bf16_f32 v165, v8, -v7
    v_and_b32 v7, 1023, v10
    v_cvt_f32_u32 v7, v7
    v_mul_f32 v7, s64, v7
    v_cos_f32 v8, v7
    v_sin_f32 v7, v7
    v_add_u32 v10, v10, v9
    v_mul_f32 v8, v8, v11
    v_cvt_pk_bf16_f32 v169, v8, -v7
    v_and_b32 v7, 1023, v10
    v_cvt_f32_u32 v7, v7
    v_mul_f32 v7, s64, v7
    v_cos_f32 v8, v7
    v_sin_f32 v7, v7
    v_add_u32 v10, v10, v9
    v_mul_f32 v8, v8, v11
    v_cvt_pk_bf16_f32 v173, v8, -v7
    v_add_u32 v6, 2, v5
    v_bfe_u32 v7, v6, 3, 5
    v_and_b32 v8, 7, v6
    v_lshrrev_b32 v9, 8, v6
    v_lshl_add_u32 v8, v8, 1, v9
    v_and_b32 v9, 16, v7
    v_or_b32 v9, v9, v8
    v_cmp_eq_u32 vcc, 0, v9
    v_lshl_add_u32 v9, v7, 5, v8
    v_add_u32 v7, 16, v9
    v_cndmask_b32 v9, v9, v7, vcc
    v_mul_u32_u24 v10, v9, v4
    v_cmp_eq_u32 vcc, 512, v9
    v_lshlrev_b32 v9, 4, v9
    v_mov_b32 v11, 1.0
    v_cndmask_b32 v11, v11, 0.5, vcc
    v_and_b32 v7, 1023, v10
    v_cvt_f32_u32 v7, v7
    v_mul_f32 v7, s64, v7
    v_cos_f32 v8, v7
    v_sin_f32 v7, v7
    v_add_u32 v10, v10, v9
    v_mul_f32 v8, v8, v11
    v_cvt_pk_bf16_f32 v162, v8, -v7
    v_and_b32 v7, 1023, v10
    v_cvt_f32_u32 v7, v7
    v_mul_f32 v7, s64, v7
    v_cos_f32 v8, v7
    v_sin_f32 v7, v7
    v_add_u32 v10, v10, v9
    v_mul_f32 v8, v8, v11
    v_cvt_pk_bf16_f32 v166, v8, -v7
    v_and_b32 v7, 1023, v10
    v_cvt_f32_u32 v7, v7
    v_mul_f32 v7, s64, v7
    v_cos_f32 v8, v7
    v_sin_f32 v7, v7
    v_add_u32 v10, v10, v9
    v_mul_f32 v8, v8, v11
    v_cvt_pk_bf16_f32 v170, v8, -v7
    v_and_b32 v7, 1023, v10
    v_cvt_f32_u32 v7, v7
    v_mul_f32 v7, s64, v7
    v_cos_f32 v8, v7
    v_sin_f32 v7, v7
    v_add_u32 v10, v10, v9
    v_mul_f32 v8, v8, v11
    v_cvt_pk_bf16_f32 v174, v8, -v7
    v_add_u32 v6, 3, v5
    v_bfe_u32 v7, v6, 3, 5
    v_and_b32 v8, 7, v6
    v_lshrrev_b32 v9, 8, v6
    v_lshl_add_u32 v8, v8, 1, v9
    v_and_b32 v9, 16, v7
    v_or_b32 v9, v9, v8
    v_cmp_eq_u32 vcc, 0, v9
    v_lshl_add_u32 v9, v7, 5, v8
    v_add_u32 v7, 16, v9
    v_cndmask_b32 v9, v9, v7, vcc
    v_mul_u32_u24 v10, v9, v4
    v_cmp_eq_u32 vcc, 512, v9
    v_lshlrev_b32 v9, 4, v9
    v_mov_b32 v11, 1.0
    v_cndmask_b32 v11, v11, 0.5, vcc
    v_and_b32 v7, 1023, v10
    v_cvt_f32_u32 v7, v7
    v_mul_f32 v7, s64, v7
    v_cos_f32 v8, v7
    v_sin_f32 v7, v7
    v_add_u32 v10, v10, v9
    v_mul_f32 v8, v8, v11
    v_cvt_pk_bf16_f32 v163, v8, -v7
    v_and_b32 v7, 1023, v10
    v_cvt_f32_u32 v7, v7
    v_mul_f32 v7, s64, v7
    v_cos_f32 v8, v7
    v_sin_f32 v7, v7
    v_add_u32 v10, v10, v9
    v_mul_f32 v8, v8, v11
    v_cvt_pk_bf16_f32 v167, v8, -v7
    v_and_b32 v7, 1023, v10
    v_cvt_f32_u32 v7, v7
    v_mul_f32 v7, s64, v7
    v_cos_f32 v8, v7
    v_sin_f32 v7, v7
    v_add_u32 v10, v10, v9
    v_mul_f32 v8, v8, v11
    v_cvt_pk_bf16_f32 v171, v8, -v7
    v_and_b32 v7, 1023, v10
    v_cvt_f32_u32 v7, v7
    v_mul_f32 v7, s64, v7
    v_cos_f32 v8, v7
    v_sin_f32 v7, v7
    v_add_u32 v10, v10, v9
    v_mul_f32 v8, v8, v11
    v_cvt_pk_bf16_f32 v175, v8, -v7
    v_lshrrev_b32 v5, 4, v2
    v_and_b32 v6, 15, v2
    v_cmp_eq_u32 vcc, 0, v6
    v_lshl_add_u32 v7, v5, 5, v6
    v_add_u32 v8, 16, v7
    v_cndmask_b32 v8, v7, v8, vcc
    v_lshlrev_b32 v18, 1, v8
    v_add_u32 v18, 136704, v18
    v_sub_u32 v7, 128, v7
    v_lshlrev_b32 v19, 1, v7
    v_add_u32 v19, 136704, v19
    v_lshrrev_b32 v8, 3, v2
    v_lshlrev_b32 v7, 15, v8
    v_and_b32 v9, 7, v2
    v_lshl_add_u32 v7, v9, 4, v7
    s_and_b32 s41, s57, 7
    v_xor_b32 v8, s41, v8
    v_lshl_add_u32 v20, v8, 7, v7
    v_xor_b32 v21, 0x380, v20
    s_lshl_b32 s41, s56, 5
    s_add_u32 s41, s41, s57
    s_and_b32 s41, s41, 0xf8
    s_lshl_b32 s41, s41, 7
    v_mul_u32_u24 v7, 272, v5
    v_lshl_add_u32 v7, v6, 4, v7
    v_add_u32 v22, 136704, v7
    v_mov_b32 v28, 0x3f803f80
    v_mov_b32 v29, 0x3f803f80
    v_mov_b32 v30, 0x3f803f80
    v_mov_b32 v31, 0x3f803f80
    s_bfe_u32 s66, s56, 0x10001
    v_bfe_u32 v7, v2, 2, 2
    v_lshl_add_u32 v7, v5, 3, v7
    v_mul_u32_u24 v7, 448, v7
    v_and_b32 v8, 3, v2
    v_lshl_add_u32 v7, v8, 3, v7
    v_add_u32 v7, 16384, v7
    v_lshrrev_b32 v8, 1, v5
    v_lshl_add_u32 v7, v8, 7, v7
    s_mul_i32 s43, s66, 45568
    v_add_u32 v7, s43, v7
    v_and_b32 v8, 1, v5
    v_lshlrev_b32 v8, 5, v8
    v_add_u32 v24, v7, v8
    v_sub_u32 v25, v7, v8
    v_lshlrev_b32 v7, 4, v5
    v_add_u32 v26, 161536, v7
    v_add_u32 v27, 161408, v14
    s_and_b32 s43, s2, 1
    s_mul_i32 s43, s43, 1792
    s_mul_i32 s44, s57, 56
    s_add_u32 s43, s43, s44
    s_lshl_b32 s43, s43, 11
    s_bfe_u32 s44, s2, 0x10002
    s_lshl_b32 s44, s44, 9
    s_add_u32 s43, s43, s44
    v_lshrrev_b32 v4, 3, v2
    v_lshlrev_b32 v4, 11, v4
    v_and_b32 v5, 3, v2
    v_lshl_add_u32 v4, v5, 7, v4
    v_bfe_u32 v5, v2, 2, 1
    v_lshl_add_u32 v4, v5, 10, v4
    v_add_u32 v23, s43, v4
    s_lshl_b32 s61, s57, 1
    s_lshl_b32 s62, s56, 8
    s_add_u32 s61, s61, s62
    s_mul_i32 s61, s61, 1026
    v_and_b32 v4, 31, v2
    v_min_u32 v4, 24, v4
    v_lshlrev_b32 v4, 7, v4
    v_lshrrev_b32 v5, 5, v2
    v_mul_u32_u24 v5, 65664, v5
    v_add_u32 v17, v4, v5
    v_mov_b32 v13, 1
    s_bfe_u32 s43, s2, 0x20003
    s_lshl_b32 s43, s43, 6
    v_mov_b32 v32, s43
    v_bfe_u32 v4, v2, 2, 2
    s_mov_b32 s43, 0x3f803f80
    v_mov_b32 v5, s43
    v_cmp_eq_u32 vcc, 0, v4
    s_nop 1
    v_cndmask_b32 v240, 0, v5, vcc
    v_mov_b32 v241, v240
    v_mov_b32 v242, v240
    v_mov_b32 v243, v240
    v_cmp_eq_u32 vcc, 1, v4
    s_nop 1
    v_cndmask_b32 v244, 0, v5, vcc
    v_mov_b32 v245, v244
    v_mov_b32 v246, v244
    v_mov_b32 v247, v244
    v_cmp_eq_u32 vcc, 2, v4
    s_nop 1
    v_cndmask_b32 v248, 0, v5, vcc
    v_mov_b32 v249, v248
    v_mov_b32 v250, v248
    v_mov_b32 v251, v248
    v_cmp_eq_u32 vcc, 3, v4
    s_nop 1
    v_cndmask_b32 v252, 0, v5, vcc
    v_mov_b32 v253, v252
    v_mov_b32 v254, v252
    v_mov_b32 v255, v252
    s_barrier
    s_cmp_lg_u32 s66, 0
    s_cbranch_scc1 parallel_sum__spectral_gfnet__dense_activation_mish__prompt_kernel_cq_1
    ds_read_b64_tr_b16 v[44:45], v24 offset:0
    ds_read_b64_tr_b16 v[46:47], v24 offset:1792
    ds_read_b64_tr_b16 v[48:49], v24 offset:14592
    ds_read_b64_tr_b16 v[50:51], v24 offset:16384
    ds_read_b64_tr_b16 v[52:53], v25 offset:32
    ds_read_b64_tr_b16 v[54:55], v25 offset:1824
    ds_read_b64_tr_b16 v[56:57], v25 offset:14624
    ds_read_b64_tr_b16 v[58:59], v25 offset:16416
    ds_read_b64_tr_b16 v[60:61], v24 offset:64
    ds_read_b64_tr_b16 v[62:63], v24 offset:1856
    ds_read_b64_tr_b16 v[64:65], v24 offset:14656
    ds_read_b64_tr_b16 v[66:67], v24 offset:16448
    ds_read_b64_tr_b16 v[68:69], v25 offset:96
    ds_read_b64_tr_b16 v[70:71], v25 offset:1888
    ds_read_b64_tr_b16 v[72:73], v25 offset:14688
    ds_read_b64_tr_b16 v[74:75], v25 offset:16480
    ds_read_b64_tr_b16 v[76:77], v24 offset:128
    ds_read_b64_tr_b16 v[78:79], v24 offset:1920
    ds_read_b64_tr_b16 v[80:81], v24 offset:14720
    ds_read_b64_tr_b16 v[82:83], v24 offset:16512
    ds_read_b64_tr_b16 v[84:85], v25 offset:160
    ds_read_b64_tr_b16 v[86:87], v25 offset:1952
    ds_read_b64_tr_b16 v[88:89], v25 offset:14752
    ds_read_b64_tr_b16 v[90:91], v25 offset:16544
    ds_read_b64_tr_b16 v[92:93], v24 offset:192
    ds_read_b64_tr_b16 v[94:95], v24 offset:1984
    ds_read_b64_tr_b16 v[96:97], v24 offset:14784
    ds_read_b64_tr_b16 v[98:99], v24 offset:16576
    ds_read_b64_tr_b16 v[100:101], v25 offset:224
    ds_read_b64_tr_b16 v[102:103], v25 offset:2016
    ds_read_b64_tr_b16 v[104:105], v25 offset:14816
    ds_read_b64_tr_b16 v[106:107], v25 offset:16608
    ds_read_b64_tr_b16 v[108:109], v24 offset:256
    ds_read_b64_tr_b16 v[110:111], v24 offset:2048
    ds_read_b64_tr_b16 v[112:113], v24 offset:14848
    ds_read_b64_tr_b16 v[114:115], v24 offset:16640
    ds_read_b64_tr_b16 v[116:117], v25 offset:288
    ds_read_b64_tr_b16 v[118:119], v25 offset:2080
    ds_read_b64_tr_b16 v[120:121], v25 offset:14880
    ds_read_b64_tr_b16 v[122:123], v25 offset:16672
    ds_read_b64_tr_b16 v[124:125], v24 offset:320
    ds_read_b64_tr_b16 v[126:127], v24 offset:2112
    ds_read_b64_tr_b16 v[128:129], v24 offset:14912
    ds_read_b64_tr_b16 v[130:131], v24 offset:16704
    ds_read_b64_tr_b16 v[132:133], v25 offset:352
    ds_read_b64_tr_b16 v[134:135], v25 offset:2144
    ds_read_b64_tr_b16 v[136:137], v25 offset:14944
    ds_read_b64_tr_b16 v[138:139], v25 offset:16736
    ds_read_b64_tr_b16 v[140:141], v24 offset:384
    ds_read_b64_tr_b16 v[142:143], v24 offset:2176
    ds_read_b64_tr_b16 v[144:145], v24 offset:14976
    ds_read_b64_tr_b16 v[146:147], v24 offset:16768
    ds_read_b64_tr_b16 v[148:149], v25 offset:416
    ds_read_b64_tr_b16 v[150:151], v25 offset:2208
    ds_read_b64_tr_b16 v[152:153], v25 offset:15008
    ds_read_b64_tr_b16 v[154:155], v25 offset:16800
    s_waitcnt lgkmcnt(0)
parallel_sum__spectral_gfnet__dense_activation_mish__prompt_kernel_cq_1:
    ds_read_b128 v[176:179], v22 offset:0
    ds_read_b128 v[180:183], v22 offset:4352
    ds_read_b128 v[184:187], v22 offset:8704
    ds_read_b128 v[188:191], v22 offset:13056
    s_add_u32 s43, s41, 20971520
    s_waitcnt lgkmcnt(3)
    buffer_store_dwordx4 v[176:179], v20, s[16:19], s43 offen sc1
    s_add_u32 s43, s41, 22020096
    s_waitcnt lgkmcnt(2)
    buffer_store_dwordx4 v[180:183], v20, s[16:19], s43 offen sc1
    s_add_u32 s43, s41, 23068672
    s_waitcnt lgkmcnt(1)
    buffer_store_dwordx4 v[184:187], v20, s[16:19], s43 offen sc1
    s_add_u32 s43, s41, 24117248
    s_waitcnt lgkmcnt(0)
    buffer_store_dwordx4 v[188:191], v20, s[16:19], s43 offen sc1
    s_barrier
    s_cmp_lg_u32 s66, 1
    s_cbranch_scc1 parallel_sum__spectral_gfnet__dense_activation_mish__prompt_kernel_cq_2
    ds_read_b64_tr_b16 v[44:45], v24 offset:0
    ds_read_b64_tr_b16 v[46:47], v24 offset:1792
    ds_read_b64_tr_b16 v[48:49], v24 offset:14592
    ds_read_b64_tr_b16 v[50:51], v24 offset:16384
    ds_read_b64_tr_b16 v[52:53], v25 offset:32
    ds_read_b64_tr_b16 v[54:55], v25 offset:1824
    ds_read_b64_tr_b16 v[56:57], v25 offset:14624
    ds_read_b64_tr_b16 v[58:59], v25 offset:16416
    ds_read_b64_tr_b16 v[60:61], v24 offset:64
    ds_read_b64_tr_b16 v[62:63], v24 offset:1856
    ds_read_b64_tr_b16 v[64:65], v24 offset:14656
    ds_read_b64_tr_b16 v[66:67], v24 offset:16448
    ds_read_b64_tr_b16 v[68:69], v25 offset:96
    ds_read_b64_tr_b16 v[70:71], v25 offset:1888
    ds_read_b64_tr_b16 v[72:73], v25 offset:14688
    ds_read_b64_tr_b16 v[74:75], v25 offset:16480
    ds_read_b64_tr_b16 v[76:77], v24 offset:128
    ds_read_b64_tr_b16 v[78:79], v24 offset:1920
    ds_read_b64_tr_b16 v[80:81], v24 offset:14720
    ds_read_b64_tr_b16 v[82:83], v24 offset:16512
    ds_read_b64_tr_b16 v[84:85], v25 offset:160
    ds_read_b64_tr_b16 v[86:87], v25 offset:1952
    ds_read_b64_tr_b16 v[88:89], v25 offset:14752
    ds_read_b64_tr_b16 v[90:91], v25 offset:16544
    ds_read_b64_tr_b16 v[92:93], v24 offset:192
    ds_read_b64_tr_b16 v[94:95], v24 offset:1984
    ds_read_b64_tr_b16 v[96:97], v24 offset:14784
    ds_read_b64_tr_b16 v[98:99], v24 offset:16576
    ds_read_b64_tr_b16 v[100:101], v25 offset:224
    ds_read_b64_tr_b16 v[102:103], v25 offset:2016
    ds_read_b64_tr_b16 v[104:105], v25 offset:14816
    ds_read_b64_tr_b16 v[106:107], v25 offset:16608
    ds_read_b64_tr_b16 v[108:109], v24 offset:256
    ds_read_b64_tr_b16 v[110:111], v24 offset:2048
    ds_read_b64_tr_b16 v[112:113], v24 offset:14848
    ds_read_b64_tr_b16 v[114:115], v24 offset:16640
    ds_read_b64_tr_b16 v[116:117], v25 offset:288
    ds_read_b64_tr_b16 v[118:119], v25 offset:2080
    ds_read_b64_tr_b16 v[120:121], v25 offset:14880
    ds_read_b64_tr_b16 v[122:123], v25 offset:16672
    ds_read_b64_tr_b16 v[124:125], v24 offset:320
    ds_read_b64_tr_b16 v[126:127], v24 offset:2112
    ds_read_b64_tr_b16 v[128:129], v24 offset:14912
    ds_read_b64_tr_b16 v[130:131], v24 offset:16704
    ds_read_b64_tr_b16 v[132:133], v25 offset:352
    ds_read_b64_tr_b16 v[134:135], v25 offset:2144
    ds_read_b64_tr_b16 v[136:137], v25 offset:14944
    ds_read_b64_tr_b16 v[138:139], v25 offset:16736
    ds_read_b64_tr_b16 v[140:141], v24 offset:384
    ds_read_b64_tr_b16 v[142:143], v24 offset:2176
    ds_read_b64_tr_b16 v[144:145], v24 offset:14976
    ds_read_b64_tr_b16 v[146:147], v24 offset:16768
    ds_read_b64_tr_b16 v[148:149], v25 offset:416
    ds_read_b64_tr_b16 v[150:151], v25 offset:2208
    ds_read_b64_tr_b16 v[152:153], v25 offset:15008
    ds_read_b64_tr_b16 v[154:155], v25 offset:16800
    s_waitcnt lgkmcnt(0)
parallel_sum__spectral_gfnet__dense_activation_mish__prompt_kernel_cq_2:
    ds_read_b128 v[176:179], v22 offset:1088
    ds_read_b128 v[180:183], v22 offset:5440
    ds_read_b128 v[184:187], v22 offset:9792
    ds_read_b128 v[188:191], v22 offset:14144
    s_add_u32 s43, s41, 21233664
    s_waitcnt lgkmcnt(3)
    buffer_store_dwordx4 v[176:179], v20, s[16:19], s43 offen sc1
    s_add_u32 s43, s41, 22282240
    s_waitcnt lgkmcnt(2)
    buffer_store_dwordx4 v[180:183], v20, s[16:19], s43 offen sc1
    s_add_u32 s43, s41, 23330816
    s_waitcnt lgkmcnt(1)
    buffer_store_dwordx4 v[184:187], v20, s[16:19], s43 offen sc1
    s_add_u32 s43, s41, 24379392
    s_waitcnt lgkmcnt(0)
    buffer_store_dwordx4 v[188:191], v20, s[16:19], s43 offen sc1
    s_barrier
    v_mfma_f32_16x16x32_bf16 v[208:211], v[240:243], v[44:47], 0
    v_mfma_f32_16x16x32_bf16 v[208:211], v[240:243], v[48:51], v[208:211]
    v_mfma_f32_16x16x32_bf16 v[208:211], v[244:247], v[52:55], v[208:211]
    v_mfma_f32_16x16x32_bf16 v[208:211], v[244:247], v[56:59], v[208:211]
    v_mfma_f32_16x16x32_bf16 v[208:211], v[248:251], v[60:63], v[208:211]
    v_mfma_f32_16x16x32_bf16 v[208:211], v[248:251], v[64:67], v[208:211]
    v_mfma_f32_16x16x32_bf16 v[208:211], v[252:255], v[68:71], v[208:211]
    v_mfma_f32_16x16x32_bf16 v[208:211], v[252:255], v[72:75], v[208:211]
    v_mfma_f32_16x16x32_bf16 v[212:215], v[240:243], v[76:79], 0
    v_mfma_f32_16x16x32_bf16 v[212:215], v[240:243], v[80:83], v[212:215]
    v_mfma_f32_16x16x32_bf16 v[212:215], v[244:247], v[84:87], v[212:215]
    v_mfma_f32_16x16x32_bf16 v[212:215], v[244:247], v[88:91], v[212:215]
    v_mfma_f32_16x16x32_bf16 v[212:215], v[248:251], v[92:95], v[212:215]
    v_mfma_f32_16x16x32_bf16 v[212:215], v[248:251], v[96:99], v[212:215]
    ds_read_b128 v[176:179], v22 offset:2176
    ds_read_b128 v[180:183], v22 offset:6528
    ds_read_b128 v[184:187], v22 offset:10880
    ds_read_b128 v[188:191], v22 offset:15232
    s_add_u32 s43, s41, 21495808
    s_waitcnt lgkmcnt(3)
    buffer_store_dwordx4 v[176:179], v20, s[16:19], s43 offen sc1
    s_add_u32 s43, s41, 22544384
    s_waitcnt lgkmcnt(2)
    buffer_store_dwordx4 v[180:183], v20, s[16:19], s43 offen sc1
    s_add_u32 s43, s41, 23592960
    s_waitcnt lgkmcnt(1)
    buffer_store_dwordx4 v[184:187], v20, s[16:19], s43 offen sc1
    s_add_u32 s43, s41, 24641536
    s_waitcnt lgkmcnt(0)
    buffer_store_dwordx4 v[188:191], v20, s[16:19], s43 offen sc1
    ds_read_b128 v[176:179], v22 offset:3264
    ds_read_b128 v[180:183], v22 offset:7616
    ds_read_b128 v[184:187], v22 offset:11968
    ds_read_b128 v[188:191], v22 offset:16320
    s_add_u32 s43, s41, 21757952
    s_waitcnt lgkmcnt(3)
    buffer_store_dwordx4 v[176:179], v20, s[16:19], s43 offen sc1
    s_add_u32 s43, s41, 22806528
    s_waitcnt lgkmcnt(2)
    buffer_store_dwordx4 v[180:183], v20, s[16:19], s43 offen sc1
    s_add_u32 s43, s41, 23855104
    s_waitcnt lgkmcnt(1)
    buffer_store_dwordx4 v[184:187], v20, s[16:19], s43 offen sc1
    s_add_u32 s43, s41, 24903680
    s_waitcnt lgkmcnt(0)
    buffer_store_dwordx4 v[188:191], v20, s[16:19], s43 offen sc1
    s_barrier
    v_mfma_f32_16x16x32_bf16 v[212:215], v[252:255], v[100:103], v[212:215]
    v_mfma_f32_16x16x32_bf16 v[212:215], v[252:255], v[104:107], v[212:215]
    v_mfma_f32_16x16x32_bf16 v[216:219], v[240:243], v[108:111], 0
    v_mfma_f32_16x16x32_bf16 v[216:219], v[240:243], v[112:115], v[216:219]
    v_mfma_f32_16x16x32_bf16 v[216:219], v[244:247], v[116:119], v[216:219]
    v_mfma_f32_16x16x32_bf16 v[216:219], v[244:247], v[120:123], v[216:219]
    v_mfma_f32_16x16x32_bf16 v[216:219], v[248:251], v[124:127], v[216:219]
    v_mfma_f32_16x16x32_bf16 v[216:219], v[248:251], v[128:131], v[216:219]
    v_mfma_f32_16x16x32_bf16 v[216:219], v[252:255], v[132:135], v[216:219]
    v_mfma_f32_16x16x32_bf16 v[216:219], v[252:255], v[136:139], v[216:219]
    v_mfma_f32_16x16x32_bf16 v[220:223], v[240:243], v[140:143], 0
    v_mfma_f32_16x16x32_bf16 v[220:223], v[240:243], v[144:147], v[220:223]
    v_mfma_f32_16x16x32_bf16 v[220:223], v[244:247], v[148:151], v[220:223]
    v_mfma_f32_16x16x32_bf16 v[220:223], v[244:247], v[152:155], v[220:223]
    s_add_u32 s43, s61, 0
    s_mov_b32 m0, 136704
    s_nop 0
    buffer_load_dwordx4 v3, s[20:23], s43 offen offset:0 nt lds
    buffer_load_dwordx4 v3, s[20:23], s43 offen offset:1024 nt lds
    buffer_load_dwordx4 v3, s[20:23], s43 offen offset:2048 nt lds
    s_mov_b64 exec, 3
    buffer_load_dword v14, s[20:23], s43 offen offset:3072 nt lds
    s_mov_b64 exec, -1
    s_mov_b32 m0, 139792
    s_nop 0
    buffer_load_dwordx4 v3, s[24:27], s43 offen offset:0 nt lds
    buffer_load_dwordx4 v3, s[24:27], s43 offen offset:1024 nt lds
    buffer_load_dwordx4 v3, s[24:27], s43 offen offset:2048 nt lds
    s_mov_b64 exec, 3
    buffer_load_dword v14, s[24:27], s43 offen offset:3072 nt lds
    s_mov_b64 exec, -1
    s_add_u32 s43, s61, 65664
    s_mov_b32 m0, 142880
    s_nop 0
    buffer_load_dwordx4 v3, s[20:23], s43 offen offset:0 nt lds
    buffer_load_dwordx4 v3, s[20:23], s43 offen offset:1024 nt lds
    buffer_load_dwordx4 v3, s[20:23], s43 offen offset:2048 nt lds
    s_mov_b64 exec, 3
    buffer_load_dword v14, s[20:23], s43 offen offset:3072 nt lds
    s_mov_b64 exec, -1
    s_mov_b32 m0, 145968
    s_nop 0
    buffer_load_dwordx4 v3, s[24:27], s43 offen offset:0 nt lds
    buffer_load_dwordx4 v3, s[24:27], s43 offen offset:1024 nt lds
    buffer_load_dwordx4 v3, s[24:27], s43 offen offset:2048 nt lds
    s_mov_b64 exec, 3
    buffer_load_dword v14, s[24:27], s43 offen offset:3072 nt lds
    s_mov_b64 exec, -1
    s_add_u32 s43, s61, 131328
    s_mov_b32 m0, 149056
    s_nop 0
    buffer_load_dwordx4 v3, s[20:23], s43 offen offset:0 nt lds
    buffer_load_dwordx4 v3, s[20:23], s43 offen offset:1024 nt lds
    buffer_load_dwordx4 v3, s[20:23], s43 offen offset:2048 nt lds
    s_mov_b64 exec, 3
    buffer_load_dword v14, s[20:23], s43 offen offset:3072 nt lds
    s_mov_b64 exec, -1
    s_mov_b32 m0, 152144
    s_nop 0
    buffer_load_dwordx4 v3, s[24:27], s43 offen offset:0 nt lds
    buffer_load_dwordx4 v3, s[24:27], s43 offen offset:1024 nt lds
    buffer_load_dwordx4 v3, s[24:27], s43 offen offset:2048 nt lds
    s_mov_b64 exec, 3
    buffer_load_dword v14, s[24:27], s43 offen offset:3072 nt lds
    s_mov_b64 exec, -1
    s_add_u32 s43, s61, 196992
    s_mov_b32 m0, 155232
    s_nop 0
    buffer_load_dwordx4 v3, s[20:23], s43 offen offset:0 nt lds
    buffer_load_dwordx4 v3, s[20:23], s43 offen offset:1024 nt lds
    buffer_load_dwordx4 v3, s[20:23], s43 offen offset:2048 nt lds
    s_mov_b64 exec, 3
    buffer_load_dword v14, s[20:23], s43 offen offset:3072 nt lds
    s_mov_b64 exec, -1
    s_mov_b32 m0, 158320
    s_nop 0
    buffer_load_dwordx4 v3, s[24:27], s43 offen offset:0 nt lds
    buffer_load_dwordx4 v3, s[24:27], s43 offen offset:1024 nt lds
    buffer_load_dwordx4 v3, s[24:27], s43 offen offset:2048 nt lds
    s_mov_b64 exec, 3
    buffer_load_dword v14, s[24:27], s43 offen offset:3072 nt lds
    s_mov_b64 exec, -1
    s_cmp_lg_u32 s2, 255
    s_cbranch_scc1 parallel_sum__spectral_gfnet__dense_activation_mish__prompt_kernel_wf
    s_mov_b32 m0, 157284
    s_nop 0
    buffer_load_dword v14, s[20:23], 0 offen offset:0 lds
    buffer_load_dword v14, s[20:23], 0 offen offset:256 lds
    buffer_load_dword v14, s[20:23], 0 offen offset:512 lds
    buffer_load_dword v14, s[20:23], 0 offen offset:768 lds
    s_mov_b64 exec, 1
    buffer_load_dword v14, s[20:23], 0 offen offset:1024 lds
    s_mov_b64 exec, -1
    s_add_u32 m0, m0, 3088
    s_nop 0
    buffer_load_dword v14, s[24:27], 0 offen offset:0 lds
    buffer_load_dword v14, s[24:27], 0 offen offset:256 lds
    buffer_load_dword v14, s[24:27], 0 offen offset:512 lds
    buffer_load_dword v14, s[24:27], 0 offen offset:768 lds
    s_mov_b64 exec, 1
    buffer_load_dword v14, s[24:27], 0 offen offset:1024 lds
    s_mov_b64 exec, -1
parallel_sum__spectral_gfnet__dense_activation_mish__prompt_kernel_wf:
    s_barrier
    ds_read_b32 v36, v27
    s_lshl_b32 s43, s2, 10
    s_add_u32 s43, s43, 36700160
    buffer_store_dword v208, v14, s[16:19], s43 offen offset:128 sc1
    buffer_store_dword v212, v14, s[16:19], s43 offen offset:384 sc1
    buffer_store_dword v216, v14, s[16:19], s43 offen offset:640 sc1
    s_mov_b32 exec_hi, 0
    buffer_store_dword v220, v14, s[16:19], s43 offen offset:896 sc1
    s_waitcnt lgkmcnt(0)
    buffer_store_dword v36, v14, s[16:19], s43 offen sc1
    s_mov_b32 exec_hi, -1
    s_lshl_b32 s43, s2, 12
    s_add_u32 s43, s43, 33554432
    buffer_store_dwordx4 v[160:163], v3, s[16:19], s43 offen offset:0 sc1
    buffer_store_dwordx4 v[164:167], v3, s[16:19], s43 offen offset:1024 sc1
    buffer_store_dwordx4 v[168:171], v3, s[16:19], s43 offen offset:2048 sc1
    buffer_store_dwordx4 v[172:175], v3, s[16:19], s43 offen offset:3072 sc1
    s_barrier
    s_waitcnt vmcnt(9)
    ds_read_u16 v192, v18 offset:0
    ds_read_u16 v224, v18 offset:3088
    ds_read_u16 v193, v18 offset:6176
    ds_read_u16 v225, v18 offset:9264
    ds_read_u16 v194, v18 offset:12352
    ds_read_u16 v226, v18 offset:15440
    ds_read_u16 v195, v18 offset:18528
    ds_read_u16 v227, v18 offset:21616
    ds_read_u16 v196, v18 offset:1026
    ds_read_u16 v228, v18 offset:4114
    ds_read_u16 v197, v18 offset:7202
    ds_read_u16 v229, v18 offset:10290
    ds_read_u16 v198, v18 offset:13378
    ds_read_u16 v230, v18 offset:16466
    ds_read_u16 v199, v18 offset:19554
    ds_read_u16 v231, v18 offset:22642
    ds_read_u16 v200, v19 offset:21348
    ds_read_u16 v232, v19 offset:24436
    ds_read_u16 v201, v19 offset:15172
    ds_read_u16 v233, v19 offset:18260
    ds_read_u16 v202, v19 offset:8996
    ds_read_u16 v234, v19 offset:12084
    ds_read_u16 v203, v19 offset:2820
    ds_read_u16 v235, v19 offset:5908
    ds_read_u16 v204, v19 offset:20322
    ds_read_u16 v236, v19 offset:23410
    ds_read_u16 v205, v19 offset:14146
    ds_read_u16 v237, v19 offset:17234
    ds_read_u16 v206, v19 offset:7970
    ds_read_u16 v238, v19 offset:11058
    ds_read_u16 v207, v19 offset:1794
    ds_read_u16 v239, v19 offset:4882
    s_mov_b32 s44, 0x80000000
    s_waitcnt lgkmcnt(0)
    v_lshl_or_b32 v192, v224, 16, v192
    v_lshl_or_b32 v193, v225, 16, v193
    v_lshl_or_b32 v194, v226, 16, v194
    v_lshl_or_b32 v195, v227, 16, v195
    s_add_u32 s43, s41, 25165824
    buffer_store_dwordx4 v[192:195], v20, s[16:19], s43 offen sc1
    v_lshl_or_b32 v196, v228, 16, v196
    v_lshl_or_b32 v197, v229, 16, v197
    v_lshl_or_b32 v198, v230, 16, v198
    v_lshl_or_b32 v199, v231, 16, v199
    s_add_u32 s43, s41, 27262976
    buffer_store_dwordx4 v[196:199], v20, s[16:19], s43 offen sc1
    v_lshl_or_b32 v200, v232, 16, v200
    v_xor_b32 v200, s44, v200
    v_lshl_or_b32 v201, v233, 16, v201
    v_xor_b32 v201, s44, v201
    v_lshl_or_b32 v202, v234, 16, v202
    v_xor_b32 v202, s44, v202
    v_lshl_or_b32 v203, v235, 16, v203
    v_xor_b32 v203, s44, v203
    s_sub_u32 s43, 26246144, s41
    buffer_store_dwordx4 v[200:203], v21, s[16:19], s43 offen sc1
    v_lshl_or_b32 v204, v236, 16, v204
    v_xor_b32 v204, s44, v204
    v_lshl_or_b32 v205, v237, 16, v205
    v_xor_b32 v205, s44, v205
    v_lshl_or_b32 v206, v238, 16, v206
    v_xor_b32 v206, s44, v206
    v_lshl_or_b32 v207, v239, 16, v207
    v_xor_b32 v207, s44, v207
    s_sub_u32 s43, 28343296, s41
    buffer_store_dwordx4 v[204:207], v21, s[16:19], s43 offen sc1
    s_barrier
    ds_read_u16 v192, v18 offset:256
    ds_read_u16 v224, v18 offset:3344
    ds_read_u16 v193, v18 offset:6432
    ds_read_u16 v225, v18 offset:9520
    ds_read_u16 v194, v18 offset:12608
    ds_read_u16 v226, v18 offset:15696
    ds_read_u16 v195, v18 offset:18784
    ds_read_u16 v227, v18 offset:21872
    ds_read_u16 v196, v18 offset:1282
    ds_read_u16 v228, v18 offset:4370
    ds_read_u16 v197, v18 offset:7458
    ds_read_u16 v229, v18 offset:10546
    ds_read_u16 v198, v18 offset:13634
    ds_read_u16 v230, v18 offset:16722
    ds_read_u16 v199, v18 offset:19810
    ds_read_u16 v231, v18 offset:22898
    ds_read_u16 v200, v19 offset:21092
    ds_read_u16 v232, v19 offset:24180
    ds_read_u16 v201, v19 offset:14916
    ds_read_u16 v233, v19 offset:18004
    ds_read_u16 v202, v19 offset:8740
    ds_read_u16 v234, v19 offset:11828
    ds_read_u16 v203, v19 offset:2564
    ds_read_u16 v235, v19 offset:5652
    ds_read_u16 v204, v19 offset:20066
    ds_read_u16 v236, v19 offset:23154
    ds_read_u16 v205, v19 offset:13890
    ds_read_u16 v237, v19 offset:16978
    ds_read_u16 v206, v19 offset:7714
    ds_read_u16 v238, v19 offset:10802
    ds_read_u16 v207, v19 offset:1538
    ds_read_u16 v239, v19 offset:4626
    s_mov_b32 s44, 0x80000000
    s_waitcnt lgkmcnt(0)
    v_lshl_or_b32 v192, v224, 16, v192
    v_lshl_or_b32 v193, v225, 16, v193
    v_lshl_or_b32 v194, v226, 16, v194
    v_lshl_or_b32 v195, v227, 16, v195
    s_add_u32 s43, s41, 25427968
    buffer_store_dwordx4 v[192:195], v20, s[16:19], s43 offen sc1
    v_lshl_or_b32 v196, v228, 16, v196
    v_lshl_or_b32 v197, v229, 16, v197
    v_lshl_or_b32 v198, v230, 16, v198
    v_lshl_or_b32 v199, v231, 16, v199
    s_add_u32 s43, s41, 27525120
    buffer_store_dwordx4 v[196:199], v20, s[16:19], s43 offen sc1
    v_lshl_or_b32 v200, v232, 16, v200
    v_xor_b32 v200, s44, v200
    v_lshl_or_b32 v201, v233, 16, v201
    v_xor_b32 v201, s44, v201
    v_lshl_or_b32 v202, v234, 16, v202
    v_xor_b32 v202, s44, v202
    v_lshl_or_b32 v203, v235, 16, v203
    v_xor_b32 v203, s44, v203
    s_sub_u32 s43, 26508288, s41
    buffer_store_dwordx4 v[200:203], v21, s[16:19], s43 offen sc1
    v_lshl_or_b32 v204, v236, 16, v204
    v_xor_b32 v204, s44, v204
    v_lshl_or_b32 v205, v237, 16, v205
    v_xor_b32 v205, s44, v205
    v_lshl_or_b32 v206, v238, 16, v206
    v_xor_b32 v206, s44, v206
    v_lshl_or_b32 v207, v239, 16, v207
    v_xor_b32 v207, s44, v207
    s_sub_u32 s43, 28605440, s41
    buffer_store_dwordx4 v[204:207], v21, s[16:19], s43 offen sc1
    ds_read_u16 v192, v18 offset:512
    ds_read_u16 v224, v18 offset:3600
    ds_read_u16 v193, v18 offset:6688
    ds_read_u16 v225, v18 offset:9776
    ds_read_u16 v194, v18 offset:12864
    ds_read_u16 v226, v18 offset:15952
    ds_read_u16 v195, v18 offset:19040
    ds_read_u16 v227, v18 offset:22128
    ds_read_u16 v196, v18 offset:1538
    ds_read_u16 v228, v18 offset:4626
    ds_read_u16 v197, v18 offset:7714
    ds_read_u16 v229, v18 offset:10802
    ds_read_u16 v198, v18 offset:13890
    ds_read_u16 v230, v18 offset:16978
    ds_read_u16 v199, v18 offset:20066
    ds_read_u16 v231, v18 offset:23154
    ds_read_u16 v200, v19 offset:20836
    ds_read_u16 v232, v19 offset:23924
    ds_read_u16 v201, v19 offset:14660
    ds_read_u16 v233, v19 offset:17748
    ds_read_u16 v202, v19 offset:8484
    ds_read_u16 v234, v19 offset:11572
    ds_read_u16 v203, v19 offset:2308
    ds_read_u16 v235, v19 offset:5396
    ds_read_u16 v204, v19 offset:19810
    ds_read_u16 v236, v19 offset:22898
    ds_read_u16 v205, v19 offset:13634
    ds_read_u16 v237, v19 offset:16722
    ds_read_u16 v206, v19 offset:7458
    ds_read_u16 v238, v19 offset:10546
    ds_read_u16 v207, v19 offset:1282
    ds_read_u16 v239, v19 offset:4370
    s_mov_b32 s44, 0x80000000
    s_waitcnt lgkmcnt(0)
    v_lshl_or_b32 v192, v224, 16, v192
    v_lshl_or_b32 v193, v225, 16, v193
    v_lshl_or_b32 v194, v226, 16, v194
    v_lshl_or_b32 v195, v227, 16, v195
    s_add_u32 s43, s41, 25690112
    buffer_store_dwordx4 v[192:195], v20, s[16:19], s43 offen sc1
    v_lshl_or_b32 v196, v228, 16, v196
    v_lshl_or_b32 v197, v229, 16, v197
    v_lshl_or_b32 v198, v230, 16, v198
    v_lshl_or_b32 v199, v231, 16, v199
    s_add_u32 s43, s41, 27787264
    buffer_store_dwordx4 v[196:199], v20, s[16:19], s43 offen sc1
    v_lshl_or_b32 v200, v232, 16, v200
    v_xor_b32 v200, s44, v200
    v_lshl_or_b32 v201, v233, 16, v201
    v_xor_b32 v201, s44, v201
    v_lshl_or_b32 v202, v234, 16, v202
    v_xor_b32 v202, s44, v202
    v_lshl_or_b32 v203, v235, 16, v203
    v_xor_b32 v203, s44, v203
    s_sub_u32 s43, 26770432, s41
    buffer_store_dwordx4 v[200:203], v21, s[16:19], s43 offen sc1
    v_lshl_or_b32 v204, v236, 16, v204
    v_xor_b32 v204, s44, v204
    v_lshl_or_b32 v205, v237, 16, v205
    v_xor_b32 v205, s44, v205
    v_lshl_or_b32 v206, v238, 16, v206
    v_xor_b32 v206, s44, v206
    v_lshl_or_b32 v207, v239, 16, v207
    v_xor_b32 v207, s44, v207
    s_sub_u32 s43, 28867584, s41
    buffer_store_dwordx4 v[204:207], v21, s[16:19], s43 offen sc1
    s_barrier
    ds_read_u16 v192, v18 offset:768
    ds_read_u16 v224, v18 offset:3856
    ds_read_u16 v193, v18 offset:6944
    ds_read_u16 v225, v18 offset:10032
    ds_read_u16 v194, v18 offset:13120
    ds_read_u16 v226, v18 offset:16208
    ds_read_u16 v195, v18 offset:19296
    ds_read_u16 v227, v18 offset:22384
    ds_read_u16 v196, v18 offset:1794
    ds_read_u16 v228, v18 offset:4882
    ds_read_u16 v197, v18 offset:7970
    ds_read_u16 v229, v18 offset:11058
    ds_read_u16 v198, v18 offset:14146
    ds_read_u16 v230, v18 offset:17234
    ds_read_u16 v199, v18 offset:20322
    ds_read_u16 v231, v18 offset:23410
    ds_read_u16 v200, v19 offset:20580
    ds_read_u16 v232, v19 offset:23668
    ds_read_u16 v201, v19 offset:14404
    ds_read_u16 v233, v19 offset:17492
    ds_read_u16 v202, v19 offset:8228
    ds_read_u16 v234, v19 offset:11316
    ds_read_u16 v203, v19 offset:2052
    ds_read_u16 v235, v19 offset:5140
    ds_read_u16 v204, v19 offset:19554
    ds_read_u16 v236, v19 offset:22642
    ds_read_u16 v205, v19 offset:13378
    ds_read_u16 v237, v19 offset:16466
    ds_read_u16 v206, v19 offset:7202
    ds_read_u16 v238, v19 offset:10290
    ds_read_u16 v207, v19 offset:1026
    ds_read_u16 v239, v19 offset:4114
    s_mov_b32 s44, 0x80000000
    s_waitcnt lgkmcnt(0)
    v_lshl_or_b32 v192, v224, 16, v192
    v_lshl_or_b32 v193, v225, 16, v193
    v_lshl_or_b32 v194, v226, 16, v194
    v_lshl_or_b32 v195, v227, 16, v195
    s_add_u32 s43, s41, 25952256
    buffer_store_dwordx4 v[192:195], v20, s[16:19], s43 offen sc1
    v_lshl_or_b32 v196, v228, 16, v196
    v_lshl_or_b32 v197, v229, 16, v197
    v_lshl_or_b32 v198, v230, 16, v198
    v_lshl_or_b32 v199, v231, 16, v199
    s_add_u32 s43, s41, 28049408
    buffer_store_dwordx4 v[196:199], v20, s[16:19], s43 offen sc1
    v_lshl_or_b32 v200, v232, 16, v200
    v_xor_b32 v200, s44, v200
    v_lshl_or_b32 v201, v233, 16, v201
    v_xor_b32 v201, s44, v201
    v_lshl_or_b32 v202, v234, 16, v202
    v_xor_b32 v202, s44, v202
    v_lshl_or_b32 v203, v235, 16, v203
    v_xor_b32 v203, s44, v203
    s_sub_u32 s43, 27032576, s41
    buffer_store_dwordx4 v[200:203], v21, s[16:19], s43 offen sc1
    v_lshl_or_b32 v204, v236, 16, v204
    v_xor_b32 v204, s44, v204
    v_lshl_or_b32 v205, v237, 16, v205
    v_xor_b32 v205, s44, v205
    v_lshl_or_b32 v206, v238, 16, v206
    v_xor_b32 v206, s44, v206
    v_lshl_or_b32 v207, v239, 16, v207
    v_xor_b32 v207, s44, v207
    s_sub_u32 s43, 29129728, s41
    buffer_store_dwordx4 v[204:207], v21, s[16:19], s43 offen sc1
    s_barrier
    s_and_b32 s95, s2, 1
    s_and_b32 s96, s59, 7
    s_and_b32 s97, s60, 1
    s_lshl_b32 s43, s58, 1
    s_add_u32 s43, s43, s95
    s_and_b32 s43, s43, 7
    s_lshl_b32 s43, s43, 7
    v_xor_b32 v249, s43, v3
    s_lshl_b32 s98, s58, 6
    s_lshl_b32 s99, s95, 5
    s_add_u32 s98, s98, s99
    s_lshr_b32 s99, s60, 1
    s_lshl_b32 s99, s99, 4
    s_add_u32 s98, s98, s99
    s_lshl_b32 s98, s98, 11
    s_lshl_b32 s99, s96, 7
    s_add_u32 s98, s98, s99
    s_lshl_b32 s99, s97, 6
    s_add_u32 s98, s98, s99
    s_add_u32 s99, s98, 2097152
    v_lshrrev_b32 v4, 4, v2
    v_and_b32 v5, 15, v2
    v_lshlrev_b32 v6, 11, v5
    v_and_b32 v7, 1, v4
    v_lshl_add_u32 v6, v7, 5, v6
    v_lshrrev_b32 v7, 1, v4
    v_lshl_add_u32 v250, v7, 4, v6
    s_and_b32 s44, s57, 7
    s_lshl_b32 s43, s44, 1
    s_add_u32 s43, s43, 11
    v_add_u32 v6, s43, v2
    v_subrev_u32 v7, 14, v6
    v_min_u32 v6, v6, v7
    v_subrev_u32 v7, 14, v6
    v_min_u32 v6, v6, v7
    v_lshrrev_b32 v8, 1, v6
    v_and_b32 v9, 1, v6
    v_lshlrev_b32 v9, 2, v9
    s_sub_u32 s43, s44, 17
    v_add_u32 v6, s43, v2
    v_cmp_lt_u32 vcc, 16, v2
    v_subrev_u32 v7, 7, v6
    v_min_u32 v6, v6, v7
    v_cndmask_b32 v8, v8, v6, vcc
    v_cndmask_b32 v9, v9, 2, vcc
    v_cmp_le_u32 vcc, s96, v8
    v_add_u32 v6, 1, v8
    v_add_u32 v9, s97, v9
    v_cndmask_b32 v8, v8, v6, vcc
    s_lshl_b32 s43, s44, 1
    s_add_u32 s43, s43, s97
    v_cmp_lt_u32 vcc, 23, v2
    v_lshl_add_u32 v6, v2, 1, s43
    v_and_b32 v6, 7, v6
    v_cndmask_b32 v8, v8, v6, vcc
    v_cndmask_b32 v9, v9, 6, vcc
    v_lshlrev_b32 v6, 2, v2
    v_and_b32 v6, 4, v6
    v_cmp_gt_u32 vcc, 3, v2
    v_and_b32 v7, 2, v2
    v_add3_u32 v6, v6, v7, s97
    v_mov_b32 v7, s96
    v_cndmask_b32 v8, v8, v7, vcc
    v_cndmask_b32 v9, v9, v6, vcc
    v_mad_u32_u24 v8, v8, 7, v9
    s_mul_i32 s43, s95, 3670016
    v_lshl_add_u32 v248, v8, 16, s43
    s_lshl_b32 s43, s96, 7
    v_add_u32 v6, 0, v4
    v_lshlrev_b32 v7, 1, v6
    v_xor_b32 v7, v7, v5
    v_and_b32 v8, 7, v7
    v_lshrrev_b32 v7, 3, v7
    v_lshlrev_b32 v6, 11, v6
    v_lshl_add_u32 v6, v8, 4, v6
    v_lshl_add_u32 v6, v7, 10, v6
    v_add_u32 v6, s43, v6
    v_subrev_u32 v240, 0, v6
    v_add_u32 v242, 14336, v240
    v_add_u32 v244, 32768, v240
    v_add_u32 v246, 47104, v240
    v_add_u32 v6, 4, v4
    v_lshlrev_b32 v7, 1, v6
    v_xor_b32 v7, v7, v5
    v_and_b32 v8, 7, v7
    v_lshrrev_b32 v7, 3, v7
    v_lshlrev_b32 v6, 11, v6
    v_lshl_add_u32 v6, v8, 4, v6
    v_lshl_add_u32 v6, v7, 10, v6
    v_add_u32 v6, s43, v6
    v_subrev_u32 v241, 1024, v6
    v_add_u32 v243, 14336, v241
    v_add_u32 v245, 32768, v241
    v_add_u32 v247, 47104, v241
    s_barrier
    s_waitcnt vmcnt(0)
    s_mov_b64 exec, 1
    buffer_atomic_add v13, v32, s[28:31], 0 offen offset:4 sc1
    s_mov_b64 exec, -1
    s_lshr_b32 s43, s2, 7
    s_mul_i32 s43, s43, 40960
    s_add_u32 s43, s43, 28672
    s_mov_b32 m0, 136704
    s_nop 0
    buffer_load_dwordx4 v3, s[12:15], s43 offen offset:0 lds
    buffer_load_dwordx4 v3, s[12:15], s43 offen offset:1024 lds
    buffer_load_dwordx4 v3, s[12:15], s43 offen offset:2048 lds
    buffer_load_dwordx4 v3, s[12:15], s43 offen offset:3072 lds
    s_add_u32 s43, s43, 4096
    s_mov_b32 m0, 140800
    s_nop 0
    buffer_load_dwordx4 v3, s[12:15], s43 offen offset:0 lds
    buffer_load_dwordx4 v3, s[12:15], s43 offen offset:1024 lds
    buffer_load_dwordx4 v3, s[12:15], s43 offen offset:2048 lds
    buffer_load_dwordx4 v3, s[12:15], s43 offen offset:3072 lds
    s_barrier
    s_lshr_b32 s43, s2, 7
    s_mul_i32 s43, s43, 40960
    s_add_u32 s43, s43, 36864
    s_mov_b32 m0, 144896
    s_nop 0
    buffer_load_dwordx4 v3, s[12:15], s43 offen offset:0 lds
    buffer_load_dwordx4 v3, s[12:15], s43 offen offset:1024 lds
    buffer_load_dwordx4 v3, s[12:15], s43 offen offset:2048 lds
    buffer_load_dwordx4 v3, s[12:15], s43 offen offset:3072 lds
    s_add_u32 s43, s43, 4096
    s_mov_b32 m0, 148992
    s_nop 0
    buffer_load_dwordx4 v3, s[12:15], s43 offen offset:0 lds
    buffer_load_dwordx4 v3, s[12:15], s43 offen offset:1024 lds
    buffer_load_dwordx4 v3, s[12:15], s43 offen offset:2048 lds
    buffer_load_dwordx4 v3, s[12:15], s43 offen offset:3072 lds
    s_barrier
    s_lshr_b32 s43, s2, 7
    s_mul_i32 s43, s43, 40960
    s_add_u32 s43, s43, 45056
    s_mov_b32 m0, 153088
    s_nop 0
    buffer_load_dwordx4 v3, s[12:15], s43 offen offset:0 lds
    buffer_load_dwordx4 v3, s[12:15], s43 offen offset:1024 lds
    buffer_load_dwordx4 v3, s[12:15], s43 offen offset:2048 lds
    buffer_load_dwordx4 v3, s[12:15], s43 offen offset:3072 lds
    s_add_u32 s43, s43, 4096
    s_mov_b32 m0, 157184
    s_nop 0
    buffer_load_dwordx4 v3, s[12:15], s43 offen offset:0 lds
    buffer_load_dwordx4 v3, s[12:15], s43 offen offset:1024 lds
    buffer_load_dwordx4 v3, s[12:15], s43 offen offset:2048 lds
    buffer_load_dwordx4 v3, s[12:15], s43 offen offset:3072 lds
    s_mul_i32 s43, s59, 224
    s_and_b32 s44, s57, 7
    s_mul_i32 s44, s44, 24
    s_add_u32 s43, s43, s44
    s_lshl_b32 s43, s43, 11
    s_and_b32 s44, s59, 7
    s_lshl_b32 s44, s44, 7
    s_add_u32 s43, s43, s44
    v_min_u32 v4, 47, v2
    v_lshlrev_b32 v4, 10, v4
    buffer_load_dword v35, v4, s[32:35], s43 offen
    s_and_b32 s43, s2, 1
    s_mul_i32 s43, s43, 1792
    s_mul_i32 s44, s57, 56
    s_add_u32 s43, s43, s44
    s_lshl_b32 s43, s43, 11
    s_bfe_u32 s44, s2, 0x10002
    s_lshl_b32 s44, s44, 30
    s_add_u32 s43, s43, s44
    s_add_u32 s44, s43, 49152
    v_lshlrev_b32 v4, 10, v2
    buffer_load_dword v35, v4, s[32:35], s43 offen offset:384
    buffer_load_dword v35, v4, s[32:35], s44 offen offset:384
    s_barrier
    s_barrier
    s_mov_b64 exec, 15
    buffer_load_dwordx2 v[10:11], v12, s[28:31], 0 offen sc1
    s_mov_b64 exec, -1
    s_waitcnt vmcnt(0)
parallel_sum__spectral_gfnet__dense_activation_mish__prompt_kernel_p2:
    v_add_u32 v10, v10, v11
    s_nop 0
    v_readlane_b32 s43, v10, 0
    v_readlane_b32 s44, v10, 1
    s_add_u32 s43, s43, s44
    v_readlane_b32 s44, v10, 2
    s_add_u32 s43, s43, s44
    v_readlane_b32 s44, v10, 3
    s_add_u32 s43, s43, s44
    s_cmp_eq_u32 s43, 256
    s_cbranch_scc1 parallel_sum__spectral_gfnet__dense_activation_mish__prompt_kernel_p2_ok
    s_sleep 16
    s_mov_b64 exec, 15
    buffer_load_dwordx2 v[10:11], v12, s[28:31], 0 offen sc1
    s_mov_b64 exec, -1
    s_waitcnt vmcnt(0)
    s_branch parallel_sum__spectral_gfnet__dense_activation_mish__prompt_kernel_p2
parallel_sum__spectral_gfnet__dense_activation_mish__prompt_kernel_p2_ok:
parallel_sum__spectral_gfnet__dense_activation_mish__prompt_kernel_join:
    s_mov_b32 s16, s54
    s_mov_b32 s17, s55
    s_mov_b32 s18, 67108864
    s_mov_b32 s19, 0x00020000
    s_mov_b32 s28, s52
    s_mov_b32 s29, s53
    s_mov_b32 s30, 256
    s_mov_b32 s31, 0x00020000
    s_mov_b32 s32, s46
    s_mov_b32 s33, s47
    s_mov_b32 s34, 7340032
    s_mov_b32 s35, 0x00020000
    s_mov_b32 s36, s50
    s_mov_b32 s37, s51
    s_mov_b32 s38, 7168
    s_mov_b32 s39, 0x00020000
    v_lshlrev_b32 v14, 2, v2
    v_lshlrev_b32 v12, 6, v2
    s_lshl_b32 s62, s60, 12
    v_lshrrev_b32 v7, 1, v2
    v_lshlrev_b32 v7, 13, v7
    v_and_b32 v5, 1, v2
    v_lshl_add_u32 v32, v5, 2, v7
    s_lshr_b32 s44, s60, 1
    s_xor_b32 s44, s44, s2
    s_and_b32 s44, s44, 1
    s_lshl_b32 s45, s58, 1
    s_add_u32 s44, s44, s45
    s_lshr_b32 s45, s44, 2
    s_lshl_b32 s45, s45, 10
    s_and_b32 s44, s44, 3
    s_lshl_b32 s44, s44, 3
    s_add_u32 s45, s45, s44
    s_and_b32 s44, s60, 1
    s_lshl_b32 s44, s44, 5
    s_add_u32 s45, s45, s44
    s_add_u32 s45, s45, 36700160
    s_and_b32 s46, s2, 0xc5
    s_lshl_b32 s46, s46, 10
    s_mul_i32 s44, s60, 224
    s_add_u32 s46, s46, s44
    s_add_u32 s46, s46, 36700288
    v_and_b32 v4, 15, v2
    v_min_u32 v4, 13, v4
    v_lshlrev_b32 v4, 4, v4
    v_lshrrev_b32 v5, 4, v2
    v_lshl_add_u32 v33, v5, 14, v4
    s_add_u32 s44, s44, 162432
    v_add_u32 v34, s44, v4
    s_waitcnt vmcnt(16)
    s_barrier
    s_lshl_b32 s44, s60, 8
    s_add_u32 m0, s44, 161408
    s_add_u32 s44, s46, 8192
    buffer_load_dword v32, s[16:19], s45 offen sc1 lds
    buffer_load_dwordx4 v[224:227], v33, s[16:19], s46 offen offset:0 sc1
    buffer_load_dwordx4 v[228:231], v33, s[16:19], s46 offen offset:2048 sc1
    buffer_load_dwordx4 v[232:235], v33, s[16:19], s44 offen offset:0 sc1
    buffer_load_dwordx4 v[236:239], v33, s[16:19], s44 offen offset:2048 sc1
    s_mul_i32 s43, s59, 448
    s_mul_i32 s44, s60, 112
    s_add_u32 s43, s43, s44
    s_add_u32 m0, s44, 163328
    s_mov_b64 exec, 0x0fffffff
    buffer_load_dword v14, s[36:39], s43 offen lds
    s_mov_b64 exec, -1
    s_and_b32 s49, s2, 7
    s_lshl_b32 s49, s49, 1
    s_bfe_u32 s43, s2, 0x10003
    s_add_u32 s49, s49, s43
    s_and_b32 s43, s2, 0xf0
    s_add_u32 s49, s49, s43
    s_lshr_b32 s47, s2, 7
    s_mul_i32 s47, s47, 40960
    s_add_u32 s47, s47, s62
    s_add_u32 s47, s47, 53248
    v_lshrrev_b32 v6, 2, v2
    s_bfe_u32 s43, s49, 0x30001
    v_xor_b32 v6, s43, v6
    v_lshlrev_b32 v6, 7, v6
    v_and_b32 v5, 3, v2
    v_lshl_add_u32 v6, v5, 4, v6
    s_lshr_b32 s50, s49, 1
    s_lshl_b32 s50, s50, 15
    s_and_b32 s43, s49, 1
    s_lshl_b32 s43, s43, 6
    s_add_u32 s50, s50, s43
    s_lshl_b32 s43, s60, 13
    s_add_u32 s50, s50, s43
    s_add_u32 m0, s62, 49152
    s_add_u32 s43, s50, 20971520
    buffer_load_dwordx4 v6, s[16:19], s43 offen sc1 lds
    s_add_u32 m0, m0, 1024
    s_add_u32 s43, s43, 2048
    buffer_load_dwordx4 v6, s[16:19], s43 offen sc1 lds
    s_add_u32 m0, m0, 1024
    s_add_u32 s43, s43, 2048
    buffer_load_dwordx4 v6, s[16:19], s43 offen sc1 lds
    s_add_u32 m0, m0, 1024
    s_add_u32 s43, s43, 2048
    buffer_load_dwordx4 v6, s[16:19], s43 offen sc1 lds
    s_add_u32 m0, s62, 65536
    s_add_u32 s43, s50, 25165824
    buffer_load_dwordx4 v6, s[16:19], s43 offen sc1 lds
    s_add_u32 m0, m0, 1024
    s_add_u32 s43, s43, 2048
    buffer_load_dwordx4 v6, s[16:19], s43 offen sc1 lds
    s_add_u32 m0, m0, 1024
    s_add_u32 s43, s43, 2048
    buffer_load_dwordx4 v6, s[16:19], s43 offen sc1 lds
    s_add_u32 m0, m0, 1024
    s_add_u32 s43, s43, 2048
    buffer_load_dwordx4 v6, s[16:19], s43 offen sc1 lds
    s_waitcnt vmcnt(14)
    s_barrier
    s_add_u32 m0, s62, 81920
    s_nop 0
    buffer_load_dwordx4 v3, s[12:15], s47 offen offset:0 lds
    buffer_load_dwordx4 v3, s[12:15], s47 offen offset:1024 lds
    buffer_load_dwordx4 v3, s[12:15], s47 offen offset:2048 lds
    buffer_load_dwordx4 v3, s[12:15], s47 offen offset:3072 lds
    s_waitcnt vmcnt(12)
    v_pk_add_f32 v[224:225], v[224:225], v[228:229]
    v_pk_add_f32 v[226:227], v[226:227], v[230:231]
    v_pk_add_f32 v[232:233], v[232:233], v[236:237]
    v_pk_add_f32 v[234:235], v[234:235], v[238:239]
    v_pk_add_f32 v[224:225], v[224:225], v[232:233]
    v_pk_add_f32 v[226:227], v[226:227], v[234:235]
    v_mov_b32 v228, v224
    v_mov_b32 v229, v225
    v_mov_b32 v230, v226
    v_mov_b32 v231, v227
    s_nop 0
    v_permlane32_swap_b32 v224, v228
    v_permlane32_swap_b32 v225, v229
    v_permlane32_swap_b32 v226, v230
    v_permlane32_swap_b32 v227, v231
    v_pk_add_f32 v[224:225], v[224:225], v[228:229]
    v_pk_add_f32 v[226:227], v[226:227], v[230:231]
    v_mov_b32 v228, v224
    v_mov_b32 v229, v225
    v_mov_b32 v230, v226
    v_mov_b32 v231, v227
    s_nop 0
    v_permlane16_swap_b32 v224, v228
    v_permlane16_swap_b32 v225, v229
    v_permlane16_swap_b32 v226, v230
    v_permlane16_swap_b32 v227, v231
    v_pk_add_f32 v[224:225], v[224:225], v[228:229]
    v_pk_add_f32 v[226:227], v[226:227], v[230:231]
    ds_write_b128 v34, v[224:227]
    v_add_u32 v252, 136704, v3
    v_add_u32 v253, 57344, v3
    s_lshl_b32 s43, s60, 4
    s_add_u32 s43, s43, 49152
    v_lshl_add_u32 v13, v2, 6, s43
    s_lshl_b32 s101, s49, 2
    s_add_u32 s101, s101, s60
    s_waitcnt vmcnt(0) lgkmcnt(0)
    s_barrier
    ds_read_b128 v[208:211], v13 offset:0
    ds_read_b128 v[212:215], v13 offset:4096
    ds_read_b128 v[216:219], v13 offset:8192
    ds_read_b128 v[220:223], v13 offset:12288
    ds_read_b128 v[16:19], v252 offset:0
    ds_read_b128 v[20:23], v252 offset:1024
    ds_read_b128 v[24:27], v252 offset:2048
    ds_read_b128 v[28:31], v252 offset:3072
    ds_read_b128 v[32:35], v252 offset:4096
    ds_read_b128 v[36:39], v252 offset:5120
    ds_read_b128 v[40:43], v252 offset:6144
    ds_read_b128 v[44:47], v252 offset:7168
    s_waitcnt lgkmcnt(0)
    v_mfma_f32_32x32x16_bf16 v[176:191], v[208:211], v[16:19], 0
    ds_read_b128 v[48:51], v252 offset:8192
    ds_read_b128 v[52:55], v252 offset:9216
    ds_read_b128 v[56:59], v252 offset:10240
    v_mfma_f32_32x32x16_bf16 v[192:207], v[208:211], v[32:35], 0
    ds_read_b128 v[60:63], v252 offset:11264
    ds_read_b128 v[64:67], v252 offset:12288
    ds_read_b128 v[68:71], v252 offset:13312
    v_mfma_f32_32x32x16_bf16 v[176:191], v[212:215], v[20:23], v[176:191]
    ds_read_b128 v[72:75], v252 offset:14336
    ds_read_b128 v[76:79], v252 offset:15360
    ds_read_b128 v[80:83], v252 offset:16384
    v_mfma_f32_32x32x16_bf16 v[192:207], v[212:215], v[36:39], v[192:207]
    ds_read_b128 v[84:87], v252 offset:17408
    ds_read_b128 v[88:91], v252 offset:18432
    ds_read_b128 v[92:95], v252 offset:19456
    v_mfma_f32_32x32x16_bf16 v[176:191], v[216:219], v[24:27], v[176:191]
    ds_read_b128 v[96:99], v252 offset:20480
    ds_read_b128 v[100:103], v252 offset:21504
    ds_read_b128 v[104:107], v252 offset:22528
    v_mfma_f32_32x32x16_bf16 v[192:207], v[216:219], v[40:43], v[192:207]
    ds_read_b128 v[108:111], v252 offset:23552
    ds_read_b128 v[224:227], v13 offset:16384
    ds_read_b128 v[228:231], v13 offset:20480
    v_mfma_f32_32x32x16_bf16 v[176:191], v[220:223], v[28:31], v[176:191]
    ds_read_b128 v[232:235], v13 offset:24576
    ds_read_b128 v[236:239], v13 offset:28672
    ds_read_b128 v[112:115], v253 offset:24576
    v_mfma_f32_32x32x16_bf16 v[192:207], v[220:223], v[44:47], v[192:207]
    ds_read_b128 v[116:119], v253 offset:25600
    ds_read_b128 v[120:123], v253 offset:26624
    ds_read_b128 v[124:127], v253 offset:27648
    ds_read_b128 v[128:131], v253 offset:28672
    ds_read_b128 v[132:135], v253 offset:29696
    ds_read_b128 v[136:139], v253 offset:30720
    ds_read_b128 v[140:143], v253 offset:31744
    ds_read_b128 v[144:147], v253 offset:32768
    ds_read_b128 v[148:151], v253 offset:33792
    ds_read_b128 v[152:155], v253 offset:34816
    ds_read_b128 v[156:159], v253 offset:35840
    ds_read_b128 v[160:163], v253 offset:36864
    ds_read_b128 v[164:167], v253 offset:37888
    ds_read_b128 v[168:171], v253 offset:38912
    ds_read_b128 v[172:175], v253 offset:39936
    s_load_dwordx2 s[40:41], s[0:1], 0
    s_and_b32 s50, s2, 1
    s_and_b32 s53, s59, 7
    s_lshl_b32 s43, s58, 1
    s_add_u32 s43, s43, s50
    s_lshl_b32 s51, s43, 10
    s_add_u32 s51, s51, 36700224
    s_lshl_b32 s63, s43, 17
    s_lshr_b32 s64, s60, 1
    s_lshl_b32 s64, s64, 16
    s_add_u32 s63, s63, s64
    s_and_b32 s64, s60, 1
    s_lshl_b32 s64, s64, 12
    s_add_u32 s63, s63, s64
    s_add_u32 s63, s63, 29360128
    s_lshl_b32 s64, s53, 17
    s_add_u32 s64, s64, s62
    s_add_u32 s64, s64, 33554432
    s_lshl_b32 s65, s60, 13
    s_cmp_lt_u32 s60, 2
    s_cbranch_scc0 parallel_sum__spectral_gfnet__dense_activation_mish__prompt_kernel_ub
    s_mov_b32 s20, s16
    s_mov_b32 s21, s17
    s_mov_b32 s22, 67108864
    s_mov_b32 s23, 0x00020000
    s_branch parallel_sum__spectral_gfnet__dense_activation_mish__prompt_kernel_uc
parallel_sum__spectral_gfnet__dense_activation_mish__prompt_kernel_ub:
    s_mov_b32 s20, s32
    s_mov_b32 s21, s33
    s_mov_b32 s22, 7340032
    s_mov_b32 s23, 0x00020000
    v_readlane_b32 s68, v248, 0
    s_nop 2
    s_add_u32 m0, s65, 98304
    s_nop 0
    buffer_load_dwordx4 v240, s[20:23], s68 offen offset:0 sc1 lds
    buffer_load_dwordx4 v241, s[20:23], s68 offen offset:1024 sc1 lds
    buffer_load_dwordx4 v242, s[20:23], s68 offen offset:2048 sc1 lds
    buffer_load_dwordx4 v243, s[20:23], s68 offen offset:3072 sc1 lds
    s_add_u32 m0, m0, 4096
    s_nop 0
    buffer_load_dwordx4 v244, s[20:23], s68 offen offset:0 sc1 lds
    buffer_load_dwordx4 v245, s[20:23], s68 offen offset:1024 sc1 lds
    buffer_load_dwordx4 v246, s[20:23], s68 offen offset:2048 sc1 lds
    buffer_load_dwordx4 v247, s[20:23], s68 offen offset:3072 sc1 lds
    v_readlane_b32 s68, v248, 1
    s_nop 2
    s_add_u32 m0, s65, 0
    s_nop 0
    buffer_load_dwordx4 v240, s[20:23], s68 offen offset:0 sc1 lds
    buffer_load_dwordx4 v241, s[20:23], s68 offen offset:1024 sc1 lds
    buffer_load_dwordx4 v242, s[20:23], s68 offen offset:2048 sc1 lds
    buffer_load_dwordx4 v243, s[20:23], s68 offen offset:3072 sc1 lds
    s_add_u32 m0, m0, 4096
    s_nop 0
    buffer_load_dwordx4 v244, s[20:23], s68 offen offset:0 sc1 lds
    buffer_load_dwordx4 v245, s[20:23], s68 offen offset:1024 sc1 lds
    buffer_load_dwordx4 v246, s[20:23], s68 offen offset:2048 sc1 lds
    buffer_load_dwordx4 v247, s[20:23], s68 offen offset:3072 sc1 lds
parallel_sum__spectral_gfnet__dense_activation_mish__prompt_kernel_uc:
    s_mov_b32 s67, 0
    s_waitcnt lgkmcnt(0)
    s_mov_b32 s4, s40
    s_mov_b32 s5, s41
    s_mov_b32 s6, 4194304
    s_mov_b32 s7, 0x00020000
    v_mov_b32 v4, 163792
    v_mov_b32 v5, 1
    s_mov_b64 exec, 1
    ds_add_u32 v4, v5
    s_mov_b64 exec, -1
parallel_sum__spectral_gfnet__dense_activation_mish__prompt_kernel_sc:
    ds_read_b32 v5, v4
    s_waitcnt lgkmcnt(0)
    v_readfirstlane_b32 s43, v5
    s_cmp_lt_u32 s43, 4
    s_cbranch_scc1 parallel_sum__spectral_gfnet__dense_activation_mish__prompt_kernel_sc
    s_cmp_lt_u32 s60, 2
    s_cbranch_scc1 parallel_sum__spectral_gfnet__dense_activation_mish__prompt_kernel_s1e
    v_readlane_b32 s68, v248, 2
    s_nop 2
    s_add_u32 m0, s65, 32768
    s_nop 0
    buffer_load_dwordx4 v240, s[20:23], s68 offen offset:0 sc1 lds
    buffer_load_dwordx4 v241, s[20:23], s68 offen offset:1024 sc1 lds
    buffer_load_dwordx4 v242, s[20:23], s68 offen offset:2048 sc1 lds
    buffer_load_dwordx4 v243, s[20:23], s68 offen offset:3072 sc1 lds
    s_add_u32 m0, m0, 4096
    s_nop 0
    buffer_load_dwordx4 v244, s[20:23], s68 offen offset:0 sc1 lds
    buffer_load_dwordx4 v245, s[20:23], s68 offen offset:1024 sc1 lds
    buffer_load_dwordx4 v246, s[20:23], s68 offen offset:2048 sc1 lds
    buffer_load_dwordx4 v247, s[20:23], s68 offen offset:3072 sc1 lds
    s_mov_b32 s67, 1
parallel_sum__spectral_gfnet__dense_activation_mish__prompt_kernel_s1e:
    v_mul_f32 v4, v176, v48
    v_mul_f32 v6, v192, v48
    v_mul_f32 v5, v177, v49
    v_mul_f32 v7, v193, v49
    v_fmac_f32 v4, v192, v64
    v_fma_f32 v6, -v176, v64, v6
    v_fmac_f32 v5, v193, v65
    v_fma_f32 v7, -v177, v65, v7
    v_cvt_pk_bf16_f32 v208, v4, v6
    v_cvt_pk_bf16_f32 v209, v5, v7
    v_mul_f32 v8, v178, v50
    v_mul_f32 v10, v194, v50
    v_mul_f32 v9, v179, v51
    v_mul_f32 v11, v195, v51
    v_fmac_f32 v8, v194, v66
    v_fma_f32 v10, -v178, v66, v10
    v_fmac_f32 v9, v195, v67
    v_fma_f32 v11, -v179, v67, v11
    v_cvt_pk_bf16_f32 v210, v8, v10
    v_cvt_pk_bf16_f32 v211, v9, v11
    v_mul_f32 v4, v180, v52
    v_mul_f32 v6, v196, v52
    v_mfma_f32_32x32x16_bf16 v[16:31], v[80:83], v[208:211], 0
    v_mul_f32 v5, v181, v53
    v_mul_f32 v7, v197, v53
    v_fmac_f32 v4, v196, v68
    v_fma_f32 v6, -v180, v68, v6
    v_fmac_f32 v5, v197, v69
    v_fma_f32 v7, -v181, v69, v7
    v_cvt_pk_bf16_f32 v212, v4, v6
    v_cvt_pk_bf16_f32 v213, v5, v7
    v_mul_f32 v8, v182, v54
    v_mul_f32 v10, v198, v54
    v_mfma_f32_32x32x16_bf16 v[32:47], v[96:99], v[208:211], 0
    v_mul_f32 v9, v183, v55
    v_mul_f32 v11, v199, v55
    v_fmac_f32 v8, v198, v70
    v_fma_f32 v10, -v182, v70, v10
    v_fmac_f32 v9, v199, v71
    v_fma_f32 v11, -v183, v71, v11
    v_cvt_pk_bf16_f32 v214, v8, v10
    v_cvt_pk_bf16_f32 v215, v9, v11
    s_cmp_lt_u32 s60, 2
    s_cbranch_scc1 parallel_sum__spectral_gfnet__dense_activation_mish__prompt_kernel_sv0a
    s_waitcnt vmcnt(8)
    v_mov_b32 v4, 163776
    v_mov_b32 v5, 1
    s_mov_b64 exec, 1
    ds_add_u32 v4, v5
    s_mov_b64 exec, -1
parallel_sum__spectral_gfnet__dense_activation_mish__prompt_kernel_sv0a:
    v_mul_f32 v4, v184, v56
    v_mul_f32 v6, v200, v56
    v_mfma_f32_32x32x16_bf16 v[16:31], v[84:87], v[212:215], v[16:31]
    v_mul_f32 v5, v185, v57
    v_mul_f32 v7, v201, v57
    v_fmac_f32 v4, v200, v72
    v_fma_f32 v6, -v184, v72, v6
    v_fmac_f32 v5, v201, v73
    v_fma_f32 v7, -v185, v73, v7
    v_cvt_pk_bf16_f32 v216, v4, v6
    v_cvt_pk_bf16_f32 v217, v5, v7
    v_mul_f32 v8, v186, v58
    v_mul_f32 v10, v202, v58
    v_mfma_f32_32x32x16_bf16 v[32:47], v[100:103], v[212:215], v[32:47]
    v_mul_f32 v9, v187, v59
    v_mul_f32 v11, v203, v59
    v_fmac_f32 v8, v202, v74
    v_fma_f32 v10, -v186, v74, v10
    v_fmac_f32 v9, v203, v75
    v_fma_f32 v11, -v187, v75, v11
    v_cvt_pk_bf16_f32 v218, v8, v10
    v_cvt_pk_bf16_f32 v219, v9, v11
    v_mul_f32 v4, v188, v60
    v_mul_f32 v6, v204, v60
    v_mfma_f32_32x32x16_bf16 v[16:31], v[88:91], v[216:219], v[16:31]
    v_mul_f32 v5, v189, v61
    v_mul_f32 v7, v205, v61
    v_fmac_f32 v4, v204, v76
    v_fma_f32 v6, -v188, v76, v6
    v_fmac_f32 v5, v205, v77
    v_fma_f32 v7, -v189, v77, v7
    v_cvt_pk_bf16_f32 v220, v4, v6
    v_cvt_pk_bf16_f32 v221, v5, v7
    v_mul_f32 v8, v190, v62
    v_mul_f32 v10, v206, v62
    v_mfma_f32_32x32x16_bf16 v[32:47], v[104:107], v[216:219], v[32:47]
    v_mul_f32 v9, v191, v63
    v_mul_f32 v11, v207, v63
    v_fmac_f32 v8, v206, v78
    v_fma_f32 v10, -v190, v78, v10
    v_fmac_f32 v9, v207, v79
    v_fma_f32 v11, -v191, v79, v11
    v_cvt_pk_bf16_f32 v222, v8, v10
    v_cvt_pk_bf16_f32 v223, v9, v11
    s_nop 1
    v_mfma_f32_32x32x16_bf16 v[16:31], v[92:95], v[220:223], v[16:31]
    v_mfma_f32_32x32x16_bf16 v[32:47], v[108:111], v[220:223], v[32:47]
    s_cmp_lt_u32 s60, 2
    s_cbranch_scc1 parallel_sum__spectral_gfnet__dense_activation_mish__prompt_kernel_sv1a
    s_waitcnt vmcnt(0)
    v_mov_b32 v4, 163800
    v_mov_b32 v5, 1
    s_mov_b64 exec, 1
    ds_add_u32 v4, v5
    s_mov_b64 exec, -1
parallel_sum__spectral_gfnet__dense_activation_mish__prompt_kernel_sv1a:
    v_lshlrev_b32 v48, 16, v224
    v_and_b32 v64, 0xffff0000, v224
    v_lshlrev_b32 v49, 16, v225
    v_and_b32 v65, 0xffff0000, v225
    v_lshlrev_b32 v50, 16, v226
    v_and_b32 v66, 0xffff0000, v226
    v_lshlrev_b32 v51, 16, v227
    v_and_b32 v67, 0xffff0000, v227
    v_lshlrev_b32 v52, 16, v228
    v_and_b32 v68, 0xffff0000, v228
    v_lshlrev_b32 v53, 16, v229
    v_and_b32 v69, 0xffff0000, v229
    v_lshlrev_b32 v54, 16, v230
    v_and_b32 v70, 0xffff0000, v230
    v_lshlrev_b32 v55, 16, v231
    v_and_b32 v71, 0xffff0000, v231
    v_lshlrev_b32 v56, 16, v232
    v_and_b32 v72, 0xffff0000, v232
    v_lshlrev_b32 v57, 16, v233
    v_and_b32 v73, 0xffff0000, v233
    v_lshlrev_b32 v58, 16, v234
    v_and_b32 v74, 0xffff0000, v234
    v_lshlrev_b32 v59, 16, v235
    v_and_b32 v75, 0xffff0000, v235
    v_lshlrev_b32 v60, 16, v236
    v_and_b32 v76, 0xffff0000, v236
    v_lshlrev_b32 v61, 16, v237
    v_and_b32 v77, 0xffff0000, v237
    v_lshlrev_b32 v62, 16, v238
    v_and_b32 v78, 0xffff0000, v238
    v_lshlrev_b32 v63, 16, v239
    v_and_b32 v79, 0xffff0000, v239
    v_mul_f32 v4, v32, v48
    v_mul_f32 v6, v16, v48
    v_mul_f32 v5, v33, v49
    v_mul_f32 v7, v17, v49
    v_fmac_f32 v4, v16, v64
    v_fma_f32 v6, -v32, v64, v6
    v_fmac_f32 v5, v17, v65
    v_fma_f32 v7, -v33, v65, v7
    v_cvt_pk_bf16_f32 v208, v4, v6
    v_cvt_pk_bf16_f32 v209, v5, v7
    v_mul_f32 v8, v34, v50
    v_mul_f32 v10, v18, v50
    v_mul_f32 v9, v35, v51
    v_mul_f32 v11, v19, v51
    v_fmac_f32 v8, v18, v66
    v_fma_f32 v10, -v34, v66, v10
    v_fmac_f32 v9, v19, v67
    v_fma_f32 v11, -v35, v67, v11
    v_cvt_pk_bf16_f32 v210, v8, v10
    v_cvt_pk_bf16_f32 v211, v9, v11
    v_mul_f32 v4, v36, v52
    v_mul_f32 v6, v20, v52
    v_mfma_f32_32x32x16_bf16 v[176:191], v[208:211], v[80:83], 0
    v_mul_f32 v5, v37, v53
    v_mul_f32 v7, v21, v53
    v_fmac_f32 v4, v20, v68
    v_fma_f32 v6, -v36, v68, v6
    v_fmac_f32 v5, v21, v69
    v_fma_f32 v7, -v37, v69, v7
    v_cvt_pk_bf16_f32 v212, v4, v6
    v_cvt_pk_bf16_f32 v213, v5, v7
    v_mul_f32 v8, v38, v54
    v_mul_f32 v10, v22, v54
    v_mfma_f32_32x32x16_bf16 v[192:207], v[208:211], v[96:99], 0
    v_mul_f32 v9, v39, v55
    v_mul_f32 v11, v23, v55
    v_fmac_f32 v8, v22, v70
    v_fma_f32 v10, -v38, v70, v10
    v_fmac_f32 v9, v23, v71
    v_fma_f32 v11, -v39, v71, v11
    v_cvt_pk_bf16_f32 v214, v8, v10
    v_cvt_pk_bf16_f32 v215, v9, v11
    v_mul_f32 v4, v40, v56
    v_mul_f32 v6, v24, v56
    v_mfma_f32_32x32x16_bf16 v[176:191], v[212:215], v[84:87], v[176:191]
    v_mul_f32 v5, v41, v57
    v_mul_f32 v7, v25, v57
    v_fmac_f32 v4, v24, v72
    v_fma_f32 v6, -v40, v72, v6
    v_fmac_f32 v5, v25, v73
    v_fma_f32 v7, -v41, v73, v7
    v_cvt_pk_bf16_f32 v216, v4, v6
    v_cvt_pk_bf16_f32 v217, v5, v7
    v_mul_f32 v8, v42, v58
    v_mul_f32 v10, v26, v58
    v_mfma_f32_32x32x16_bf16 v[192:207], v[212:215], v[100:103], v[192:207]
    v_mul_f32 v9, v43, v59
    v_mul_f32 v11, v27, v59
    v_fmac_f32 v8, v26, v74
    v_fma_f32 v10, -v42, v74, v10
    v_fmac_f32 v9, v27, v75
    v_fma_f32 v11, -v43, v75, v11
    v_cvt_pk_bf16_f32 v218, v8, v10
    v_cvt_pk_bf16_f32 v219, v9, v11
    v_mul_f32 v4, v44, v60
    v_mul_f32 v6, v28, v60
    v_mfma_f32_32x32x16_bf16 v[176:191], v[216:219], v[88:91], v[176:191]
    v_mul_f32 v5, v45, v61
    v_mul_f32 v7, v29, v61
    v_fmac_f32 v4, v28, v76
    v_fma_f32 v6, -v44, v76, v6
    v_fmac_f32 v5, v29, v77
    v_fma_f32 v7, -v45, v77, v7
    v_cvt_pk_bf16_f32 v220, v4, v6
    v_cvt_pk_bf16_f32 v221, v5, v7
    v_mul_f32 v8, v46, v62
    v_mul_f32 v10, v30, v62
    v_mfma_f32_32x32x16_bf16 v[192:207], v[216:219], v[104:107], v[192:207]
    v_mul_f32 v9, v47, v63
    v_mul_f32 v11, v31, v63
    v_fmac_f32 v8, v30, v78
    v_fma_f32 v10, -v46, v78, v10
    v_fmac_f32 v9, v31, v79
    v_fma_f32 v11, -v47, v79, v11
    v_cvt_pk_bf16_f32 v222, v8, v10
    v_cvt_pk_bf16_f32 v223, v9, v11
    s_nop 1
    v_mfma_f32_32x32x16_bf16 v[176:191], v[220:223], v[92:95], v[176:191]
    v_mfma_f32_32x32x16_bf16 v[192:207], v[220:223], v[108:111], v[192:207]
    s_cmp_lt_u32 s60, 2
    s_cbranch_scc1 parallel_sum__spectral_gfnet__dense_activation_mish__prompt_kernel_sv4b
    v_readlane_b32 s68, v248, 3
    s_nop 2
    s_add_u32 m0, s65, 65536
    s_nop 0
    buffer_load_dwordx4 v240, s[20:23], s68 offen offset:0 sc1 lds
    buffer_load_dwordx4 v241, s[20:23], s68 offen offset:1024 sc1 lds
    buffer_load_dwordx4 v242, s[20:23], s68 offen offset:2048 sc1 lds
    buffer_load_dwordx4 v243, s[20:23], s68 offen offset:3072 sc1 lds
    s_add_u32 m0, m0, 4096
    s_nop 0
    buffer_load_dwordx4 v244, s[20:23], s68 offen offset:0 sc1 lds
    buffer_load_dwordx4 v245, s[20:23], s68 offen offset:1024 sc1 lds
    buffer_load_dwordx4 v246, s[20:23], s68 offen offset:2048 sc1 lds
    buffer_load_dwordx4 v247, s[20:23], s68 offen offset:3072 sc1 lds
parallel_sum__spectral_gfnet__dense_activation_mish__prompt_kernel_sv4b:
    s_and_b32 s44, s101, 15
    s_bfe_u32 s45, s101, 0x50004
    s_and_b32 s46, s44, 1
    s_lshl_b32 s46, s46, 8
    s_lshr_b32 s44, s44, 1
    s_lshl_b32 s45, s45, 3
    s_add_u32 s44, s44, s45
    s_add_u32 s44, s44, s46
    s_bfe_u32 s45, s44, 0x10002
    s_lshl_b32 s45, s45, 4
    s_and_b32 s47, s44, 7
    s_and_b32 s44, s44, 0x1f8
    s_lshl_b32 s44, s44, 7
    s_lshr_b32 s46, s101, 9
    s_lshl_b32 s46, s46, 16
    s_add_u32 s44, s44, s46
    s_add_u32 s100, s44, 29360128
    s_mul_i32 s46, s60, 4608
    s_add_u32 s46, s46, 136704
    v_and_b32 v48, 31, v2
    v_mul_u32_u24 v48, 144, v48
    v_lshrrev_b32 v49, 5, v2
    v_lshl_add_u32 v48, v49, 5, v48
    v_add_u32 v48, s46, v48
    v_add_u32 v64, s45, v48
    s_xor_b32 s45, s45, 16
    v_add_u32 v65, s45, v48
    v_lshrrev_b32 v48, 3, v2
    v_and_b32 v49, 7, v2
    v_mul_u32_u24 v50, 144, v48
    v_lshl_add_u32 v50, v49, 4, v50
    v_add_u32 v66, s46, v50
    v_xor_b32 v50, s47, v48
    v_lshlrev_b32 v48, 17, v48
    v_lshl_add_u32 v48, v50, 7, v48
    v_lshl_add_u32 v252, v49, 4, v48
    v_mul_f32 v4, v176, v112
    v_mul_f32 v6, v192, v112
    v_mul_f32 v5, v177, v113
    v_mul_f32 v7, v193, v113
    v_fmac_f32 v4, v192, v128
    v_fma_f32 v6, -v176, v128, v6
    v_fmac_f32 v5, v193, v129
    v_fma_f32 v7, -v177, v129, v7
    v_cvt_pk_bf16_f32 v208, v4, v6
    v_cvt_pk_bf16_f32 v209, v5, v7
    v_mul_f32 v8, v178, v114
    v_mul_f32 v10, v194, v114
    v_mul_f32 v9, v179, v115
    v_mul_f32 v11, v195, v115
    v_fmac_f32 v8, v194, v130
    v_fma_f32 v10, -v178, v130, v10
    v_fmac_f32 v9, v195, v131
    v_fma_f32 v11, -v179, v131, v11
    v_cvt_pk_bf16_f32 v210, v8, v10
    v_cvt_pk_bf16_f32 v211, v9, v11
    v_mul_f32 v4, v180, v116
    v_mul_f32 v6, v196, v116
    v_mfma_f32_32x32x16_bf16 v[16:31], v[208:211], v[144:147], 0
    v_mul_f32 v5, v181, v117
    v_mul_f32 v7, v197, v117
    v_fmac_f32 v4, v196, v132
    v_fma_f32 v6, -v180, v132, v6
    v_fmac_f32 v5, v197, v133
    v_fma_f32 v7, -v181, v133, v7
    v_cvt_pk_bf16_f32 v212, v4, v6
    v_cvt_pk_bf16_f32 v213, v5, v7
    v_mul_f32 v8, v182, v118
    v_mul_f32 v10, v198, v118
    v_mfma_f32_32x32x16_bf16 v[32:47], v[208:211], v[160:163], 0
    v_mul_f32 v9, v183, v119
    v_mul_f32 v11, v199, v119
    v_fmac_f32 v8, v198, v134
    v_fma_f32 v10, -v182, v134, v10
    v_fmac_f32 v9, v199, v135
    v_fma_f32 v11, -v183, v135, v11
    v_cvt_pk_bf16_f32 v214, v8, v10
    v_cvt_pk_bf16_f32 v215, v9, v11
    s_cmp_eq_u32 s67, 1
    s_cbranch_scc1 parallel_sum__spectral_gfnet__dense_activation_mish__prompt_kernel_pi
    s_mov_b64 exec, 0xff
    buffer_load_dword v15, v14, s[16:19], s51 offen sc1
    s_mov_b64 exec, -1
    parallel_sum__spectral_gfnet__dense_activation_mish__prompt_kernel_pi:
    v_mul_f32 v4, v184, v120
    v_mul_f32 v6, v200, v120
    v_mfma_f32_32x32x16_bf16 v[16:31], v[212:215], v[148:151], v[16:31]
    v_mul_f32 v5, v185, v121
    v_mul_f32 v7, v201, v121
    v_fmac_f32 v4, v200, v136
    v_fma_f32 v6, -v184, v136, v6
    v_fmac_f32 v5, v201, v137
    v_fma_f32 v7, -v185, v137, v7
    v_cvt_pk_bf16_f32 v216, v4, v6
    v_cvt_pk_bf16_f32 v217, v5, v7
    v_mul_f32 v8, v186, v122
    v_mul_f32 v10, v202, v122
    v_mfma_f32_32x32x16_bf16 v[32:47], v[212:215], v[164:167], v[32:47]
    v_mul_f32 v9, v187, v123
    v_mul_f32 v11, v203, v123
    v_fmac_f32 v8, v202, v138
    v_fma_f32 v10, -v186, v138, v10
    v_fmac_f32 v9, v203, v139
    v_fma_f32 v11, -v187, v139, v11
    v_cvt_pk_bf16_f32 v218, v8, v10
    v_cvt_pk_bf16_f32 v219, v9, v11
    v_mul_f32 v4, v188, v124
    v_mul_f32 v6, v204, v124
    v_mfma_f32_32x32x16_bf16 v[16:31], v[216:219], v[152:155], v[16:31]
    v_mul_f32 v5, v189, v125
    v_mul_f32 v7, v205, v125
    v_fmac_f32 v4, v204, v140
    v_fma_f32 v6, -v188, v140, v6
    v_fmac_f32 v5, v205, v141
    v_fma_f32 v7, -v189, v141, v7
    v_cvt_pk_bf16_f32 v220, v4, v6
    v_cvt_pk_bf16_f32 v221, v5, v7
    v_mul_f32 v8, v190, v126
    v_mul_f32 v10, v206, v126
    v_mfma_f32_32x32x16_bf16 v[32:47], v[216:219], v[168:171], v[32:47]
    v_mul_f32 v9, v191, v127
    v_mul_f32 v11, v207, v127
    v_fmac_f32 v8, v206, v142
    v_fma_f32 v10, -v190, v142, v10
    v_fmac_f32 v9, v207, v143
    v_fma_f32 v11, -v191, v143, v11
    v_cvt_pk_bf16_f32 v222, v8, v10
    v_cvt_pk_bf16_f32 v223, v9, v11
    s_nop 1
    v_mfma_f32_32x32x16_bf16 v[16:31], v[220:223], v[156:159], v[16:31]
    v_mfma_f32_32x32x16_bf16 v[32:47], v[220:223], v[172:175], v[32:47]
    s_cmp_eq_u32 s67, 1
    s_cbranch_scc1 parallel_sum__spectral_gfnet__dense_activation_mish__prompt_kernel_s3e
parallel_sum__spectral_gfnet__dense_activation_mish__prompt_kernel_s3:
    s_waitcnt vmcnt(0)
    v_bfe_u32 v15, v15, 0, 8
    v_cmp_eq_u32 vcc, 4, v15
    s_nop 4
    s_and_b32 s43, vcc_lo, 0xff
    s_cmp_eq_u32 s43, 0xff
    s_cbranch_scc1 parallel_sum__spectral_gfnet__dense_activation_mish__prompt_kernel_s3k
    s_sleep 4
    s_mov_b64 exec, 0xff
    buffer_load_dword v15, v14, s[16:19], s51 offen sc1
    s_mov_b64 exec, -1
    s_branch parallel_sum__spectral_gfnet__dense_activation_mish__prompt_kernel_s3
parallel_sum__spectral_gfnet__dense_activation_mish__prompt_kernel_s3k:
    v_readlane_b32 s68, v248, 3
    s_nop 2
    s_add_u32 m0, s65, 65536
    s_nop 0
    buffer_load_dwordx4 v240, s[20:23], s68 offen offset:0 sc1 lds
    buffer_load_dwordx4 v241, s[20:23], s68 offen offset:1024 sc1 lds
    buffer_load_dwordx4 v242, s[20:23], s68 offen offset:2048 sc1 lds
    buffer_load_dwordx4 v243, s[20:23], s68 offen offset:3072 sc1 lds
    s_add_u32 m0, m0, 4096
    s_nop 0
    buffer_load_dwordx4 v244, s[20:23], s68 offen offset:0 sc1 lds
    buffer_load_dwordx4 v245, s[20:23], s68 offen offset:1024 sc1 lds
    buffer_load_dwordx4 v246, s[20:23], s68 offen offset:2048 sc1 lds
    buffer_load_dwordx4 v247, s[20:23], s68 offen offset:3072 sc1 lds
parallel_sum__spectral_gfnet__dense_activation_mish__prompt_kernel_s3e:
    s_add_u32 s61, s65, 98304
    s_mov_b32 s66, 5
    v_readlane_b32 s68, v248, 4
    v_mov_b32 v4, 163784
parallel_sum__spectral_gfnet__dense_activation_mish__prompt_kernel_w1:
    ds_read_b32 v5, v4
    s_waitcnt lgkmcnt(0)
    v_readfirstlane_b32 s43, v5
    s_cmp_lt_u32 s43, 4
    s_cbranch_scc1 parallel_sum__spectral_gfnet__dense_activation_mish__prompt_kernel_w1
    s_mov_b32 m0, s61
    s_nop 0
    buffer_load_dwordx4 v240, s[20:23], s68 offen offset:0 sc1 lds
    buffer_load_dwordx4 v241, s[20:23], s68 offen offset:1024 sc1 lds
    buffer_load_dwordx4 v242, s[20:23], s68 offen offset:2048 sc1 lds
    buffer_load_dwordx4 v243, s[20:23], s68 offen offset:3072 sc1 lds
    s_add_u32 m0, m0, 4096
    s_nop 0
    buffer_load_dwordx4 v244, s[20:23], s68 offen offset:0 sc1 lds
    buffer_load_dwordx4 v245, s[20:23], s68 offen offset:1024 sc1 lds
    buffer_load_dwordx4 v246, s[20:23], s68 offen offset:2048 sc1 lds
    buffer_load_dwordx4 v247, s[20:23], s68 offen offset:3072 sc1 lds
    v_readlane_b32 s68, v248, s66
    s_add_u32 s61, s61, 32768
    s_and_b32 s61, s61, 131071
    s_add_u32 s66, s66, 1
    s_nop 11
    v_cvt_pk_bf16_f32 v56, v16, v17
    v_cvt_pk_bf16_f32 v57, v18, v19
    v_cvt_pk_bf16_f32 v58, v20, v21
    v_cvt_pk_bf16_f32 v59, v22, v23
    v_cvt_pk_bf16_f32 v60, v24, v25
    v_cvt_pk_bf16_f32 v61, v26, v27
    v_cvt_pk_bf16_f32 v62, v28, v29
    v_cvt_pk_bf16_f32 v63, v30, v31
    ds_write_b128 v64, v[56:59] offset:64
    ds_write_b128 v65, v[60:63] offset:64
    v_cvt_pk_bf16_f32 v48, v32, v33
    v_cvt_pk_bf16_f32 v49, v34, v35
    v_cvt_pk_bf16_f32 v50, v36, v37
    v_cvt_pk_bf16_f32 v51, v38, v39
    v_cvt_pk_bf16_f32 v52, v40, v41
    v_cvt_pk_bf16_f32 v53, v42, v43
    v_cvt_pk_bf16_f32 v54, v44, v45
    v_cvt_pk_bf16_f32 v55, v46, v47
    ds_write_b128 v64, v[48:51]
    ds_write_b128 v65, v[52:55]
    v_mov_b32 v4, 163788
parallel_sum__spectral_gfnet__dense_activation_mish__prompt_kernel_w2:
    ds_read_b32 v5, v4
    s_waitcnt lgkmcnt(0)
    v_readfirstlane_b32 s43, v5
    s_cmp_lt_u32 s43, 4
    s_cbranch_scc1 parallel_sum__spectral_gfnet__dense_activation_mish__prompt_kernel_w2
    s_mov_b32 m0, s61
    s_nop 0
    buffer_load_dwordx4 v240, s[20:23], s68 offen offset:0 sc1 lds
    buffer_load_dwordx4 v241, s[20:23], s68 offen offset:1024 sc1 lds
    buffer_load_dwordx4 v242, s[20:23], s68 offen offset:2048 sc1 lds
    buffer_load_dwordx4 v243, s[20:23], s68 offen offset:3072 sc1 lds
    s_add_u32 m0, m0, 4096
    s_nop 0
    buffer_load_dwordx4 v244, s[20:23], s68 offen offset:0 sc1 lds
    buffer_load_dwordx4 v245, s[20:23], s68 offen offset:1024 sc1 lds
    buffer_load_dwordx4 v246, s[20:23], s68 offen offset:2048 sc1 lds
    buffer_load_dwordx4 v247, s[20:23], s68 offen offset:3072 sc1 lds
    v_readlane_b32 s68, v248, s66
    s_add_u32 s61, s61, 32768
    s_and_b32 s61, s61, 131071
    s_add_u32 s66, s66, 1
    s_waitcnt lgkmcnt(0)
    ds_read_b128 v[80:83], v66 offset:0
    ds_read_b128 v[84:87], v66 offset:1152
    ds_read_b128 v[88:91], v66 offset:2304
    ds_read_b128 v[92:95], v66 offset:3456
    s_waitcnt vmcnt(16)
    s_barrier
    s_mov_b32 m0, s61
    s_nop 0
    buffer_load_dwordx4 v240, s[20:23], s68 offen offset:0 sc1 lds
    buffer_load_dwordx4 v241, s[20:23], s68 offen offset:1024 sc1 lds
    buffer_load_dwordx4 v242, s[20:23], s68 offen offset:2048 sc1 lds
    buffer_load_dwordx4 v243, s[20:23], s68 offen offset:3072 sc1 lds
    s_add_u32 m0, m0, 4096
    s_nop 0
    buffer_load_dwordx4 v244, s[20:23], s68 offen offset:0 sc1 lds
    buffer_load_dwordx4 v245, s[20:23], s68 offen offset:1024 sc1 lds
    buffer_load_dwordx4 v246, s[20:23], s68 offen offset:2048 sc1 lds
    buffer_load_dwordx4 v247, s[20:23], s68 offen offset:3072 sc1 lds
    v_readlane_b32 s68, v248, s66
    s_add_u32 s61, s61, 32768
    s_and_b32 s61, s61, 131071
    s_add_u32 s66, s66, 1
    s_waitcnt vmcnt(16)
    s_barrier
    s_mov_b32 m0, s61
    s_nop 0
    buffer_load_dwordx4 v240, s[20:23], s68 offen offset:0 sc1 lds
    buffer_load_dwordx4 v241, s[20:23], s68 offen offset:1024 sc1 lds
    buffer_load_dwordx4 v242, s[20:23], s68 offen offset:2048 sc1 lds
    buffer_load_dwordx4 v243, s[20:23], s68 offen offset:3072 sc1 lds
    s_add_u32 m0, m0, 4096
    s_nop 0
    buffer_load_dwordx4 v244, s[20:23], s68 offen offset:0 sc1 lds
    buffer_load_dwordx4 v245, s[20:23], s68 offen offset:1024 sc1 lds
    buffer_load_dwordx4 v246, s[20:23], s68 offen offset:2048 sc1 lds
    buffer_load_dwordx4 v247, s[20:23], s68 offen offset:3072 sc1 lds
    v_readlane_b32 s68, v248, s66
    s_add_u32 s61, s61, 32768
    s_and_b32 s61, s61, 131071
    s_add_u32 s66, s66, 1
    s_waitcnt lgkmcnt(0)
    buffer_store_dwordx4 v[80:83], v252, s[16:19], s100 offen sc1
    s_add_u32 s100, s100, 1048576
    buffer_store_dwordx4 v[84:87], v252, s[16:19], s100 offen sc1
    s_add_u32 s100, s100, 1048576
    buffer_store_dwordx4 v[88:91], v252, s[16:19], s100 offen sc1
    s_add_u32 s100, s100, 1048576
    buffer_store_dwordx4 v[92:95], v252, s[16:19], s100 offen sc1
    s_add_u32 s100, s100, 1048576
    s_waitcnt vmcnt(20)
    s_barrier
    s_mov_b32 m0, s61
    s_nop 0
    buffer_load_dwordx4 v240, s[20:23], s68 offen offset:0 sc1 lds
    buffer_load_dwordx4 v241, s[20:23], s68 offen offset:1024 sc1 lds
    buffer_load_dwordx4 v242, s[20:23], s68 offen offset:2048 sc1 lds
    buffer_load_dwordx4 v243, s[20:23], s68 offen offset:3072 sc1 lds
    s_add_u32 m0, m0, 4096
    s_nop 0
    buffer_load_dwordx4 v244, s[20:23], s68 offen offset:0 sc1 lds
    buffer_load_dwordx4 v245, s[20:23], s68 offen offset:1024 sc1 lds
    buffer_load_dwordx4 v246, s[20:23], s68 offen offset:2048 sc1 lds
    buffer_load_dwordx4 v247, s[20:23], s68 offen offset:3072 sc1 lds
    v_readlane_b32 s68, v248, s66
    s_add_u32 s61, s61, 32768
    s_and_b32 s61, s61, 131071
    s_add_u32 s66, s66, 1
    s_waitcnt vmcnt(20)
    s_barrier
    s_mov_b32 m0, s61
    s_nop 0
    buffer_load_dwordx4 v240, s[20:23], s68 offen offset:0 sc1 lds
    buffer_load_dwordx4 v241, s[20:23], s68 offen offset:1024 sc1 lds
    buffer_load_dwordx4 v242, s[20:23], s68 offen offset:2048 sc1 lds
    buffer_load_dwordx4 v243, s[20:23], s68 offen offset:3072 sc1 lds
    s_add_u32 m0, m0, 4096
    s_nop 0
    buffer_load_dwordx4 v244, s[20:23], s68 offen offset:0 sc1 lds
    buffer_load_dwordx4 v245, s[20:23], s68 offen offset:1024 sc1 lds
    buffer_load_dwordx4 v246, s[20:23], s68 offen offset:2048 sc1 lds
    buffer_load_dwordx4 v247, s[20:23], s68 offen offset:3072 sc1 lds
    v_readlane_b32 s68, v248, s66
    s_add_u32 s61, s61, 32768
    s_and_b32 s61, s61, 131071
    s_add_u32 s66, s66, 1
    s_waitcnt vmcnt(20)
    s_barrier
    s_mov_b32 m0, s61
    s_nop 0
    buffer_load_dwordx4 v240, s[20:23], s68 offen offset:0 sc1 lds
    buffer_load_dwordx4 v241, s[20:23], s68 offen offset:1024 sc1 lds
    buffer_load_dwordx4 v242, s[20:23], s68 offen offset:2048 sc1 lds
    buffer_load_dwordx4 v243, s[20:23], s68 offen offset:3072 sc1 lds
    s_add_u32 m0, m0, 4096
    s_nop 0
    buffer_load_dwordx4 v244, s[20:23], s68 offen offset:0 sc1 lds
    buffer_load_dwordx4 v245, s[20:23], s68 offen offset:1024 sc1 lds
    buffer_load_dwordx4 v246, s[20:23], s68 offen offset:2048 sc1 lds
    buffer_load_dwordx4 v247, s[20:23], s68 offen offset:3072 sc1 lds
    v_readlane_b32 s68, v248, s66
    s_add_u32 s61, s61, 32768
    s_and_b32 s61, s61, 131071
    s_add_u32 s66, s66, 1
    s_waitcnt vmcnt(16)
    s_barrier
    s_mov_b32 m0, s61
    s_nop 0
    buffer_load_dwordx4 v240, s[20:23], s68 offen offset:0 sc1 lds
    buffer_load_dwordx4 v241, s[20:23], s68 offen offset:1024 sc1 lds
    buffer_load_dwordx4 v242, s[20:23], s68 offen offset:2048 sc1 lds
    buffer_load_dwordx4 v243, s[20:23], s68 offen offset:3072 sc1 lds
    s_add_u32 m0, m0, 4096
    s_nop 0
    buffer_load_dwordx4 v244, s[20:23], s68 offen offset:0 sc1 lds
    buffer_load_dwordx4 v245, s[20:23], s68 offen offset:1024 sc1 lds
    buffer_load_dwordx4 v246, s[20:23], s68 offen offset:2048 sc1 lds
    buffer_load_dwordx4 v247, s[20:23], s68 offen offset:3072 sc1 lds
    v_readlane_b32 s68, v248, s66
    s_add_u32 s61, s61, 32768
    s_and_b32 s61, s61, 131071
    s_add_u32 s66, s66, 1
    s_mov_b64 exec, 0xff
    buffer_load_dword v15, v14, s[16:19], s51 offen sc1
    s_mov_b64 exec, -1
    s_waitcnt vmcnt(17)
    s_barrier
    s_mov_b32 m0, s61
    s_nop 0
    buffer_load_dwordx4 v240, s[20:23], s68 offen offset:0 sc1 lds
    buffer_load_dwordx4 v241, s[20:23], s68 offen offset:1024 sc1 lds
    buffer_load_dwordx4 v242, s[20:23], s68 offen offset:2048 sc1 lds
    buffer_load_dwordx4 v243, s[20:23], s68 offen offset:3072 sc1 lds
    s_add_u32 m0, m0, 4096
    s_nop 0
    buffer_load_dwordx4 v244, s[20:23], s68 offen offset:0 sc1 lds
    buffer_load_dwordx4 v245, s[20:23], s68 offen offset:1024 sc1 lds
    buffer_load_dwordx4 v246, s[20:23], s68 offen offset:2048 sc1 lds
    buffer_load_dwordx4 v247, s[20:23], s68 offen offset:3072 sc1 lds
    v_readlane_b32 s68, v248, s66
    s_add_u32 s61, s61, 32768
    s_and_b32 s61, s61, 131071
    s_add_u32 s66, s66, 1
    s_add_u32 m0, s62, 131072
    s_nop 0
    buffer_load_dwordx4 v250, s[4:7], s98 offen offset:0 lds
    s_add_u32 m0, s62, 131072
    s_nop 0
    buffer_load_dwordx4 v250, s[4:7], s98 offen offset:1024 lds
    s_add_u32 m0, s62, 133120
    s_nop 0
    buffer_load_dwordx4 v250, s[4:7], s99 offen offset:0 lds
    s_add_u32 m0, s62, 133120
    s_nop 0
    buffer_load_dwordx4 v250, s[4:7], s99 offen offset:1024 lds
    s_waitcnt vmcnt(21)
    s_barrier
    s_mov_b32 m0, s61
    s_nop 0
    buffer_load_dwordx4 v240, s[20:23], s68 offen offset:0 sc1 lds
    buffer_load_dwordx4 v241, s[20:23], s68 offen offset:1024 sc1 lds
    buffer_load_dwordx4 v242, s[20:23], s68 offen offset:2048 sc1 lds
    buffer_load_dwordx4 v243, s[20:23], s68 offen offset:3072 sc1 lds
    s_add_u32 m0, m0, 4096
    s_nop 0
    buffer_load_dwordx4 v244, s[20:23], s68 offen offset:0 sc1 lds
    buffer_load_dwordx4 v245, s[20:23], s68 offen offset:1024 sc1 lds
    buffer_load_dwordx4 v246, s[20:23], s68 offen offset:2048 sc1 lds
    buffer_load_dwordx4 v247, s[20:23], s68 offen offset:3072 sc1 lds
    v_readlane_b32 s68, v248, s66
    s_add_u32 s61, s61, 32768
    s_and_b32 s61, s61, 131071
    s_add_u32 s66, s66, 1
    s_waitcnt vmcnt(21)
    s_barrier
    s_mov_b32 m0, s61
    s_nop 0
    buffer_load_dwordx4 v240, s[20:23], s68 offen offset:0 sc1 lds
    buffer_load_dwordx4 v241, s[20:23], s68 offen offset:1024 sc1 lds
    buffer_load_dwordx4 v242, s[20:23], s68 offen offset:2048 sc1 lds
    buffer_load_dwordx4 v243, s[20:23], s68 offen offset:3072 sc1 lds
    s_add_u32 m0, m0, 4096
    s_nop 0
    buffer_load_dwordx4 v244, s[20:23], s68 offen offset:0 sc1 lds
    buffer_load_dwordx4 v245, s[20:23], s68 offen offset:1024 sc1 lds
    buffer_load_dwordx4 v246, s[20:23], s68 offen offset:2048 sc1 lds
    buffer_load_dwordx4 v247, s[20:23], s68 offen offset:3072 sc1 lds
    v_readlane_b32 s68, v248, s66
    s_add_u32 s61, s61, 32768
    s_and_b32 s61, s61, 131071
    s_add_u32 s66, s66, 1
    s_waitcnt vmcnt(20)
parallel_sum__spectral_gfnet__dense_activation_mish__prompt_kernel_lp:
    v_bfe_u32 v15, v15, 8, 8
    v_cmp_eq_u32 vcc, 4, v15
    s_nop 4
    s_and_b32 s43, vcc_lo, 0xff
    s_cmp_eq_u32 s43, 0xff
    s_cbranch_scc1 parallel_sum__spectral_gfnet__dense_activation_mish__prompt_kernel_lk
    s_mov_b64 exec, 0xff
    buffer_load_dword v15, v14, s[16:19], s51 offen sc1
    s_mov_b64 exec, -1
    s_waitcnt vmcnt(0)
    s_branch parallel_sum__spectral_gfnet__dense_activation_mish__prompt_kernel_lp
parallel_sum__spectral_gfnet__dense_activation_mish__prompt_kernel_lk:
    s_barrier
    s_mov_b32 m0, s61
    s_nop 0
    buffer_load_dwordx4 v240, s[20:23], s68 offen offset:0 sc1 lds
    buffer_load_dwordx4 v241, s[20:23], s68 offen offset:1024 sc1 lds
    buffer_load_dwordx4 v242, s[20:23], s68 offen offset:2048 sc1 lds
    buffer_load_dwordx4 v243, s[20:23], s68 offen offset:3072 sc1 lds
    s_add_u32 m0, m0, 4096
    s_nop 0
    buffer_load_dwordx4 v244, s[20:23], s68 offen offset:0 sc1 lds
    buffer_load_dwordx4 v245, s[20:23], s68 offen offset:1024 sc1 lds
    buffer_load_dwordx4 v246, s[20:23], s68 offen offset:2048 sc1 lds
    buffer_load_dwordx4 v247, s[20:23], s68 offen offset:3072 sc1 lds
    v_readlane_b32 s68, v248, s66
    s_add_u32 s61, s61, 32768
    s_and_b32 s61, s61, 131071
    s_add_u32 s66, s66, 1
    s_waitcnt vmcnt(16)
    s_barrier
    s_mov_b32 m0, s61
    s_nop 0
    buffer_load_dwordx4 v240, s[20:23], s68 offen offset:0 sc1 lds
    buffer_load_dwordx4 v241, s[20:23], s68 offen offset:1024 sc1 lds
    buffer_load_dwordx4 v242, s[20:23], s68 offen offset:2048 sc1 lds
    buffer_load_dwordx4 v243, s[20:23], s68 offen offset:3072 sc1 lds
    s_add_u32 m0, m0, 4096
    s_nop 0
    buffer_load_dwordx4 v244, s[20:23], s68 offen offset:0 sc1 lds
    buffer_load_dwordx4 v245, s[20:23], s68 offen offset:1024 sc1 lds
    buffer_load_dwordx4 v246, s[20:23], s68 offen offset:2048 sc1 lds
    buffer_load_dwordx4 v247, s[20:23], s68 offen offset:3072 sc1 lds
    v_readlane_b32 s68, v248, s66
    s_add_u32 s61, s61, 32768
    s_and_b32 s61, s61, 131071
    s_add_u32 s66, s66, 1
    s_mov_b32 s69, 14
parallel_sum__spectral_gfnet__dense_activation_mish__prompt_kernel_l1:
    s_waitcnt vmcnt(16)
    s_barrier
    s_mov_b32 m0, s61
    s_nop 0
    buffer_load_dwordx4 v240, s[20:23], s68 offen offset:0 sc1 lds
    buffer_load_dwordx4 v241, s[20:23], s68 offen offset:1024 sc1 lds
    buffer_load_dwordx4 v242, s[20:23], s68 offen offset:2048 sc1 lds
    buffer_load_dwordx4 v243, s[20:23], s68 offen offset:3072 sc1 lds
    s_add_u32 m0, m0, 4096
    s_nop 0
    buffer_load_dwordx4 v244, s[20:23], s68 offen offset:0 sc1 lds
    buffer_load_dwordx4 v245, s[20:23], s68 offen offset:1024 sc1 lds
    buffer_load_dwordx4 v246, s[20:23], s68 offen offset:2048 sc1 lds
    buffer_load_dwordx4 v247, s[20:23], s68 offen offset:3072 sc1 lds
    v_readlane_b32 s68, v248, s66
    s_add_u32 s61, s61, 32768
    s_and_b32 s61, s61, 131071
    s_add_u32 s66, s66, 1
    s_add_u32 s69, s69, 1
    s_cmp_le_u32 s69, 22
    s_cbranch_scc1 parallel_sum__spectral_gfnet__dense_activation_mish__prompt_kernel_l1
    s_waitcnt vmcnt(16)
    s_barrier
    s_cmp_lg_u32 s60, 3
    s_cbranch_scc1 parallel_sum__spectral_gfnet__dense_activation_mish__prompt_kernel_pi_3
    s_mov_b64 exec, 15
    buffer_load_dword v15, v12, s[28:31], 0 offen offset:8 sc1
    s_mov_b64 exec, -1
parallel_sum__spectral_gfnet__dense_activation_mish__prompt_kernel_pi_3:
    s_mov_b32 m0, s61
    s_nop 0
    buffer_load_dwordx4 v240, s[20:23], s68 offen offset:0 sc1 lds
    buffer_load_dwordx4 v241, s[20:23], s68 offen offset:1024 sc1 lds
    buffer_load_dwordx4 v242, s[20:23], s68 offen offset:2048 sc1 lds
    buffer_load_dwordx4 v243, s[20:23], s68 offen offset:3072 sc1 lds
    s_add_u32 m0, m0, 4096
    s_nop 0
    buffer_load_dwordx4 v244, s[20:23], s68 offen offset:0 sc1 lds
    buffer_load_dwordx4 v245, s[20:23], s68 offen offset:1024 sc1 lds
    buffer_load_dwordx4 v246, s[20:23], s68 offen offset:2048 sc1 lds
    buffer_load_dwordx4 v247, s[20:23], s68 offen offset:3072 sc1 lds
    v_readlane_b32 s68, v248, s66
    s_add_u32 s61, s61, 32768
    s_and_b32 s61, s61, 131071
    s_add_u32 s66, s66, 1
    s_waitcnt vmcnt(16)
    s_barrier
    s_mov_b32 m0, s61
    s_nop 0
    buffer_load_dwordx4 v240, s[20:23], s68 offen offset:0 sc1 lds
    buffer_load_dwordx4 v241, s[20:23], s68 offen offset:1024 sc1 lds
    buffer_load_dwordx4 v242, s[20:23], s68 offen offset:2048 sc1 lds
    buffer_load_dwordx4 v243, s[20:23], s68 offen offset:3072 sc1 lds
    s_add_u32 m0, m0, 4096
    s_nop 0
    buffer_load_dwordx4 v244, s[20:23], s68 offen offset:0 sc1 lds
    buffer_load_dwordx4 v245, s[20:23], s68 offen offset:1024 sc1 lds
    buffer_load_dwordx4 v246, s[20:23], s68 offen offset:2048 sc1 lds
    buffer_load_dwordx4 v247, s[20:23], s68 offen offset:3072 sc1 lds
    v_readlane_b32 s68, v248, s66
    s_add_u32 s61, s61, 32768
    s_and_b32 s61, s61, 131071
    s_add_u32 s66, s66, 1
    s_waitcnt vmcnt(16)
    s_cmp_lg_u32 s60, 3
    s_cbranch_scc1 parallel_sum__spectral_gfnet__dense_activation_mish__prompt_kernel_ps_5
parallel_sum__spectral_gfnet__dense_activation_mish__prompt_kernel_pl_4:
    v_readlane_b32 s43, v15, 0
    v_readlane_b32 s44, v15, 1
    s_add_u32 s43, s43, s44
    v_readlane_b32 s44, v15, 2
    s_add_u32 s43, s43, s44
    v_readlane_b32 s44, v15, 3
    s_add_u32 s43, s43, s44
    s_cmp_eq_u32 s43, 256
    s_cbranch_scc1 parallel_sum__spectral_gfnet__dense_activation_mish__prompt_kernel_ps_5
    s_sleep 16
    s_mov_b64 exec, 15
    buffer_load_dword v15, v12, s[28:31], 0 offen offset:8 sc1
    s_mov_b64 exec, -1
    s_waitcnt vmcnt(0)
    s_branch parallel_sum__spectral_gfnet__dense_activation_mish__prompt_kernel_pl_4
parallel_sum__spectral_gfnet__dense_activation_mish__prompt_kernel_ps_5:
    s_barrier
    s_add_u32 m0, s62, 98304
    s_add_u32 s61, s65, 0
    buffer_load_dwordx4 v249, s[16:19], s63 offen offset:0 sc1 lds
    buffer_load_dwordx4 v249, s[16:19], s63 offen offset:1024 sc1 lds
    buffer_load_dwordx4 v249, s[16:19], s63 offen offset:2048 sc1 lds
    buffer_load_dwordx4 v249, s[16:19], s63 offen offset:3072 sc1 lds
    s_add_u32 m0, m0, 16384
    s_add_u32 s63, s63, 8192
    buffer_load_dwordx4 v3, s[16:19], s64 offen offset:0 sc1 lds
    buffer_load_dwordx4 v3, s[16:19], s64 offen offset:1024 sc1 lds
    buffer_load_dwordx4 v3, s[16:19], s64 offen offset:2048 sc1 lds
    buffer_load_dwordx4 v3, s[16:19], s64 offen offset:3072 sc1 lds
    s_add_u32 s64, s64, 16384
    s_waitcnt vmcnt(16)
    s_barrier
    s_add_u32 m0, s62, 0
    s_add_u32 s61, s65, 32768
    buffer_load_dwordx4 v249, s[16:19], s63 offen offset:0 sc1 lds
    buffer_load_dwordx4 v249, s[16:19], s63 offen offset:1024 sc1 lds
    buffer_load_dwordx4 v249, s[16:19], s63 offen offset:2048 sc1 lds
    buffer_load_dwordx4 v249, s[16:19], s63 offen offset:3072 sc1 lds
    s_add_u32 m0, m0, 16384
    s_add_u32 s63, s63, 8192
    buffer_load_dwordx4 v3, s[16:19], s64 offen offset:0 sc1 lds
    buffer_load_dwordx4 v3, s[16:19], s64 offen offset:1024 sc1 lds
    buffer_load_dwordx4 v3, s[16:19], s64 offen offset:2048 sc1 lds
    buffer_load_dwordx4 v3, s[16:19], s64 offen offset:3072 sc1 lds
    s_add_u32 s64, s64, 16384
    s_waitcnt vmcnt(16)
    s_barrier
    s_add_u32 m0, s62, 32768
    s_add_u32 s61, s65, 65536
    buffer_load_dwordx4 v249, s[16:19], s63 offen offset:0 sc1 lds
    buffer_load_dwordx4 v249, s[16:19], s63 offen offset:1024 sc1 lds
    buffer_load_dwordx4 v249, s[16:19], s63 offen offset:2048 sc1 lds
    buffer_load_dwordx4 v249, s[16:19], s63 offen offset:3072 sc1 lds
    s_add_u32 m0, m0, 16384
    s_add_u32 s63, s63, 8192
    buffer_load_dwordx4 v3, s[16:19], s64 offen offset:0 sc1 lds
    buffer_load_dwordx4 v3, s[16:19], s64 offen offset:1024 sc1 lds
    buffer_load_dwordx4 v3, s[16:19], s64 offen offset:2048 sc1 lds
    buffer_load_dwordx4 v3, s[16:19], s64 offen offset:3072 sc1 lds
    s_add_u32 s64, s64, 16384
    s_waitcnt vmcnt(16)
    s_barrier
    s_add_u32 m0, s62, 65536
    s_add_u32 s61, s65, 98304
    buffer_load_dwordx4 v249, s[16:19], s63 offen offset:0 sc1 lds
    buffer_load_dwordx4 v249, s[16:19], s63 offen offset:1024 sc1 lds
    buffer_load_dwordx4 v249, s[16:19], s63 offen offset:2048 sc1 lds
    buffer_load_dwordx4 v249, s[16:19], s63 offen offset:3072 sc1 lds
    s_add_u32 m0, m0, 16384
    s_add_u32 s63, s63, 8192
    buffer_load_dwordx4 v3, s[16:19], s64 offen offset:0 sc1 lds
    buffer_load_dwordx4 v3, s[16:19], s64 offen offset:1024 sc1 lds
    buffer_load_dwordx4 v3, s[16:19], s64 offen offset:2048 sc1 lds
    buffer_load_dwordx4 v3, s[16:19], s64 offen offset:3072 sc1 lds
    s_add_u32 s64, s64, 16384
    s_waitcnt vmcnt(16)
    s_barrier
    s_add_u32 m0, s62, 98304
    s_add_u32 s61, s65, 0
    buffer_load_dwordx4 v249, s[16:19], s63 offen offset:0 sc1 lds
    buffer_load_dwordx4 v249, s[16:19], s63 offen offset:1024 sc1 lds
    buffer_load_dwordx4 v249, s[16:19], s63 offen offset:2048 sc1 lds
    buffer_load_dwordx4 v249, s[16:19], s63 offen offset:3072 sc1 lds
    s_add_u32 m0, m0, 16384
    s_add_u32 s63, s63, 8192
    buffer_load_dwordx4 v3, s[16:19], s64 offen offset:0 sc1 lds
    buffer_load_dwordx4 v3, s[16:19], s64 offen offset:1024 sc1 lds
    buffer_load_dwordx4 v3, s[16:19], s64 offen offset:2048 sc1 lds
    buffer_load_dwordx4 v3, s[16:19], s64 offen offset:3072 sc1 lds
    s_add_u32 s64, s64, 16384
    s_waitcnt vmcnt(16)
    s_barrier
    s_add_u32 m0, s62, 0
    s_add_u32 s61, s65, 32768
    buffer_load_dwordx4 v249, s[16:19], s63 offen offset:0 sc1 lds
    buffer_load_dwordx4 v249, s[16:19], s63 offen offset:1024 sc1 lds
    buffer_load_dwordx4 v249, s[16:19], s63 offen offset:2048 sc1 lds
    buffer_load_dwordx4 v249, s[16:19], s63 offen offset:3072 sc1 lds
    s_add_u32 m0, m0, 16384
    s_add_u32 s63, s63, 8192
    buffer_load_dwordx4 v3, s[16:19], s64 offen offset:0 sc1 lds
    buffer_load_dwordx4 v3, s[16:19], s64 offen offset:1024 sc1 lds
    buffer_load_dwordx4 v3, s[16:19], s64 offen offset:2048 sc1 lds
    buffer_load_dwordx4 v3, s[16:19], s64 offen offset:3072 sc1 lds
    s_add_u32 s64, s64, 16384
    s_waitcnt vmcnt(16)
    s_barrier
    s_add_u32 m0, s62, 32768
    s_add_u32 s61, s65, 65536
    buffer_load_dwordx4 v249, s[16:19], s63 offen offset:0 sc1 lds
    buffer_load_dwordx4 v249, s[16:19], s63 offen offset:1024 sc1 lds
    buffer_load_dwordx4 v249, s[16:19], s63 offen offset:2048 sc1 lds
    buffer_load_dwordx4 v249, s[16:19], s63 offen offset:3072 sc1 lds
    s_add_u32 m0, m0, 16384
    s_add_u32 s63, s63, 8192
    buffer_load_dwordx4 v3, s[16:19], s64 offen offset:0 sc1 lds
    buffer_load_dwordx4 v3, s[16:19], s64 offen offset:1024 sc1 lds
    buffer_load_dwordx4 v3, s[16:19], s64 offen offset:2048 sc1 lds
    buffer_load_dwordx4 v3, s[16:19], s64 offen offset:3072 sc1 lds
    s_add_u32 s64, s64, 16384
    s_waitcnt vmcnt(16)
    s_barrier
    s_add_u32 m0, s62, 65536
    s_add_u32 s61, s65, 98304
    buffer_load_dwordx4 v249, s[16:19], s63 offen offset:0 sc1 lds
    buffer_load_dwordx4 v249, s[16:19], s63 offen offset:1024 sc1 lds
    buffer_load_dwordx4 v249, s[16:19], s63 offen offset:2048 sc1 lds
    buffer_load_dwordx4 v249, s[16:19], s63 offen offset:3072 sc1 lds
    s_add_u32 m0, m0, 16384
    s_add_u32 s63, s63, 8192
    buffer_load_dwordx4 v3, s[16:19], s64 offen offset:0 sc1 lds
    buffer_load_dwordx4 v3, s[16:19], s64 offen offset:1024 sc1 lds
    buffer_load_dwordx4 v3, s[16:19], s64 offen offset:2048 sc1 lds
    buffer_load_dwordx4 v3, s[16:19], s64 offen offset:3072 sc1 lds
    s_add_u32 s64, s64, 16384
    s_waitcnt vmcnt(16)
    s_barrier
    s_waitcnt vmcnt(8)
    s_barrier
    s_waitcnt vmcnt(0)
    s_barrier
    s_endpgm
parallel_sum__spectral_gfnet__dense_activation_mish__prompt_kernel_comp:
    s_lshl_b32 s60, s56, 2
    s_add_u32 s60, s60, s3
    s_lshl_b32 s60, s60, 5
    s_add_u32 s60, s60, s57
    s_lshl_b32 s61, s60, 11
    s_add_u32 s62, s61, 2097152
    s_lshl_b32 s63, s3, 12
    s_add_u32 s63, s63, 91136
    s_mul_i32 s64, s3, 7168
    s_add_u32 m0, s64, 107520
    s_nop 0
    buffer_load_dwordx4 v3, s[12:15], s64 offen offset:0 lds
    buffer_load_dwordx4 v3, s[12:15], s64 offen offset:1024 lds
    buffer_load_dwordx4 v3, s[12:15], s64 offen offset:2048 lds
    buffer_load_dwordx4 v3, s[12:15], s64 offen offset:3072 lds
    s_add_u32 m0, m0, 4096
    s_add_u32 s64, s64, 4096
    buffer_load_dwordx4 v3, s[12:15], s64 offen offset:0 lds
    buffer_load_dwordx4 v3, s[12:15], s64 offen offset:1024 lds
    buffer_load_dwordx4 v3, s[12:15], s64 offen offset:2048 lds
    s_waitcnt lgkmcnt(0)
    s_mov_b32 s4, s40
    s_mov_b32 s5, s41
    s_mov_b32 s6, 4194304
    s_mov_b32 s7, 0x00020000
    s_mov_b32 m0, s63
    s_load_dwordx2 s[42:43], s[0:1], 56
    buffer_load_dwordx4 v3, s[4:7], s61 offen lds
    buffer_load_dwordx4 v3, s[4:7], s61 offen offset:1024 lds
    s_add_u32 m0, m0, 2048
    s_nop 0
    buffer_load_dwordx4 v3, s[4:7], s62 offen lds
    buffer_load_dwordx4 v3, s[4:7], s62 offen offset:1024 lds
    s_lshr_b32 s44, s2, 7
    s_mul_i32 s44, s44, 40960
    s_bfe_u32 s45, s2, 0x40003
    s_lshl_b32 s45, s45, 2
    s_add_u32 s45, s45, s3
    s_mul_i32 s45, s45, 640
    s_add_u32 s44, s44, s45
    s_add_u32 s44, s44, 28672
    v_lshlrev_b32 v4, 7, v2
    s_mov_b64 exec, 31
    buffer_load_dword v254, v4, s[12:15], s44 offen
    s_mov_b64 exec, -1
    s_barrier
    s_mov_b32 s28, s52
    s_mov_b32 s29, s53
    s_mov_b32 s30, 256
    s_mov_b32 s31, 0x00020000
    s_mov_b32 s16, s54
    s_mov_b32 s17, s55
    s_mov_b32 s18, 67108864
    s_mov_b32 s19, 0x00020000
    s_lshr_b32 s40, s3, 1
    s_and_b32 s41, s3, 1
    v_and_b32 v12, 15, v2
    v_lshrrev_b32 v13, 4, v2
    v_lshrrev_b32 v6, 1, v12
    v_xor_b32 v6, v6, v13
    s_lshl_b32 s46, s40, 13
    s_lshl_b32 s47, s41, 12
    s_add_u32 s46, s46, s47
    s_xor_b32 s47, s46, 4096
    v_lshlrev_b32 v7, 7, v12
    v_lshl_add_u32 v8, v6, 4, v7
    v_add_u32 v224, s46, v8
    v_add_u32 v225, s47, v8
    v_xor_b32 v8, 64, v8
    v_add_u32 v226, s46, v8
    v_add_u32 v227, s47, v8
    v_lshrrev_b32 v6, 2, v12
    v_lshl_add_u32 v6, v13, 3, v6
    v_mul_u32_u24 v6, 448, v6
    v_and_b32 v7, 3, v2
    v_lshl_add_u32 v6, v7, 3, v6
    v_add_u32 v6, 16384, v6
    v_lshrrev_b32 v7, 1, v13
    v_lshl_add_u32 v6, v7, 7, v6
    v_and_b32 v7, 1, v13
    v_lshlrev_b32 v7, 5, v7
    v_add_u32 v230, v6, v7
    v_sub_u32 v231, v6, v7
    s_lshl_b32 s46, s41, 8
    v_add_u32 v228, s46, v230
    v_add_u32 v229, s46, v231
    s_mov_b32 s66, 98304
    s_mov_b32 s67, 32768
    s_mov_b32 s68, 131072
    v_mov_b32 v7, 0
    s_xor_b32 s98, s2, s40
    s_and_b32 s98, s98, 1
    s_lshl_b32 s98, s98, 1
    s_lshl_b32 s99, s58, 2
    s_add_u32 s98, s98, s99
    s_lshl_b32 s99, s41, 6
    s_add_u32 s98, s98, s99
    s_xor_b32 s99, s98, 64
    s_mul_i32 s98, s98, 112
    s_mul_i32 s99, s99, 112
    s_mul_i32 s100, s59, 7
    s_add_u32 s98, s98, s100
    s_add_u32 s99, s99, s100
    s_add_u32 s100, s98, 3
    s_lshl_b32 s101, s41, 2
    s_add_u32 s98, s98, s101
    s_add_u32 s99, s99, s101
    s_lshl_b32 s98, s98, 10
    s_lshl_b32 s99, s99, 10
    s_lshl_b32 s100, s100, 10
    s_add_u32 s98, s98, 4194304
    s_add_u32 s99, s99, 4194304
    s_add_u32 s100, s100, 4194304
    s_lshl_b32 s101, s58, 1
    s_lshr_b32 s44, s59, 3
    s_add_u32 s101, s101, s44
    s_lshl_b32 s101, s101, 10
    s_and_b32 s44, s59, 7
    s_lshl_b32 s44, s44, 2
    s_add_u32 s101, s101, s44
    s_add_u32 s101, s101, 36700224
    s_lshl_b32 s44, s40, 12
    s_lshl_b32 s45, s41, 11
    s_add_u32 s44, s44, s45
    v_add_u32 v232, s44, v3
    v_xor_b32 v5, 2048, v232
    s_cmp_eq_u32 s41, 0
    s_cselect_b32 s44, s66, 0
    s_cselect_b32 s45, 0, s68
    v_add_u32 v233, s44, v232
    v_add_u32 v234, s44, v5
    v_add_u32 v235, s67, v232
    v_add_u32 v236, s67, v5
    v_mov_b32 v232, v235
    v_add_u32 v6, s68, v3
    v_cmp_eq_u32 vcc, s45, v7
    s_nop 1
    v_cndmask_b32 v235, v6, v235, vcc
    v_cndmask_b32 v236, v6, v236, vcc
    v_lshrrev_b32 v5, 5, v2
    v_bfe_u32 v6, v2, 2, 2
    v_lshl_add_u32 v5, v5, 3, v6
    v_lshlrev_b32 v5, 6, v5
    v_bfe_u32 v6, v2, 4, 1
    v_lshl_add_u32 v5, v6, 5, v5
    v_and_b32 v6, 3, v2
    v_lshl_add_u32 v5, v6, 3, v5
    v_add_u32 v5, s63, v5
    v_add_u32 v14, 107520, v3
    v_and_b32 v6, 31, v2
    v_mul_u32_u24 v6, 272, v6
    v_lshrrev_b32 v7, 5, v2
    v_lshl_add_u32 v6, v7, 6, v6
    s_lshl_b32 s46, s3, 2
    s_add_u32 s46, s46, 136704
    v_add_u32 v15, s46, v6
    s_mov_b32 s47, 0x3f803f80
    s_mov_b32 s48, 0x3a800000
    s_waitcnt vmcnt(1) lgkmcnt(0)
    s_mov_b32 s8, s42
    s_mov_b32 s9, s43
    s_mov_b32 s10, 4194304
    s_mov_b32 s11, 0x00020000
    v_mov_b32 v4, 163780
    v_mov_b32 v6, 1
    s_mov_b64 exec, 1
    ds_add_u32 v4, v6
    s_mov_b64 exec, -1
    ds_read_b64_tr_b16 v[16:17], v5 offset:0
    ds_read_b64_tr_b16 v[18:19], v5 offset:256
    ds_read_b64_tr_b16 v[20:21], v5 offset:1024
    ds_read_b64_tr_b16 v[22:23], v5 offset:1280
    ds_read_b64_tr_b16 v[24:25], v5 offset:2048
    ds_read_b64_tr_b16 v[26:27], v5 offset:2304
    ds_read_b64_tr_b16 v[28:29], v5 offset:3072
    ds_read_b64_tr_b16 v[30:31], v5 offset:3328
parallel_sum__spectral_gfnet__dense_activation_mish__prompt_kernel_cs:
    ds_read_b32 v6, v4
    s_waitcnt lgkmcnt(0)
    v_readfirstlane_b32 s64, v6
    s_cmp_lt_u32 s64, 4
    s_cbranch_scc1 parallel_sum__spectral_gfnet__dense_activation_mish__prompt_kernel_cs
    ds_read_b128 v[32:35], v14 offset:24576
    ds_read_b128 v[36:39], v14 offset:25600
    s_waitcnt lgkmcnt(0)
    v_mfma_f32_32x32x16_bf16 v[40:55], v[16:19], v[32:35], 0
    v_mfma_f32_32x32x16_bf16 v[40:55], v[20:23], v[36:39], v[40:55]
    v_mfma_f32_32x32x16_bf16 v[56:71], v[24:27], v[32:35], 0
    v_mfma_f32_32x32x16_bf16 v[56:71], v[28:31], v[36:39], v[56:71]
    ds_read_b128 v[72:75], v14 offset:0
    ds_read_b128 v[76:79], v14 offset:1024
    ds_read_b128 v[80:83], v14 offset:2048
    ds_read_b128 v[84:87], v14 offset:3072
    ds_read_b128 v[88:91], v14 offset:4096
    ds_read_b128 v[92:95], v14 offset:5120
    ds_read_b128 v[96:99], v14 offset:6144
    ds_read_b128 v[100:103], v14 offset:7168
    ds_read_b128 v[136:139], v14 offset:16384
    ds_read_b128 v[140:143], v14 offset:17408
    ds_read_b128 v[144:147], v14 offset:18432
    ds_read_b128 v[148:151], v14 offset:19456
    ds_read_b128 v[152:155], v14 offset:20480
    ds_read_b128 v[156:159], v14 offset:21504
    ds_read_b128 v[160:163], v14 offset:22528
    v_dot2_f32_bf16 v4, v16, s47, 0
    v_dot2_f32_bf16 v5, v24, s47, 0
    v_dot2_f32_bf16 v6, v16, v16, 0
    v_dot2_f32_bf16 v7, v24, v24, 0
    v_dot2_f32_bf16 v4, v17, s47, v4
    v_dot2_f32_bf16 v5, v25, s47, v5
    v_dot2_f32_bf16 v6, v17, v17, v6
    v_dot2_f32_bf16 v7, v25, v25, v7
    v_dot2_f32_bf16 v4, v18, s47, v4
    v_dot2_f32_bf16 v5, v26, s47, v5
    v_dot2_f32_bf16 v6, v18, v18, v6
    v_dot2_f32_bf16 v7, v26, v26, v7
    v_dot2_f32_bf16 v4, v19, s47, v4
    v_dot2_f32_bf16 v5, v27, s47, v5
    v_dot2_f32_bf16 v6, v19, v19, v6
    v_dot2_f32_bf16 v7, v27, v27, v7
    v_dot2_f32_bf16 v4, v20, s47, v4
    v_dot2_f32_bf16 v5, v28, s47, v5
    v_dot2_f32_bf16 v6, v20, v20, v6
    v_dot2_f32_bf16 v7, v28, v28, v7
    v_dot2_f32_bf16 v4, v21, s47, v4
    v_dot2_f32_bf16 v5, v29, s47, v5
    v_dot2_f32_bf16 v6, v21, v21, v6
    v_dot2_f32_bf16 v7, v29, v29, v7
    v_dot2_f32_bf16 v4, v22, s47, v4
    v_dot2_f32_bf16 v5, v30, s47, v5
    v_dot2_f32_bf16 v6, v22, v22, v6
    v_dot2_f32_bf16 v7, v30, v30, v7
    v_dot2_f32_bf16 v4, v23, s47, v4
    v_dot2_f32_bf16 v5, v31, s47, v5
    v_dot2_f32_bf16 v6, v23, v23, v6
    v_dot2_f32_bf16 v7, v31, v31, v7
    v_readlane_b32 s64, v40, 0
    v_readlane_b32 s65, v56, 0
    v_and_b32 v8, 31, v2
    v_cmp_eq_u32 vcc, 0, v8
    v_mov_b32 v9, s64
    s_waitcnt lgkmcnt(0)
    v_cndmask_b32 v10, 0, v9, vcc
    v_cmp_eq_u32 vcc, 16, v8
    v_mov_b32 v9, s65
    ds_read_b128 v[164:167], v14 offset:23552
    v_cndmask_b32 v8, v10, v9, vcc
    v_mov_b32 v9, v8
    ds_read_b128 v[104:107], v14 offset:8192
    ds_read_b128 v[108:111], v14 offset:9216
    ds_read_b128 v[112:115], v14 offset:10240
    ds_read_b128 v[116:119], v14 offset:11264
    ds_read_b128 v[120:123], v14 offset:12288
    ds_read_b128 v[124:127], v14 offset:13312
    ds_read_b128 v[128:131], v14 offset:14336
    ds_read_b128 v[132:135], v14 offset:15360
    v_permlane16_swap_b32 v40, v56
    v_permlane16_swap_b32 v41, v57
    v_permlane16_swap_b32 v42, v58
    v_permlane16_swap_b32 v43, v59
    v_permlane16_swap_b32 v44, v60
    v_permlane16_swap_b32 v45, v61
    v_permlane16_swap_b32 v46, v62
    v_permlane16_swap_b32 v47, v63
    v_permlane16_swap_b32 v48, v64
    v_permlane16_swap_b32 v49, v65
    v_permlane16_swap_b32 v50, v66
    v_permlane16_swap_b32 v51, v67
    v_permlane16_swap_b32 v52, v68
    v_permlane16_swap_b32 v53, v69
    v_permlane16_swap_b32 v54, v70
    v_permlane16_swap_b32 v55, v71
    v_pk_add_f32 v[40:41], v[40:41], v[8:9] neg_lo:[0,1] neg_hi:[0,1]
    v_pk_add_f32 v[42:43], v[42:43], v[8:9] neg_lo:[0,1] neg_hi:[0,1]
    v_pk_add_f32 v[44:45], v[44:45], v[8:9] neg_lo:[0,1] neg_hi:[0,1]
    v_pk_add_f32 v[46:47], v[46:47], v[8:9] neg_lo:[0,1] neg_hi:[0,1]
    v_pk_add_f32 v[48:49], v[48:49], v[8:9] neg_lo:[0,1] neg_hi:[0,1]
    v_pk_add_f32 v[50:51], v[50:51], v[8:9] neg_lo:[0,1] neg_hi:[0,1]
    v_pk_add_f32 v[52:53], v[52:53], v[8:9] neg_lo:[0,1] neg_hi:[0,1]
    v_pk_add_f32 v[54:55], v[54:55], v[8:9] neg_lo:[0,1] neg_hi:[0,1]
    v_pk_mul_f32 v[246:247], v[40:41], v[72:73]
    v_pk_mul_f32 v[248:249], v[56:57], v[72:73]
    v_pk_fma_f32 v[246:247], v[56:57], v[88:89], v[246:247]
    v_pk_fma_f32 v[248:249], v[40:41], v[88:89], v[248:249] neg_lo:[1,0,0] neg_hi:[1,0,0]
    v_cvt_pk_bf16_f32 v168, v246, v248
    v_cvt_pk_bf16_f32 v169, v247, v249
    v_pk_mul_f32 v[250:251], v[42:43], v[74:75]
    v_pk_mul_f32 v[252:253], v[58:59], v[74:75]
    v_pk_fma_f32 v[250:251], v[58:59], v[90:91], v[250:251]
    v_pk_fma_f32 v[252:253], v[42:43], v[90:91], v[252:253] neg_lo:[1,0,0] neg_hi:[1,0,0]
    v_cvt_pk_bf16_f32 v170, v250, v252
    v_cvt_pk_bf16_f32 v171, v251, v253
    v_pk_mul_f32 v[246:247], v[44:45], v[76:77]
    v_pk_mul_f32 v[248:249], v[60:61], v[76:77]
    v_pk_fma_f32 v[246:247], v[60:61], v[92:93], v[246:247]
    v_pk_fma_f32 v[248:249], v[44:45], v[92:93], v[248:249] neg_lo:[1,0,0] neg_hi:[1,0,0]
    v_cvt_pk_bf16_f32 v172, v246, v248
    v_cvt_pk_bf16_f32 v173, v247, v249
    v_pk_mul_f32 v[250:251], v[46:47], v[78:79]
    v_pk_mul_f32 v[252:253], v[62:63], v[78:79]
    v_pk_fma_f32 v[250:251], v[62:63], v[94:95], v[250:251]
    v_pk_fma_f32 v[252:253], v[46:47], v[94:95], v[252:253] neg_lo:[1,0,0] neg_hi:[1,0,0]
    v_cvt_pk_bf16_f32 v174, v250, v252
    v_cvt_pk_bf16_f32 v175, v251, v253
    v_pk_mul_f32 v[246:247], v[48:49], v[80:81]
    v_pk_mul_f32 v[248:249], v[64:65], v[80:81]
    v_pk_fma_f32 v[246:247], v[64:65], v[96:97], v[246:247]
    v_pk_fma_f32 v[248:249], v[48:49], v[96:97], v[248:249] neg_lo:[1,0,0] neg_hi:[1,0,0]
    v_cvt_pk_bf16_f32 v176, v246, v248
    v_cvt_pk_bf16_f32 v177, v247, v249
    v_pk_mul_f32 v[250:251], v[50:51], v[82:83]
    v_pk_mul_f32 v[252:253], v[66:67], v[82:83]
    v_pk_fma_f32 v[250:251], v[66:67], v[98:99], v[250:251]
    v_pk_fma_f32 v[252:253], v[50:51], v[98:99], v[252:253] neg_lo:[1,0,0] neg_hi:[1,0,0]
    v_cvt_pk_bf16_f32 v178, v250, v252
    v_cvt_pk_bf16_f32 v179, v251, v253
    v_pk_mul_f32 v[246:247], v[52:53], v[84:85]
    v_pk_mul_f32 v[248:249], v[68:69], v[84:85]
    v_pk_fma_f32 v[246:247], v[68:69], v[100:101], v[246:247]
    v_pk_fma_f32 v[248:249], v[52:53], v[100:101], v[248:249] neg_lo:[1,0,0] neg_hi:[1,0,0]
    v_cvt_pk_bf16_f32 v180, v246, v248
    v_cvt_pk_bf16_f32 v181, v247, v249
    v_pk_mul_f32 v[250:251], v[54:55], v[86:87]
    v_pk_mul_f32 v[252:253], v[70:71], v[86:87]
    v_pk_fma_f32 v[250:251], v[70:71], v[102:103], v[250:251]
    v_pk_fma_f32 v[252:253], v[54:55], v[102:103], v[252:253] neg_lo:[1,0,0] neg_hi:[1,0,0]
    v_cvt_pk_bf16_f32 v182, v250, v252
    v_cvt_pk_bf16_f32 v183, v251, v253
    s_waitcnt lgkmcnt(0)
    s_nop 0
    v_mfma_f32_32x32x16_bf16 v[72:87], v[168:171], v[136:139], 0
    v_add_f32_dpp v4, v4, v4 row_ror:8 row_mask:0xf bank_mask:0xf
    v_add_f32_dpp v5, v5, v5 row_ror:8 row_mask:0xf bank_mask:0xf
    v_add_f32_dpp v6, v6, v6 row_ror:8 row_mask:0xf bank_mask:0xf
    v_add_f32_dpp v7, v7, v7 row_ror:8 row_mask:0xf bank_mask:0xf
    v_mfma_f32_32x32x16_bf16 v[72:87], v[172:175], v[140:143], v[72:87]
    v_add_f32_dpp v4, v4, v4 row_ror:4 row_mask:0xf bank_mask:0xf
    v_add_f32_dpp v5, v5, v5 row_ror:4 row_mask:0xf bank_mask:0xf
    v_add_f32_dpp v6, v6, v6 row_ror:4 row_mask:0xf bank_mask:0xf
    v_add_f32_dpp v7, v7, v7 row_ror:4 row_mask:0xf bank_mask:0xf
    v_mfma_f32_32x32x16_bf16 v[72:87], v[176:179], v[144:147], v[72:87]
    v_add_f32_dpp v4, v4, v4 row_ror:2 row_mask:0xf bank_mask:0xf
    v_add_f32_dpp v5, v5, v5 row_ror:2 row_mask:0xf bank_mask:0xf
    v_add_f32_dpp v6, v6, v6 row_ror:2 row_mask:0xf bank_mask:0xf
    v_add_f32_dpp v7, v7, v7 row_ror:2 row_mask:0xf bank_mask:0xf
    v_mfma_f32_32x32x16_bf16 v[72:87], v[180:183], v[148:151], v[72:87]
    v_add_f32_dpp v4, v4, v4 row_ror:1 row_mask:0xf bank_mask:0xf
    v_add_f32_dpp v5, v5, v5 row_ror:1 row_mask:0xf bank_mask:0xf
    v_add_f32_dpp v6, v6, v6 row_ror:1 row_mask:0xf bank_mask:0xf
    v_add_f32_dpp v7, v7, v7 row_ror:1 row_mask:0xf bank_mask:0xf
    v_mfma_f32_32x32x16_bf16 v[88:103], v[168:171], v[152:155], 0
    v_add_f32_dpp v4, v4, v4 row_bcast:15 row_mask:0xa bank_mask:0xf
    v_add_f32_dpp v5, v5, v5 row_bcast:15 row_mask:0xa bank_mask:0xf
    v_add_f32_dpp v6, v6, v6 row_bcast:15 row_mask:0xa bank_mask:0xf
    v_add_f32_dpp v7, v7, v7 row_bcast:15 row_mask:0xa bank_mask:0xf
    v_mfma_f32_32x32x16_bf16 v[88:103], v[172:175], v[156:159], v[88:103]
    v_add_f32_dpp v4, v4, v4 row_bcast:31 row_mask:0xc bank_mask:0xf
    v_add_f32_dpp v5, v5, v5 row_bcast:31 row_mask:0xc bank_mask:0xf
    v_add_f32_dpp v6, v6, v6 row_bcast:31 row_mask:0xc bank_mask:0xf
    v_add_f32_dpp v7, v7, v7 row_bcast:31 row_mask:0xc bank_mask:0xf
    v_mfma_f32_32x32x16_bf16 v[88:103], v[176:179], v[160:163], v[88:103]
    v_readlane_b32 s64, v4, 63
    v_readlane_b32 s65, v5, 63
    v_readlane_b32 s66, v6, 63
    v_readlane_b32 s67, v7, 63
    v_mfma_f32_32x32x16_bf16 v[88:103], v[180:183], v[164:167], v[88:103]
    v_mov_b32 v8, s48
    s_nop 0
    v_mul_f32 v4, s64, v8
    v_mul_f32 v5, s65, v8
    v_mfma_f32_32x32x16_bf16 v[184:199], v[168:171], v[104:107], 0
    v_mul_f32 v6, s66, v8
    v_mul_f32 v7, s67, v8
    v_fma_f32 v6, -v4, v4, v6
    v_fma_f32 v7, -v5, v5, v7
    v_mfma_f32_32x32x16_bf16 v[184:199], v[172:175], v[108:111], v[184:199]
    v_max_f32 v6, 0, v6
    v_max_f32 v7, 0, v7
    v_cvt_pk_bf16_f32 v6, v6, v7
    v_and_b32 v7, 0xffff0000, v6
    v_mfma_f32_32x32x16_bf16 v[184:199], v[176:179], v[112:115], v[184:199]
    v_lshlrev_b32 v6, 16, v6
    v_add_f32 v6, 0x3727c5ac, v6
    v_add_f32 v7, 0x3727c5ac, v7
    v_cvt_pk_bf16_f32 v6, v6, v7
    v_mfma_f32_32x32x16_bf16 v[184:199], v[180:183], v[116:119], v[184:199]
    v_and_b32 v7, 0xffff0000, v6
    v_lshlrev_b32 v6, 16, v6
    v_sqrt_f32 v6, v6
    v_sqrt_f32 v7, v7
    v_mfma_f32_32x32x16_bf16 v[200:215], v[168:171], v[120:123], 0
    v_cvt_pk_bf16_f32 v4, v4, v5
    v_cvt_pk_bf16_f32 v6, v6, v7
    v_and_b32 v7, 0xffff0000, v6
    v_lshlrev_b32 v6, 16, v6
    v_mfma_f32_32x32x16_bf16 v[200:215], v[172:175], v[124:127], v[200:215]
    v_rcp_f32 v10, v6
    v_rcp_f32 v11, v7
    v_and_b32 v244, 0xffff0000, v4
    v_lshlrev_b32 v242, 16, v4
    v_mfma_f32_32x32x16_bf16 v[200:215], v[176:179], v[128:131], v[200:215]
    v_mov_b32 v243, v10
    v_mov_b32 v245, v11
    s_lshl_b32 s64, s3, 3
    s_add_u32 s64, s64, 161408
    v_mfma_f32_32x32x16_bf16 v[200:215], v[180:183], v[132:135], v[200:215]
    v_mov_b32 v4, s64
    ds_write_b64 v4, v[242:243]
    ds_write_b64 v4, v[244:245] offset:32
    s_cmp_eq_u32 s3, 3
    s_cselect_b32 s64, -2, -1
    s_nop 9
    s_mov_b32 exec_hi, 0
    v_mov_b32 v184, v72
    v_mov_b32 v192, v80
    v_mov_b32 v200, v88
    v_mov_b32 v208, v96
    s_mov_b32 exec_hi, -1
    v_mov_b32 v6, v11
    v_mov_b32 v7, v11
    v_mov_b32 v11, v10
    v_pk_mul_f32 v[4:5], v[184:185], v[10:11]
    v_pk_fma_f32 v[40:41], v[192:193], v[6:7], v[4:5]
    v_pk_fma_f32 v[48:49], v[192:193], v[6:7], v[4:5] neg_lo:[1,0,0] neg_hi:[1,0,0]
    v_pk_mul_f32 v[4:5], v[200:201], v[10:11]
    v_pk_fma_f32 v[56:57], v[208:209], v[6:7], v[4:5]
    v_pk_fma_f32 v[64:65], v[208:209], v[6:7], v[4:5] neg_lo:[1,0,0] neg_hi:[1,0,0]
    v_cvt_pk_bf16_f32 v16, v40, v56
    v_and_b32 v16, s64, v16
    ds_write_b32 v15, v16 offset:0
    v_cvt_pk_bf16_f32 v17, v41, v57
    v_and_b32 v17, s64, v17
    ds_write_b32 v15, v17 offset:16
    v_cvt_pk_bf16_f32 v24, v48, v64
    v_and_b32 v24, s64, v24
    ds_write_b32 v15, v24 offset:8704
    v_cvt_pk_bf16_f32 v25, v49, v65
    v_and_b32 v25, s64, v25
    ds_write_b32 v15, v25 offset:8720
    v_pk_mul_f32 v[4:5], v[186:187], v[10:11]
    v_pk_fma_f32 v[42:43], v[194:195], v[6:7], v[4:5]
    v_pk_fma_f32 v[50:51], v[194:195], v[6:7], v[4:5] neg_lo:[1,0,0] neg_hi:[1,0,0]
    v_pk_mul_f32 v[4:5], v[202:203], v[10:11]
    v_pk_fma_f32 v[58:59], v[210:211], v[6:7], v[4:5]
    v_pk_fma_f32 v[66:67], v[210:211], v[6:7], v[4:5] neg_lo:[1,0,0] neg_hi:[1,0,0]
    v_cvt_pk_bf16_f32 v18, v42, v58
    v_and_b32 v18, s64, v18
    ds_write_b32 v15, v18 offset:32
    v_cvt_pk_bf16_f32 v19, v43, v59
    v_and_b32 v19, s64, v19
    ds_write_b32 v15, v19 offset:48
    v_cvt_pk_bf16_f32 v26, v50, v66
    v_and_b32 v26, s64, v26
    ds_write_b32 v15, v26 offset:8736
    v_cvt_pk_bf16_f32 v27, v51, v67
    v_and_b32 v27, s64, v27
    ds_write_b32 v15, v27 offset:8752
    v_pk_mul_f32 v[4:5], v[188:189], v[10:11]
    v_pk_fma_f32 v[44:45], v[196:197], v[6:7], v[4:5]
    v_pk_fma_f32 v[52:53], v[196:197], v[6:7], v[4:5] neg_lo:[1,0,0] neg_hi:[1,0,0]
    v_pk_mul_f32 v[4:5], v[204:205], v[10:11]
    v_pk_fma_f32 v[60:61], v[212:213], v[6:7], v[4:5]
    v_pk_fma_f32 v[68:69], v[212:213], v[6:7], v[4:5] neg_lo:[1,0,0] neg_hi:[1,0,0]
    v_cvt_pk_bf16_f32 v20, v44, v60
    v_and_b32 v20, s64, v20
    ds_write_b32 v15, v20 offset:128
    v_cvt_pk_bf16_f32 v21, v45, v61
    v_and_b32 v21, s64, v21
    ds_write_b32 v15, v21 offset:144
    v_cvt_pk_bf16_f32 v28, v52, v68
    v_and_b32 v28, s64, v28
    ds_write_b32 v15, v28 offset:8832
    v_cvt_pk_bf16_f32 v29, v53, v69
    v_and_b32 v29, s64, v29
    ds_write_b32 v15, v29 offset:8848
    v_pk_mul_f32 v[4:5], v[190:191], v[10:11]
    v_pk_fma_f32 v[46:47], v[198:199], v[6:7], v[4:5]
    v_pk_fma_f32 v[54:55], v[198:199], v[6:7], v[4:5] neg_lo:[1,0,0] neg_hi:[1,0,0]
    v_pk_mul_f32 v[4:5], v[206:207], v[10:11]
    v_pk_fma_f32 v[62:63], v[214:215], v[6:7], v[4:5]
    v_pk_fma_f32 v[70:71], v[214:215], v[6:7], v[4:5] neg_lo:[1,0,0] neg_hi:[1,0,0]
    v_cvt_pk_bf16_f32 v22, v46, v62
    v_and_b32 v22, s64, v22
    ds_write_b32 v15, v22 offset:160
    v_cvt_pk_bf16_f32 v23, v47, v63
    v_and_b32 v23, s64, v23
    ds_write_b32 v15, v23 offset:176
    v_cvt_pk_bf16_f32 v30, v54, v70
    v_and_b32 v30, s64, v30
    ds_write_b32 v15, v30 offset:8864
    v_cvt_pk_bf16_f32 v31, v55, v71
    v_and_b32 v31, s64, v31
    ds_write_b32 v15, v31 offset:8880
    s_mov_b32 s46, 0
    s_mov_b32 s51, 4294876160
    s_mov_b32 s52, 45568
    v_mov_b32 v14, 1
    s_bfe_u32 s48, s2, 0x20003
    s_lshl_b32 s48, s48, 6
    v_mov_b32 v15, s48
    s_waitcnt lgkmcnt(0)
    s_barrier
    ds_read_b128 v[128:131], v224 offset:0
    ds_read_b64_tr_b16 v[144:145], v228 offset:0
    ds_read_b64_tr_b16 v[146:147], v228 offset:1792
    ds_read_b64_tr_b16 v[148:149], v229 offset:32
    ds_read_b64_tr_b16 v[150:151], v229 offset:1824
    ds_read_b128 v[132:135], v224 offset:2048
    ds_read_b64_tr_b16 v[152:153], v228 offset:64
    ds_read_b64_tr_b16 v[154:155], v228 offset:1856
    ds_read_b64_tr_b16 v[156:157], v229 offset:96
    ds_read_b64_tr_b16 v[158:159], v229 offset:1888
    ds_read_b128 v[136:139], v225 offset:0
    ds_read_b64_tr_b16 v[160:161], v228 offset:128
    ds_read_b64_tr_b16 v[162:163], v228 offset:1920
    ds_read_b64_tr_b16 v[164:165], v229 offset:160
    ds_read_b64_tr_b16 v[166:167], v229 offset:1952
    ds_read_b128 v[140:143], v225 offset:2048
    ds_read_b64_tr_b16 v[168:169], v230 offset:192
    ds_read_b64_tr_b16 v[170:171], v230 offset:1984
    ds_read_b64_tr_b16 v[172:173], v231 offset:224
    ds_read_b64_tr_b16 v[174:175], v231 offset:2016
    s_add_u32 s46, s46, 1
    s_cmp_eq_u32 s46, 3
    s_cselect_b32 s49, s51, s52
    s_cselect_b32 s46, 0, s46
    v_add_u32 v224, s49, v224
    v_add_u32 v225, s49, v225
    s_waitcnt lgkmcnt(0)
    v_mfma_f32_16x16x32_bf16 v[16:19], v[144:147], v[128:131], 0
    ds_read_b128 v[176:179], v226 offset:0
    v_mfma_f32_16x16x32_bf16 v[20:23], v[148:151], v[128:131], 0
    ds_read_b64_tr_b16 v[192:193], v228 offset:14592
    v_mfma_f32_16x16x32_bf16 v[24:27], v[152:155], v[128:131], 0
    ds_read_b64_tr_b16 v[194:195], v228 offset:16384
    v_mfma_f32_16x16x32_bf16 v[28:31], v[156:159], v[128:131], 0
    ds_read_b64_tr_b16 v[196:197], v229 offset:14624
    v_mfma_f32_16x16x32_bf16 v[32:35], v[160:163], v[128:131], 0
    ds_read_b64_tr_b16 v[198:199], v229 offset:16416
    v_mfma_f32_16x16x32_bf16 v[36:39], v[164:167], v[128:131], 0
    ds_read_b128 v[180:183], v226 offset:2048
    v_mfma_f32_16x16x32_bf16 v[112:115], v[168:171], v[128:131], 0
    ds_read_b64_tr_b16 v[200:201], v228 offset:14656
    v_mfma_f32_16x16x32_bf16 v[116:119], v[172:175], v[128:131], 0
    ds_read_b64_tr_b16 v[202:203], v228 offset:16448
    v_mfma_f32_16x16x32_bf16 v[40:43], v[144:147], v[132:135], 0
    ds_read_b64_tr_b16 v[204:205], v229 offset:14688
    v_mfma_f32_16x16x32_bf16 v[44:47], v[148:151], v[132:135], 0
    ds_read_b64_tr_b16 v[206:207], v229 offset:16480
    v_mfma_f32_16x16x32_bf16 v[48:51], v[152:155], v[132:135], 0
    ds_read_b128 v[184:187], v227 offset:0
    v_mfma_f32_16x16x32_bf16 v[52:55], v[156:159], v[132:135], 0
    ds_read_b64_tr_b16 v[208:209], v228 offset:14720
    v_mfma_f32_16x16x32_bf16 v[56:59], v[160:163], v[132:135], 0
    ds_read_b64_tr_b16 v[210:211], v228 offset:16512
    v_mfma_f32_16x16x32_bf16 v[60:63], v[164:167], v[132:135], 0
    ds_read_b64_tr_b16 v[212:213], v229 offset:14752
    v_mfma_f32_16x16x32_bf16 v[120:123], v[168:171], v[132:135], 0
    ds_read_b64_tr_b16 v[214:215], v229 offset:16544
    v_mfma_f32_16x16x32_bf16 v[124:127], v[172:175], v[132:135], 0
    ds_read_b128 v[188:191], v227 offset:2048
    v_mfma_f32_16x16x32_bf16 v[64:67], v[144:147], v[136:139], 0
    ds_read_b64_tr_b16 v[216:217], v230 offset:14784
    v_mfma_f32_16x16x32_bf16 v[68:71], v[148:151], v[136:139], 0
    ds_read_b64_tr_b16 v[218:219], v230 offset:16576
    v_mfma_f32_16x16x32_bf16 v[72:75], v[152:155], v[136:139], 0
    ds_read_b64_tr_b16 v[220:221], v231 offset:14816
    v_mfma_f32_16x16x32_bf16 v[76:79], v[156:159], v[136:139], 0
    ds_read_b64_tr_b16 v[222:223], v231 offset:16608
    v_mfma_f32_16x16x32_bf16 v[80:83], v[160:163], v[136:139], 0
    v_add_u32 v228, s49, v228
    v_mfma_f32_16x16x32_bf16 v[84:87], v[164:167], v[136:139], 0
    v_add_u32 v229, s49, v229
    v_mfma_f32_16x16x32_bf16 v[88:91], v[144:147], v[140:143], 0
    v_add_u32 v230, s49, v230
    v_mfma_f32_16x16x32_bf16 v[92:95], v[148:151], v[140:143], 0
    v_add_u32 v231, s49, v231
    v_mfma_f32_16x16x32_bf16 v[96:99], v[152:155], v[140:143], 0
    v_mfma_f32_16x16x32_bf16 v[100:103], v[156:159], v[140:143], 0
    v_mfma_f32_16x16x32_bf16 v[104:107], v[160:163], v[140:143], 0
    v_mfma_f32_16x16x32_bf16 v[108:111], v[164:167], v[140:143], 0
    s_mov_b32 s47, 1
    s_waitcnt lgkmcnt(0)
parallel_sum__spectral_gfnet__dense_activation_mish__prompt_kernel_cloop:
    s_barrier
    v_mfma_f32_16x16x32_bf16 v[16:19], v[192:195], v[176:179], v[16:19]
    v_add_u32 v226, s49, v226
    v_mfma_f32_16x16x32_bf16 v[20:23], v[196:199], v[176:179], v[20:23]
    v_add_u32 v227, s49, v227
    v_mfma_f32_16x16x32_bf16 v[24:27], v[200:203], v[176:179], v[24:27]
    ds_read_b128 v[128:131], v224 offset:0
    v_mfma_f32_16x16x32_bf16 v[28:31], v[204:207], v[176:179], v[28:31]
    ds_read_b64_tr_b16 v[144:145], v228 offset:0
    v_mfma_f32_16x16x32_bf16 v[32:35], v[208:211], v[176:179], v[32:35]
    ds_read_b64_tr_b16 v[146:147], v228 offset:1792
    v_mfma_f32_16x16x32_bf16 v[36:39], v[212:215], v[176:179], v[36:39]
    ds_read_b64_tr_b16 v[148:149], v229 offset:32
    v_mfma_f32_16x16x32_bf16 v[112:115], v[216:219], v[176:179], v[112:115]
    ds_read_b64_tr_b16 v[150:151], v229 offset:1824
    v_mfma_f32_16x16x32_bf16 v[116:119], v[220:223], v[176:179], v[116:119]
    ds_read_b128 v[132:135], v224 offset:2048
    v_mfma_f32_16x16x32_bf16 v[40:43], v[192:195], v[180:183], v[40:43]
    ds_read_b64_tr_b16 v[152:153], v228 offset:64
    v_mfma_f32_16x16x32_bf16 v[44:47], v[196:199], v[180:183], v[44:47]
    ds_read_b64_tr_b16 v[154:155], v228 offset:1856
    v_mfma_f32_16x16x32_bf16 v[48:51], v[200:203], v[180:183], v[48:51]
    ds_read_b64_tr_b16 v[156:157], v229 offset:96
    v_mfma_f32_16x16x32_bf16 v[52:55], v[204:207], v[180:183], v[52:55]
    ds_read_b64_tr_b16 v[158:159], v229 offset:1888
    v_mfma_f32_16x16x32_bf16 v[56:59], v[208:211], v[180:183], v[56:59]
    ds_read_b128 v[136:139], v225 offset:0
    v_mfma_f32_16x16x32_bf16 v[60:63], v[212:215], v[180:183], v[60:63]
    ds_read_b64_tr_b16 v[160:161], v228 offset:128
    v_mfma_f32_16x16x32_bf16 v[120:123], v[216:219], v[180:183], v[120:123]
    ds_read_b64_tr_b16 v[162:163], v228 offset:1920
    v_mfma_f32_16x16x32_bf16 v[124:127], v[220:223], v[180:183], v[124:127]
    ds_read_b64_tr_b16 v[164:165], v229 offset:160
    v_mfma_f32_16x16x32_bf16 v[64:67], v[192:195], v[184:187], v[64:67]
    ds_read_b64_tr_b16 v[166:167], v229 offset:1952
    v_mfma_f32_16x16x32_bf16 v[68:71], v[196:199], v[184:187], v[68:71]
    ds_read_b128 v[140:143], v225 offset:2048
    v_mfma_f32_16x16x32_bf16 v[72:75], v[200:203], v[184:187], v[72:75]
    ds_read_b64_tr_b16 v[168:169], v230 offset:192
    v_mfma_f32_16x16x32_bf16 v[76:79], v[204:207], v[184:187], v[76:79]
    ds_read_b64_tr_b16 v[170:171], v230 offset:1984
    v_mfma_f32_16x16x32_bf16 v[80:83], v[208:211], v[184:187], v[80:83]
    ds_read_b64_tr_b16 v[172:173], v231 offset:224
    v_mfma_f32_16x16x32_bf16 v[84:87], v[212:215], v[184:187], v[84:87]
    ds_read_b64_tr_b16 v[174:175], v231 offset:2016
    v_mfma_f32_16x16x32_bf16 v[88:91], v[192:195], v[188:191], v[88:91]
    s_add_u32 s46, s46, 1
    v_mfma_f32_16x16x32_bf16 v[92:95], v[196:199], v[188:191], v[92:95]
    s_cmp_eq_u32 s46, 3
    v_mfma_f32_16x16x32_bf16 v[96:99], v[200:203], v[188:191], v[96:99]
    s_cselect_b32 s49, s51, s52
    v_mfma_f32_16x16x32_bf16 v[100:103], v[204:207], v[188:191], v[100:103]
    s_cselect_b32 s46, 0, s46
    v_mfma_f32_16x16x32_bf16 v[104:107], v[208:211], v[188:191], v[104:107]
    v_add_u32 v224, s49, v224
    v_mfma_f32_16x16x32_bf16 v[108:111], v[212:215], v[188:191], v[108:111]
    v_add_u32 v225, s49, v225
    s_waitcnt lgkmcnt(0)
    v_mfma_f32_16x16x32_bf16 v[16:19], v[144:147], v[128:131], v[16:19]
    ds_read_b128 v[176:179], v226 offset:0
    v_mfma_f32_16x16x32_bf16 v[20:23], v[148:151], v[128:131], v[20:23]
    ds_read_b64_tr_b16 v[192:193], v228 offset:14592
    v_mfma_f32_16x16x32_bf16 v[24:27], v[152:155], v[128:131], v[24:27]
    ds_read_b64_tr_b16 v[194:195], v228 offset:16384
    v_mfma_f32_16x16x32_bf16 v[28:31], v[156:159], v[128:131], v[28:31]
    ds_read_b64_tr_b16 v[196:197], v229 offset:14624
    v_mfma_f32_16x16x32_bf16 v[32:35], v[160:163], v[128:131], v[32:35]
    ds_read_b64_tr_b16 v[198:199], v229 offset:16416
    v_mfma_f32_16x16x32_bf16 v[36:39], v[164:167], v[128:131], v[36:39]
    ds_read_b128 v[180:183], v226 offset:2048
    v_mfma_f32_16x16x32_bf16 v[112:115], v[168:171], v[128:131], v[112:115]
    ds_read_b64_tr_b16 v[200:201], v228 offset:14656
    v_mfma_f32_16x16x32_bf16 v[116:119], v[172:175], v[128:131], v[116:119]
    ds_read_b64_tr_b16 v[202:203], v228 offset:16448
    v_mfma_f32_16x16x32_bf16 v[40:43], v[144:147], v[132:135], v[40:43]
    ds_read_b64_tr_b16 v[204:205], v229 offset:14688
    v_mfma_f32_16x16x32_bf16 v[44:47], v[148:151], v[132:135], v[44:47]
    ds_read_b64_tr_b16 v[206:207], v229 offset:16480
    v_mfma_f32_16x16x32_bf16 v[48:51], v[152:155], v[132:135], v[48:51]
    ds_read_b128 v[184:187], v227 offset:0
    v_mfma_f32_16x16x32_bf16 v[52:55], v[156:159], v[132:135], v[52:55]
    ds_read_b64_tr_b16 v[208:209], v228 offset:14720
    v_mfma_f32_16x16x32_bf16 v[56:59], v[160:163], v[132:135], v[56:59]
    ds_read_b64_tr_b16 v[210:211], v228 offset:16512
    v_mfma_f32_16x16x32_bf16 v[60:63], v[164:167], v[132:135], v[60:63]
    ds_read_b64_tr_b16 v[212:213], v229 offset:14752
    v_mfma_f32_16x16x32_bf16 v[120:123], v[168:171], v[132:135], v[120:123]
    ds_read_b64_tr_b16 v[214:215], v229 offset:16544
    v_mfma_f32_16x16x32_bf16 v[124:127], v[172:175], v[132:135], v[124:127]
    ds_read_b128 v[188:191], v227 offset:2048
    v_mfma_f32_16x16x32_bf16 v[64:67], v[144:147], v[136:139], v[64:67]
    ds_read_b64_tr_b16 v[216:217], v230 offset:14784
    v_mfma_f32_16x16x32_bf16 v[68:71], v[148:151], v[136:139], v[68:71]
    ds_read_b64_tr_b16 v[218:219], v230 offset:16576
    v_mfma_f32_16x16x32_bf16 v[72:75], v[152:155], v[136:139], v[72:75]
    ds_read_b64_tr_b16 v[220:221], v231 offset:14816
    v_mfma_f32_16x16x32_bf16 v[76:79], v[156:159], v[136:139], v[76:79]
    ds_read_b64_tr_b16 v[222:223], v231 offset:16608
    v_mfma_f32_16x16x32_bf16 v[80:83], v[160:163], v[136:139], v[80:83]
    v_add_u32 v228, s49, v228
    v_mfma_f32_16x16x32_bf16 v[84:87], v[164:167], v[136:139], v[84:87]
    v_add_u32 v229, s49, v229
    v_mfma_f32_16x16x32_bf16 v[88:91], v[144:147], v[140:143], v[88:91]
    v_add_u32 v230, s49, v230
    v_mfma_f32_16x16x32_bf16 v[92:95], v[148:151], v[140:143], v[92:95]
    v_add_u32 v231, s49, v231
    v_mfma_f32_16x16x32_bf16 v[96:99], v[152:155], v[140:143], v[96:99]
    s_add_u32 s47, s47, 1
    v_mfma_f32_16x16x32_bf16 v[100:103], v[156:159], v[140:143], v[100:103]
    s_cmp_lt_u32 s47, 15
    v_mfma_f32_16x16x32_bf16 v[104:107], v[160:163], v[140:143], v[104:107]
    v_mfma_f32_16x16x32_bf16 v[108:111], v[164:167], v[140:143], v[108:111]
    s_waitcnt lgkmcnt(0)
    s_cbranch_scc1 parallel_sum__spectral_gfnet__dense_activation_mish__prompt_kernel_cloop
    s_waitcnt vmcnt(0)
    s_barrier
    v_mfma_f32_16x16x32_bf16 v[16:19], v[192:195], v[176:179], v[16:19]
    v_add_u32 v226, s49, v226
    v_mfma_f32_16x16x32_bf16 v[20:23], v[196:199], v[176:179], v[20:23]
    v_add_u32 v227, s49, v227
    v_mfma_f32_16x16x32_bf16 v[24:27], v[200:203], v[176:179], v[24:27]
    ds_read_b128 v[128:131], v224 offset:0
    v_mfma_f32_16x16x32_bf16 v[28:31], v[204:207], v[176:179], v[28:31]
    ds_read_b64_tr_b16 v[144:145], v228 offset:0
    v_mfma_f32_16x16x32_bf16 v[32:35], v[208:211], v[176:179], v[32:35]
    ds_read_b64_tr_b16 v[146:147], v228 offset:1792
    v_mfma_f32_16x16x32_bf16 v[36:39], v[212:215], v[176:179], v[36:39]
    ds_read_b64_tr_b16 v[148:149], v229 offset:32
    v_mfma_f32_16x16x32_bf16 v[112:115], v[216:219], v[176:179], v[112:115]
    ds_read_b64_tr_b16 v[150:151], v229 offset:1824
    v_mfma_f32_16x16x32_bf16 v[116:119], v[220:223], v[176:179], v[116:119]
    ds_read_b128 v[132:135], v224 offset:2048
    v_mfma_f32_16x16x32_bf16 v[40:43], v[192:195], v[180:183], v[40:43]
    ds_read_b64_tr_b16 v[152:153], v228 offset:64
    v_mfma_f32_16x16x32_bf16 v[44:47], v[196:199], v[180:183], v[44:47]
    ds_read_b64_tr_b16 v[154:155], v228 offset:1856
    v_mfma_f32_16x16x32_bf16 v[48:51], v[200:203], v[180:183], v[48:51]
    ds_read_b64_tr_b16 v[156:157], v229 offset:96
    v_mfma_f32_16x16x32_bf16 v[52:55], v[204:207], v[180:183], v[52:55]
    ds_read_b64_tr_b16 v[158:159], v229 offset:1888
    v_mfma_f32_16x16x32_bf16 v[56:59], v[208:211], v[180:183], v[56:59]
    ds_read_b128 v[136:139], v225 offset:0
    v_mfma_f32_16x16x32_bf16 v[60:63], v[212:215], v[180:183], v[60:63]
    ds_read_b64_tr_b16 v[160:161], v228 offset:128
    v_mfma_f32_16x16x32_bf16 v[120:123], v[216:219], v[180:183], v[120:123]
    ds_read_b64_tr_b16 v[162:163], v228 offset:1920
    v_mfma_f32_16x16x32_bf16 v[124:127], v[220:223], v[180:183], v[124:127]
    ds_read_b64_tr_b16 v[164:165], v229 offset:160
    v_mfma_f32_16x16x32_bf16 v[64:67], v[192:195], v[184:187], v[64:67]
    ds_read_b64_tr_b16 v[166:167], v229 offset:1952
    v_mfma_f32_16x16x32_bf16 v[68:71], v[196:199], v[184:187], v[68:71]
    ds_read_b128 v[140:143], v225 offset:2048
    v_mfma_f32_16x16x32_bf16 v[72:75], v[200:203], v[184:187], v[72:75]
    ds_read_b64_tr_b16 v[168:169], v230 offset:192
    v_mfma_f32_16x16x32_bf16 v[76:79], v[204:207], v[184:187], v[76:79]
    ds_read_b64_tr_b16 v[170:171], v230 offset:1984
    v_mfma_f32_16x16x32_bf16 v[80:83], v[208:211], v[184:187], v[80:83]
    ds_read_b64_tr_b16 v[172:173], v231 offset:224
    v_mfma_f32_16x16x32_bf16 v[84:87], v[212:215], v[184:187], v[84:87]
    ds_read_b64_tr_b16 v[174:175], v231 offset:2016
    v_mfma_f32_16x16x32_bf16 v[88:91], v[192:195], v[188:191], v[88:91]
    v_mfma_f32_16x16x32_bf16 v[92:95], v[196:199], v[188:191], v[92:95]
    v_mfma_f32_16x16x32_bf16 v[96:99], v[200:203], v[188:191], v[96:99]
    v_mfma_f32_16x16x32_bf16 v[100:103], v[204:207], v[188:191], v[100:103]
    v_mfma_f32_16x16x32_bf16 v[104:107], v[208:211], v[188:191], v[104:107]
    v_mfma_f32_16x16x32_bf16 v[108:111], v[212:215], v[188:191], v[108:111]
    s_waitcnt lgkmcnt(0)
    v_mfma_f32_16x16x32_bf16 v[16:19], v[144:147], v[128:131], v[16:19]
    ds_read_b128 v[176:179], v226 offset:0
    v_mfma_f32_16x16x32_bf16 v[20:23], v[148:151], v[128:131], v[20:23]
    ds_read_b64_tr_b16 v[192:193], v228 offset:14592
    v_mfma_f32_16x16x32_bf16 v[24:27], v[152:155], v[128:131], v[24:27]
    ds_read_b64_tr_b16 v[194:195], v228 offset:16384
    v_mfma_f32_16x16x32_bf16 v[28:31], v[156:159], v[128:131], v[28:31]
    ds_read_b64_tr_b16 v[196:197], v229 offset:14624
    v_mfma_f32_16x16x32_bf16 v[32:35], v[160:163], v[128:131], v[32:35]
    ds_read_b64_tr_b16 v[198:199], v229 offset:16416
    v_mfma_f32_16x16x32_bf16 v[36:39], v[164:167], v[128:131], v[36:39]
    ds_read_b128 v[180:183], v226 offset:2048
    v_mfma_f32_16x16x32_bf16 v[112:115], v[168:171], v[128:131], v[112:115]
    ds_read_b64_tr_b16 v[200:201], v228 offset:14656
    v_mfma_f32_16x16x32_bf16 v[116:119], v[172:175], v[128:131], v[116:119]
    ds_read_b64_tr_b16 v[202:203], v228 offset:16448
    v_mfma_f32_16x16x32_bf16 v[40:43], v[144:147], v[132:135], v[40:43]
    ds_read_b64_tr_b16 v[204:205], v229 offset:14688
    v_mfma_f32_16x16x32_bf16 v[44:47], v[148:151], v[132:135], v[44:47]
    ds_read_b64_tr_b16 v[206:207], v229 offset:16480
    v_mfma_f32_16x16x32_bf16 v[48:51], v[152:155], v[132:135], v[48:51]
    ds_read_b128 v[184:187], v227 offset:0
    v_mfma_f32_16x16x32_bf16 v[52:55], v[156:159], v[132:135], v[52:55]
    ds_read_b64_tr_b16 v[208:209], v228 offset:14720
    v_mfma_f32_16x16x32_bf16 v[56:59], v[160:163], v[132:135], v[56:59]
    ds_read_b64_tr_b16 v[210:211], v228 offset:16512
    v_mfma_f32_16x16x32_bf16 v[60:63], v[164:167], v[132:135], v[60:63]
    ds_read_b64_tr_b16 v[212:213], v229 offset:14752
    v_mfma_f32_16x16x32_bf16 v[120:123], v[168:171], v[132:135], v[120:123]
    ds_read_b64_tr_b16 v[214:215], v229 offset:16544
    v_mfma_f32_16x16x32_bf16 v[124:127], v[172:175], v[132:135], v[124:127]
    ds_read_b128 v[188:191], v227 offset:2048
    v_mfma_f32_16x16x32_bf16 v[64:67], v[144:147], v[136:139], v[64:67]
    ds_read_b64_tr_b16 v[216:217], v230 offset:14784
    v_mfma_f32_16x16x32_bf16 v[68:71], v[148:151], v[136:139], v[68:71]
    ds_read_b64_tr_b16 v[218:219], v230 offset:16576
    v_mfma_f32_16x16x32_bf16 v[72:75], v[152:155], v[136:139], v[72:75]
    ds_read_b64_tr_b16 v[220:221], v231 offset:14816
    v_mfma_f32_16x16x32_bf16 v[76:79], v[156:159], v[136:139], v[76:79]
    ds_read_b64_tr_b16 v[222:223], v231 offset:16608
    v_mfma_f32_16x16x32_bf16 v[80:83], v[160:163], v[136:139], v[80:83]
    s_lshl_b32 s47, s40, 9
    v_mfma_f32_16x16x32_bf16 v[84:87], v[164:167], v[136:139], v[84:87]
    s_lshl_b32 s48, s41, 8
    v_mfma_f32_16x16x32_bf16 v[88:91], v[144:147], v[140:143], v[88:91]
    s_add_u32 s47, s47, s48
    v_mfma_f32_16x16x32_bf16 v[92:95], v[148:151], v[140:143], v[92:95]
    s_add_u32 s47, s47, 161408
    v_mfma_f32_16x16x32_bf16 v[96:99], v[152:155], v[140:143], v[96:99]
    v_lshl_add_u32 v4, v12, 3, s47
    v_mfma_f32_16x16x32_bf16 v[100:103], v[156:159], v[140:143], v[100:103]
    v_xor_b32 v7, 256, v4
    v_mfma_f32_16x16x32_bf16 v[104:107], v[160:163], v[140:143], v[104:107]
    v_lshlrev_b32 v6, 4, v13
    v_mfma_f32_16x16x32_bf16 v[108:111], v[164:167], v[140:143], v[108:111]
    v_add_u32 v6, 162432, v6
    s_lshl_b32 s47, s41, 9
    v_add_u32 v5, s47, v6
    v_lshlrev_b32 v9, 3, v13
    v_add_u32 v9, 163328, v9
    v_add_u32 v8, s48, v9
    s_waitcnt lgkmcnt(0)
    s_barrier
    v_mfma_f32_16x16x32_bf16 v[16:19], v[192:195], v[176:179], v[16:19]
    v_mfma_f32_16x16x32_bf16 v[20:23], v[196:199], v[176:179], v[20:23]
    v_mfma_f32_16x16x32_bf16 v[24:27], v[200:203], v[176:179], v[24:27]
    ds_read_b128 v[128:131], v5 offset:0
    v_mfma_f32_16x16x32_bf16 v[28:31], v[204:207], v[176:179], v[28:31]
    ds_read_b128 v[132:135], v5 offset:64
    v_mfma_f32_16x16x32_bf16 v[32:35], v[208:211], v[176:179], v[32:35]
    ds_read_b128 v[136:139], v5 offset:128
    v_mfma_f32_16x16x32_bf16 v[36:39], v[212:215], v[176:179], v[36:39]
    ds_read_b128 v[140:143], v5 offset:192
    v_mfma_f32_16x16x32_bf16 v[112:115], v[216:219], v[176:179], v[112:115]
    ds_read_b128 v[144:147], v5 offset:256
    v_mfma_f32_16x16x32_bf16 v[116:119], v[220:223], v[176:179], v[116:119]
    ds_read_b128 v[148:151], v5 offset:320
    v_mfma_f32_16x16x32_bf16 v[40:43], v[192:195], v[180:183], v[40:43]
    ds_read_b128 v[152:155], v6 offset:384
    v_mfma_f32_16x16x32_bf16 v[44:47], v[196:199], v[180:183], v[44:47]
    ds_read_b128 v[156:159], v6 offset:448
    v_mfma_f32_16x16x32_bf16 v[48:51], v[200:203], v[180:183], v[48:51]
    ds_read_b64 v[160:161], v4 offset:0
    v_mfma_f32_16x16x32_bf16 v[52:55], v[204:207], v[180:183], v[52:55]
    ds_read_b64 v[162:163], v4 offset:128
    v_mfma_f32_16x16x32_bf16 v[56:59], v[208:211], v[180:183], v[56:59]
    ds_read_b64 v[164:165], v7 offset:0
    v_mfma_f32_16x16x32_bf16 v[60:63], v[212:215], v[180:183], v[60:63]
    ds_read_b64 v[166:167], v7 offset:128
    v_mfma_f32_16x16x32_bf16 v[120:123], v[216:219], v[180:183], v[120:123]
    ds_read_b64 v[240:241], v8 offset:0
    v_mfma_f32_16x16x32_bf16 v[124:127], v[220:223], v[180:183], v[124:127]
    ds_read_b64 v[242:243], v8 offset:32
    v_mfma_f32_16x16x32_bf16 v[64:67], v[192:195], v[184:187], v[64:67]
    ds_read_b64 v[244:245], v8 offset:64
    v_mfma_f32_16x16x32_bf16 v[68:71], v[196:199], v[184:187], v[68:71]
    ds_read_b64 v[246:247], v8 offset:96
    v_mfma_f32_16x16x32_bf16 v[72:75], v[200:203], v[184:187], v[72:75]
    ds_read_b64 v[248:249], v8 offset:128
    v_mfma_f32_16x16x32_bf16 v[76:79], v[204:207], v[184:187], v[76:79]
    ds_read_b64 v[250:251], v8 offset:160
    v_mfma_f32_16x16x32_bf16 v[80:83], v[208:211], v[184:187], v[80:83]
    ds_read_b64 v[252:253], v9 offset:192
    v_mfma_f32_16x16x32_bf16 v[84:87], v[212:215], v[184:187], v[84:87]
    ds_read_b64 v[254:255], v9 offset:224
    v_mfma_f32_16x16x32_bf16 v[88:91], v[192:195], v[188:191], v[88:91]
    v_mfma_f32_16x16x32_bf16 v[92:95], v[196:199], v[188:191], v[92:95]
    v_mfma_f32_16x16x32_bf16 v[96:99], v[200:203], v[188:191], v[96:99]
    v_mfma_f32_16x16x32_bf16 v[100:103], v[204:207], v[188:191], v[100:103]
    v_mfma_f32_16x16x32_bf16 v[104:107], v[208:211], v[188:191], v[104:107]
    v_mfma_f32_16x16x32_bf16 v[108:111], v[212:215], v[188:191], v[108:111]
    v_mov_b32 v8, 0x3fb8aa3b
    s_waitcnt lgkmcnt(0)
    v_lshlrev_b32 v176, 16, v240
    v_and_b32 v177, 0xffff0000, v240
    v_lshlrev_b32 v178, 16, v241
    v_and_b32 v179, 0xffff0000, v241
    v_lshlrev_b32 v180, 16, v242
    v_and_b32 v181, 0xffff0000, v242
    v_lshlrev_b32 v182, 16, v243
    v_and_b32 v183, 0xffff0000, v243
    v_lshlrev_b32 v184, 16, v244
    v_and_b32 v185, 0xffff0000, v244
    v_lshlrev_b32 v186, 16, v245
    v_and_b32 v187, 0xffff0000, v245
    v_lshlrev_b32 v188, 16, v246
    v_and_b32 v189, 0xffff0000, v246
    v_lshlrev_b32 v190, 16, v247
    v_and_b32 v191, 0xffff0000, v247
    v_lshlrev_b32 v192, 16, v248
    v_and_b32 v193, 0xffff0000, v248
    v_lshlrev_b32 v194, 16, v249
    v_and_b32 v195, 0xffff0000, v249
    v_lshlrev_b32 v196, 16, v250
    v_and_b32 v197, 0xffff0000, v250
    v_lshlrev_b32 v198, 16, v251
    v_and_b32 v199, 0xffff0000, v251
    v_lshlrev_b32 v200, 16, v252
    v_and_b32 v201, 0xffff0000, v252
    v_lshlrev_b32 v202, 16, v253
    v_and_b32 v203, 0xffff0000, v253
    v_lshlrev_b32 v204, 16, v254
    v_and_b32 v205, 0xffff0000, v254
    v_lshlrev_b32 v206, 16, v255
    v_and_b32 v207, 0xffff0000, v255
    v_mov_b32 v168, v161
    v_mov_b32 v169, v161
    v_mov_b32 v161, v160
    v_mov_b32 v170, v163
    v_mov_b32 v171, v163
    v_mov_b32 v163, v162
    v_mov_b32 v172, v165
    v_mov_b32 v173, v165
    v_mov_b32 v165, v164
    v_mov_b32 v174, v167
    v_mov_b32 v175, v167
    v_mov_b32 v167, v166
    v_mov_b32 v9, v8
    s_add_u32 s64, s98, 114688
    s_add_u32 s65, s99, 114688
    s_add_u32 s66, s100, 114688
    v_pk_fma_f32 v[16:17], v[128:129], v[160:161], v[16:17] neg_lo:[1,0,0] neg_hi:[1,0,0]
    v_pk_fma_f32 v[18:19], v[130:131], v[160:161], v[18:19] neg_lo:[1,0,0] neg_hi:[1,0,0]
    v_pk_fma_f32 v[20:21], v[132:133], v[160:161], v[20:21] neg_lo:[1,0,0] neg_hi:[1,0,0]
    v_pk_fma_f32 v[22:23], v[134:135], v[160:161], v[22:23] neg_lo:[1,0,0] neg_hi:[1,0,0]
    v_pk_fma_f32 v[16:17], v[16:17], v[168:169], v[176:177]
    v_pk_fma_f32 v[18:19], v[18:19], v[168:169], v[178:179]
    v_pk_fma_f32 v[20:21], v[20:21], v[168:169], v[180:181]
    v_pk_fma_f32 v[22:23], v[22:23], v[168:169], v[182:183]
    v_pk_mul_f32 v[208:209], v[16:17], v[8:9]
    v_pk_mul_f32 v[210:211], v[18:19], v[8:9]
    v_pk_mul_f32 v[212:213], v[20:21], v[8:9]
    v_pk_mul_f32 v[214:215], v[22:23], v[8:9]
    v_exp_f32 v208, v208
    v_exp_f32 v209, v209
    v_exp_f32 v210, v210
    v_exp_f32 v211, v211
    v_exp_f32 v212, v212
    v_exp_f32 v213, v213
    v_exp_f32 v214, v214
    v_exp_f32 v215, v215
    v_pk_add_f32 v[208:209], v[208:209], 1.0 op_sel_hi:[1,0]
    v_pk_add_f32 v[210:211], v[210:211], 1.0 op_sel_hi:[1,0]
    v_pk_add_f32 v[212:213], v[212:213], 1.0 op_sel_hi:[1,0]
    v_pk_add_f32 v[214:215], v[214:215], 1.0 op_sel_hi:[1,0]
    v_pk_fma_f32 v[208:209], v[208:209], v[208:209], 1.0 op_sel_hi:[1,1,0]
    v_pk_fma_f32 v[210:211], v[210:211], v[210:211], 1.0 op_sel_hi:[1,1,0]
    v_pk_fma_f32 v[212:213], v[212:213], v[212:213], 1.0 op_sel_hi:[1,1,0]
    v_pk_fma_f32 v[214:215], v[214:215], v[214:215], 1.0 op_sel_hi:[1,1,0]
    v_rcp_f32 v208, v208
    v_rcp_f32 v209, v209
    v_rcp_f32 v210, v210
    v_rcp_f32 v211, v211
    v_rcp_f32 v212, v212
    v_rcp_f32 v213, v213
    v_rcp_f32 v214, v214
    v_rcp_f32 v215, v215
    v_pk_fma_f32 v[208:209], v[208:209], -2.0, 1.0 op_sel_hi:[1,0,0]
    v_pk_fma_f32 v[210:211], v[210:211], -2.0, 1.0 op_sel_hi:[1,0,0]
    v_pk_fma_f32 v[212:213], v[212:213], -2.0, 1.0 op_sel_hi:[1,0,0]
    v_pk_fma_f32 v[214:215], v[214:215], -2.0, 1.0 op_sel_hi:[1,0,0]
    v_pk_mul_f32 v[16:17], v[16:17], v[208:209]
    v_pk_mul_f32 v[18:19], v[18:19], v[210:211]
    v_pk_mul_f32 v[20:21], v[20:21], v[212:213]
    v_pk_mul_f32 v[22:23], v[22:23], v[214:215]
    v_cvt_pk_bf16_f32 v16, v16, v17
    v_cvt_pk_bf16_f32 v17, v18, v19
    v_cvt_pk_bf16_f32 v18, v20, v21
    v_cvt_pk_bf16_f32 v19, v22, v23
    buffer_store_dwordx4 v[16:19], v3, s[16:19], s98 offen offset:0 sc1
    ds_write_b128 v233, v[16:19] offset:0
    v_pk_fma_f32 v[40:41], v[128:129], v[162:163], v[40:41] neg_lo:[1,0,0] neg_hi:[1,0,0]
    v_pk_fma_f32 v[42:43], v[130:131], v[162:163], v[42:43] neg_lo:[1,0,0] neg_hi:[1,0,0]
    v_pk_fma_f32 v[44:45], v[132:133], v[162:163], v[44:45] neg_lo:[1,0,0] neg_hi:[1,0,0]
    v_pk_fma_f32 v[46:47], v[134:135], v[162:163], v[46:47] neg_lo:[1,0,0] neg_hi:[1,0,0]
    v_pk_fma_f32 v[40:41], v[40:41], v[170:171], v[176:177]
    v_pk_fma_f32 v[42:43], v[42:43], v[170:171], v[178:179]
    v_pk_fma_f32 v[44:45], v[44:45], v[170:171], v[180:181]
    v_pk_fma_f32 v[46:47], v[46:47], v[170:171], v[182:183]
    v_pk_mul_f32 v[208:209], v[40:41], v[8:9]
    v_pk_mul_f32 v[210:211], v[42:43], v[8:9]
    v_pk_mul_f32 v[212:213], v[44:45], v[8:9]
    v_pk_mul_f32 v[214:215], v[46:47], v[8:9]
    v_exp_f32 v208, v208
    v_exp_f32 v209, v209
    v_exp_f32 v210, v210
    v_exp_f32 v211, v211
    v_exp_f32 v212, v212
    v_exp_f32 v213, v213
    v_exp_f32 v214, v214
    v_exp_f32 v215, v215
    v_pk_add_f32 v[208:209], v[208:209], 1.0 op_sel_hi:[1,0]
    v_pk_add_f32 v[210:211], v[210:211], 1.0 op_sel_hi:[1,0]
    v_pk_add_f32 v[212:213], v[212:213], 1.0 op_sel_hi:[1,0]
    v_pk_add_f32 v[214:215], v[214:215], 1.0 op_sel_hi:[1,0]
    v_pk_fma_f32 v[208:209], v[208:209], v[208:209], 1.0 op_sel_hi:[1,1,0]
    v_pk_fma_f32 v[210:211], v[210:211], v[210:211], 1.0 op_sel_hi:[1,1,0]
    v_pk_fma_f32 v[212:213], v[212:213], v[212:213], 1.0 op_sel_hi:[1,1,0]
    v_pk_fma_f32 v[214:215], v[214:215], v[214:215], 1.0 op_sel_hi:[1,1,0]
    v_rcp_f32 v208, v208
    v_rcp_f32 v209, v209
    v_rcp_f32 v210, v210
    v_rcp_f32 v211, v211
    v_rcp_f32 v212, v212
    v_rcp_f32 v213, v213
    v_rcp_f32 v214, v214
    v_rcp_f32 v215, v215
    v_pk_fma_f32 v[208:209], v[208:209], -2.0, 1.0 op_sel_hi:[1,0,0]
    v_pk_fma_f32 v[210:211], v[210:211], -2.0, 1.0 op_sel_hi:[1,0,0]
    v_pk_fma_f32 v[212:213], v[212:213], -2.0, 1.0 op_sel_hi:[1,0,0]
    v_pk_fma_f32 v[214:215], v[214:215], -2.0, 1.0 op_sel_hi:[1,0,0]
    v_pk_mul_f32 v[40:41], v[40:41], v[208:209]
    v_pk_mul_f32 v[42:43], v[42:43], v[210:211]
    v_pk_mul_f32 v[44:45], v[44:45], v[212:213]
    v_pk_mul_f32 v[46:47], v[46:47], v[214:215]
    v_cvt_pk_bf16_f32 v40, v40, v41
    v_cvt_pk_bf16_f32 v41, v42, v43
    v_cvt_pk_bf16_f32 v42, v44, v45
    v_cvt_pk_bf16_f32 v43, v46, v47
    buffer_store_dwordx4 v[40:43], v3, s[16:19], s64 offen offset:0 sc1
    ds_write_b128 v233, v[40:43] offset:1024
    v_pk_fma_f32 v[64:65], v[128:129], v[164:165], v[64:65] neg_lo:[1,0,0] neg_hi:[1,0,0]
    v_pk_fma_f32 v[66:67], v[130:131], v[164:165], v[66:67] neg_lo:[1,0,0] neg_hi:[1,0,0]
    v_pk_fma_f32 v[68:69], v[132:133], v[164:165], v[68:69] neg_lo:[1,0,0] neg_hi:[1,0,0]
    v_pk_fma_f32 v[70:71], v[134:135], v[164:165], v[70:71] neg_lo:[1,0,0] neg_hi:[1,0,0]
    v_pk_fma_f32 v[64:65], v[64:65], v[172:173], v[176:177]
    v_pk_fma_f32 v[66:67], v[66:67], v[172:173], v[178:179]
    v_pk_fma_f32 v[68:69], v[68:69], v[172:173], v[180:181]
    v_pk_fma_f32 v[70:71], v[70:71], v[172:173], v[182:183]
    v_pk_mul_f32 v[208:209], v[64:65], v[8:9]
    v_pk_mul_f32 v[210:211], v[66:67], v[8:9]
    v_pk_mul_f32 v[212:213], v[68:69], v[8:9]
    v_pk_mul_f32 v[214:215], v[70:71], v[8:9]
    v_exp_f32 v208, v208
    v_exp_f32 v209, v209
    v_exp_f32 v210, v210
    v_exp_f32 v211, v211
    v_exp_f32 v212, v212
    v_exp_f32 v213, v213
    v_exp_f32 v214, v214
    v_exp_f32 v215, v215
    v_pk_add_f32 v[208:209], v[208:209], 1.0 op_sel_hi:[1,0]
    v_pk_add_f32 v[210:211], v[210:211], 1.0 op_sel_hi:[1,0]
    v_pk_add_f32 v[212:213], v[212:213], 1.0 op_sel_hi:[1,0]
    v_pk_add_f32 v[214:215], v[214:215], 1.0 op_sel_hi:[1,0]
    v_pk_fma_f32 v[208:209], v[208:209], v[208:209], 1.0 op_sel_hi:[1,1,0]
    v_pk_fma_f32 v[210:211], v[210:211], v[210:211], 1.0 op_sel_hi:[1,1,0]
    v_pk_fma_f32 v[212:213], v[212:213], v[212:213], 1.0 op_sel_hi:[1,1,0]
    v_pk_fma_f32 v[214:215], v[214:215], v[214:215], 1.0 op_sel_hi:[1,1,0]
    v_rcp_f32 v208, v208
    v_rcp_f32 v209, v209
    v_rcp_f32 v210, v210
    v_rcp_f32 v211, v211
    v_rcp_f32 v212, v212
    v_rcp_f32 v213, v213
    v_rcp_f32 v214, v214
    v_rcp_f32 v215, v215
    v_pk_fma_f32 v[208:209], v[208:209], -2.0, 1.0 op_sel_hi:[1,0,0]
    v_pk_fma_f32 v[210:211], v[210:211], -2.0, 1.0 op_sel_hi:[1,0,0]
    v_pk_fma_f32 v[212:213], v[212:213], -2.0, 1.0 op_sel_hi:[1,0,0]
    v_pk_fma_f32 v[214:215], v[214:215], -2.0, 1.0 op_sel_hi:[1,0,0]
    v_pk_mul_f32 v[64:65], v[64:65], v[208:209]
    v_pk_mul_f32 v[66:67], v[66:67], v[210:211]
    v_pk_mul_f32 v[68:69], v[68:69], v[212:213]
    v_pk_mul_f32 v[70:71], v[70:71], v[214:215]
    v_cvt_pk_bf16_f32 v64, v64, v65
    v_cvt_pk_bf16_f32 v65, v66, v67
    v_cvt_pk_bf16_f32 v66, v68, v69
    v_cvt_pk_bf16_f32 v67, v70, v71
    buffer_store_dwordx4 v[64:67], v3, s[16:19], s99 offen offset:0 sc1
    ds_write_b128 v234, v[64:67] offset:0
    v_pk_fma_f32 v[88:89], v[128:129], v[166:167], v[88:89] neg_lo:[1,0,0] neg_hi:[1,0,0]
    v_pk_fma_f32 v[90:91], v[130:131], v[166:167], v[90:91] neg_lo:[1,0,0] neg_hi:[1,0,0]
    v_pk_fma_f32 v[92:93], v[132:133], v[166:167], v[92:93] neg_lo:[1,0,0] neg_hi:[1,0,0]
    v_pk_fma_f32 v[94:95], v[134:135], v[166:167], v[94:95] neg_lo:[1,0,0] neg_hi:[1,0,0]
    v_pk_fma_f32 v[88:89], v[88:89], v[174:175], v[176:177]
    v_pk_fma_f32 v[90:91], v[90:91], v[174:175], v[178:179]
    v_pk_fma_f32 v[92:93], v[92:93], v[174:175], v[180:181]
    v_pk_fma_f32 v[94:95], v[94:95], v[174:175], v[182:183]
    v_pk_mul_f32 v[208:209], v[88:89], v[8:9]
    v_pk_mul_f32 v[210:211], v[90:91], v[8:9]
    v_pk_mul_f32 v[212:213], v[92:93], v[8:9]
    v_pk_mul_f32 v[214:215], v[94:95], v[8:9]
    v_exp_f32 v208, v208
    v_exp_f32 v209, v209
    v_exp_f32 v210, v210
    v_exp_f32 v211, v211
    v_exp_f32 v212, v212
    v_exp_f32 v213, v213
    v_exp_f32 v214, v214
    v_exp_f32 v215, v215
    v_pk_add_f32 v[208:209], v[208:209], 1.0 op_sel_hi:[1,0]
    v_pk_add_f32 v[210:211], v[210:211], 1.0 op_sel_hi:[1,0]
    v_pk_add_f32 v[212:213], v[212:213], 1.0 op_sel_hi:[1,0]
    v_pk_add_f32 v[214:215], v[214:215], 1.0 op_sel_hi:[1,0]
    v_pk_fma_f32 v[208:209], v[208:209], v[208:209], 1.0 op_sel_hi:[1,1,0]
    v_pk_fma_f32 v[210:211], v[210:211], v[210:211], 1.0 op_sel_hi:[1,1,0]
    v_pk_fma_f32 v[212:213], v[212:213], v[212:213], 1.0 op_sel_hi:[1,1,0]
    v_pk_fma_f32 v[214:215], v[214:215], v[214:215], 1.0 op_sel_hi:[1,1,0]
    v_rcp_f32 v208, v208
    v_rcp_f32 v209, v209
    v_rcp_f32 v210, v210
    v_rcp_f32 v211, v211
    v_rcp_f32 v212, v212
    v_rcp_f32 v213, v213
    v_rcp_f32 v214, v214
    v_rcp_f32 v215, v215
    v_pk_fma_f32 v[208:209], v[208:209], -2.0, 1.0 op_sel_hi:[1,0,0]
    v_pk_fma_f32 v[210:211], v[210:211], -2.0, 1.0 op_sel_hi:[1,0,0]
    v_pk_fma_f32 v[212:213], v[212:213], -2.0, 1.0 op_sel_hi:[1,0,0]
    v_pk_fma_f32 v[214:215], v[214:215], -2.0, 1.0 op_sel_hi:[1,0,0]
    v_pk_mul_f32 v[88:89], v[88:89], v[208:209]
    v_pk_mul_f32 v[90:91], v[90:91], v[210:211]
    v_pk_mul_f32 v[92:93], v[92:93], v[212:213]
    v_pk_mul_f32 v[94:95], v[94:95], v[214:215]
    v_cvt_pk_bf16_f32 v88, v88, v89
    v_cvt_pk_bf16_f32 v89, v90, v91
    v_cvt_pk_bf16_f32 v90, v92, v93
    v_cvt_pk_bf16_f32 v91, v94, v95
    buffer_store_dwordx4 v[88:91], v3, s[16:19], s65 offen offset:0 sc1
    ds_write_b128 v234, v[88:91] offset:1024
    v_pk_fma_f32 v[24:25], v[136:137], v[160:161], v[24:25] neg_lo:[1,0,0] neg_hi:[1,0,0]
    v_pk_fma_f32 v[26:27], v[138:139], v[160:161], v[26:27] neg_lo:[1,0,0] neg_hi:[1,0,0]
    v_pk_fma_f32 v[28:29], v[140:141], v[160:161], v[28:29] neg_lo:[1,0,0] neg_hi:[1,0,0]
    v_pk_fma_f32 v[30:31], v[142:143], v[160:161], v[30:31] neg_lo:[1,0,0] neg_hi:[1,0,0]
    v_pk_fma_f32 v[24:25], v[24:25], v[168:169], v[184:185]
    v_pk_fma_f32 v[26:27], v[26:27], v[168:169], v[186:187]
    v_pk_fma_f32 v[28:29], v[28:29], v[168:169], v[188:189]
    v_pk_fma_f32 v[30:31], v[30:31], v[168:169], v[190:191]
    v_pk_mul_f32 v[208:209], v[24:25], v[8:9]
    v_pk_mul_f32 v[210:211], v[26:27], v[8:9]
    v_pk_mul_f32 v[212:213], v[28:29], v[8:9]
    v_pk_mul_f32 v[214:215], v[30:31], v[8:9]
    v_exp_f32 v208, v208
    v_exp_f32 v209, v209
    v_exp_f32 v210, v210
    v_exp_f32 v211, v211
    v_exp_f32 v212, v212
    v_exp_f32 v213, v213
    v_exp_f32 v214, v214
    v_exp_f32 v215, v215
    v_pk_add_f32 v[208:209], v[208:209], 1.0 op_sel_hi:[1,0]
    v_pk_add_f32 v[210:211], v[210:211], 1.0 op_sel_hi:[1,0]
    v_pk_add_f32 v[212:213], v[212:213], 1.0 op_sel_hi:[1,0]
    v_pk_add_f32 v[214:215], v[214:215], 1.0 op_sel_hi:[1,0]
    v_pk_fma_f32 v[208:209], v[208:209], v[208:209], 1.0 op_sel_hi:[1,1,0]
    v_pk_fma_f32 v[210:211], v[210:211], v[210:211], 1.0 op_sel_hi:[1,1,0]
    v_pk_fma_f32 v[212:213], v[212:213], v[212:213], 1.0 op_sel_hi:[1,1,0]
    v_pk_fma_f32 v[214:215], v[214:215], v[214:215], 1.0 op_sel_hi:[1,1,0]
    v_rcp_f32 v208, v208
    v_rcp_f32 v209, v209
    v_rcp_f32 v210, v210
    v_rcp_f32 v211, v211
    v_rcp_f32 v212, v212
    v_rcp_f32 v213, v213
    v_rcp_f32 v214, v214
    v_rcp_f32 v215, v215
    v_pk_fma_f32 v[208:209], v[208:209], -2.0, 1.0 op_sel_hi:[1,0,0]
    v_pk_fma_f32 v[210:211], v[210:211], -2.0, 1.0 op_sel_hi:[1,0,0]
    v_pk_fma_f32 v[212:213], v[212:213], -2.0, 1.0 op_sel_hi:[1,0,0]
    v_pk_fma_f32 v[214:215], v[214:215], -2.0, 1.0 op_sel_hi:[1,0,0]
    v_pk_mul_f32 v[24:25], v[24:25], v[208:209]
    v_pk_mul_f32 v[26:27], v[26:27], v[210:211]
    v_pk_mul_f32 v[28:29], v[28:29], v[212:213]
    v_pk_mul_f32 v[30:31], v[30:31], v[214:215]
    v_cvt_pk_bf16_f32 v24, v24, v25
    v_cvt_pk_bf16_f32 v25, v26, v27
    v_cvt_pk_bf16_f32 v26, v28, v29
    v_cvt_pk_bf16_f32 v27, v30, v31
    buffer_store_dwordx4 v[24:27], v3, s[16:19], s98 offen offset:1024 sc1
    ds_write_b128 v233, v[24:27] offset:8192
    v_pk_fma_f32 v[48:49], v[136:137], v[162:163], v[48:49] neg_lo:[1,0,0] neg_hi:[1,0,0]
    v_pk_fma_f32 v[50:51], v[138:139], v[162:163], v[50:51] neg_lo:[1,0,0] neg_hi:[1,0,0]
    v_pk_fma_f32 v[52:53], v[140:141], v[162:163], v[52:53] neg_lo:[1,0,0] neg_hi:[1,0,0]
    v_pk_fma_f32 v[54:55], v[142:143], v[162:163], v[54:55] neg_lo:[1,0,0] neg_hi:[1,0,0]
    v_pk_fma_f32 v[48:49], v[48:49], v[170:171], v[184:185]
    v_pk_fma_f32 v[50:51], v[50:51], v[170:171], v[186:187]
    v_pk_fma_f32 v[52:53], v[52:53], v[170:171], v[188:189]
    v_pk_fma_f32 v[54:55], v[54:55], v[170:171], v[190:191]
    v_pk_mul_f32 v[208:209], v[48:49], v[8:9]
    v_pk_mul_f32 v[210:211], v[50:51], v[8:9]
    v_pk_mul_f32 v[212:213], v[52:53], v[8:9]
    v_pk_mul_f32 v[214:215], v[54:55], v[8:9]
    v_exp_f32 v208, v208
    v_exp_f32 v209, v209
    v_exp_f32 v210, v210
    v_exp_f32 v211, v211
    v_exp_f32 v212, v212
    v_exp_f32 v213, v213
    v_exp_f32 v214, v214
    v_exp_f32 v215, v215
    v_pk_add_f32 v[208:209], v[208:209], 1.0 op_sel_hi:[1,0]
    v_pk_add_f32 v[210:211], v[210:211], 1.0 op_sel_hi:[1,0]
    v_pk_add_f32 v[212:213], v[212:213], 1.0 op_sel_hi:[1,0]
    v_pk_add_f32 v[214:215], v[214:215], 1.0 op_sel_hi:[1,0]
    v_pk_fma_f32 v[208:209], v[208:209], v[208:209], 1.0 op_sel_hi:[1,1,0]
    v_pk_fma_f32 v[210:211], v[210:211], v[210:211], 1.0 op_sel_hi:[1,1,0]
    v_pk_fma_f32 v[212:213], v[212:213], v[212:213], 1.0 op_sel_hi:[1,1,0]
    v_pk_fma_f32 v[214:215], v[214:215], v[214:215], 1.0 op_sel_hi:[1,1,0]
    v_rcp_f32 v208, v208
    v_rcp_f32 v209, v209
    v_rcp_f32 v210, v210
    v_rcp_f32 v211, v211
    v_rcp_f32 v212, v212
    v_rcp_f32 v213, v213
    v_rcp_f32 v214, v214
    v_rcp_f32 v215, v215
    v_pk_fma_f32 v[208:209], v[208:209], -2.0, 1.0 op_sel_hi:[1,0,0]
    v_pk_fma_f32 v[210:211], v[210:211], -2.0, 1.0 op_sel_hi:[1,0,0]
    v_pk_fma_f32 v[212:213], v[212:213], -2.0, 1.0 op_sel_hi:[1,0,0]
    v_pk_fma_f32 v[214:215], v[214:215], -2.0, 1.0 op_sel_hi:[1,0,0]
    v_pk_mul_f32 v[48:49], v[48:49], v[208:209]
    v_pk_mul_f32 v[50:51], v[50:51], v[210:211]
    v_pk_mul_f32 v[52:53], v[52:53], v[212:213]
    v_pk_mul_f32 v[54:55], v[54:55], v[214:215]
    v_cvt_pk_bf16_f32 v48, v48, v49
    v_cvt_pk_bf16_f32 v49, v50, v51
    v_cvt_pk_bf16_f32 v50, v52, v53
    v_cvt_pk_bf16_f32 v51, v54, v55
    buffer_store_dwordx4 v[48:51], v3, s[16:19], s64 offen offset:1024 sc1
    ds_write_b128 v233, v[48:51] offset:9216
    v_pk_fma_f32 v[72:73], v[136:137], v[164:165], v[72:73] neg_lo:[1,0,0] neg_hi:[1,0,0]
    v_pk_fma_f32 v[74:75], v[138:139], v[164:165], v[74:75] neg_lo:[1,0,0] neg_hi:[1,0,0]
    v_pk_fma_f32 v[76:77], v[140:141], v[164:165], v[76:77] neg_lo:[1,0,0] neg_hi:[1,0,0]
    v_pk_fma_f32 v[78:79], v[142:143], v[164:165], v[78:79] neg_lo:[1,0,0] neg_hi:[1,0,0]
    v_pk_fma_f32 v[72:73], v[72:73], v[172:173], v[184:185]
    v_pk_fma_f32 v[74:75], v[74:75], v[172:173], v[186:187]
    v_pk_fma_f32 v[76:77], v[76:77], v[172:173], v[188:189]
    v_pk_fma_f32 v[78:79], v[78:79], v[172:173], v[190:191]
    v_pk_mul_f32 v[208:209], v[72:73], v[8:9]
    v_pk_mul_f32 v[210:211], v[74:75], v[8:9]
    v_pk_mul_f32 v[212:213], v[76:77], v[8:9]
    v_pk_mul_f32 v[214:215], v[78:79], v[8:9]
    v_exp_f32 v208, v208
    v_exp_f32 v209, v209
    v_exp_f32 v210, v210
    v_exp_f32 v211, v211
    v_exp_f32 v212, v212
    v_exp_f32 v213, v213
    v_exp_f32 v214, v214
    v_exp_f32 v215, v215
    v_pk_add_f32 v[208:209], v[208:209], 1.0 op_sel_hi:[1,0]
    v_pk_add_f32 v[210:211], v[210:211], 1.0 op_sel_hi:[1,0]
    v_pk_add_f32 v[212:213], v[212:213], 1.0 op_sel_hi:[1,0]
    v_pk_add_f32 v[214:215], v[214:215], 1.0 op_sel_hi:[1,0]
    v_pk_fma_f32 v[208:209], v[208:209], v[208:209], 1.0 op_sel_hi:[1,1,0]
    v_pk_fma_f32 v[210:211], v[210:211], v[210:211], 1.0 op_sel_hi:[1,1,0]
    v_pk_fma_f32 v[212:213], v[212:213], v[212:213], 1.0 op_sel_hi:[1,1,0]
    v_pk_fma_f32 v[214:215], v[214:215], v[214:215], 1.0 op_sel_hi:[1,1,0]
    v_rcp_f32 v208, v208
    v_rcp_f32 v209, v209
    v_rcp_f32 v210, v210
    v_rcp_f32 v211, v211
    v_rcp_f32 v212, v212
    v_rcp_f32 v213, v213
    v_rcp_f32 v214, v214
    v_rcp_f32 v215, v215
    v_pk_fma_f32 v[208:209], v[208:209], -2.0, 1.0 op_sel_hi:[1,0,0]
    v_pk_fma_f32 v[210:211], v[210:211], -2.0, 1.0 op_sel_hi:[1,0,0]
    v_pk_fma_f32 v[212:213], v[212:213], -2.0, 1.0 op_sel_hi:[1,0,0]
    v_pk_fma_f32 v[214:215], v[214:215], -2.0, 1.0 op_sel_hi:[1,0,0]
    v_pk_mul_f32 v[72:73], v[72:73], v[208:209]
    v_pk_mul_f32 v[74:75], v[74:75], v[210:211]
    v_pk_mul_f32 v[76:77], v[76:77], v[212:213]
    v_pk_mul_f32 v[78:79], v[78:79], v[214:215]
    v_cvt_pk_bf16_f32 v72, v72, v73
    v_cvt_pk_bf16_f32 v73, v74, v75
    v_cvt_pk_bf16_f32 v74, v76, v77
    v_cvt_pk_bf16_f32 v75, v78, v79
    buffer_store_dwordx4 v[72:75], v3, s[16:19], s99 offen offset:1024 sc1
    ds_write_b128 v234, v[72:75] offset:8192
    v_pk_fma_f32 v[96:97], v[136:137], v[166:167], v[96:97] neg_lo:[1,0,0] neg_hi:[1,0,0]
    v_pk_fma_f32 v[98:99], v[138:139], v[166:167], v[98:99] neg_lo:[1,0,0] neg_hi:[1,0,0]
    v_pk_fma_f32 v[100:101], v[140:141], v[166:167], v[100:101] neg_lo:[1,0,0] neg_hi:[1,0,0]
    v_pk_fma_f32 v[102:103], v[142:143], v[166:167], v[102:103] neg_lo:[1,0,0] neg_hi:[1,0,0]
    v_pk_fma_f32 v[96:97], v[96:97], v[174:175], v[184:185]
    v_pk_fma_f32 v[98:99], v[98:99], v[174:175], v[186:187]
    v_pk_fma_f32 v[100:101], v[100:101], v[174:175], v[188:189]
    v_pk_fma_f32 v[102:103], v[102:103], v[174:175], v[190:191]
    v_pk_mul_f32 v[208:209], v[96:97], v[8:9]
    v_pk_mul_f32 v[210:211], v[98:99], v[8:9]
    v_pk_mul_f32 v[212:213], v[100:101], v[8:9]
    v_pk_mul_f32 v[214:215], v[102:103], v[8:9]
    v_exp_f32 v208, v208
    v_exp_f32 v209, v209
    v_exp_f32 v210, v210
    v_exp_f32 v211, v211
    v_exp_f32 v212, v212
    v_exp_f32 v213, v213
    v_exp_f32 v214, v214
    v_exp_f32 v215, v215
    v_pk_add_f32 v[208:209], v[208:209], 1.0 op_sel_hi:[1,0]
    v_pk_add_f32 v[210:211], v[210:211], 1.0 op_sel_hi:[1,0]
    v_pk_add_f32 v[212:213], v[212:213], 1.0 op_sel_hi:[1,0]
    v_pk_add_f32 v[214:215], v[214:215], 1.0 op_sel_hi:[1,0]
    v_pk_fma_f32 v[208:209], v[208:209], v[208:209], 1.0 op_sel_hi:[1,1,0]
    v_pk_fma_f32 v[210:211], v[210:211], v[210:211], 1.0 op_sel_hi:[1,1,0]
    v_pk_fma_f32 v[212:213], v[212:213], v[212:213], 1.0 op_sel_hi:[1,1,0]
    v_pk_fma_f32 v[214:215], v[214:215], v[214:215], 1.0 op_sel_hi:[1,1,0]
    v_rcp_f32 v208, v208
    v_rcp_f32 v209, v209
    v_rcp_f32 v210, v210
    v_rcp_f32 v211, v211
    v_rcp_f32 v212, v212
    v_rcp_f32 v213, v213
    v_rcp_f32 v214, v214
    v_rcp_f32 v215, v215
    v_pk_fma_f32 v[208:209], v[208:209], -2.0, 1.0 op_sel_hi:[1,0,0]
    v_pk_fma_f32 v[210:211], v[210:211], -2.0, 1.0 op_sel_hi:[1,0,0]
    v_pk_fma_f32 v[212:213], v[212:213], -2.0, 1.0 op_sel_hi:[1,0,0]
    v_pk_fma_f32 v[214:215], v[214:215], -2.0, 1.0 op_sel_hi:[1,0,0]
    v_pk_mul_f32 v[96:97], v[96:97], v[208:209]
    v_pk_mul_f32 v[98:99], v[98:99], v[210:211]
    v_pk_mul_f32 v[100:101], v[100:101], v[212:213]
    v_pk_mul_f32 v[102:103], v[102:103], v[214:215]
    v_cvt_pk_bf16_f32 v96, v96, v97
    v_cvt_pk_bf16_f32 v97, v98, v99
    v_cvt_pk_bf16_f32 v98, v100, v101
    v_cvt_pk_bf16_f32 v99, v102, v103
    buffer_store_dwordx4 v[96:99], v3, s[16:19], s65 offen offset:1024 sc1
    ds_write_b128 v234, v[96:99] offset:9216
    v_pk_fma_f32 v[32:33], v[144:145], v[160:161], v[32:33] neg_lo:[1,0,0] neg_hi:[1,0,0]
    v_pk_fma_f32 v[34:35], v[146:147], v[160:161], v[34:35] neg_lo:[1,0,0] neg_hi:[1,0,0]
    v_pk_fma_f32 v[36:37], v[148:149], v[160:161], v[36:37] neg_lo:[1,0,0] neg_hi:[1,0,0]
    v_pk_fma_f32 v[38:39], v[150:151], v[160:161], v[38:39] neg_lo:[1,0,0] neg_hi:[1,0,0]
    v_pk_fma_f32 v[32:33], v[32:33], v[168:169], v[192:193]
    v_pk_fma_f32 v[34:35], v[34:35], v[168:169], v[194:195]
    v_pk_fma_f32 v[36:37], v[36:37], v[168:169], v[196:197]
    v_pk_fma_f32 v[38:39], v[38:39], v[168:169], v[198:199]
    v_pk_mul_f32 v[208:209], v[32:33], v[8:9]
    v_pk_mul_f32 v[210:211], v[34:35], v[8:9]
    v_pk_mul_f32 v[212:213], v[36:37], v[8:9]
    v_pk_mul_f32 v[214:215], v[38:39], v[8:9]
    v_exp_f32 v208, v208
    v_exp_f32 v209, v209
    v_exp_f32 v210, v210
    v_exp_f32 v211, v211
    v_exp_f32 v212, v212
    v_exp_f32 v213, v213
    v_exp_f32 v214, v214
    v_exp_f32 v215, v215
    v_pk_add_f32 v[208:209], v[208:209], 1.0 op_sel_hi:[1,0]
    v_pk_add_f32 v[210:211], v[210:211], 1.0 op_sel_hi:[1,0]
    v_pk_add_f32 v[212:213], v[212:213], 1.0 op_sel_hi:[1,0]
    v_pk_add_f32 v[214:215], v[214:215], 1.0 op_sel_hi:[1,0]
    v_pk_fma_f32 v[208:209], v[208:209], v[208:209], 1.0 op_sel_hi:[1,1,0]
    v_pk_fma_f32 v[210:211], v[210:211], v[210:211], 1.0 op_sel_hi:[1,1,0]
    v_pk_fma_f32 v[212:213], v[212:213], v[212:213], 1.0 op_sel_hi:[1,1,0]
    v_pk_fma_f32 v[214:215], v[214:215], v[214:215], 1.0 op_sel_hi:[1,1,0]
    v_rcp_f32 v208, v208
    v_rcp_f32 v209, v209
    v_rcp_f32 v210, v210
    v_rcp_f32 v211, v211
    v_rcp_f32 v212, v212
    v_rcp_f32 v213, v213
    v_rcp_f32 v214, v214
    v_rcp_f32 v215, v215
    v_pk_fma_f32 v[208:209], v[208:209], -2.0, 1.0 op_sel_hi:[1,0,0]
    v_pk_fma_f32 v[210:211], v[210:211], -2.0, 1.0 op_sel_hi:[1,0,0]
    v_pk_fma_f32 v[212:213], v[212:213], -2.0, 1.0 op_sel_hi:[1,0,0]
    v_pk_fma_f32 v[214:215], v[214:215], -2.0, 1.0 op_sel_hi:[1,0,0]
    v_pk_mul_f32 v[32:33], v[32:33], v[208:209]
    v_pk_mul_f32 v[34:35], v[34:35], v[210:211]
    v_pk_mul_f32 v[36:37], v[36:37], v[212:213]
    v_pk_mul_f32 v[38:39], v[38:39], v[214:215]
    v_cvt_pk_bf16_f32 v32, v32, v33
    v_cvt_pk_bf16_f32 v33, v34, v35
    v_cvt_pk_bf16_f32 v34, v36, v37
    v_cvt_pk_bf16_f32 v35, v38, v39
    buffer_store_dwordx4 v[32:35], v3, s[16:19], s98 offen offset:2048 sc1
    ds_write_b128 v235, v[32:35] offset:0
    v_pk_fma_f32 v[56:57], v[144:145], v[162:163], v[56:57] neg_lo:[1,0,0] neg_hi:[1,0,0]
    v_pk_fma_f32 v[58:59], v[146:147], v[162:163], v[58:59] neg_lo:[1,0,0] neg_hi:[1,0,0]
    v_pk_fma_f32 v[60:61], v[148:149], v[162:163], v[60:61] neg_lo:[1,0,0] neg_hi:[1,0,0]
    v_pk_fma_f32 v[62:63], v[150:151], v[162:163], v[62:63] neg_lo:[1,0,0] neg_hi:[1,0,0]
    v_pk_fma_f32 v[56:57], v[56:57], v[170:171], v[192:193]
    v_pk_fma_f32 v[58:59], v[58:59], v[170:171], v[194:195]
    v_pk_fma_f32 v[60:61], v[60:61], v[170:171], v[196:197]
    v_pk_fma_f32 v[62:63], v[62:63], v[170:171], v[198:199]
    v_pk_mul_f32 v[208:209], v[56:57], v[8:9]
    v_pk_mul_f32 v[210:211], v[58:59], v[8:9]
    v_pk_mul_f32 v[212:213], v[60:61], v[8:9]
    v_pk_mul_f32 v[214:215], v[62:63], v[8:9]
    v_exp_f32 v208, v208
    v_exp_f32 v209, v209
    v_exp_f32 v210, v210
    v_exp_f32 v211, v211
    v_exp_f32 v212, v212
    v_exp_f32 v213, v213
    v_exp_f32 v214, v214
    v_exp_f32 v215, v215
    v_pk_add_f32 v[208:209], v[208:209], 1.0 op_sel_hi:[1,0]
    v_pk_add_f32 v[210:211], v[210:211], 1.0 op_sel_hi:[1,0]
    v_pk_add_f32 v[212:213], v[212:213], 1.0 op_sel_hi:[1,0]
    v_pk_add_f32 v[214:215], v[214:215], 1.0 op_sel_hi:[1,0]
    v_pk_fma_f32 v[208:209], v[208:209], v[208:209], 1.0 op_sel_hi:[1,1,0]
    v_pk_fma_f32 v[210:211], v[210:211], v[210:211], 1.0 op_sel_hi:[1,1,0]
    v_pk_fma_f32 v[212:213], v[212:213], v[212:213], 1.0 op_sel_hi:[1,1,0]
    v_pk_fma_f32 v[214:215], v[214:215], v[214:215], 1.0 op_sel_hi:[1,1,0]
    v_rcp_f32 v208, v208
    v_rcp_f32 v209, v209
    v_rcp_f32 v210, v210
    v_rcp_f32 v211, v211
    v_rcp_f32 v212, v212
    v_rcp_f32 v213, v213
    v_rcp_f32 v214, v214
    v_rcp_f32 v215, v215
    v_pk_fma_f32 v[208:209], v[208:209], -2.0, 1.0 op_sel_hi:[1,0,0]
    v_pk_fma_f32 v[210:211], v[210:211], -2.0, 1.0 op_sel_hi:[1,0,0]
    v_pk_fma_f32 v[212:213], v[212:213], -2.0, 1.0 op_sel_hi:[1,0,0]
    v_pk_fma_f32 v[214:215], v[214:215], -2.0, 1.0 op_sel_hi:[1,0,0]
    v_pk_mul_f32 v[56:57], v[56:57], v[208:209]
    v_pk_mul_f32 v[58:59], v[58:59], v[210:211]
    v_pk_mul_f32 v[60:61], v[60:61], v[212:213]
    v_pk_mul_f32 v[62:63], v[62:63], v[214:215]
    v_cvt_pk_bf16_f32 v56, v56, v57
    v_cvt_pk_bf16_f32 v57, v58, v59
    v_cvt_pk_bf16_f32 v58, v60, v61
    v_cvt_pk_bf16_f32 v59, v62, v63
    buffer_store_dwordx4 v[56:59], v3, s[16:19], s64 offen offset:2048 sc1
    ds_write_b128 v235, v[56:59] offset:1024
    v_mov_b32 v4, 0
    s_waitcnt vmcnt(2)
    s_mov_b64 exec, 1
    buffer_atomic_add v14, v4, s[16:19], s101 offen sc1
    s_mov_b64 exec, -1
    v_pk_fma_f32 v[80:81], v[144:145], v[164:165], v[80:81] neg_lo:[1,0,0] neg_hi:[1,0,0]
    v_pk_fma_f32 v[82:83], v[146:147], v[164:165], v[82:83] neg_lo:[1,0,0] neg_hi:[1,0,0]
    v_pk_fma_f32 v[84:85], v[148:149], v[164:165], v[84:85] neg_lo:[1,0,0] neg_hi:[1,0,0]
    v_pk_fma_f32 v[86:87], v[150:151], v[164:165], v[86:87] neg_lo:[1,0,0] neg_hi:[1,0,0]
    v_pk_fma_f32 v[80:81], v[80:81], v[172:173], v[192:193]
    v_pk_fma_f32 v[82:83], v[82:83], v[172:173], v[194:195]
    v_pk_fma_f32 v[84:85], v[84:85], v[172:173], v[196:197]
    v_pk_fma_f32 v[86:87], v[86:87], v[172:173], v[198:199]
    v_pk_mul_f32 v[208:209], v[80:81], v[8:9]
    v_pk_mul_f32 v[210:211], v[82:83], v[8:9]
    v_pk_mul_f32 v[212:213], v[84:85], v[8:9]
    v_pk_mul_f32 v[214:215], v[86:87], v[8:9]
    v_exp_f32 v208, v208
    v_exp_f32 v209, v209
    v_exp_f32 v210, v210
    v_exp_f32 v211, v211
    v_exp_f32 v212, v212
    v_exp_f32 v213, v213
    v_exp_f32 v214, v214
    v_exp_f32 v215, v215
    v_pk_add_f32 v[208:209], v[208:209], 1.0 op_sel_hi:[1,0]
    v_pk_add_f32 v[210:211], v[210:211], 1.0 op_sel_hi:[1,0]
    v_pk_add_f32 v[212:213], v[212:213], 1.0 op_sel_hi:[1,0]
    v_pk_add_f32 v[214:215], v[214:215], 1.0 op_sel_hi:[1,0]
    v_pk_fma_f32 v[208:209], v[208:209], v[208:209], 1.0 op_sel_hi:[1,1,0]
    v_pk_fma_f32 v[210:211], v[210:211], v[210:211], 1.0 op_sel_hi:[1,1,0]
    v_pk_fma_f32 v[212:213], v[212:213], v[212:213], 1.0 op_sel_hi:[1,1,0]
    v_pk_fma_f32 v[214:215], v[214:215], v[214:215], 1.0 op_sel_hi:[1,1,0]
    v_rcp_f32 v208, v208
    v_rcp_f32 v209, v209
    v_rcp_f32 v210, v210
    v_rcp_f32 v211, v211
    v_rcp_f32 v212, v212
    v_rcp_f32 v213, v213
    v_rcp_f32 v214, v214
    v_rcp_f32 v215, v215
    v_pk_fma_f32 v[208:209], v[208:209], -2.0, 1.0 op_sel_hi:[1,0,0]
    v_pk_fma_f32 v[210:211], v[210:211], -2.0, 1.0 op_sel_hi:[1,0,0]
    v_pk_fma_f32 v[212:213], v[212:213], -2.0, 1.0 op_sel_hi:[1,0,0]
    v_pk_fma_f32 v[214:215], v[214:215], -2.0, 1.0 op_sel_hi:[1,0,0]
    v_pk_mul_f32 v[80:81], v[80:81], v[208:209]
    v_pk_mul_f32 v[82:83], v[82:83], v[210:211]
    v_pk_mul_f32 v[84:85], v[84:85], v[212:213]
    v_pk_mul_f32 v[86:87], v[86:87], v[214:215]
    v_cvt_pk_bf16_f32 v80, v80, v81
    v_cvt_pk_bf16_f32 v81, v82, v83
    v_cvt_pk_bf16_f32 v82, v84, v85
    v_cvt_pk_bf16_f32 v83, v86, v87
    buffer_store_dwordx4 v[80:83], v3, s[16:19], s99 offen offset:2048 sc1
    ds_write_b128 v236, v[80:83] offset:0
    v_pk_fma_f32 v[104:105], v[144:145], v[166:167], v[104:105] neg_lo:[1,0,0] neg_hi:[1,0,0]
    v_pk_fma_f32 v[106:107], v[146:147], v[166:167], v[106:107] neg_lo:[1,0,0] neg_hi:[1,0,0]
    v_pk_fma_f32 v[108:109], v[148:149], v[166:167], v[108:109] neg_lo:[1,0,0] neg_hi:[1,0,0]
    v_pk_fma_f32 v[110:111], v[150:151], v[166:167], v[110:111] neg_lo:[1,0,0] neg_hi:[1,0,0]
    v_pk_fma_f32 v[104:105], v[104:105], v[174:175], v[192:193]
    v_pk_fma_f32 v[106:107], v[106:107], v[174:175], v[194:195]
    v_pk_fma_f32 v[108:109], v[108:109], v[174:175], v[196:197]
    v_pk_fma_f32 v[110:111], v[110:111], v[174:175], v[198:199]
    v_pk_mul_f32 v[208:209], v[104:105], v[8:9]
    v_pk_mul_f32 v[210:211], v[106:107], v[8:9]
    v_pk_mul_f32 v[212:213], v[108:109], v[8:9]
    v_pk_mul_f32 v[214:215], v[110:111], v[8:9]
    v_exp_f32 v208, v208
    v_exp_f32 v209, v209
    v_exp_f32 v210, v210
    v_exp_f32 v211, v211
    v_exp_f32 v212, v212
    v_exp_f32 v213, v213
    v_exp_f32 v214, v214
    v_exp_f32 v215, v215
    v_pk_add_f32 v[208:209], v[208:209], 1.0 op_sel_hi:[1,0]
    v_pk_add_f32 v[210:211], v[210:211], 1.0 op_sel_hi:[1,0]
    v_pk_add_f32 v[212:213], v[212:213], 1.0 op_sel_hi:[1,0]
    v_pk_add_f32 v[214:215], v[214:215], 1.0 op_sel_hi:[1,0]
    v_pk_fma_f32 v[208:209], v[208:209], v[208:209], 1.0 op_sel_hi:[1,1,0]
    v_pk_fma_f32 v[210:211], v[210:211], v[210:211], 1.0 op_sel_hi:[1,1,0]
    v_pk_fma_f32 v[212:213], v[212:213], v[212:213], 1.0 op_sel_hi:[1,1,0]
    v_pk_fma_f32 v[214:215], v[214:215], v[214:215], 1.0 op_sel_hi:[1,1,0]
    v_rcp_f32 v208, v208
    v_rcp_f32 v209, v209
    v_rcp_f32 v210, v210
    v_rcp_f32 v211, v211
    v_rcp_f32 v212, v212
    v_rcp_f32 v213, v213
    v_rcp_f32 v214, v214
    v_rcp_f32 v215, v215
    v_pk_fma_f32 v[208:209], v[208:209], -2.0, 1.0 op_sel_hi:[1,0,0]
    v_pk_fma_f32 v[210:211], v[210:211], -2.0, 1.0 op_sel_hi:[1,0,0]
    v_pk_fma_f32 v[212:213], v[212:213], -2.0, 1.0 op_sel_hi:[1,0,0]
    v_pk_fma_f32 v[214:215], v[214:215], -2.0, 1.0 op_sel_hi:[1,0,0]
    v_pk_mul_f32 v[104:105], v[104:105], v[208:209]
    v_pk_mul_f32 v[106:107], v[106:107], v[210:211]
    v_pk_mul_f32 v[108:109], v[108:109], v[212:213]
    v_pk_mul_f32 v[110:111], v[110:111], v[214:215]
    v_cvt_pk_bf16_f32 v104, v104, v105
    v_cvt_pk_bf16_f32 v105, v106, v107
    v_cvt_pk_bf16_f32 v106, v108, v109
    v_cvt_pk_bf16_f32 v107, v110, v111
    buffer_store_dwordx4 v[104:107], v3, s[16:19], s65 offen offset:2048 sc1
    ds_write_b128 v236, v[104:107] offset:1024
    v_pk_fma_f32 v[112:113], v[152:153], v[160:161], v[112:113] neg_lo:[1,0,0] neg_hi:[1,0,0]
    v_pk_fma_f32 v[114:115], v[154:155], v[160:161], v[114:115] neg_lo:[1,0,0] neg_hi:[1,0,0]
    v_pk_fma_f32 v[116:117], v[156:157], v[160:161], v[116:117] neg_lo:[1,0,0] neg_hi:[1,0,0]
    v_pk_fma_f32 v[118:119], v[158:159], v[160:161], v[118:119] neg_lo:[1,0,0] neg_hi:[1,0,0]
    v_pk_fma_f32 v[112:113], v[112:113], v[168:169], v[200:201]
    v_pk_fma_f32 v[114:115], v[114:115], v[168:169], v[202:203]
    v_pk_fma_f32 v[116:117], v[116:117], v[168:169], v[204:205]
    v_pk_fma_f32 v[118:119], v[118:119], v[168:169], v[206:207]
    v_pk_mul_f32 v[208:209], v[112:113], v[8:9]
    v_pk_mul_f32 v[210:211], v[114:115], v[8:9]
    v_pk_mul_f32 v[212:213], v[116:117], v[8:9]
    v_pk_mul_f32 v[214:215], v[118:119], v[8:9]
    v_exp_f32 v208, v208
    v_exp_f32 v209, v209
    v_exp_f32 v210, v210
    v_exp_f32 v211, v211
    v_exp_f32 v212, v212
    v_exp_f32 v213, v213
    v_exp_f32 v214, v214
    v_exp_f32 v215, v215
    v_pk_add_f32 v[208:209], v[208:209], 1.0 op_sel_hi:[1,0]
    v_pk_add_f32 v[210:211], v[210:211], 1.0 op_sel_hi:[1,0]
    v_pk_add_f32 v[212:213], v[212:213], 1.0 op_sel_hi:[1,0]
    v_pk_add_f32 v[214:215], v[214:215], 1.0 op_sel_hi:[1,0]
    v_pk_fma_f32 v[208:209], v[208:209], v[208:209], 1.0 op_sel_hi:[1,1,0]
    v_pk_fma_f32 v[210:211], v[210:211], v[210:211], 1.0 op_sel_hi:[1,1,0]
    v_pk_fma_f32 v[212:213], v[212:213], v[212:213], 1.0 op_sel_hi:[1,1,0]
    v_pk_fma_f32 v[214:215], v[214:215], v[214:215], 1.0 op_sel_hi:[1,1,0]
    v_rcp_f32 v208, v208
    v_rcp_f32 v209, v209
    v_rcp_f32 v210, v210
    v_rcp_f32 v211, v211
    v_rcp_f32 v212, v212
    v_rcp_f32 v213, v213
    v_rcp_f32 v214, v214
    v_rcp_f32 v215, v215
    v_pk_fma_f32 v[208:209], v[208:209], -2.0, 1.0 op_sel_hi:[1,0,0]
    v_pk_fma_f32 v[210:211], v[210:211], -2.0, 1.0 op_sel_hi:[1,0,0]
    v_pk_fma_f32 v[212:213], v[212:213], -2.0, 1.0 op_sel_hi:[1,0,0]
    v_pk_fma_f32 v[214:215], v[214:215], -2.0, 1.0 op_sel_hi:[1,0,0]
    v_pk_mul_f32 v[112:113], v[112:113], v[208:209]
    v_pk_mul_f32 v[114:115], v[114:115], v[210:211]
    v_pk_mul_f32 v[116:117], v[116:117], v[212:213]
    v_pk_mul_f32 v[118:119], v[118:119], v[214:215]
    v_cvt_pk_bf16_f32 v112, v112, v113
    v_cvt_pk_bf16_f32 v113, v114, v115
    v_cvt_pk_bf16_f32 v114, v116, v117
    v_cvt_pk_bf16_f32 v115, v118, v119
    buffer_store_dwordx4 v[112:115], v3, s[16:19], s100 offen offset:0 sc1
    ds_write_b128 v232, v[112:115] offset:8192
    v_pk_fma_f32 v[120:121], v[152:153], v[162:163], v[120:121] neg_lo:[1,0,0] neg_hi:[1,0,0]
    v_pk_fma_f32 v[122:123], v[154:155], v[162:163], v[122:123] neg_lo:[1,0,0] neg_hi:[1,0,0]
    v_pk_fma_f32 v[124:125], v[156:157], v[162:163], v[124:125] neg_lo:[1,0,0] neg_hi:[1,0,0]
    v_pk_fma_f32 v[126:127], v[158:159], v[162:163], v[126:127] neg_lo:[1,0,0] neg_hi:[1,0,0]
    v_pk_fma_f32 v[120:121], v[120:121], v[170:171], v[200:201]
    v_pk_fma_f32 v[122:123], v[122:123], v[170:171], v[202:203]
    v_pk_fma_f32 v[124:125], v[124:125], v[170:171], v[204:205]
    v_pk_fma_f32 v[126:127], v[126:127], v[170:171], v[206:207]
    v_pk_mul_f32 v[208:209], v[120:121], v[8:9]
    v_pk_mul_f32 v[210:211], v[122:123], v[8:9]
    v_pk_mul_f32 v[212:213], v[124:125], v[8:9]
    v_pk_mul_f32 v[214:215], v[126:127], v[8:9]
    v_exp_f32 v208, v208
    v_exp_f32 v209, v209
    v_exp_f32 v210, v210
    v_exp_f32 v211, v211
    v_exp_f32 v212, v212
    v_exp_f32 v213, v213
    v_exp_f32 v214, v214
    v_exp_f32 v215, v215
    v_pk_add_f32 v[208:209], v[208:209], 1.0 op_sel_hi:[1,0]
    v_pk_add_f32 v[210:211], v[210:211], 1.0 op_sel_hi:[1,0]
    v_pk_add_f32 v[212:213], v[212:213], 1.0 op_sel_hi:[1,0]
    v_pk_add_f32 v[214:215], v[214:215], 1.0 op_sel_hi:[1,0]
    v_pk_fma_f32 v[208:209], v[208:209], v[208:209], 1.0 op_sel_hi:[1,1,0]
    v_pk_fma_f32 v[210:211], v[210:211], v[210:211], 1.0 op_sel_hi:[1,1,0]
    v_pk_fma_f32 v[212:213], v[212:213], v[212:213], 1.0 op_sel_hi:[1,1,0]
    v_pk_fma_f32 v[214:215], v[214:215], v[214:215], 1.0 op_sel_hi:[1,1,0]
    v_rcp_f32 v208, v208
    v_rcp_f32 v209, v209
    v_rcp_f32 v210, v210
    v_rcp_f32 v211, v211
    v_rcp_f32 v212, v212
    v_rcp_f32 v213, v213
    v_rcp_f32 v214, v214
    v_rcp_f32 v215, v215
    v_pk_fma_f32 v[208:209], v[208:209], -2.0, 1.0 op_sel_hi:[1,0,0]
    v_pk_fma_f32 v[210:211], v[210:211], -2.0, 1.0 op_sel_hi:[1,0,0]
    v_pk_fma_f32 v[212:213], v[212:213], -2.0, 1.0 op_sel_hi:[1,0,0]
    v_pk_fma_f32 v[214:215], v[214:215], -2.0, 1.0 op_sel_hi:[1,0,0]
    v_pk_mul_f32 v[120:121], v[120:121], v[208:209]
    v_pk_mul_f32 v[122:123], v[122:123], v[210:211]
    v_pk_mul_f32 v[124:125], v[124:125], v[212:213]
    v_pk_mul_f32 v[126:127], v[126:127], v[214:215]
    v_cvt_pk_bf16_f32 v120, v120, v121
    v_cvt_pk_bf16_f32 v121, v122, v123
    v_cvt_pk_bf16_f32 v122, v124, v125
    v_cvt_pk_bf16_f32 v123, v126, v127
    buffer_store_dwordx4 v[120:123], v3, s[16:19], s66 offen offset:0 sc1
    ds_write_b128 v232, v[120:123] offset:9216
    s_waitcnt lgkmcnt(0)
    v_mov_b32 v4, 163796
    v_mov_b32 v5, 1
    s_mov_b64 exec, 1
    ds_add_u32 v4, v5
    s_mov_b64 exec, -1
    s_and_b32 s50, s2, 1
    s_and_b32 s53, s59, 7
    s_lshl_b32 s46, s40, 10
    v_add_u32 v240, s46, v3
    v_bfe_u32 v6, v2, 2, 2
    v_and_b32 v7, 3, v2
    v_lshl_add_u32 v8, v13, 2, v6
    v_and_b32 v9, 7, v8
    v_lshlrev_b32 v8, 8, v8
    v_lshl_add_u32 v8, v7, 3, v8
    v_add_u32 v8, 16384, v8
    s_lshl_b32 s46, s41, 1
    v_xor_b32 v9, s46, v9
    v_lshl_add_u32 v241, v9, 5, v8
    v_xor_b32 v242, 32, v241
    v_xor_b32 v243, 128, v241
    v_xor_b32 v244, 160, v241
    s_mov_b32 s62, 98304
    s_mov_b32 s63, 3
    s_lshl_b32 s47, s3, 8
    s_add_u32 s47, s47, 8
    v_add_u32 v224, s62, v240
    v_add_u32 v225, s62, v241
    v_add_u32 v226, s62, v242
    v_add_u32 v227, s62, v243
    v_add_u32 v228, s62, v244
parallel_sum__spectral_gfnet__dense_activation_mish__prompt_kernel_ca:
    ds_read_b32 v5, v4
    s_waitcnt lgkmcnt(0)
    v_readfirstlane_b32 s43, v5
    s_cmp_lt_u32 s43, 4
    s_cbranch_scc1 parallel_sum__spectral_gfnet__dense_activation_mish__prompt_kernel_ca
    v_mov_b32 v4, 163776
    v_mov_b32 v254, 163784
parallel_sum__spectral_gfnet__dense_activation_mish__prompt_kernel_cb:
    ds_read_b32 v5, v4
    s_waitcnt lgkmcnt(0)
    v_readfirstlane_b32 s43, v5
    s_cmp_lt_u32 s43, 2
    s_cbranch_scc1 parallel_sum__spectral_gfnet__dense_activation_mish__prompt_kernel_cb
    ds_read_b128 v[112:115], v224 offset:0
    ds_read_b64_tr_b16 v[128:129], v225 offset:0
    ds_read_b64_tr_b16 v[130:131], v225 offset:4096
    ds_read_b128 v[116:119], v224 offset:2048
    ds_read_b64_tr_b16 v[132:133], v226 offset:0
    ds_read_b64_tr_b16 v[134:135], v226 offset:4096
    ds_read_b128 v[120:123], v224 offset:4096
    ds_read_b64_tr_b16 v[136:137], v227 offset:0
    ds_read_b64_tr_b16 v[138:139], v227 offset:4096
    ds_read_b128 v[124:127], v224 offset:6144
    ds_read_b64_tr_b16 v[140:141], v228 offset:0
    ds_read_b64_tr_b16 v[142:143], v228 offset:4096
    s_lshl_b32 s60, s58, 6
    s_lshl_b32 s61, s50, 5
    s_add_u32 s60, s60, s61
    s_lshl_b32 s61, s40, 4
    s_add_u32 s60, s60, s61
    s_lshl_b32 s60, s60, 11
    s_lshl_b32 s61, s53, 7
    s_add_u32 s60, s60, s61
    s_lshl_b32 s61, s41, 6
    s_add_u32 s60, s60, s61
    s_add_u32 s61, s60, 2097152
    v_lshlrev_b32 v8, 11, v12
    v_and_b32 v9, 1, v13
    v_lshl_add_u32 v8, v9, 5, v8
    v_lshrrev_b32 v9, 1, v13
    v_lshl_add_u32 v247, v9, 4, v8
    v_lshl_add_u32 v8, v13, 3, v6
    v_lshlrev_b32 v8, 6, v8
    v_and_b32 v9, 1, v7
    v_lshlrev_b32 v9, 5, v9
    v_lshrrev_b32 v10, 1, v7
    v_lshl_add_u32 v9, v10, 3, v9
    s_lshl_b32 s46, s40, 4
    v_add_u32 v9, s46, v9
    v_and_b32 v10, 1, v13
    v_lshlrev_b32 v10, 4, v10
    v_xor_b32 v9, v9, v10
    v_add_u32 v245, v8, v9
    s_lshl_b32 s46, s41, 11
    s_add_u32 s46, s46, 16384
    v_add_u32 v246, s46, v3
    s_lshl_b32 s64, s2, 2
    s_add_u32 s64, s64, s3
    s_xor_b32 s65, s64, 4
    s_lshl_b32 s64, s64, 12
    s_lshl_b32 s65, s65, 12
    s_add_u32 s64, s64, 20971520
    s_add_u32 s65, s65, 20971520
    s_waitcnt lgkmcnt(0)
    v_mfma_f32_16x16x32_bf16 v[16:19], v[128:131], v[112:115], 0
    ds_read_b128 v[144:147], v224 offset:8192
    ds_read_b64_tr_b16 v[160:161], v225 offset:8192
    v_mfma_f32_16x16x32_bf16 v[20:23], v[132:135], v[112:115], 0
    ds_read_b64_tr_b16 v[162:163], v225 offset:12288
    ds_read_b128 v[148:151], v224 offset:10240
    v_mfma_f32_16x16x32_bf16 v[24:27], v[136:139], v[112:115], 0
    ds_read_b64_tr_b16 v[164:165], v226 offset:8192
    ds_read_b64_tr_b16 v[166:167], v226 offset:12288
    v_mfma_f32_16x16x32_bf16 v[28:31], v[140:143], v[112:115], 0
    ds_read_b128 v[152:155], v224 offset:12288
    ds_read_b64_tr_b16 v[168:169], v227 offset:8192
    v_mfma_f32_16x16x32_bf16 v[32:35], v[128:131], v[116:119], 0
    ds_read_b64_tr_b16 v[170:171], v227 offset:12288
    ds_read_b128 v[156:159], v224 offset:14336
    v_mfma_f32_16x16x32_bf16 v[36:39], v[132:135], v[116:119], 0
    ds_read_b64_tr_b16 v[172:173], v228 offset:8192
    ds_read_b64_tr_b16 v[174:175], v228 offset:12288
    v_mfma_f32_16x16x32_bf16 v[40:43], v[136:139], v[116:119], 0
    s_add_u32 s62, s62, 32768
    v_mfma_f32_16x16x32_bf16 v[44:47], v[140:143], v[116:119], 0
    s_and_b32 s62, s62, 131071
    v_mfma_f32_16x16x32_bf16 v[48:51], v[128:131], v[120:123], 0
    v_add_u32 v224, s62, v240
    v_mfma_f32_16x16x32_bf16 v[52:55], v[132:135], v[120:123], 0
    v_add_u32 v225, s62, v241
    v_mfma_f32_16x16x32_bf16 v[56:59], v[136:139], v[120:123], 0
    v_add_u32 v226, s62, v242
    v_mfma_f32_16x16x32_bf16 v[60:63], v[140:143], v[120:123], 0
    v_add_u32 v227, s62, v243
    v_mfma_f32_16x16x32_bf16 v[64:67], v[128:131], v[124:127], 0
    v_add_u32 v228, s62, v244
    v_mfma_f32_16x16x32_bf16 v[68:71], v[132:135], v[124:127], 0
    v_mfma_f32_16x16x32_bf16 v[72:75], v[136:139], v[124:127], 0
    v_mfma_f32_16x16x32_bf16 v[76:79], v[140:143], v[124:127], 0
    s_waitcnt lgkmcnt(0)
    s_mov_b64 exec, 1
    ds_add_u32 v254, v14 offset:0
    s_mov_b64 exec, -1
    v_mfma_f32_16x16x32_bf16 v[16:19], v[160:163], v[144:147], v[16:19]
    ds_read_b128 v[112:115], v224 offset:0
    v_mfma_f32_16x16x32_bf16 v[20:23], v[164:167], v[144:147], v[20:23]
    ds_read_b64_tr_b16 v[128:129], v225 offset:0
    v_mfma_f32_16x16x32_bf16 v[24:27], v[168:171], v[144:147], v[24:27]
    ds_read_b64_tr_b16 v[130:131], v225 offset:4096
    v_mfma_f32_16x16x32_bf16 v[28:31], v[172:175], v[144:147], v[28:31]
    ds_read_b128 v[116:119], v224 offset:2048
    v_mfma_f32_16x16x32_bf16 v[32:35], v[160:163], v[148:151], v[32:35]
    ds_read_b64_tr_b16 v[132:133], v226 offset:0
    v_mfma_f32_16x16x32_bf16 v[36:39], v[164:167], v[148:151], v[36:39]
    ds_read_b64_tr_b16 v[134:135], v226 offset:4096
    v_mfma_f32_16x16x32_bf16 v[40:43], v[168:171], v[148:151], v[40:43]
    ds_read_b128 v[120:123], v224 offset:4096
    v_mfma_f32_16x16x32_bf16 v[44:47], v[172:175], v[148:151], v[44:47]
    ds_read_b64_tr_b16 v[136:137], v227 offset:0
    v_mfma_f32_16x16x32_bf16 v[48:51], v[160:163], v[152:155], v[48:51]
    ds_read_b64_tr_b16 v[138:139], v227 offset:4096
    v_mfma_f32_16x16x32_bf16 v[52:55], v[164:167], v[152:155], v[52:55]
    ds_read_b128 v[124:127], v224 offset:6144
    v_mfma_f32_16x16x32_bf16 v[56:59], v[168:171], v[152:155], v[56:59]
    ds_read_b64_tr_b16 v[140:141], v228 offset:0
    v_mfma_f32_16x16x32_bf16 v[60:63], v[172:175], v[152:155], v[60:63]
    ds_read_b64_tr_b16 v[142:143], v228 offset:4096
    v_mfma_f32_16x16x32_bf16 v[64:67], v[160:163], v[156:159], v[64:67]
    v_mfma_f32_16x16x32_bf16 v[68:71], v[164:167], v[156:159], v[68:71]
    v_mfma_f32_16x16x32_bf16 v[72:75], v[168:171], v[156:159], v[72:75]
    v_mfma_f32_16x16x32_bf16 v[76:79], v[172:175], v[156:159], v[76:79]
    s_waitcnt lgkmcnt(0)
    v_mfma_f32_16x16x32_bf16 v[16:19], v[128:131], v[112:115], v[16:19]
    ds_read_b128 v[144:147], v224 offset:8192
    ds_read_b64_tr_b16 v[160:161], v225 offset:8192
    v_mfma_f32_16x16x32_bf16 v[20:23], v[132:135], v[112:115], v[20:23]
    ds_read_b64_tr_b16 v[162:163], v225 offset:12288
    ds_read_b128 v[148:151], v224 offset:10240
    v_mfma_f32_16x16x32_bf16 v[24:27], v[136:139], v[112:115], v[24:27]
    ds_read_b64_tr_b16 v[164:165], v226 offset:8192
    ds_read_b64_tr_b16 v[166:167], v226 offset:12288
    v_mfma_f32_16x16x32_bf16 v[28:31], v[140:143], v[112:115], v[28:31]
    ds_read_b128 v[152:155], v224 offset:12288
    ds_read_b64_tr_b16 v[168:169], v227 offset:8192
    v_mfma_f32_16x16x32_bf16 v[32:35], v[128:131], v[116:119], v[32:35]
    ds_read_b64_tr_b16 v[170:171], v227 offset:12288
    ds_read_b128 v[156:159], v224 offset:14336
    v_mfma_f32_16x16x32_bf16 v[36:39], v[132:135], v[116:119], v[36:39]
    ds_read_b64_tr_b16 v[172:173], v228 offset:8192
    ds_read_b64_tr_b16 v[174:175], v228 offset:12288
    v_mfma_f32_16x16x32_bf16 v[40:43], v[136:139], v[116:119], v[40:43]
    s_add_u32 s62, s62, 32768
    v_mfma_f32_16x16x32_bf16 v[44:47], v[140:143], v[116:119], v[44:47]
    s_and_b32 s62, s62, 131071
    v_mfma_f32_16x16x32_bf16 v[48:51], v[128:131], v[120:123], v[48:51]
    v_add_u32 v224, s62, v240
    v_mfma_f32_16x16x32_bf16 v[52:55], v[132:135], v[120:123], v[52:55]
    v_add_u32 v225, s62, v241
    v_mfma_f32_16x16x32_bf16 v[56:59], v[136:139], v[120:123], v[56:59]
    v_add_u32 v226, s62, v242
    v_mfma_f32_16x16x32_bf16 v[60:63], v[140:143], v[120:123], v[60:63]
    v_add_u32 v227, s62, v243
    v_mfma_f32_16x16x32_bf16 v[64:67], v[128:131], v[124:127], v[64:67]
    v_add_u32 v228, s62, v244
    v_mfma_f32_16x16x32_bf16 v[68:71], v[132:135], v[124:127], v[68:71]
    v_mfma_f32_16x16x32_bf16 v[72:75], v[136:139], v[124:127], v[72:75]
    v_mfma_f32_16x16x32_bf16 v[76:79], v[140:143], v[124:127], v[76:79]
    s_waitcnt lgkmcnt(0)
    s_mov_b64 exec, 1
    ds_add_u32 v254, v14 offset:4
    s_mov_b64 exec, -1
    v_mov_b32 v4, 163800
parallel_sum__spectral_gfnet__dense_activation_mish__prompt_kernel_cc:
    ds_read_b32 v5, v4
    s_waitcnt lgkmcnt(0)
    v_readfirstlane_b32 s43, v5
    s_cmp_lt_u32 s43, 2
    s_cbranch_scc1 parallel_sum__spectral_gfnet__dense_activation_mish__prompt_kernel_cc
    v_mfma_f32_16x16x32_bf16 v[16:19], v[160:163], v[144:147], v[16:19]
    ds_read_b128 v[112:115], v224 offset:0
    v_mfma_f32_16x16x32_bf16 v[20:23], v[164:167], v[144:147], v[20:23]
    ds_read_b64_tr_b16 v[128:129], v225 offset:0
    v_mfma_f32_16x16x32_bf16 v[24:27], v[168:171], v[144:147], v[24:27]
    ds_read_b64_tr_b16 v[130:131], v225 offset:4096
    v_mfma_f32_16x16x32_bf16 v[28:31], v[172:175], v[144:147], v[28:31]
    ds_read_b128 v[116:119], v224 offset:2048
    v_mfma_f32_16x16x32_bf16 v[32:35], v[160:163], v[148:151], v[32:35]
    ds_read_b64_tr_b16 v[132:133], v226 offset:0
    v_mfma_f32_16x16x32_bf16 v[36:39], v[164:167], v[148:151], v[36:39]
    ds_read_b64_tr_b16 v[134:135], v226 offset:4096
    v_mfma_f32_16x16x32_bf16 v[40:43], v[168:171], v[148:151], v[40:43]
    ds_read_b128 v[120:123], v224 offset:4096
    v_mfma_f32_16x16x32_bf16 v[44:47], v[172:175], v[148:151], v[44:47]
    ds_read_b64_tr_b16 v[136:137], v227 offset:0
    v_mfma_f32_16x16x32_bf16 v[48:51], v[160:163], v[152:155], v[48:51]
    ds_read_b64_tr_b16 v[138:139], v227 offset:4096
    v_mfma_f32_16x16x32_bf16 v[52:55], v[164:167], v[152:155], v[52:55]
    ds_read_b128 v[124:127], v224 offset:6144
    v_mfma_f32_16x16x32_bf16 v[56:59], v[168:171], v[152:155], v[56:59]
    ds_read_b64_tr_b16 v[140:141], v228 offset:0
    v_mfma_f32_16x16x32_bf16 v[60:63], v[172:175], v[152:155], v[60:63]
    ds_read_b64_tr_b16 v[142:143], v228 offset:4096
    v_mfma_f32_16x16x32_bf16 v[64:67], v[160:163], v[156:159], v[64:67]
    v_mfma_f32_16x16x32_bf16 v[68:71], v[164:167], v[156:159], v[68:71]
    v_mfma_f32_16x16x32_bf16 v[72:75], v[168:171], v[156:159], v[72:75]
    v_mfma_f32_16x16x32_bf16 v[76:79], v[172:175], v[156:159], v[76:79]
    s_waitcnt lgkmcnt(0)
    v_mfma_f32_16x16x32_bf16 v[16:19], v[128:131], v[112:115], v[16:19]
    ds_read_b128 v[144:147], v224 offset:8192
    ds_read_b64_tr_b16 v[160:161], v225 offset:8192
    v_mfma_f32_16x16x32_bf16 v[20:23], v[132:135], v[112:115], v[20:23]
    ds_read_b64_tr_b16 v[162:163], v225 offset:12288
    ds_read_b128 v[148:151], v224 offset:10240
    v_mfma_f32_16x16x32_bf16 v[24:27], v[136:139], v[112:115], v[24:27]
    ds_read_b64_tr_b16 v[164:165], v226 offset:8192
    ds_read_b64_tr_b16 v[166:167], v226 offset:12288
    v_mfma_f32_16x16x32_bf16 v[28:31], v[140:143], v[112:115], v[28:31]
    ds_read_b128 v[152:155], v224 offset:12288
    ds_read_b64_tr_b16 v[168:169], v227 offset:8192
    v_mfma_f32_16x16x32_bf16 v[32:35], v[128:131], v[116:119], v[32:35]
    ds_read_b64_tr_b16 v[170:171], v227 offset:12288
    ds_read_b128 v[156:159], v224 offset:14336
    v_mfma_f32_16x16x32_bf16 v[36:39], v[132:135], v[116:119], v[36:39]
    ds_read_b64_tr_b16 v[172:173], v228 offset:8192
    ds_read_b64_tr_b16 v[174:175], v228 offset:12288
    v_mfma_f32_16x16x32_bf16 v[40:43], v[136:139], v[116:119], v[40:43]
    s_add_u32 s62, s62, 32768
    v_mfma_f32_16x16x32_bf16 v[44:47], v[140:143], v[116:119], v[44:47]
    s_and_b32 s62, s62, 131071
    v_mfma_f32_16x16x32_bf16 v[48:51], v[128:131], v[120:123], v[48:51]
    v_add_u32 v224, s62, v240
    v_mfma_f32_16x16x32_bf16 v[52:55], v[132:135], v[120:123], v[52:55]
    v_add_u32 v225, s62, v241
    v_mfma_f32_16x16x32_bf16 v[56:59], v[136:139], v[120:123], v[56:59]
    v_add_u32 v226, s62, v242
    v_mfma_f32_16x16x32_bf16 v[60:63], v[140:143], v[120:123], v[60:63]
    v_add_u32 v227, s62, v243
    v_mfma_f32_16x16x32_bf16 v[64:67], v[128:131], v[124:127], v[64:67]
    v_add_u32 v228, s62, v244
    v_mfma_f32_16x16x32_bf16 v[68:71], v[132:135], v[124:127], v[68:71]
    v_mfma_f32_16x16x32_bf16 v[72:75], v[136:139], v[124:127], v[72:75]
    v_mfma_f32_16x16x32_bf16 v[76:79], v[140:143], v[124:127], v[76:79]
    v_mov_b32 v4, 0
    v_mov_b32 v5, 256
    s_waitcnt vmcnt(0)
    s_mov_b64 exec, 1
    buffer_atomic_add v5, v4, s[16:19], s101 offen sc1
    s_mov_b64 exec, -1
    s_waitcnt lgkmcnt(0)
    s_branch parallel_sum__spectral_gfnet__dense_activation_mish__prompt_kernel_dloop
parallel_sum__spectral_gfnet__dense_activation_mish__prompt_kernel_jook:
    s_mov_b64 exec, 1
    buffer_atomic_add v14, v15, s[28:31], 0 offen offset:8 sc1
    s_mov_b64 exec, -1
    s_branch parallel_sum__spectral_gfnet__dense_activation_mish__prompt_kernel_jack
parallel_sum__spectral_gfnet__dense_activation_mish__prompt_kernel_dloop:
    s_barrier
    s_cmp_eq_u32 s63, s47
    s_cbranch_scc1 parallel_sum__spectral_gfnet__dense_activation_mish__prompt_kernel_jook
parallel_sum__spectral_gfnet__dense_activation_mish__prompt_kernel_jack:
    v_mfma_f32_16x16x32_bf16 v[16:19], v[160:163], v[144:147], v[16:19]
    ds_read_b128 v[112:115], v224 offset:0
    v_mfma_f32_16x16x32_bf16 v[20:23], v[164:167], v[144:147], v[20:23]
    ds_read_b64_tr_b16 v[128:129], v225 offset:0
    v_mfma_f32_16x16x32_bf16 v[24:27], v[168:171], v[144:147], v[24:27]
    ds_read_b64_tr_b16 v[130:131], v225 offset:4096
    v_mfma_f32_16x16x32_bf16 v[28:31], v[172:175], v[144:147], v[28:31]
    ds_read_b128 v[116:119], v224 offset:2048
    v_mfma_f32_16x16x32_bf16 v[32:35], v[160:163], v[148:151], v[32:35]
    ds_read_b64_tr_b16 v[132:133], v226 offset:0
    v_mfma_f32_16x16x32_bf16 v[36:39], v[164:167], v[148:151], v[36:39]
    ds_read_b64_tr_b16 v[134:135], v226 offset:4096
    v_mfma_f32_16x16x32_bf16 v[40:43], v[168:171], v[148:151], v[40:43]
    ds_read_b128 v[120:123], v224 offset:4096
    v_mfma_f32_16x16x32_bf16 v[44:47], v[172:175], v[148:151], v[44:47]
    ds_read_b64_tr_b16 v[136:137], v227 offset:0
    v_mfma_f32_16x16x32_bf16 v[48:51], v[160:163], v[152:155], v[48:51]
    ds_read_b64_tr_b16 v[138:139], v227 offset:4096
    v_mfma_f32_16x16x32_bf16 v[52:55], v[164:167], v[152:155], v[52:55]
    ds_read_b128 v[124:127], v224 offset:6144
    v_mfma_f32_16x16x32_bf16 v[56:59], v[168:171], v[152:155], v[56:59]
    ds_read_b64_tr_b16 v[140:141], v228 offset:0
    v_mfma_f32_16x16x32_bf16 v[60:63], v[172:175], v[152:155], v[60:63]
    ds_read_b64_tr_b16 v[142:143], v228 offset:4096
    v_mfma_f32_16x16x32_bf16 v[64:67], v[160:163], v[156:159], v[64:67]
    v_mfma_f32_16x16x32_bf16 v[68:71], v[164:167], v[156:159], v[68:71]
    v_mfma_f32_16x16x32_bf16 v[72:75], v[168:171], v[156:159], v[72:75]
    v_mfma_f32_16x16x32_bf16 v[76:79], v[172:175], v[156:159], v[76:79]
    s_waitcnt lgkmcnt(0)
    v_mfma_f32_16x16x32_bf16 v[16:19], v[128:131], v[112:115], v[16:19]
    ds_read_b128 v[144:147], v224 offset:8192
    ds_read_b64_tr_b16 v[160:161], v225 offset:8192
    v_mfma_f32_16x16x32_bf16 v[20:23], v[132:135], v[112:115], v[20:23]
    ds_read_b64_tr_b16 v[162:163], v225 offset:12288
    ds_read_b128 v[148:151], v224 offset:10240
    v_mfma_f32_16x16x32_bf16 v[24:27], v[136:139], v[112:115], v[24:27]
    ds_read_b64_tr_b16 v[164:165], v226 offset:8192
    ds_read_b64_tr_b16 v[166:167], v226 offset:12288
    v_mfma_f32_16x16x32_bf16 v[28:31], v[140:143], v[112:115], v[28:31]
    ds_read_b128 v[152:155], v224 offset:12288
    ds_read_b64_tr_b16 v[168:169], v227 offset:8192
    v_mfma_f32_16x16x32_bf16 v[32:35], v[128:131], v[116:119], v[32:35]
    ds_read_b64_tr_b16 v[170:171], v227 offset:12288
    ds_read_b128 v[156:159], v224 offset:14336
    v_mfma_f32_16x16x32_bf16 v[36:39], v[132:135], v[116:119], v[36:39]
    ds_read_b64_tr_b16 v[172:173], v228 offset:8192
    ds_read_b64_tr_b16 v[174:175], v228 offset:12288
    v_mfma_f32_16x16x32_bf16 v[40:43], v[136:139], v[116:119], v[40:43]
    s_add_u32 s62, s62, 32768
    v_mfma_f32_16x16x32_bf16 v[44:47], v[140:143], v[116:119], v[44:47]
    s_and_b32 s62, s62, 131071
    v_mfma_f32_16x16x32_bf16 v[48:51], v[128:131], v[120:123], v[48:51]
    v_add_u32 v224, s62, v240
    v_mfma_f32_16x16x32_bf16 v[52:55], v[132:135], v[120:123], v[52:55]
    v_add_u32 v225, s62, v241
    v_mfma_f32_16x16x32_bf16 v[56:59], v[136:139], v[120:123], v[56:59]
    v_add_u32 v226, s62, v242
    v_mfma_f32_16x16x32_bf16 v[60:63], v[140:143], v[120:123], v[60:63]
    v_add_u32 v227, s62, v243
    v_mfma_f32_16x16x32_bf16 v[64:67], v[128:131], v[124:127], v[64:67]
    v_add_u32 v228, s62, v244
    v_mfma_f32_16x16x32_bf16 v[68:71], v[132:135], v[124:127], v[68:71]
    s_add_u32 s63, s63, 1
    v_mfma_f32_16x16x32_bf16 v[72:75], v[136:139], v[124:127], v[72:75]
    s_cmp_lt_u32 s63, 27
    v_mfma_f32_16x16x32_bf16 v[76:79], v[140:143], v[124:127], v[76:79]
    s_waitcnt lgkmcnt(0)
    s_cbranch_scc1 parallel_sum__spectral_gfnet__dense_activation_mish__prompt_kernel_dloop
    s_barrier
    v_mfma_f32_16x16x32_bf16 v[16:19], v[160:163], v[144:147], v[16:19]
    ds_read_b128 v[112:115], v224 offset:0
    v_mfma_f32_16x16x32_bf16 v[20:23], v[164:167], v[144:147], v[20:23]
    ds_read_b64_tr_b16 v[128:129], v225 offset:0
    v_mfma_f32_16x16x32_bf16 v[24:27], v[168:171], v[144:147], v[24:27]
    ds_read_b64_tr_b16 v[130:131], v225 offset:4096
    v_mfma_f32_16x16x32_bf16 v[28:31], v[172:175], v[144:147], v[28:31]
    ds_read_b128 v[116:119], v224 offset:2048
    v_mfma_f32_16x16x32_bf16 v[32:35], v[160:163], v[148:151], v[32:35]
    ds_read_b64_tr_b16 v[132:133], v226 offset:0
    v_mfma_f32_16x16x32_bf16 v[36:39], v[164:167], v[148:151], v[36:39]
    ds_read_b64_tr_b16 v[134:135], v226 offset:4096
    v_mfma_f32_16x16x32_bf16 v[40:43], v[168:171], v[148:151], v[40:43]
    ds_read_b128 v[120:123], v224 offset:4096
    v_mfma_f32_16x16x32_bf16 v[44:47], v[172:175], v[148:151], v[44:47]
    ds_read_b64_tr_b16 v[136:137], v227 offset:0
    v_mfma_f32_16x16x32_bf16 v[48:51], v[160:163], v[152:155], v[48:51]
    ds_read_b64_tr_b16 v[138:139], v227 offset:4096
    v_mfma_f32_16x16x32_bf16 v[52:55], v[164:167], v[152:155], v[52:55]
    ds_read_b128 v[124:127], v224 offset:6144
    v_mfma_f32_16x16x32_bf16 v[56:59], v[168:171], v[152:155], v[56:59]
    ds_read_b64_tr_b16 v[140:141], v228 offset:0
    v_mfma_f32_16x16x32_bf16 v[60:63], v[172:175], v[152:155], v[60:63]
    ds_read_b64_tr_b16 v[142:143], v228 offset:4096
    v_mfma_f32_16x16x32_bf16 v[64:67], v[160:163], v[156:159], v[64:67]
    v_mfma_f32_16x16x32_bf16 v[68:71], v[164:167], v[156:159], v[68:71]
    v_mfma_f32_16x16x32_bf16 v[72:75], v[168:171], v[156:159], v[72:75]
    v_mfma_f32_16x16x32_bf16 v[76:79], v[172:175], v[156:159], v[76:79]
    s_waitcnt lgkmcnt(0)
    v_mfma_f32_16x16x32_bf16 v[16:19], v[128:131], v[112:115], v[16:19]
    ds_read_b128 v[144:147], v224 offset:8192
    ds_read_b64_tr_b16 v[160:161], v225 offset:8192
    v_mfma_f32_16x16x32_bf16 v[20:23], v[132:135], v[112:115], v[20:23]
    ds_read_b64_tr_b16 v[162:163], v225 offset:12288
    ds_read_b128 v[148:151], v224 offset:10240
    v_mfma_f32_16x16x32_bf16 v[24:27], v[136:139], v[112:115], v[24:27]
    ds_read_b64_tr_b16 v[164:165], v226 offset:8192
    ds_read_b64_tr_b16 v[166:167], v226 offset:12288
    v_mfma_f32_16x16x32_bf16 v[28:31], v[140:143], v[112:115], v[28:31]
    ds_read_b128 v[152:155], v224 offset:12288
    ds_read_b64_tr_b16 v[168:169], v227 offset:8192
    v_mfma_f32_16x16x32_bf16 v[32:35], v[128:131], v[116:119], v[32:35]
    ds_read_b64_tr_b16 v[170:171], v227 offset:12288
    ds_read_b128 v[156:159], v224 offset:14336
    v_mfma_f32_16x16x32_bf16 v[36:39], v[132:135], v[116:119], v[36:39]
    ds_read_b64_tr_b16 v[172:173], v228 offset:8192
    ds_read_b64_tr_b16 v[174:175], v228 offset:12288
    v_mfma_f32_16x16x32_bf16 v[40:43], v[136:139], v[116:119], v[40:43]
    s_add_u32 s62, s62, 32768
    v_mfma_f32_16x16x32_bf16 v[44:47], v[140:143], v[116:119], v[44:47]
    s_and_b32 s62, s62, 131071
    v_mfma_f32_16x16x32_bf16 v[48:51], v[128:131], v[120:123], v[48:51]
    v_add_u32 v229, s62, v245
    v_mfma_f32_16x16x32_bf16 v[52:55], v[132:135], v[120:123], v[52:55]
    v_add_u32 v230, s62, v246
    v_mfma_f32_16x16x32_bf16 v[56:59], v[136:139], v[120:123], v[56:59]
    v_mfma_f32_16x16x32_bf16 v[60:63], v[140:143], v[120:123], v[60:63]
    v_mfma_f32_16x16x32_bf16 v[64:67], v[128:131], v[124:127], v[64:67]
    v_mfma_f32_16x16x32_bf16 v[68:71], v[132:135], v[124:127], v[68:71]
    v_mfma_f32_16x16x32_bf16 v[72:75], v[136:139], v[124:127], v[72:75]
    v_mfma_f32_16x16x32_bf16 v[76:79], v[140:143], v[124:127], v[76:79]
    s_waitcnt lgkmcnt(0)
    s_barrier
    v_mfma_f32_16x16x32_bf16 v[48:51], v[160:163], v[152:155], v[48:51]
    ds_read_b64_tr_b16 v[112:113], v229 offset:0
    v_mfma_f32_16x16x32_bf16 v[52:55], v[164:167], v[152:155], v[52:55]
    ds_read_b64_tr_b16 v[114:115], v229 offset:256
    v_mfma_f32_16x16x32_bf16 v[56:59], v[168:171], v[152:155], v[56:59]
    ds_read_b64_tr_b16 v[116:117], v229 offset:8192
    v_mfma_f32_16x16x32_bf16 v[60:63], v[172:175], v[152:155], v[60:63]
    ds_read_b64_tr_b16 v[118:119], v229 offset:8448
    v_mfma_f32_16x16x32_bf16 v[64:67], v[160:163], v[156:159], v[64:67]
    ds_read_b128 v[120:123], v230 offset:0
    v_mfma_f32_16x16x32_bf16 v[68:71], v[164:167], v[156:159], v[68:71]
    ds_read_b128 v[124:127], v230 offset:1024
    v_mfma_f32_16x16x32_bf16 v[72:75], v[168:171], v[156:159], v[72:75]
    ds_read_b64_tr_b16 v[128:129], v229 offset:2048
    v_mfma_f32_16x16x32_bf16 v[76:79], v[172:175], v[156:159], v[76:79]
    ds_read_b64_tr_b16 v[130:131], v229 offset:2304
    v_mfma_f32_16x16x32_bf16 v[16:19], v[160:163], v[144:147], v[16:19]
    ds_read_b64_tr_b16 v[132:133], v229 offset:10240
    v_mfma_f32_16x16x32_bf16 v[20:23], v[164:167], v[144:147], v[20:23]
    ds_read_b64_tr_b16 v[134:135], v229 offset:10496
    v_mfma_f32_16x16x32_bf16 v[24:27], v[168:171], v[144:147], v[24:27]
    ds_read_b128 v[136:139], v230 offset:4096
    v_mfma_f32_16x16x32_bf16 v[28:31], v[172:175], v[144:147], v[28:31]
    ds_read_b128 v[140:143], v230 offset:5120
    v_mfma_f32_16x16x32_bf16 v[32:35], v[160:163], v[148:151], v[32:35]
    v_mfma_f32_16x16x32_bf16 v[36:39], v[164:167], v[148:151], v[36:39]
    v_mfma_f32_16x16x32_bf16 v[40:43], v[168:171], v[148:151], v[40:43]
    v_mfma_f32_16x16x32_bf16 v[44:47], v[172:175], v[148:151], v[44:47]
    v_cvt_pk_bf16_f32 v208, v48, v49
    v_cvt_pk_bf16_f32 v209, v50, v51
    v_cvt_pk_bf16_f32 v210, v52, v53
    v_cvt_pk_bf16_f32 v211, v54, v55
    v_or_b32 v211, 1, v211
    buffer_store_dwordx4 v[208:211], v3, s[16:19], s64 offen offset:0 sc1
    v_cvt_pk_bf16_f32 v212, v56, v57
    v_cvt_pk_bf16_f32 v213, v58, v59
    v_cvt_pk_bf16_f32 v214, v60, v61
    v_cvt_pk_bf16_f32 v215, v62, v63
    v_or_b32 v215, 1, v215
    buffer_store_dwordx4 v[212:215], v3, s[16:19], s64 offen offset:1024 sc1
    v_cvt_pk_bf16_f32 v216, v64, v65
    v_cvt_pk_bf16_f32 v217, v66, v67
    v_cvt_pk_bf16_f32 v218, v68, v69
    v_cvt_pk_bf16_f32 v219, v70, v71
    v_or_b32 v219, 1, v219
    buffer_store_dwordx4 v[216:219], v3, s[16:19], s64 offen offset:2048 sc1
    v_cvt_pk_bf16_f32 v220, v72, v73
    v_cvt_pk_bf16_f32 v221, v74, v75
    v_cvt_pk_bf16_f32 v222, v76, v77
    v_cvt_pk_bf16_f32 v223, v78, v79
    v_or_b32 v223, 1, v223
    buffer_store_dwordx4 v[220:223], v3, s[16:19], s64 offen offset:3072 sc1
    s_waitcnt lgkmcnt(0)
    v_mfma_f32_16x16x32_bf16 v[80:83], v[120:123], v[112:115], 0
    ds_read_b64_tr_b16 v[144:145], v229 offset:4096
    ds_read_b64_tr_b16 v[146:147], v229 offset:4352
    v_mfma_f32_16x16x32_bf16 v[84:87], v[124:127], v[112:115], 0
    ds_read_b64_tr_b16 v[148:149], v229 offset:12288
    ds_read_b64_tr_b16 v[150:151], v229 offset:12544
    v_mfma_f32_16x16x32_bf16 v[88:91], v[120:123], v[116:119], 0
    ds_read_b128 v[152:155], v230 offset:8192
    ds_read_b128 v[156:159], v230 offset:9216
    v_mfma_f32_16x16x32_bf16 v[92:95], v[124:127], v[116:119], 0
    ds_read_b64_tr_b16 v[160:161], v229 offset:6144
    ds_read_b64_tr_b16 v[162:163], v229 offset:6400
    v_mfma_f32_16x16x32_bf16 v[80:83], v[136:139], v[128:131], v[80:83]
    ds_read_b64_tr_b16 v[164:165], v229 offset:14336
    ds_read_b64_tr_b16 v[166:167], v229 offset:14592
    v_mfma_f32_16x16x32_bf16 v[84:87], v[140:143], v[128:131], v[84:87]
    ds_read_b128 v[168:171], v230 offset:12288
    ds_read_b128 v[172:175], v230 offset:13312
    v_mfma_f32_16x16x32_bf16 v[88:91], v[136:139], v[132:135], v[88:91]
    s_add_u32 s62, s62, 32768
    s_and_b32 s62, s62, 131071
    v_mfma_f32_16x16x32_bf16 v[92:95], v[140:143], v[132:135], v[92:95]
    v_add_u32 v229, s62, v245
    v_add_u32 v230, s62, v246
    s_waitcnt lgkmcnt(0)
    s_barrier
    v_mfma_f32_16x16x32_bf16 v[80:83], v[152:155], v[144:147], v[80:83]
    ds_read_b64_tr_b16 v[112:113], v229 offset:0
    ds_read_b64_tr_b16 v[114:115], v229 offset:256
    v_mfma_f32_16x16x32_bf16 v[84:87], v[156:159], v[144:147], v[84:87]
    ds_read_b64_tr_b16 v[116:117], v229 offset:8192
    ds_read_b64_tr_b16 v[118:119], v229 offset:8448
    v_mfma_f32_16x16x32_bf16 v[88:91], v[152:155], v[148:151], v[88:91]
    ds_read_b128 v[120:123], v230 offset:0
    ds_read_b128 v[124:127], v230 offset:1024
    v_mfma_f32_16x16x32_bf16 v[92:95], v[156:159], v[148:151], v[92:95]
    ds_read_b64_tr_b16 v[128:129], v229 offset:2048
    ds_read_b64_tr_b16 v[130:131], v229 offset:2304
    v_mfma_f32_16x16x32_bf16 v[80:83], v[168:171], v[160:163], v[80:83]
    ds_read_b64_tr_b16 v[132:133], v229 offset:10240
    ds_read_b64_tr_b16 v[134:135], v229 offset:10496
    v_mfma_f32_16x16x32_bf16 v[84:87], v[172:175], v[160:163], v[84:87]
    ds_read_b128 v[136:139], v230 offset:4096
    ds_read_b128 v[140:143], v230 offset:5120
    v_mfma_f32_16x16x32_bf16 v[88:91], v[168:171], v[164:167], v[88:91]
    v_mfma_f32_16x16x32_bf16 v[92:95], v[172:175], v[164:167], v[92:95]
    s_waitcnt lgkmcnt(0)
    v_mfma_f32_16x16x32_bf16 v[80:83], v[120:123], v[112:115], v[80:83]
    ds_read_b64_tr_b16 v[144:145], v229 offset:4096
    ds_read_b64_tr_b16 v[146:147], v229 offset:4352
    v_mfma_f32_16x16x32_bf16 v[84:87], v[124:127], v[112:115], v[84:87]
    ds_read_b64_tr_b16 v[148:149], v229 offset:12288
    ds_read_b64_tr_b16 v[150:151], v229 offset:12544
    v_mfma_f32_16x16x32_bf16 v[88:91], v[120:123], v[116:119], v[88:91]
    ds_read_b128 v[152:155], v230 offset:8192
    ds_read_b128 v[156:159], v230 offset:9216
    v_mfma_f32_16x16x32_bf16 v[92:95], v[124:127], v[116:119], v[92:95]
    ds_read_b64_tr_b16 v[160:161], v229 offset:6144
    ds_read_b64_tr_b16 v[162:163], v229 offset:6400
    v_mfma_f32_16x16x32_bf16 v[80:83], v[136:139], v[128:131], v[80:83]
    ds_read_b64_tr_b16 v[164:165], v229 offset:14336
    ds_read_b64_tr_b16 v[166:167], v229 offset:14592
    v_mfma_f32_16x16x32_bf16 v[84:87], v[140:143], v[128:131], v[84:87]
    ds_read_b128 v[168:171], v230 offset:12288
    ds_read_b128 v[172:175], v230 offset:13312
    v_mfma_f32_16x16x32_bf16 v[88:91], v[136:139], v[132:135], v[88:91]
    s_add_u32 s62, s62, 32768
    s_and_b32 s62, s62, 131071
    v_mfma_f32_16x16x32_bf16 v[92:95], v[140:143], v[132:135], v[92:95]
    v_add_u32 v229, s62, v245
    v_add_u32 v230, s62, v246
    s_waitcnt lgkmcnt(0)
    s_barrier
    v_mfma_f32_16x16x32_bf16 v[80:83], v[152:155], v[144:147], v[80:83]
    ds_read_b64_tr_b16 v[112:113], v229 offset:0
    ds_read_b64_tr_b16 v[114:115], v229 offset:256
    v_mfma_f32_16x16x32_bf16 v[84:87], v[156:159], v[144:147], v[84:87]
    ds_read_b64_tr_b16 v[116:117], v229 offset:8192
    ds_read_b64_tr_b16 v[118:119], v229 offset:8448
    v_mfma_f32_16x16x32_bf16 v[88:91], v[152:155], v[148:151], v[88:91]
    ds_read_b128 v[120:123], v230 offset:0
    ds_read_b128 v[124:127], v230 offset:1024
    v_mfma_f32_16x16x32_bf16 v[92:95], v[156:159], v[148:151], v[92:95]
    ds_read_b64_tr_b16 v[128:129], v229 offset:2048
    ds_read_b64_tr_b16 v[130:131], v229 offset:2304
    v_mfma_f32_16x16x32_bf16 v[80:83], v[168:171], v[160:163], v[80:83]
    ds_read_b64_tr_b16 v[132:133], v229 offset:10240
    ds_read_b64_tr_b16 v[134:135], v229 offset:10496
    v_mfma_f32_16x16x32_bf16 v[84:87], v[172:175], v[160:163], v[84:87]
    ds_read_b128 v[136:139], v230 offset:4096
    ds_read_b128 v[140:143], v230 offset:5120
    v_mfma_f32_16x16x32_bf16 v[88:91], v[168:171], v[164:167], v[88:91]
    v_mfma_f32_16x16x32_bf16 v[92:95], v[172:175], v[164:167], v[92:95]
    s_lshl_b32 s43, s3, 12
    s_add_u32 s43, s43, 131072
    v_add_u32 v4, s43, v3
    ds_read_b128 v[176:179], v4 offset:0
    ds_read_b128 v[180:183], v4 offset:1024
    ds_read_b128 v[184:187], v4 offset:2048
    ds_read_b128 v[188:191], v4 offset:3072
    s_waitcnt lgkmcnt(0)
    v_mfma_f32_16x16x32_bf16 v[80:83], v[120:123], v[112:115], v[80:83]
    ds_read_b64_tr_b16 v[144:145], v229 offset:4096
    ds_read_b64_tr_b16 v[146:147], v229 offset:4352
    v_mfma_f32_16x16x32_bf16 v[84:87], v[124:127], v[112:115], v[84:87]
    ds_read_b64_tr_b16 v[148:149], v229 offset:12288
    ds_read_b64_tr_b16 v[150:151], v229 offset:12544
    v_mfma_f32_16x16x32_bf16 v[88:91], v[120:123], v[116:119], v[88:91]
    ds_read_b128 v[152:155], v230 offset:8192
    ds_read_b128 v[156:159], v230 offset:9216
    v_mfma_f32_16x16x32_bf16 v[92:95], v[124:127], v[116:119], v[92:95]
    ds_read_b64_tr_b16 v[160:161], v229 offset:6144
    ds_read_b64_tr_b16 v[162:163], v229 offset:6400
    v_mfma_f32_16x16x32_bf16 v[80:83], v[136:139], v[128:131], v[80:83]
    ds_read_b64_tr_b16 v[164:165], v229 offset:14336
    ds_read_b64_tr_b16 v[166:167], v229 offset:14592
    v_mfma_f32_16x16x32_bf16 v[84:87], v[140:143], v[128:131], v[84:87]
    ds_read_b128 v[168:171], v230 offset:12288
    ds_read_b128 v[172:175], v230 offset:13312
    v_mfma_f32_16x16x32_bf16 v[88:91], v[136:139], v[132:135], v[88:91]
    s_add_u32 s62, s62, 32768
    s_and_b32 s62, s62, 131071
    v_mfma_f32_16x16x32_bf16 v[92:95], v[140:143], v[132:135], v[92:95]
    v_add_u32 v229, s62, v245
    v_add_u32 v230, s62, v246
    s_waitcnt lgkmcnt(0)
    s_barrier
    v_mfma_f32_16x16x32_bf16 v[80:83], v[152:155], v[144:147], v[80:83]
    ds_read_b64_tr_b16 v[112:113], v229 offset:0
    ds_read_b64_tr_b16 v[114:115], v229 offset:256
    v_mfma_f32_16x16x32_bf16 v[84:87], v[156:159], v[144:147], v[84:87]
    ds_read_b64_tr_b16 v[116:117], v229 offset:8192
    ds_read_b64_tr_b16 v[118:119], v229 offset:8448
    v_mfma_f32_16x16x32_bf16 v[88:91], v[152:155], v[148:151], v[88:91]
    ds_read_b128 v[120:123], v230 offset:0
    ds_read_b128 v[124:127], v230 offset:1024
    v_mfma_f32_16x16x32_bf16 v[92:95], v[156:159], v[148:151], v[92:95]
    ds_read_b64_tr_b16 v[128:129], v229 offset:2048
    ds_read_b64_tr_b16 v[130:131], v229 offset:2304
    v_mfma_f32_16x16x32_bf16 v[80:83], v[168:171], v[160:163], v[80:83]
    ds_read_b64_tr_b16 v[132:133], v229 offset:10240
    ds_read_b64_tr_b16 v[134:135], v229 offset:10496
    v_mfma_f32_16x16x32_bf16 v[84:87], v[172:175], v[160:163], v[84:87]
    ds_read_b128 v[136:139], v230 offset:4096
    ds_read_b128 v[140:143], v230 offset:5120
    v_mfma_f32_16x16x32_bf16 v[88:91], v[168:171], v[164:167], v[88:91]
    v_mfma_f32_16x16x32_bf16 v[92:95], v[172:175], v[164:167], v[92:95]
    v_permlane16_swap_b32 v176, v178
    v_permlane16_swap_b32 v177, v179
    v_permlane16_swap_b32 v180, v182
    v_permlane16_swap_b32 v181, v183
    v_permlane16_swap_b32 v184, v186
    v_permlane16_swap_b32 v185, v187
    v_permlane16_swap_b32 v188, v190
    v_permlane16_swap_b32 v189, v191
    v_lshlrev_b32 v4, 16, v176
    v_and_b32 v5, 0xffff0000, v176
    v_lshlrev_b32 v6, 16, v177
    v_and_b32 v7, 0xffff0000, v177
    v_pk_add_f32 v[16:17], v[16:17], v[4:5]
    v_pk_add_f32 v[18:19], v[18:19], v[6:7]
    v_lshlrev_b32 v4, 16, v178
    v_and_b32 v5, 0xffff0000, v178
    v_lshlrev_b32 v6, 16, v179
    v_and_b32 v7, 0xffff0000, v179
    v_pk_add_f32 v[20:21], v[20:21], v[4:5]
    v_pk_add_f32 v[22:23], v[22:23], v[6:7]
    v_lshlrev_b32 v4, 16, v180
    v_and_b32 v5, 0xffff0000, v180
    v_lshlrev_b32 v6, 16, v181
    v_and_b32 v7, 0xffff0000, v181
    v_pk_add_f32 v[24:25], v[24:25], v[4:5]
    v_pk_add_f32 v[26:27], v[26:27], v[6:7]
    v_lshlrev_b32 v4, 16, v182
    v_and_b32 v5, 0xffff0000, v182
    v_lshlrev_b32 v6, 16, v183
    v_and_b32 v7, 0xffff0000, v183
    v_pk_add_f32 v[28:29], v[28:29], v[4:5]
    v_pk_add_f32 v[30:31], v[30:31], v[6:7]
    v_lshlrev_b32 v4, 16, v184
    v_and_b32 v5, 0xffff0000, v184
    v_lshlrev_b32 v6, 16, v185
    v_and_b32 v7, 0xffff0000, v185
    v_pk_add_f32 v[32:33], v[32:33], v[4:5]
    v_pk_add_f32 v[34:35], v[34:35], v[6:7]
    v_lshlrev_b32 v4, 16, v186
    v_and_b32 v5, 0xffff0000, v186
    v_lshlrev_b32 v6, 16, v187
    v_and_b32 v7, 0xffff0000, v187
    v_pk_add_f32 v[36:37], v[36:37], v[4:5]
    v_pk_add_f32 v[38:39], v[38:39], v[6:7]
    v_lshlrev_b32 v4, 16, v188
    v_and_b32 v5, 0xffff0000, v188
    v_lshlrev_b32 v6, 16, v189
    v_and_b32 v7, 0xffff0000, v189
    v_pk_add_f32 v[40:41], v[40:41], v[4:5]
    v_pk_add_f32 v[42:43], v[42:43], v[6:7]
    v_lshlrev_b32 v4, 16, v190
    v_and_b32 v5, 0xffff0000, v190
    v_lshlrev_b32 v6, 16, v191
    v_and_b32 v7, 0xffff0000, v191
    v_pk_add_f32 v[44:45], v[44:45], v[4:5]
    v_pk_add_f32 v[46:47], v[46:47], v[6:7]
    s_nop 0
    s_waitcnt lgkmcnt(0)
    v_mfma_f32_16x16x32_bf16 v[80:83], v[120:123], v[112:115], v[80:83]
    ds_read_b64_tr_b16 v[144:145], v229 offset:4096
    ds_read_b64_tr_b16 v[146:147], v229 offset:4352
    v_mfma_f32_16x16x32_bf16 v[84:87], v[124:127], v[112:115], v[84:87]
    ds_read_b64_tr_b16 v[148:149], v229 offset:12288
    ds_read_b64_tr_b16 v[150:151], v229 offset:12544
    v_mfma_f32_16x16x32_bf16 v[88:91], v[120:123], v[116:119], v[88:91]
    ds_read_b128 v[152:155], v230 offset:8192
    ds_read_b128 v[156:159], v230 offset:9216
    v_mfma_f32_16x16x32_bf16 v[92:95], v[124:127], v[116:119], v[92:95]
    ds_read_b64_tr_b16 v[160:161], v229 offset:6144
    ds_read_b64_tr_b16 v[162:163], v229 offset:6400
    v_mfma_f32_16x16x32_bf16 v[80:83], v[136:139], v[128:131], v[80:83]
    ds_read_b64_tr_b16 v[164:165], v229 offset:14336
    ds_read_b64_tr_b16 v[166:167], v229 offset:14592
    v_mfma_f32_16x16x32_bf16 v[84:87], v[140:143], v[128:131], v[84:87]
    ds_read_b128 v[168:171], v230 offset:12288
    ds_read_b128 v[172:175], v230 offset:13312
    v_mfma_f32_16x16x32_bf16 v[88:91], v[136:139], v[132:135], v[88:91]
    s_add_u32 s62, s62, 32768
    s_and_b32 s62, s62, 131071
    v_mfma_f32_16x16x32_bf16 v[92:95], v[140:143], v[132:135], v[92:95]
    v_add_u32 v229, s62, v245
    v_add_u32 v230, s62, v246
    s_waitcnt lgkmcnt(0)
    s_barrier
    v_mfma_f32_16x16x32_bf16 v[80:83], v[152:155], v[144:147], v[80:83]
    ds_read_b64_tr_b16 v[112:113], v229 offset:0
    ds_read_b64_tr_b16 v[114:115], v229 offset:256
    v_mfma_f32_16x16x32_bf16 v[84:87], v[156:159], v[144:147], v[84:87]
    ds_read_b64_tr_b16 v[116:117], v229 offset:8192
    ds_read_b64_tr_b16 v[118:119], v229 offset:8448
    v_mfma_f32_16x16x32_bf16 v[88:91], v[152:155], v[148:151], v[88:91]
    ds_read_b128 v[120:123], v230 offset:0
    ds_read_b128 v[124:127], v230 offset:1024
    v_mfma_f32_16x16x32_bf16 v[92:95], v[156:159], v[148:151], v[92:95]
    ds_read_b64_tr_b16 v[128:129], v229 offset:2048
    ds_read_b64_tr_b16 v[130:131], v229 offset:2304
    v_mfma_f32_16x16x32_bf16 v[80:83], v[168:171], v[160:163], v[80:83]
    ds_read_b64_tr_b16 v[132:133], v229 offset:10240
    ds_read_b64_tr_b16 v[134:135], v229 offset:10496
    v_mfma_f32_16x16x32_bf16 v[84:87], v[172:175], v[160:163], v[84:87]
    ds_read_b128 v[136:139], v230 offset:4096
    ds_read_b128 v[140:143], v230 offset:5120
    v_mfma_f32_16x16x32_bf16 v[88:91], v[168:171], v[164:167], v[88:91]
    v_mfma_f32_16x16x32_bf16 v[92:95], v[172:175], v[164:167], v[92:95]
    s_waitcnt lgkmcnt(0)
    v_mfma_f32_16x16x32_bf16 v[96:99], v[120:123], v[112:115], 0
    ds_read_b64_tr_b16 v[144:145], v229 offset:4096
    ds_read_b64_tr_b16 v[146:147], v229 offset:4352
    v_mfma_f32_16x16x32_bf16 v[100:103], v[124:127], v[112:115], 0
    ds_read_b64_tr_b16 v[148:149], v229 offset:12288
    ds_read_b64_tr_b16 v[150:151], v229 offset:12544
    v_mfma_f32_16x16x32_bf16 v[104:107], v[120:123], v[116:119], 0
    ds_read_b128 v[152:155], v230 offset:8192
    ds_read_b128 v[156:159], v230 offset:9216
    v_mfma_f32_16x16x32_bf16 v[108:111], v[124:127], v[116:119], 0
    ds_read_b64_tr_b16 v[160:161], v229 offset:6144
    ds_read_b64_tr_b16 v[162:163], v229 offset:6400
    v_mfma_f32_16x16x32_bf16 v[96:99], v[136:139], v[128:131], v[96:99]
    ds_read_b64_tr_b16 v[164:165], v229 offset:14336
    ds_read_b64_tr_b16 v[166:167], v229 offset:14592
    v_mfma_f32_16x16x32_bf16 v[100:103], v[140:143], v[128:131], v[100:103]
    ds_read_b128 v[168:171], v230 offset:12288
    ds_read_b128 v[172:175], v230 offset:13312
    v_mfma_f32_16x16x32_bf16 v[104:107], v[136:139], v[132:135], v[104:107]
    s_add_u32 s62, s62, 32768
    s_and_b32 s62, s62, 131071
    v_mfma_f32_16x16x32_bf16 v[108:111], v[140:143], v[132:135], v[108:111]
    v_add_u32 v229, s62, v245
    v_add_u32 v230, s62, v246
    s_waitcnt lgkmcnt(0)
    s_barrier
    v_mfma_f32_16x16x32_bf16 v[96:99], v[152:155], v[144:147], v[96:99]
    ds_read_b64_tr_b16 v[112:113], v229 offset:0
    ds_read_b64_tr_b16 v[114:115], v229 offset:256
    v_mfma_f32_16x16x32_bf16 v[100:103], v[156:159], v[144:147], v[100:103]
    ds_read_b64_tr_b16 v[116:117], v229 offset:8192
    ds_read_b64_tr_b16 v[118:119], v229 offset:8448
    v_mfma_f32_16x16x32_bf16 v[104:107], v[152:155], v[148:151], v[104:107]
    ds_read_b128 v[120:123], v230 offset:0
    ds_read_b128 v[124:127], v230 offset:1024
    v_mfma_f32_16x16x32_bf16 v[108:111], v[156:159], v[148:151], v[108:111]
    ds_read_b64_tr_b16 v[128:129], v229 offset:2048
    ds_read_b64_tr_b16 v[130:131], v229 offset:2304
    v_mfma_f32_16x16x32_bf16 v[96:99], v[168:171], v[160:163], v[96:99]
    ds_read_b64_tr_b16 v[132:133], v229 offset:10240
    ds_read_b64_tr_b16 v[134:135], v229 offset:10496
    v_mfma_f32_16x16x32_bf16 v[100:103], v[172:175], v[160:163], v[100:103]
    ds_read_b128 v[136:139], v230 offset:4096
    ds_read_b128 v[140:143], v230 offset:5120
    v_mfma_f32_16x16x32_bf16 v[104:107], v[168:171], v[164:167], v[104:107]
    v_mfma_f32_16x16x32_bf16 v[108:111], v[172:175], v[164:167], v[108:111]
    v_pk_add_f32 v[4:5], v[80:81], v[88:89]
    v_pk_add_f32 v[6:7], v[80:81], v[88:89] neg_lo:[0,1] neg_hi:[0,1]
    v_pk_add_f32 v[16:17], v[16:17], v[4:5]
    v_pk_add_f32 v[24:25], v[24:25], v[4:5]
    v_pk_add_f32 v[32:33], v[32:33], v[6:7]
    v_pk_add_f32 v[40:41], v[40:41], v[6:7]
    v_pk_add_f32 v[4:5], v[82:83], v[90:91]
    v_pk_add_f32 v[6:7], v[82:83], v[90:91] neg_lo:[0,1] neg_hi:[0,1]
    v_pk_add_f32 v[18:19], v[18:19], v[4:5]
    v_pk_add_f32 v[26:27], v[26:27], v[4:5]
    v_pk_add_f32 v[34:35], v[34:35], v[6:7]
    v_pk_add_f32 v[42:43], v[42:43], v[6:7]
    v_pk_add_f32 v[4:5], v[84:85], v[92:93]
    v_pk_add_f32 v[6:7], v[84:85], v[92:93] neg_lo:[0,1] neg_hi:[0,1]
    v_pk_add_f32 v[20:21], v[20:21], v[4:5]
    v_pk_add_f32 v[28:29], v[28:29], v[4:5]
    v_pk_add_f32 v[36:37], v[36:37], v[6:7]
    v_pk_add_f32 v[44:45], v[44:45], v[6:7]
    v_pk_add_f32 v[4:5], v[86:87], v[94:95]
    v_pk_add_f32 v[6:7], v[86:87], v[94:95] neg_lo:[0,1] neg_hi:[0,1]
    v_pk_add_f32 v[22:23], v[22:23], v[4:5]
    v_pk_add_f32 v[30:31], v[30:31], v[4:5]
    v_pk_add_f32 v[38:39], v[38:39], v[6:7]
    v_pk_add_f32 v[46:47], v[46:47], v[6:7]
    s_nop 0
    s_waitcnt lgkmcnt(0)
    v_mfma_f32_16x16x32_bf16 v[96:99], v[120:123], v[112:115], v[96:99]
    ds_read_b64_tr_b16 v[144:145], v229 offset:4096
    ds_read_b64_tr_b16 v[146:147], v229 offset:4352
    v_mfma_f32_16x16x32_bf16 v[100:103], v[124:127], v[112:115], v[100:103]
    ds_read_b64_tr_b16 v[148:149], v229 offset:12288
    ds_read_b64_tr_b16 v[150:151], v229 offset:12544
    v_mfma_f32_16x16x32_bf16 v[104:107], v[120:123], v[116:119], v[104:107]
    ds_read_b128 v[152:155], v230 offset:8192
    ds_read_b128 v[156:159], v230 offset:9216
    v_mfma_f32_16x16x32_bf16 v[108:111], v[124:127], v[116:119], v[108:111]
    ds_read_b64_tr_b16 v[160:161], v229 offset:6144
    ds_read_b64_tr_b16 v[162:163], v229 offset:6400
    v_mfma_f32_16x16x32_bf16 v[96:99], v[136:139], v[128:131], v[96:99]
    ds_read_b64_tr_b16 v[164:165], v229 offset:14336
    ds_read_b64_tr_b16 v[166:167], v229 offset:14592
    v_mfma_f32_16x16x32_bf16 v[100:103], v[140:143], v[128:131], v[100:103]
    ds_read_b128 v[168:171], v230 offset:12288
    ds_read_b128 v[172:175], v230 offset:13312
    v_mfma_f32_16x16x32_bf16 v[104:107], v[136:139], v[132:135], v[104:107]
    s_add_u32 s62, s62, 32768
    s_and_b32 s62, s62, 131071
    v_mfma_f32_16x16x32_bf16 v[108:111], v[140:143], v[132:135], v[108:111]
    v_add_u32 v229, s62, v245
    v_add_u32 v230, s62, v246
    s_waitcnt lgkmcnt(0)
    s_barrier
    v_mfma_f32_16x16x32_bf16 v[96:99], v[152:155], v[144:147], v[96:99]
    ds_read_b64_tr_b16 v[112:113], v229 offset:0
    ds_read_b64_tr_b16 v[114:115], v229 offset:256
    v_mfma_f32_16x16x32_bf16 v[100:103], v[156:159], v[144:147], v[100:103]
    ds_read_b64_tr_b16 v[116:117], v229 offset:8192
    ds_read_b64_tr_b16 v[118:119], v229 offset:8448
    v_mfma_f32_16x16x32_bf16 v[104:107], v[152:155], v[148:151], v[104:107]
    ds_read_b128 v[120:123], v230 offset:0
    ds_read_b128 v[124:127], v230 offset:1024
    v_mfma_f32_16x16x32_bf16 v[108:111], v[156:159], v[148:151], v[108:111]
    ds_read_b64_tr_b16 v[128:129], v229 offset:2048
    ds_read_b64_tr_b16 v[130:131], v229 offset:2304
    v_mfma_f32_16x16x32_bf16 v[96:99], v[168:171], v[160:163], v[96:99]
    ds_read_b64_tr_b16 v[132:133], v229 offset:10240
    ds_read_b64_tr_b16 v[134:135], v229 offset:10496
    v_mfma_f32_16x16x32_bf16 v[100:103], v[172:175], v[160:163], v[100:103]
    ds_read_b128 v[136:139], v230 offset:4096
    ds_read_b128 v[140:143], v230 offset:5120
    v_mfma_f32_16x16x32_bf16 v[104:107], v[168:171], v[164:167], v[104:107]
    v_mfma_f32_16x16x32_bf16 v[108:111], v[172:175], v[164:167], v[108:111]
    buffer_load_dwordx4 v[192:195], v3, s[16:19], s65 offen offset:0 sc1
    buffer_load_dwordx4 v[196:199], v3, s[16:19], s65 offen offset:1024 sc1
    buffer_load_dwordx4 v[200:203], v3, s[16:19], s65 offen offset:2048 sc1
    buffer_load_dwordx4 v[204:207], v3, s[16:19], s65 offen offset:3072 sc1
    s_waitcnt lgkmcnt(0)
    v_mfma_f32_16x16x32_bf16 v[96:99], v[120:123], v[112:115], v[96:99]
    ds_read_b64_tr_b16 v[144:145], v229 offset:4096
    ds_read_b64_tr_b16 v[146:147], v229 offset:4352
    v_mfma_f32_16x16x32_bf16 v[100:103], v[124:127], v[112:115], v[100:103]
    ds_read_b64_tr_b16 v[148:149], v229 offset:12288
    ds_read_b64_tr_b16 v[150:151], v229 offset:12544
    v_mfma_f32_16x16x32_bf16 v[104:107], v[120:123], v[116:119], v[104:107]
    ds_read_b128 v[152:155], v230 offset:8192
    ds_read_b128 v[156:159], v230 offset:9216
    v_mfma_f32_16x16x32_bf16 v[108:111], v[124:127], v[116:119], v[108:111]
    ds_read_b64_tr_b16 v[160:161], v229 offset:6144
    ds_read_b64_tr_b16 v[162:163], v229 offset:6400
    v_mfma_f32_16x16x32_bf16 v[96:99], v[136:139], v[128:131], v[96:99]
    ds_read_b64_tr_b16 v[164:165], v229 offset:14336
    ds_read_b64_tr_b16 v[166:167], v229 offset:14592
    v_mfma_f32_16x16x32_bf16 v[100:103], v[140:143], v[128:131], v[100:103]
    ds_read_b128 v[168:171], v230 offset:12288
    ds_read_b128 v[172:175], v230 offset:13312
    v_mfma_f32_16x16x32_bf16 v[104:107], v[136:139], v[132:135], v[104:107]
    s_add_u32 s62, s62, 32768
    s_and_b32 s62, s62, 131071
    v_mfma_f32_16x16x32_bf16 v[108:111], v[140:143], v[132:135], v[108:111]
    v_add_u32 v229, s62, v245
    v_add_u32 v230, s62, v246
    s_waitcnt lgkmcnt(0)
    s_barrier
    v_mfma_f32_16x16x32_bf16 v[96:99], v[152:155], v[144:147], v[96:99]
    ds_read_b64_tr_b16 v[112:113], v229 offset:0
    ds_read_b64_tr_b16 v[114:115], v229 offset:256
    v_mfma_f32_16x16x32_bf16 v[100:103], v[156:159], v[144:147], v[100:103]
    ds_read_b64_tr_b16 v[116:117], v229 offset:8192
    ds_read_b64_tr_b16 v[118:119], v229 offset:8448
    v_mfma_f32_16x16x32_bf16 v[104:107], v[152:155], v[148:151], v[104:107]
    ds_read_b128 v[120:123], v230 offset:0
    ds_read_b128 v[124:127], v230 offset:1024
    v_mfma_f32_16x16x32_bf16 v[108:111], v[156:159], v[148:151], v[108:111]
    ds_read_b64_tr_b16 v[128:129], v229 offset:2048
    ds_read_b64_tr_b16 v[130:131], v229 offset:2304
    v_mfma_f32_16x16x32_bf16 v[96:99], v[168:171], v[160:163], v[96:99]
    ds_read_b64_tr_b16 v[132:133], v229 offset:10240
    ds_read_b64_tr_b16 v[134:135], v229 offset:10496
    v_mfma_f32_16x16x32_bf16 v[100:103], v[172:175], v[160:163], v[100:103]
    ds_read_b128 v[136:139], v230 offset:4096
    ds_read_b128 v[140:143], v230 offset:5120
    v_mfma_f32_16x16x32_bf16 v[104:107], v[168:171], v[164:167], v[104:107]
    v_mfma_f32_16x16x32_bf16 v[108:111], v[172:175], v[164:167], v[108:111]
    s_waitcnt lgkmcnt(0)
    v_mfma_f32_16x16x32_bf16 v[96:99], v[120:123], v[112:115], v[96:99]
    ds_read_b64_tr_b16 v[144:145], v229 offset:4096
    ds_read_b64_tr_b16 v[146:147], v229 offset:4352
    v_mfma_f32_16x16x32_bf16 v[100:103], v[124:127], v[112:115], v[100:103]
    ds_read_b64_tr_b16 v[148:149], v229 offset:12288
    ds_read_b64_tr_b16 v[150:151], v229 offset:12544
    v_mfma_f32_16x16x32_bf16 v[104:107], v[120:123], v[116:119], v[104:107]
    ds_read_b128 v[152:155], v230 offset:8192
    ds_read_b128 v[156:159], v230 offset:9216
    v_mfma_f32_16x16x32_bf16 v[108:111], v[124:127], v[116:119], v[108:111]
    ds_read_b64_tr_b16 v[160:161], v229 offset:6144
    ds_read_b64_tr_b16 v[162:163], v229 offset:6400
    v_mfma_f32_16x16x32_bf16 v[96:99], v[136:139], v[128:131], v[96:99]
    ds_read_b64_tr_b16 v[164:165], v229 offset:14336
    ds_read_b64_tr_b16 v[166:167], v229 offset:14592
    v_mfma_f32_16x16x32_bf16 v[100:103], v[140:143], v[128:131], v[100:103]
    ds_read_b128 v[168:171], v230 offset:12288
    ds_read_b128 v[172:175], v230 offset:13312
    v_mfma_f32_16x16x32_bf16 v[104:107], v[136:139], v[132:135], v[104:107]
    v_mfma_f32_16x16x32_bf16 v[108:111], v[140:143], v[132:135], v[108:111]
    s_waitcnt lgkmcnt(0)
    v_mfma_f32_16x16x32_bf16 v[96:99], v[152:155], v[144:147], v[96:99]
    v_mfma_f32_16x16x32_bf16 v[100:103], v[156:159], v[144:147], v[100:103]
    v_mfma_f32_16x16x32_bf16 v[104:107], v[152:155], v[148:151], v[104:107]
    v_mfma_f32_16x16x32_bf16 v[108:111], v[156:159], v[148:151], v[108:111]
    v_mfma_f32_16x16x32_bf16 v[96:99], v[168:171], v[160:163], v[96:99]
    v_mfma_f32_16x16x32_bf16 v[100:103], v[172:175], v[160:163], v[100:103]
    v_mfma_f32_16x16x32_bf16 v[104:107], v[168:171], v[164:167], v[104:107]
    v_mfma_f32_16x16x32_bf16 v[108:111], v[172:175], v[164:167], v[108:111]
    s_nop 7
    v_pk_add_f32 v[4:5], v[96:97], v[104:105]
    v_pk_add_f32 v[6:7], v[96:97], v[104:105] neg_lo:[0,1] neg_hi:[0,1]
    v_pk_add_f32 v[16:17], v[16:17], v[4:5]
    v_pk_add_f32 v[24:25], v[24:25], v[4:5] neg_lo:[0,1] neg_hi:[0,1]
    v_pk_add_f32 v[32:33], v[32:33], v[6:7]
    v_pk_add_f32 v[40:41], v[40:41], v[6:7] neg_lo:[0,1] neg_hi:[0,1]
    v_pk_add_f32 v[4:5], v[98:99], v[106:107]
    v_pk_add_f32 v[6:7], v[98:99], v[106:107] neg_lo:[0,1] neg_hi:[0,1]
    v_pk_add_f32 v[18:19], v[18:19], v[4:5]
    v_pk_add_f32 v[26:27], v[26:27], v[4:5] neg_lo:[0,1] neg_hi:[0,1]
    v_pk_add_f32 v[34:35], v[34:35], v[6:7]
    v_pk_add_f32 v[42:43], v[42:43], v[6:7] neg_lo:[0,1] neg_hi:[0,1]
    v_pk_add_f32 v[4:5], v[100:101], v[108:109]
    v_pk_add_f32 v[6:7], v[100:101], v[108:109] neg_lo:[0,1] neg_hi:[0,1]
    v_pk_add_f32 v[20:21], v[20:21], v[4:5]
    v_pk_add_f32 v[28:29], v[28:29], v[4:5] neg_lo:[0,1] neg_hi:[0,1]
    v_pk_add_f32 v[36:37], v[36:37], v[6:7]
    v_pk_add_f32 v[44:45], v[44:45], v[6:7] neg_lo:[0,1] neg_hi:[0,1]
    v_pk_add_f32 v[4:5], v[102:103], v[110:111]
    v_pk_add_f32 v[6:7], v[102:103], v[110:111] neg_lo:[0,1] neg_hi:[0,1]
    v_pk_add_f32 v[22:23], v[22:23], v[4:5]
    v_pk_add_f32 v[30:31], v[30:31], v[4:5] neg_lo:[0,1] neg_hi:[0,1]
    v_pk_add_f32 v[38:39], v[38:39], v[6:7]
    v_pk_add_f32 v[46:47], v[46:47], v[6:7] neg_lo:[0,1] neg_hi:[0,1]
parallel_sum__spectral_gfnet__dense_activation_mish__prompt_kernel_poll:
    s_waitcnt vmcnt(0)
    v_and_b32 v4, v195, v199
    v_and_b32 v5, v203, v207
    v_and_b32 v4, v4, v5
    v_and_b32 v4, 1, v4
    v_cmp_eq_u32 vcc, 0, v4
    s_nop 4
    s_cbranch_vccz parallel_sum__spectral_gfnet__dense_activation_mish__prompt_kernel_ok
    buffer_load_dwordx4 v[192:195], v3, s[16:19], s65 offen offset:0 sc1
    buffer_load_dwordx4 v[196:199], v3, s[16:19], s65 offen offset:1024 sc1
    buffer_load_dwordx4 v[200:203], v3, s[16:19], s65 offen offset:2048 sc1
    buffer_load_dwordx4 v[204:207], v3, s[16:19], s65 offen offset:3072 sc1
    s_branch parallel_sum__spectral_gfnet__dense_activation_mish__prompt_kernel_poll
parallel_sum__spectral_gfnet__dense_activation_mish__prompt_kernel_ok:
    v_lshlrev_b32 v4, 16, v192
    v_and_b32 v5, 0xffff0000, v192
    v_lshlrev_b32 v6, 16, v193
    v_and_b32 v7, 0xffff0000, v193
    v_pk_add_f32 v[16:17], v[16:17], v[4:5]
    v_pk_add_f32 v[18:19], v[18:19], v[6:7]
    v_cvt_pk_bf16_f32 v208, v16, v17
    v_cvt_pk_bf16_f32 v209, v18, v19
    v_lshlrev_b32 v4, 16, v194
    v_and_b32 v5, 0xffff0000, v194
    v_lshlrev_b32 v6, 16, v195
    v_and_b32 v7, 0xffff0000, v195
    v_pk_add_f32 v[20:21], v[20:21], v[4:5]
    v_pk_add_f32 v[22:23], v[22:23], v[6:7]
    v_cvt_pk_bf16_f32 v210, v20, v21
    v_cvt_pk_bf16_f32 v211, v22, v23
    s_nop 1
    v_permlane16_swap_b32 v208, v210
    v_permlane16_swap_b32 v209, v211
    buffer_store_dwordx4 v[208:211], v247, s[8:11], s60 offen offset:0 sc1
    v_lshlrev_b32 v4, 16, v196
    v_and_b32 v5, 0xffff0000, v196
    v_lshlrev_b32 v6, 16, v197
    v_and_b32 v7, 0xffff0000, v197
    v_pk_add_f32 v[24:25], v[24:25], v[4:5]
    v_pk_add_f32 v[26:27], v[26:27], v[6:7]
    v_cvt_pk_bf16_f32 v212, v24, v25
    v_cvt_pk_bf16_f32 v213, v26, v27
    v_lshlrev_b32 v4, 16, v198
    v_and_b32 v5, 0xffff0000, v198
    v_lshlrev_b32 v6, 16, v199
    v_and_b32 v7, 0xffff0000, v199
    v_pk_add_f32 v[28:29], v[28:29], v[4:5]
    v_pk_add_f32 v[30:31], v[30:31], v[6:7]
    v_cvt_pk_bf16_f32 v214, v28, v29
    v_cvt_pk_bf16_f32 v215, v30, v31
    s_nop 1
    v_permlane16_swap_b32 v212, v214
    v_permlane16_swap_b32 v213, v215
    buffer_store_dwordx4 v[212:215], v247, s[8:11], s60 offen offset:1024 sc1
    v_lshlrev_b32 v4, 16, v200
    v_and_b32 v5, 0xffff0000, v200
    v_lshlrev_b32 v6, 16, v201
    v_and_b32 v7, 0xffff0000, v201
    v_pk_add_f32 v[32:33], v[32:33], v[4:5]
    v_pk_add_f32 v[34:35], v[34:35], v[6:7]
    v_cvt_pk_bf16_f32 v216, v32, v33
    v_cvt_pk_bf16_f32 v217, v34, v35
    v_lshlrev_b32 v4, 16, v202
    v_and_b32 v5, 0xffff0000, v202
    v_lshlrev_b32 v6, 16, v203
    v_and_b32 v7, 0xffff0000, v203
    v_pk_add_f32 v[36:37], v[36:37], v[4:5]
    v_pk_add_f32 v[38:39], v[38:39], v[6:7]
    v_cvt_pk_bf16_f32 v218, v36, v37
    v_cvt_pk_bf16_f32 v219, v38, v39
    s_nop 1
    v_permlane16_swap_b32 v216, v218
    v_permlane16_swap_b32 v217, v219
    buffer_store_dwordx4 v[216:219], v247, s[8:11], s61 offen offset:0 sc1
    v_lshlrev_b32 v4, 16, v204
    v_and_b32 v5, 0xffff0000, v204
    v_lshlrev_b32 v6, 16, v205
    v_and_b32 v7, 0xffff0000, v205
    v_pk_add_f32 v[40:41], v[40:41], v[4:5]
    v_pk_add_f32 v[42:43], v[42:43], v[6:7]
    v_cvt_pk_bf16_f32 v220, v40, v41
    v_cvt_pk_bf16_f32 v221, v42, v43
    v_lshlrev_b32 v4, 16, v206
    v_and_b32 v5, 0xffff0000, v206
    v_lshlrev_b32 v6, 16, v207
    v_and_b32 v7, 0xffff0000, v207
    v_pk_add_f32 v[44:45], v[44:45], v[4:5]
    v_pk_add_f32 v[46:47], v[46:47], v[6:7]
    v_cvt_pk_bf16_f32 v222, v44, v45
    v_cvt_pk_bf16_f32 v223, v46, v47
    s_nop 1
    v_permlane16_swap_b32 v220, v222
    v_permlane16_swap_b32 v221, v223
    buffer_store_dwordx4 v[220:223], v247, s[8:11], s61 offen offset:1024 sc1
parallel_sum__spectral_gfnet__dense_activation_mish__prompt_kernel_end:
    s_endpgm
parallel_sum__spectral_gfnet__dense_activation_mish__prompt_kernel_last:
.section .rodata,"a"
.p2align 6
.amdhsa_kernel parallel_sum__spectral_gfnet__dense_activation_mish__prompt_kernel
  .amdhsa_next_free_vgpr 256
  .amdhsa_next_free_sgpr 102
  .amdhsa_accum_offset 256
  .amdhsa_group_segment_fixed_size 0
  .amdhsa_kernarg_size 80
  .amdhsa_user_sgpr_count 2
  .amdhsa_user_sgpr_kernarg_segment_ptr 1
  .amdhsa_system_sgpr_workgroup_id_x 1
.end_amdhsa_kernel

.p2align 8
.type fft_tab,@object
fft_tab:
.long 0x3f800000,0x3f800000,0x3f800000,0x3f800000,0x3f800000,0x3f7ffec4,0x3f7ffb11,0x3f7ff4e6
.long 0x3f800000,0x3f7ffb11,0x3f7fec43,0x3f7fd397,0x3f800000,0x3f7ff4e6,0x3f7fd397,0x3f7f9c18
.long 0x3f800000,0x3f7fec43,0x3f7fb10f,0x3f7f4e6d,0x3f800000,0x3f7fe129,0x3f7f84ab,0x3f7eea9d
.long 0x3f800000,0x3f7fd397,0x3f7f4e6d,0x3f7e70b0,0x3f800000,0x3f7fc38f,0x3f7f0e58,0x3f7de0b1
.long 0x3f800000,0x3f7fb10f,0x3f7ec46d,0x3f7d3aac,0x3f800000,0x3f7f9c18,0x3f7e70b0,0x3f7c7eb0
.long 0x3f800000,0x3f7f84ab,0x3f7e1324,0x3f7baccd,0x3f800000,0x3f7f6ac7,0x3f7dabcc,0x3f7ac516
.long 0x3f800000,0x3f7f4e6d,0x3f7d3aac,0x3f79c79d,0x3f800000,0x3f7f2f9d,0x3f7cbfc9,0x3f78b47b
.long 0x3f800000,0x3f7f0e58,0x3f7c3b28,0x3f778bc5,0x3f800000,0x3f7eea9d,0x3f7baccd,0x3f764d97
.long 0x3f800000,0x3f800000,0x3f800000,0x3f800000,0x3f800000,0x3f7ffec4,0x3f7ffb11,0x3f7ff4e6
.long 0x3f800000,0x3f7ffb11,0x3f7fec43,0x3f7fd397,0x3f800000,0x3f7ff4e6,0x3f7fd397,0x3f7f9c18
.long 0x3f800000,0x3f7fec43,0x3f7fb10f,0x3f7f4e6d,0x3f800000,0x3f7fe129,0x3f7f84ab,0x3f7eea9d
.long 0x3f800000,0x3f7fd397,0x3f7f4e6d,0x3f7e70b0,0x3f800000,0x3f7fc38f,0x3f7f0e58,0x3f7de0b1
.long 0x3f800000,0x3f7fb10f,0x3f7ec46d,0x3f7d3aac,0x3f800000,0x3f7f9c18,0x3f7e70b0,0x3f7c7eb0
.long 0x3f800000,0x3f7f84ab,0x3f7e1324,0x3f7baccd,0x3f800000,0x3f7f6ac7,0x3f7dabcc,0x3f7ac516
.long 0x3f800000,0x3f7f4e6d,0x3f7d3aac,0x3f79c79d,0x3f800000,0x3f7f2f9d,0x3f7cbfc9,0x3f78b47b
.long 0x3f800000,0x3f7f0e58,0x3f7c3b28,0x3f778bc5,0x3f800000,0x3f7eea9d,0x3f7baccd,0x3f764d97
.long 0x3f800000,0x3f800000,0x3f800000,0x3f800000,0x3f7fec43,0x3f7fe129,0x3f7fd397,0x3f7fc38f
.long 0x3f7fb10f,0x3f7f84ab,0x3f7f4e6d,0x3f7f0e58,0x3f7f4e6d,0x3f7eea9d,0x3f7e70b0,0x3f7de0b1
.long 0x3f7ec46d,0x3f7e1324,0x3f7d3aac,0x3f7c3b28,0x3f7e1324,0x3f7cfe73,0x3f7baccd,0x3f7a1e84
.long 0x3f7d3aac,0x3f7baccd,0x3f79c79d,0x3f778bc5,0x3f7c3b28,0x3f7a1e84,0x3f778bc5,0x3f748422
.long 0x3f7b14be,0x3f7853f8,0x3f74fa0b,0x3f710908,0x3f79c79d,0x3f764d97,0x3f721352,0x3f6d1c1d
.long 0x3f7853f8,0x3f740bdd,0x3f6ed89e,0x3f68bf3c,0x3f76ba07,0x3f718f57,0x3f6b4b0c,0x3f63f473
.long 0x3f74fa0b,0x3f6ed89e,0x3f676bd8,0x3f5ebe05,0x3f731447,0x3f6be858,0x3f633c5a,0x3f591e6a
.long 0x3f710908,0x3f68bf3c,0x3f5ebe05,0x3f531849,0x3f6ed89e,0x3f655e0b,0x3f59f26a,0x3f4cae79
.long 0x3f800000,0x3f800000,0x3f800000,0x3f800000,0x3f7fec43,0x3f7fe129,0x3f7fd397,0x3f7fc38f
.long 0x3f7fb10f,0x3f7f84ab,0x3f7f4e6d,0x3f7f0e58,0x3f7f4e6d,0x3f7eea9d,0x3f7e70b0,0x3f7de0b1
.long 0x3f7ec46d,0x3f7e1324,0x3f7d3aac,0x3f7c3b28,0x3f7e1324,0x3f7cfe73,0x3f7baccd,0x3f7a1e84
.long 0x3f7d3aac,0x3f7baccd,0x3f79c79d,0x3f778bc5,0x3f7c3b28,0x3f7a1e84,0x3f778bc5,0x3f748422
.long 0x3f7b14be,0x3f7853f8,0x3f74fa0b,0x3f710908,0x3f79c79d,0x3f764d97,0x3f721352,0x3f6d1c1d
.long 0x3f7853f8,0x3f740bdd,0x3f6ed89e,0x3f68bf3c,0x3f76ba07,0x3f718f57,0x3f6b4b0c,0x3f63f473
.long 0x3f74fa0b,0x3f6ed89e,0x3f676bd8,0x3f5ebe05,0x3f731447,0x3f6be858,0x3f633c5a,0x3f591e6a
.long 0x3f710908,0x3f68bf3c,0x3f5ebe05,0x3f531849,0x3f6ed89e,0x3f655e0b,0x3f59f26a,0x3f4cae79
.long 0x3f800000,0x3f800000,0x3f800000,0x3f800000,0x3f7fb10f,0x3f7f9c18,0x3f7f84ab,0x3f7f6ac7
.long 0x3f7ec46d,0x3f7e70b0,0x3f7e1324,0x3f7dabcc,0x3f7d3aac,0x3f7c7eb0,0x3f7baccd,0x3f7ac516
.long 0x3f7b14be,0x3f79c79d,0x3f7853f8,0x3f76ba07,0x3f7853f8,0x3f764d97,0x3f740bdd,0x3f718f57
.long 0x3f74fa0b,0x3f721352,0x3f6ed89e,0x3f6b4b0c,0x3f710908,0x3f6d1c1d,0x3f68bf3c,0x3f63f473
.long 0x3f6c835e,0x3f676bd8,0x3f61c598,0x3f5b941a,0x3f676bd8,0x3f6106f2,0x3f59f26a,0x3f5233c6
.long 0x3f61c598,0x3f59f26a,0x3f514d3d,0x3f47de65,0x3f5b941a,0x3f5233c6,0x3f47de65,0x3f3ca003
.long 0x3f54db31,0x3f49d112,0x3f3daef9,0x3f3085bb,0x3f4d9f02,0x3f40d0da,0x3f32c8c9,0x3f239da9
.long 0x3f45e403,0x3f373a23,0x3f273656,0x3f15f6d9,0x3f3daef9,0x3f2d1469,0x3f1b02c6,0x3f07a136
.long 0x3f800000,0x3f800000,0x3f800000,0x3f800000,0x3f7fb10f,0x3f7f9c18,0x3f7f84ab,0x3f7f6ac7
.long 0x3f7ec46d,0x3f7e70b0,0x3f7e1324,0x3f7dabcc,0x3f7d3aac,0x3f7c7eb0,0x3f7baccd,0x3f7ac516
.long 0x3f7b14be,0x3f79c79d,0x3f7853f8,0x3f76ba07,0x3f7853f8,0x3f764d97,0x3f740bdd,0x3f718f57
.long 0x3f74fa0b,0x3f721352,0x3f6ed89e,0x3f6b4b0c,0x3f710908,0x3f6d1c1d,0x3f68bf3c,0x3f63f473
.long 0x3f6c835e,0x3f676bd8,0x3f61c598,0x3f5b941a,0x3f676bd8,0x3f6106f2,0x3f59f26a,0x3f5233c6
.long 0x3f61c598,0x3f59f26a,0x3f514d3d,0x3f47de65,0x3f5b941a,0x3f5233c6,0x3f47de65,0x3f3ca003
.long 0x3f54db31,0x3f49d112,0x3f3daef9,0x3f3085bb,0x3f4d9f02,0x3f40d0da,0x3f32c8c9,0x3f239da9
.long 0x3f45e403,0x3f373a23,0x3f273656,0x3f15f6d9,0x3f3daef9,0x3f2d1469,0x3f1b02c6,0x3f07a136
.long 0x3f800000,0x3f800000,0x3f800000,0x3f800000,0x3f7f4e6d,0x3f7f2f9d,0x3f7f0e58,0x3f7eea9d
.long 0x3f7d3aac,0x3f7cbfc9,0x3f7c3b28,0x3f7baccd,0x3f79c79d,0x3f78b47b,0x3f778bc5,0x3f764d97
.long 0x3f74fa0b,0x3f731447,0x3f710908,0x3f6ed89e,0x3f6ed89e,0x3f6be858,0x3f68bf3c,0x3f655e0b
.long 0x3f676bd8,0x3f633c5a,0x3f5ebe05,0x3f59f26a,0x3f5ebe05,0x3f591e6a,0x3f531849,0x3f4cae79
.long 0x3f54db31,0x3f4d9f02,0x3f45e403,0x3f3daef9,0x3f49d112,0x3f40d0da,0x3f373a23,0x3f2d1469
.long 0x3f3daef9,0x3f32c8c9,0x3f273656,0x3f1b02c6,0x3f3085bb,0x3f239da9,0x3f15f6d9,0x3f07a136
.long 0x3f226799,0x3f13682a,0x3f039c3d,0x3ee63375,0x3f13682a,0x3f0242b1,0x3ee0924f,0x3ebb31a0
.long 0x3f039c3d,0x3ee0924f,0x3eb8442a,0x3e8e9a22,0x3ee63375,0x3ebb31a0,0x3e8e9a22,0x3e419b37
.long 0x3f800000,0x3f800000,0x3f800000,0x3f800000,0x3f7f4e6d,0x3f7f2f9d,0x3f7f0e58,0x3f7eea9d
.long 0x3f7d3aac,0x3f7cbfc9,0x3f7c3b28,0x3f7baccd,0x3f79c79d,0x3f78b47b,0x3f778bc5,0x3f764d97
.long 0x3f74fa0b,0x3f731447,0x3f710908,0x3f6ed89e,0x3f6ed89e,0x3f6be858,0x3f68bf3c,0x3f655e0b
.long 0x3f676bd8,0x3f633c5a,0x3f5ebe05,0x3f59f26a,0x3f5ebe05,0x3f591e6a,0x3f531849,0x3f4cae79
.long 0x3f54db31,0x3f4d9f02,0x3f45e403,0x3f3daef9,0x3f49d112,0x3f40d0da,0x3f373a23,0x3f2d1469
.long 0x3f3daef9,0x3f32c8c9,0x3f273656,0x3f1b02c6,0x3f3085bb,0x3f239da9,0x3f15f6d9,0x3f07a136
.long 0x3f226799,0x3f13682a,0x3f039c3d,0x3ee63375,0x3f13682a,0x3f0242b1,0x3ee0924f,0x3ebb31a0
.long 0x3f039c3d,0x3ee0924f,0x3eb8442a,0x3e8e9a22,0x3ee63375,0x3ebb31a0,0x3e8e9a22,0x3e419b37
.long 0x3f800000,0x3f800000,0x3f800000,0x3f800000,0x3f7ec46d,0x3f7e9bc9,0x3f7e70b0,0x3f7e4323
.long 0x3f7b14be,0x3f7a7302,0x3f79c79d,0x3f791298,0x3f74fa0b,0x3f73913f,0x3f721352,0x3f708066
.long 0x3f6c835e,0x3f6a09a7,0x3f676bd8,0x3f64aa59,0x3f61c598,0x3f5df6be,0x3f59f26a,0x3f55b993
.long 0x3f54db31,0x3f4f7a1f,0x3f49d112,0x3f43e200,0x3f45e403,0x3f3ebc1b,0x3f373a23,0x3f2f61a5
.long 0x3f3504f3,0x3f2beb4a,0x3f226799,0x3f187fc0,0x3f226799,0x3f173c07,0x3f0b9a6b,0x3eff17b2
.long 0x3f0e39da,0x3f00e7e4,0x3ee63375,0x3ec9b953,0x3ef15aea,0x3ed25a09,0x3eb263ef,0x3e919ddd
.long 0x3ec3ef15,0x3ea09ae5,0x3e78cfcc,0x3e2f10a2,0x3e94a031,0x3e5a3997,0x3e09cf86,0x3d621469
.long 0x3e47c5c2,0x3de1bc2e,0x3cc90ab0,0xbd7b2b74,0x3dc8bd36,0x3bc90f88,0xbdafb680,0xbe354098
.long 0x3f800000,0x3f800000,0x3f800000,0x3f800000,0x3f7ec46d,0x3f7e9bc9,0x3f7e70b0,0x3f7e4323
.long 0x3f7b14be,0x3f7a7302,0x3f79c79d,0x3f791298,0x3f74fa0b,0x3f73913f,0x3f721352,0x3f708066
.long 0x3f6c835e,0x3f6a09a7,0x3f676bd8,0x3f64aa59,0x3f61c598,0x3f5df6be,0x3f59f26a,0x3f55b993
.long 0x3f54db31,0x3f4f7a1f,0x3f49d112,0x3f43e200,0x3f45e403,0x3f3ebc1b,0x3f373a23,0x3f2f61a5
.long 0x3f3504f3,0x3f2beb4a,0x3f226799,0x3f187fc0,0x3f226799,0x3f173c07,0x3f0b9a6b,0x3eff17b2
.long 0x3f0e39da,0x3f00e7e4,0x3ee63375,0x3ec9b953,0x3ef15aea,0x3ed25a09,0x3eb263ef,0x3e919ddd
.long 0x3ec3ef15,0x3ea09ae5,0x3e78cfcc,0x3e2f10a2,0x3e94a031,0x3e5a3997,0x3e09cf86,0x3d621469
.long 0x3e47c5c2,0x3de1bc2e,0x3cc90ab0,0xbd7b2b74,0x3dc8bd36,0x3bc90f88,0xbdafb680,0xbe354098
.long 0x3f800000,0x3f800000,0x3f800000,0x3f800000,0x3f7e1324,0x3f7de0b1,0x3f7dabcc,0x3f7d7474
.long 0x3f7853f8,0x3f778bc5,0x3f76ba07,0x3f75dec6,0x3f6ed89e,0x3f6d1c1d,0x3f6b4b0c,0x3f696591
.long 0x3f61c598,0x3f5ebe05,0x3f5b941a,0x3f584853,0x3f514d3d,0x3f4cae79,0x3f47de65,0x3f42de29
.long 0x3f3daef9,0x3f373a23,0x3f3085bb,0x3f299415,0x3f273656,0x3f1ebc12,0x3f15f6d9,0x3f0cead0
.long 0x3f0e39da,0x3f039c3d,0x3ef15aea,0x3edae880,0x3ee63375,0x3ecc9b8b,0x3eb263ef,0x3e97a117
.long 0x3eac7cd4,0x3e8e9a22,0x3e605c13,0x3e22abb6,0x3e605c13,0x3e1c76de,0x3dafb680,0x3c96c9b6
.long 0x3dc8bd36,0x3cc90ab0,0xbd48fb30,0xbdfab273,0xbcc90ab0,0xbdd53db9,0xbe3b6ecf,0xbe8586ce
.long 0xbe164083,0xbe6c9a7f,0xbea09ae5,0xbec9b953,0xbe888e93,0xbeb554ec,0xbee0924f,0xbf04f484
.long 0x3f800000,0x3f800000,0x3f800000,0x3f800000,0x3f7e1324,0x3f7de0b1,0x3f7dabcc,0x3f7d7474
.long 0x3f7853f8,0x3f778bc5,0x3f76ba07,0x3f75dec6,0x3f6ed89e,0x3f6d1c1d,0x3f6b4b0c,0x3f696591
.long 0x3f61c598,0x3f5ebe05,0x3f5b941a,0x3f584853,0x3f514d3d,0x3f4cae79,0x3f47de65,0x3f42de29
.long 0x3f3daef9,0x3f373a23,0x3f3085bb,0x3f299415,0x3f273656,0x3f1ebc12,0x3f15f6d9,0x3f0cead0
.long 0x3f0e39da,0x3f039c3d,0x3ef15aea,0x3edae880,0x3ee63375,0x3ecc9b8b,0x3eb263ef,0x3e97a117
.long 0x3eac7cd4,0x3e8e9a22,0x3e605c13,0x3e22abb6,0x3e605c13,0x3e1c76de,0x3dafb680,0x3c96c9b6
.long 0x3dc8bd36,0x3cc90ab0,0xbd48fb30,0xbdfab273,0xbcc90ab0,0xbdd53db9,0xbe3b6ecf,0xbe8586ce
.long 0xbe164083,0xbe6c9a7f,0xbea09ae5,0xbec9b953,0xbe888e93,0xbeb554ec,0xbee0924f,0xbf04f484
.long 0x3f800000,0x3f800000,0x3f800000,0x3f800000,0x3f7d3aac,0x3f7cfe73,0x3f7cbfc9,0x3f7c7eb0
.long 0x3f74fa0b,0x3f740bdd,0x3f731447,0x3f721352,0x3f676bd8,0x3f655e0b,0x3f633c5a,0x3f6106f2
.long 0x3f54db31,0x3f514d3d,0x3f4d9f02,0x3f49d112,0x3f3daef9,0x3f385216,0x3f32c8c9,0x3f2d1469
.long 0x3f226799,0x3f1b02c6,0x3f13682a,0x3f0b9a6b,0x3f039c3d,0x3ef41f07,0x3ee0924f,0x3ecc9b8b
.long 0x3ec3ef15,0x3eac7cd4,0x3e94a031,0x3e78cfcc,0x3e78cfcc,0x3e419b37,0x3e09cf86,0x3da3308c
.long 0x3dc8bd36,0x3d16c32c,0xbcc90ab0,0xbdafb680,0xbd48fb30,0xbdee3876,0xbe3b6ecf,0xbe7ee6e1
.long 0xbe47c5c2,0xbe888e93,0xbeac7cd4,0xbecf7bca,0xbeac7cd4,0xbed25a09,0xbef6e0cb,0xbf0cead0
.long 0xbef15aea,0xbf0b9a6b,0xbf1d7fd1,0xbf2e3bde,0xbf187fc0,0xbf2ac082,0xbf3b8f3b,0xbf4ac77f
.long 0x3f800000,0x3f800000,0x3f800000,0x3f800000,0x3f7d3aac,0x3f7cfe73,0x3f7cbfc9,0x3f7c7eb0
.long 0x3f74fa0b,0x3f740bdd,0x3f731447,0x3f721352,0x3f676bd8,0x3f655e0b,0x3f633c5a,0x3f6106f2
.long 0x3f54db31,0x3f514d3d,0x3f4d9f02,0x3f49d112,0x3f3daef9,0x3f385216,0x3f32c8c9,0x3f2d1469
.long 0x3f226799,0x3f1b02c6,0x3f13682a,0x3f0b9a6b,0x3f039c3d,0x3ef41f07,0x3ee0924f,0x3ecc9b8b
.long 0x3ec3ef15,0x3eac7cd4,0x3e94a031,0x3e78cfcc,0x3e78cfcc,0x3e419b37,0x3e09cf86,0x3da3308c
.long 0x3dc8bd36,0x3d16c32c,0xbcc90ab0,0xbdafb680,0xbd48fb30,0xbdee3876,0xbe3b6ecf,0xbe7ee6e1
.long 0xbe47c5c2,0xbe888e93,0xbeac7cd4,0xbecf7bca,0xbeac7cd4,0xbed25a09,0xbef6e0cb,0xbf0cead0
.long 0xbef15aea,0xbf0b9a6b,0xbf1d7fd1,0xbf2e3bde,0xbf187fc0,0xbf2ac082,0xbf3b8f3b,0xbf4ac77f
.long 0x3f800000,0x3f800000,0x3f800000,0x3f800000,0x3f7c3b28,0x3f7bf531,0x3f7baccd,0x3f7b61fc
.long 0x3f710908,0x3f6ff573,0x3f6ed89e,0x3f6db293,0x3f5ebe05,0x3f5c61c7,0x3f59f26a,0x3f577026
.long 0x3f45e403,0x3f41d870,0x3f3daef9,0x3f396842,0x3f273656,0x3f212ff9,0x3f1b02c6,0x3f14b039
.long 0x3f039c3d,0x3ef6e0cb,0x3ee63375,0x3ed53641,0x3eb8442a,0x3ea395c5,0x3e8e9a22,0x3e72b651
.long 0x3e47c5c2,0x3e164083,0x3dc8bd36,0x3d48fb30,0x3cc90ab0,0xbcfb49ba,0xbdafb680,0xbe1008b7
.long 0xbe164083,0xbe541501,0xbe888e93,0xbea68f12,0xbea09ae5,0xbec1071e,0xbee0924f,0xbeff17b2
.long 0xbef15aea,0xbf08f59b,0xbf187fc0,0xbf273656,0xbf1d7fd1,0xbf2d1469,0xbf3b8f3b,0xbf48d8b3
.long 0xbf3daef9,0xbf4bbbf8,0xbf584853,0xbf633c5a,0xbf584853,0xbf63f473,0xbf6db293,0xbf756d97
.long 0x3f800000,0x3f800000,0x3f800000,0x3f800000,0x3f7c3b28,0x3f7bf531,0x3f7baccd,0x3f7b61fc
.long 0x3f710908,0x3f6ff573,0x3f6ed89e,0x3f6db293,0x3f5ebe05,0x3f5c61c7,0x3f59f26a,0x3f577026
.long 0x3f45e403,0x3f41d870,0x3f3daef9,0x3f396842,0x3f273656,0x3f212ff9,0x3f1b02c6,0x3f14b039
.long 0x3f039c3d,0x3ef6e0cb,0x3ee63375,0x3ed53641,0x3eb8442a,0x3ea395c5,0x3e8e9a22,0x3e72b651
.long 0x3e47c5c2,0x3e164083,0x3dc8bd36,0x3d48fb30,0x3cc90ab0,0xbcfb49ba,0xbdafb680,0xbe1008b7
.long 0xbe164083,0xbe541501,0xbe888e93,0xbea68f12,0xbea09ae5,0xbec1071e,0xbee0924f,0xbeff17b2
.long 0xbef15aea,0xbf08f59b,0xbf187fc0,0xbf273656,0xbf1d7fd1,0xbf2d1469,0xbf3b8f3b,0xbf48d8b3
.long 0xbf3daef9,0xbf4bbbf8,0xbf584853,0xbf633c5a,0xbf584853,0xbf63f473,0xbf6db293,0xbf756d97
.long 0,0,0,0,0,0x3bc90f88,0x3c490e90,0x3c96c9b6
.long 0,0x3c490e90,0x3cc90ab0,0x3d16c32c,0,0x3c96c9b6,0x3d16c32c,0x3d621469
.long 0,0x3cc90ab0,0x3d48fb30,0x3d96a905,0,0x3cfb49ba,0x3d7b2b74,0x3dbc3ac3
.long 0,0x3d16c32c,0x3d96a905,0x3de1bc2e,0,0x3d2fe007,0x3dafb680,0x3e039502
.long 0,0x3d48fb30,0x3dc8bd36,0x3e164083,0,0x3d621469,0x3de1bc2e,0x3e28defc
.long 0,0x3d7b2b74,0x3dfab273,0x3e3b6ecf,0,0x3d8a200a,0x3e09cf86,0x3e4dee60
.long 0,0x3d96a905,0x3e164083,0x3e605c13,0,0x3da3308c,0x3e22abb6,0x3e72b651
.long 0,0x3dafb680,0x3e2f10a2,0x3e827dc0,0,0x3dbc3ac3,0x3e3b6ecf,0x3e8b9507
.long 0,0,0,0,0,0x3bc90f88,0x3c490e90,0x3c96c9b6
.long 0,0x3c490e90,0x3cc90ab0,0x3d16c32c,0,0x3c96c9b6,0x3d16c32c,0x3d621469
.long 0,0x3cc90ab0,0x3d48fb30,0x3d96a905,0,0x3cfb49ba,0x3d7b2b74,0x3dbc3ac3
.long 0,0x3d16c32c,0x3d96a905,0x3de1bc2e,0,0x3d2fe007,0x3dafb680,0x3e039502
.long 0,0x3d48fb30,0x3dc8bd36,0x3e164083,0,0x3d621469,0x3de1bc2e,0x3e28defc
.long 0,0x3d7b2b74,0x3dfab273,0x3e3b6ecf,0,0x3d8a200a,0x3e09cf86,0x3e4dee60
.long 0,0x3d96a905,0x3e164083,0x3e605c13,0,0x3da3308c,0x3e22abb6,0x3e72b651
.long 0,0x3dafb680,0x3e2f10a2,0x3e827dc0,0,0x3dbc3ac3,0x3e3b6ecf,0x3e8b9507
.long 0,0,0,0,0x3cc90ab0,0x3cfb49ba,0x3d16c32c,0x3d2fe007
.long 0x3d48fb30,0x3d7b2b74,0x3d96a905,0x3dafb680,0x3d96a905,0x3dbc3ac3,0x3de1bc2e,0x3e039502
.long 0x3dc8bd36,0x3dfab273,0x3e164083,0x3e2f10a2,0x3dfab273,0x3e1c76de,0x3e3b6ecf,0x3e5a3997
.long 0x3e164083,0x3e3b6ecf,0x3e605c13,0x3e827dc0,0x3e2f10a2,0x3e5a3997,0x3e827dc0,0x3e97a117
.long 0x3e47c5c2,0x3e78cfcc,0x3e94a031,0x3eac7cd4,0x3e605c13,0x3e8b9507,0x3ea68f12,0x3ec1071e
.long 0x3e78cfcc,0x3e9aa086,0x3eb8442a,0x3ed53641,0x3e888e93,0x3ea986c4,0x3ec9b953,0x3ee900b7
.long 0x3e94a031,0x3eb8442a,0x3edae880,0x3efc5d27,0x3ea09ae5,0x3ec6d529,0x3eebcbbb,0x3f07a136
.long 0x3eac7cd4,0x3ed53641,0x3efc5d27,0x3f10d3cd,0x3eb8442a,0x3ee363fa,0x3f064b82,0x3f19c200
.long 0,0,0,0,0x3cc90ab0,0x3cfb49ba,0x3d16c32c,0x3d2fe007
.long 0x3d48fb30,0x3d7b2b74,0x3d96a905,0x3dafb680,0x3d96a905,0x3dbc3ac3,0x3de1bc2e,0x3e039502
.long 0x3dc8bd36,0x3dfab273,0x3e164083,0x3e2f10a2,0x3dfab273,0x3e1c76de,0x3e3b6ecf,0x3e5a3997
.long 0x3e164083,0x3e3b6ecf,0x3e605c13,0x3e827dc0,0x3e2f10a2,0x3e5a3997,0x3e827dc0,0x3e97a117
.long 0x3e47c5c2,0x3e78cfcc,0x3e94a031,0x3eac7cd4,0x3e605c13,0x3e8b9507,0x3ea68f12,0x3ec1071e
.long 0x3e78cfcc,0x3e9aa086,0x3eb8442a,0x3ed53641,0x3e888e93,0x3ea986c4,0x3ec9b953,0x3ee900b7
.long 0x3e94a031,0x3eb8442a,0x3edae880,0x3efc5d27,0x3ea09ae5,0x3ec6d529,0x3eebcbbb,0x3f07a136
.long 0x3eac7cd4,0x3ed53641,0x3efc5d27,0x3f10d3cd,0x3eb8442a,0x3ee363fa,0x3f064b82,0x3f19c200
.long 0,0,0,0,0x3d48fb30,0x3d621469,0x3d7b2b74,0x3d8a200a
.long 0x3dc8bd36,0x3de1bc2e,0x3dfab273,0x3e09cf86,0x3e164083,0x3e28defc,0x3e3b6ecf,0x3e4dee60
.long 0x3e47c5c2,0x3e605c13,0x3e78cfcc,0x3e888e93,0x3e78cfcc,0x3e8b9507,0x3e9aa086,0x3ea986c4
.long 0x3e94a031,0x3ea68f12,0x3eb8442a,0x3ec9b953,0x3eac7cd4,0x3ec1071e,0x3ed53641,0x3ee900b7
.long 0x3ec3ef15,0x3edae880,0x3ef15aea,0x3f039c3d,0x3edae880,0x3ef41f07,0x3f064b82,0x3f121eb0
.long 0x3ef15aea,0x3f064b82,0x3f13682a,0x3f1ff6cb,0x3f039c3d,0x3f121eb0,0x3f1ff6cb,0x3f2d1469
.long 0x3f0e39da,0x3f1d7fd1,0x3f2beb4a,0x3f396842,0x3f187fc0,0x3f286605,0x3f373a23,0x3f44e3f5
.long 0x3f226799,0x3f32c8c9,0x3f41d870,0x3f4f7a1f,0x3f2beb4a,0x3f3ca003,0x3f4bbbf8,0x3f591e6a
.long 0,0,0,0,0x3d48fb30,0x3d621469,0x3d7b2b74,0x3d8a200a
.long 0x3dc8bd36,0x3de1bc2e,0x3dfab273,0x3e09cf86,0x3e164083,0x3e28defc,0x3e3b6ecf,0x3e4dee60
.long 0x3e47c5c2,0x3e605c13,0x3e78cfcc,0x3e888e93,0x3e78cfcc,0x3e8b9507,0x3e9aa086,0x3ea986c4
.long 0x3e94a031,0x3ea68f12,0x3eb8442a,0x3ec9b953,0x3eac7cd4,0x3ec1071e,0x3ed53641,0x3ee900b7
.long 0x3ec3ef15,0x3edae880,0x3ef15aea,0x3f039c3d,0x3edae880,0x3ef41f07,0x3f064b82,0x3f121eb0
.long 0x3ef15aea,0x3f064b82,0x3f13682a,0x3f1ff6cb,0x3f039c3d,0x3f121eb0,0x3f1ff6cb,0x3f2d1469
.long 0x3f0e39da,0x3f1d7fd1,0x3f2beb4a,0x3f396842,0x3f187fc0,0x3f286605,0x3f373a23,0x3f44e3f5
.long 0x3f226799,0x3f32c8c9,0x3f41d870,0x3f4f7a1f,0x3f2beb4a,0x3f3ca003,0x3f4bbbf8,0x3f591e6a
.long 0,0,0,0,0x3d96a905,0x3da3308c,0x3dafb680,0x3dbc3ac3
.long 0x3e164083,0x3e22abb6,0x3e2f10a2,0x3e3b6ecf,0x3e605c13,0x3e72b651,0x3e827dc0,0x3e8b9507
.long 0x3e94a031,0x3ea09ae5,0x3eac7cd4,0x3eb8442a,0x3eb8442a,0x3ec6d529,0x3ed53641,0x3ee363fa
.long 0x3edae880,0x3eebcbbb,0x3efc5d27,0x3f064b82,0x3efc5d27,0x3f07a136,0x3f10d3cd,0x3f19c200
.long 0x3f0e39da,0x3f187fc0,0x3f226799,0x3f2beb4a,0x3f1d7fd1,0x3f286605,0x3f32c8c9,0x3f3ca003
.long 0x3f2beb4a,0x3f373a23,0x3f41d870,0x3f4bbbf8,0x3f396842,0x3f44e3f5,0x3f4f7a1f,0x3f591e6a
.long 0x3f45e403,0x3f514d3d,0x3f5b941a,0x3f64aa59,0x3f514d3d,0x3f5c61c7,0x3f660f88,0x3f6e46be
.long 0x3f5b941a,0x3f660f88,0x3f6ed89e,0x3f75dec6,0x3f64aa59,0x3f6e46be,0x3f75dec6,0x3f7b61fc
.long 0,0,0,0,0x3d96a905,0x3da3308c,0x3dafb680,0x3dbc3ac3
.long 0x3e164083,0x3e22abb6,0x3e2f10a2,0x3e3b6ecf,0x3e605c13,0x3e72b651,0x3e827dc0,0x3e8b9507
.long 0x3e94a031,0x3ea09ae5,0x3eac7cd4,0x3eb8442a,0x3eb8442a,0x3ec6d529,0x3ed53641,0x3ee363fa
.long 0x3edae880,0x3eebcbbb,0x3efc5d27,0x3f064b82,0x3efc5d27,0x3f07a136,0x3f10d3cd,0x3f19c200
.long 0x3f0e39da,0x3f187fc0,0x3f226799,0x3f2beb4a,0x3f1d7fd1,0x3f286605,0x3f32c8c9,0x3f3ca003
.long 0x3f2beb4a,0x3f373a23,0x3f41d870,0x3f4bbbf8,0x3f396842,0x3f44e3f5,0x3f4f7a1f,0x3f591e6a
.long 0x3f45e403,0x3f514d3d,0x3f5b941a,0x3f64aa59,0x3f514d3d,0x3f5c61c7,0x3f660f88,0x3f6e46be
.long 0x3f5b941a,0x3f660f88,0x3f6ed89e,0x3f75dec6,0x3f64aa59,0x3f6e46be,0x3f75dec6,0x3f7b61fc
.long 0,0,0,0,0x3dc8bd36,0x3dd53db9,0x3de1bc2e,0x3dee3876
.long 0x3e47c5c2,0x3e541501,0x3e605c13,0x3e6c9a7f,0x3e94a031,0x3e9d9e78,0x3ea68f12,0x3eaf713a
.long 0x3ec3ef15,0x3ecf7bca,0x3edae880,0x3ee63375,0x3ef15aea,0x3eff17b2,0x3f064b82,0x3f0cead0
.long 0x3f0e39da,0x3f15f6d9,0x3f1d7fd1,0x3f24d225,0x3f226799,0x3f2ac082,0x3f32c8c9,0x3f3a7ca4
.long 0x3f3504f3,0x3f3daef9,0x3f45e403,0x3f4d9f02,0x3f45e403,0x3f4e8d90,0x3f5695e5,0x3f5df6be
.long 0x3f54db31,0x3f5d2d53,0x3f64aa59,0x3f6b4b0c,0x3f61c598,0x3f696591,0x3f6ff573,0x3f756d97
.long 0x3f6c835e,0x3f731447,0x3f7853f8,0x3f7c3b28,0x3f74fa0b,0x3f7a1e84,0x3f7dabcc,0x3f7f9c18
.long 0x3f7b14be,0x3f7e70b0,0x3f7fec43,0x3f7f84ab,0x3f7ec46d,0x3f7ffec4,0x3f7f0e58,0x3f7bf531
.long 0,0,0,0,0x3dc8bd36,0x3dd53db9,0x3de1bc2e,0x3dee3876
.long 0x3e47c5c2,0x3e541501,0x3e605c13,0x3e6c9a7f,0x3e94a031,0x3e9d9e78,0x3ea68f12,0x3eaf713a
.long 0x3ec3ef15,0x3ecf7bca,0x3edae880,0x3ee63375,0x3ef15aea,0x3eff17b2,0x3f064b82,0x3f0cead0
.long 0x3f0e39da,0x3f15f6d9,0x3f1d7fd1,0x3f24d225,0x3f226799,0x3f2ac082,0x3f32c8c9,0x3f3a7ca4
.long 0x3f3504f3,0x3f3daef9,0x3f45e403,0x3f4d9f02,0x3f45e403,0x3f4e8d90,0x3f5695e5,0x3f5df6be
.long 0x3f54db31,0x3f5d2d53,0x3f64aa59,0x3f6b4b0c,0x3f61c598,0x3f696591,0x3f6ff573,0x3f756d97
.long 0x3f6c835e,0x3f731447,0x3f7853f8,0x3f7c3b28,0x3f74fa0b,0x3f7a1e84,0x3f7dabcc,0x3f7f9c18
.long 0x3f7b14be,0x3f7e70b0,0x3f7fec43,0x3f7f84ab,0x3f7ec46d,0x3f7ffec4,0x3f7f0e58,0x3f7bf531
.long 0,0,0,0,0x3dfab273,0x3e039502,0x3e09cf86,0x3e1008b7
.long 0x3e78cfcc,0x3e827dc0,0x3e888e93,0x3e8e9a22,0x3eb8442a,0x3ec1071e,0x3ec9b953,0x3ed25a09
.long 0x3ef15aea,0x3efc5d27,0x3f039c3d,0x3f08f59b,0x3f13682a,0x3f19c200,0x3f1ff6cb,0x3f26050a
.long 0x3f2beb4a,0x3f32c8c9,0x3f396842,0x3f3fc767,0x3f41d870,0x3f48d8b3,0x3f4f7a1f,0x3f55b993
.long 0x3f54db31,0x3f5b941a,0x3f61c598,0x3f676bd8,0x3f64aa59,0x3f6aab7b,0x3f6ff573,0x3f748422
.long 0x3f710908,0x3f75dec6,0x3f79c79d,0x3f7cbfc9,0x3f79c79d,0x3f7cfe73,0x3f7f0e58,0x3f7ff4e6
.long 0x3f7ec46d,0x3f7fec43,0x3f7fb10f,0x3f7e1324,0x3f7fec43,0x3f7e9bc9,0x3f7baccd,0x3f772417
.long 0x3f7d3aac,0x3f791298,0x3f731447,0x3f6b4b0c,0x3f76ba07,0x3f6f6830,0x3f660f88,0x3f5ac450
.long 0,0,0,0,0x3dfab273,0x3e039502,0x3e09cf86,0x3e1008b7
.long 0x3e78cfcc,0x3e827dc0,0x3e888e93,0x3e8e9a22,0x3eb8442a,0x3ec1071e,0x3ec9b953,0x3ed25a09
.long 0x3ef15aea,0x3efc5d27,0x3f039c3d,0x3f08f59b,0x3f13682a,0x3f19c200,0x3f1ff6cb,0x3f26050a
.long 0x3f2beb4a,0x3f32c8c9,0x3f396842,0x3f3fc767,0x3f41d870,0x3f48d8b3,0x3f4f7a1f,0x3f55b993
.long 0x3f54db31,0x3f5b941a,0x3f61c598,0x3f676bd8,0x3f64aa59,0x3f6aab7b,0x3f6ff573,0x3f748422
.long 0x3f710908,0x3f75dec6,0x3f79c79d,0x3f7cbfc9,0x3f79c79d,0x3f7cfe73,0x3f7f0e58,0x3f7ff4e6
.long 0x3f7ec46d,0x3f7fec43,0x3f7fb10f,0x3f7e1324,0x3f7fec43,0x3f7e9bc9,0x3f7baccd,0x3f772417
.long 0x3f7d3aac,0x3f791298,0x3f731447,0x3f6b4b0c,0x3f76ba07,0x3f6f6830,0x3f660f88,0x3f5ac450
.long 0,0,0,0,0x3e164083,0x3e1c76de,0x3e22abb6,0x3e28defc
.long 0x3e94a031,0x3e9aa086,0x3ea09ae5,0x3ea68f12,0x3edae880,0x3ee363fa,0x3eebcbbb,0x3ef41f07
.long 0x3f0e39da,0x3f13682a,0x3f187fc0,0x3f1d7fd1,0x3f2beb4a,0x3f31a81d,0x3f373a23,0x3f3ca003
.long 0x3f45e403,0x3f4bbbf8,0x3f514d3d,0x3f5695e5,0x3f5b941a,0x3f6106f2,0x3f660f88,0x3f6aab7b
.long 0x3f6c835e,0x3f710908,0x3f74fa0b,0x3f7853f8,0x3f7853f8,0x3f7b61fc,0x3f7dabcc,0x3f7f2f9d
.long 0x3f7ec46d,0x3f7fd397,0x3f7fec43,0x3f7f0e58,0x3f7fb10f,0x3f7e4323,0x3f7baccd,0x3f77f110
.long 0x3f7b14be,0x3f76ba07,0x3f710908,0x3f6a09a7,0x3f710908,0x3f696591,0x3f604621,0x3f55b993
.long 0x3f61c598,0x3f5695e5,0x3f49d112,0x3f3b8f3b,0x3f4d9f02,0x3f3ebc1b,0x3f2e3bde,0x3f1c420c
.long 0,0,0,0,0x3e164083,0x3e1c76de,0x3e22abb6,0x3e28defc
.long 0x3e94a031,0x3e9aa086,0x3ea09ae5,0x3ea68f12,0x3edae880,0x3ee363fa,0x3eebcbbb,0x3ef41f07
.long 0x3f0e39da,0x3f13682a,0x3f187fc0,0x3f1d7fd1,0x3f2beb4a,0x3f31a81d,0x3f373a23,0x3f3ca003
.long 0x3f45e403,0x3f4bbbf8,0x3f514d3d,0x3f5695e5,0x3f5b941a,0x3f6106f2,0x3f660f88,0x3f6aab7b
.long 0x3f6c835e,0x3f710908,0x3f74fa0b,0x3f7853f8,0x3f7853f8,0x3f7b61fc,0x3f7dabcc,0x3f7f2f9d
.long 0x3f7ec46d,0x3f7fd397,0x3f7fec43,0x3f7f0e58,0x3f7fb10f,0x3f7e4323,0x3f7baccd,0x3f77f110
.long 0x3f7b14be,0x3f76ba07,0x3f710908,0x3f6a09a7,0x3f710908,0x3f696591,0x3f604621,0x3f55b993
.long 0x3f61c598,0x3f5695e5,0x3f49d112,0x3f3b8f3b,0x3f4d9f02,0x3f3ebc1b,0x3f2e3bde,0x3f1c420c
.long 0,0,0,0,0x3e2f10a2,0x3e354098,0x3e3b6ecf,0x3e419b37
.long 0x3eac7cd4,0x3eb263ef,0x3eb8442a,0x3ebe1d4a,0x3efc5d27,0x3f0242b1,0x3f064b82,0x3f0a48ad
.long 0x3f226799,0x3f273656,0x3f2beb4a,0x3f3085bb,0x3f41d870,0x3f46e22a,0x3f4bbbf8,0x3f5064af
.long 0x3f5b941a,0x3f604621,0x3f64aa59,0x3f68bf3c,0x3f6ed89e,0x3f7294f8,0x3f75dec6,0x3f78b47b
.long 0x3f7b14be,0x3f7d3aac,0x3f7ec46d,0x3f7fb10f,0x3f7fec43,0x3f7fe129,0x3f7f0e58,0x3f7d7474
.long 0x3f7d3aac,0x3f7a7302,0x3f76ba07,0x3f721352,0x3f731447,0x3f6d1c1d,0x3f660f88,0x3f5df6be
.long 0x3f61c598,0x3f584853,0x3f4d9f02,0x3f41d870,0x3f49d112,0x3f3ca003,0x3f2e3bde,0x3f1ebc12
.long 0x3f2beb4a,0x3f1b02c6,0x3f08f59b,0x3eebcbbb,0x3f08f59b,0x3ee900b7,0x3ebe1d4a,0x3e919ddd
.long 0,0,0,0,0x3e2f10a2,0x3e354098,0x3e3b6ecf,0x3e419b37
.long 0x3eac7cd4,0x3eb263ef,0x3eb8442a,0x3ebe1d4a,0x3efc5d27,0x3f0242b1,0x3f064b82,0x3f0a48ad
.long 0x3f226799,0x3f273656,0x3f2beb4a,0x3f3085bb,0x3f41d870,0x3f46e22a,0x3f4bbbf8,0x3f5064af
.long 0x3f5b941a,0x3f604621,0x3f64aa59,0x3f68bf3c,0x3f6ed89e,0x3f7294f8,0x3f75dec6,0x3f78b47b
.long 0x3f7b14be,0x3f7d3aac,0x3f7ec46d,0x3f7fb10f,0x3f7fec43,0x3f7fe129,0x3f7f0e58,0x3f7d7474
.long 0x3f7d3aac,0x3f7a7302,0x3f76ba07,0x3f721352,0x3f731447,0x3f6d1c1d,0x3f660f88,0x3f5df6be
.long 0x3f61c598,0x3f584853,0x3f4d9f02,0x3f41d870,0x3f49d112,0x3f3ca003,0x3f2e3bde,0x3f1ebc12
.long 0x3f2beb4a,0x3f1b02c6,0x3f08f59b,0x3eebcbbb,0x3f08f59b,0x3ee900b7,0x3ebe1d4a,0x3e919ddd
.long 0x3f80,0x3f80,0x3f80,0x3f80,0x3f80,0x3e483f7b,0x3ec43f6d,0x3f0e3f55
.long 0x3f80,0x3ec43f6d,0x3f353f35,0x3f6d3ec4,0x3f80,0x3f0e3f55,0x3f6d3ec4,0x3f7bbe48
.long 0x3f80,0x3f353f35,0x3f800000,0x3f35bf35,0x3f80,0x3f553f0e,0x3f6dbec4,0x3e48bf7b
.long 0x3f80,0x3f6d3ec4,0x3f35bf35,0xbec4bf6d,0x3f80,0x3f7b3e48,0x3ec4bf6d,0xbf55bf0e
.long 0x3f80,0x3f800000,0xbf80,0xbf800000,0x3f80,0x3f7bbe48,0xbec4bf6d,0xbf553f0e
.long 0x3f80,0x3f6dbec4,0xbf35bf35,0xbec43f6d,0x3f80,0x3f55bf0e,0xbf6dbec4,0x3e483f7b
.long 0x3f80,0x3f35bf35,0xbf800000,0x3f353f35,0x3f80,0x3f0ebf55,0xbf6d3ec4,0x3f7b3e48
.long 0x3f80,0x3ec4bf6d,0xbf353f35,0x3f6dbec4,0x3f80,0x3e48bf7b,0xbec43f6d,0x3f0ebf55
.long 0x3f80,0xbf80,0x3f80,0xbf80,0x3f80,0xbe48bf7b,0x3ec43f6d,0xbf0ebf55
.long 0x3f80,0xbec4bf6d,0x3f353f35,0xbf6dbec4,0x3f80,0xbf0ebf55,0x3f6d3ec4,0xbf7b3e48
.long 0x3f80,0xbf35bf35,0x3f800000,0xbf353f35,0x3f80,0xbf55bf0e,0x3f6dbec4,0xbe483f7b
.long 0x3f80,0xbf6dbec4,0x3f35bf35,0x3ec43f6d,0x3f80,0xbf7bbe48,0x3ec4bf6d,0x3f553f0e
.long 0x3f80,0xbf800000,0xbf80,0x3f800000,0x3f80,0xbf7b3e48,0xbec4bf6d,0x3f55bf0e
.long 0x3f80,0xbf6d3ec4,0xbf35bf35,0x3ec4bf6d,0x3f80,0xbf553f0e,0xbf6dbec4,0xbe48bf7b
.long 0x3f80,0xbf353f35,0xbf800000,0xbf35bf35,0x3f80,0xbf0e3f55,0xbf6d3ec4,0xbf7bbe48
.long 0x3f80,0xbec43f6d,0xbf353f35,0xbf6d3ec4,0x3f80,0xbe483f7b,0xbec43f6d,0xbf0e3f55
.long 0x3f80,0x3f80,0x3f80,0x3f80,0x3f353f35,0x3f553f0e,0x3f6d3ec4,0x3f7b3e48
.long 0x3f800000,0x3f6dbec4,0x3f35bf35,0x3ec4bf6d,0x3f35bf35,0x3e48bf7b,0xbec4bf6d,0xbf55bf0e
.long 0xbf80,0xbf35bf35,0xbf800000,0xbf353f35,0xbf35bf35,0xbf7b3e48,0xbec43f6d,0x3f0e3f55
.long 0xbf800000,0xbec43f6d,0x3f353f35,0x3f6dbec4,0xbf353f35,0x3f0e3f55,0x3f6dbec4,0xbe48bf7b
.long 0x3f80,0x3f800000,0xbf80,0xbf800000,0x3f353f35,0x3f0ebf55,0xbf6dbec4,0xbe483f7b
.long 0x3f800000,0xbec4bf6d,0xbf353f35,0x3f6d3ec4,0x3f35bf35,0xbf7bbe48,0x3ec43f6d,0x3f0ebf55
.long 0xbf80,0xbf353f35,0x3f800000,0xbf35bf35,0xbf35bf35,0x3e483f7b,0x3ec4bf6d,0xbf553f0e
.long 0xbf800000,0x3f6d3ec4,0xbf35bf35,0x3ec43f6d,0xbf353f35,0x3f55bf0e,0xbf6d3ec4,0x3f7bbe48
.long 0x3f80,0xbf80,0x3f80,0xbf80,0x3f353f35,0xbf55bf0e,0x3f6d3ec4,0xbf7bbe48
.long 0x3f800000,0xbf6d3ec4,0x3f35bf35,0xbec43f6d,0x3f35bf35,0xbe483f7b,0xbec4bf6d,0x3f553f0e
.long 0xbf80,0x3f353f35,0xbf800000,0x3f35bf35,0xbf35bf35,0x3f7bbe48,0xbec43f6d,0xbf0ebf55
.long 0xbf800000,0x3ec4bf6d,0x3f353f35,0xbf6d3ec4,0xbf353f35,0xbf0ebf55,0x3f6dbec4,0x3e483f7b
.long 0x3f80,0xbf800000,0xbf80,0x3f800000,0x3f353f35,0xbf0e3f55,0xbf6dbec4,0x3e48bf7b
.long 0x3f800000,0x3ec43f6d,0xbf353f35,0xbf6dbec4,0x3f35bf35,0x3f7b3e48,0x3ec43f6d,0xbf0e3f55
.long 0xbf80,0x3f35bf35,0x3f800000,0x3f353f35,0xbf35bf35,0xbe48bf7b,0x3ec4bf6d,0x3f55bf0e
.long 0xbf800000,0xbf6dbec4,0xbf35bf35,0xbec4bf6d,0xbf353f35,0xbf553f0e,0xbf6d3ec4,0xbf7b3e48
.long 0x3f80,0x3f80,0x3f80,0x3f80,0x3f800000,0x3f7bbe48,0x3f6dbec4,0x3f55bf0e
.long 0xbf80,0xbec4bf6d,0xbf35bf35,0xbf6dbec4,0xbf800000,0xbf553f0e,0xbec43f6d,0x3e483f7b
.long 0x3f80,0x3f353f35,0x3f800000,0x3f35bf35,0x3f800000,0x3f0ebf55,0xbec4bf6d,0xbf7bbe48
.long 0xbf80,0xbf6dbec4,0xbf353f35,0x3ec43f6d,0xbf800000,0xbe483f7b,0x3f6d3ec4,0x3f0ebf55
.long 0x3f80,0x3f800000,0xbf80,0xbf800000,0x3f800000,0xbe48bf7b,0xbf6d3ec4,0x3f0e3f55
.long 0xbf80,0xbf6d3ec4,0x3f353f35,0x3ec4bf6d,0xbf800000,0x3f0e3f55,0x3ec4bf6d,0xbf7b3e48
.long 0x3f80,0x3f35bf35,0xbf800000,0x3f353f35,0x3f800000,0xbf55bf0e,0x3ec43f6d,0x3e48bf7b
.long 0xbf80,0xbec43f6d,0x3f35bf35,0xbf6d3ec4,0xbf800000,0x3f7b3e48,0xbf6dbec4,0x3f553f0e
.long 0x3f80,0xbf80,0x3f80,0xbf80,0x3f800000,0xbf7b3e48,0x3f6dbec4,0xbf553f0e
.long 0xbf80,0x3ec43f6d,0xbf35bf35,0x3f6d3ec4,0xbf800000,0x3f55bf0e,0xbec43f6d,0xbe48bf7b
.long 0x3f80,0xbf35bf35,0x3f800000,0xbf353f35,0x3f800000,0xbf0e3f55,0xbec4bf6d,0x3f7b3e48
.long 0xbf80,0x3f6d3ec4,0xbf353f35,0xbec4bf6d,0xbf800000,0x3e48bf7b,0x3f6d3ec4,0xbf0e3f55
.long 0x3f80,0xbf800000,0xbf80,0x3f800000,0x3f800000,0x3e483f7b,0xbf6d3ec4,0xbf0ebf55
.long 0xbf80,0x3f6dbec4,0x3f353f35,0xbec43f6d,0xbf800000,0xbf0ebf55,0x3ec4bf6d,0x3f7bbe48
.long 0x3f80,0xbf353f35,0xbf800000,0xbf35bf35,0x3f800000,0x3f553f0e,0x3ec43f6d,0xbe483f7b
.long 0xbf80,0x3ec4bf6d,0x3f35bf35,0x3f6dbec4,0xbf800000,0xbf7bbe48,0xbf6dbec4,0xbf55bf0e
.long 0x3f80,0x3f80,0x3f80,0x3f80,0x3f35bf35,0x3f0ebf55,0x3ec4bf6d,0x3e48bf7b
.long 0xbf800000,0xbf6d3ec4,0xbf353f35,0xbec43f6d,0x3f353f35,0x3f7b3e48,0x3f6dbec4,0x3f0ebf55
.long 0xbf80,0xbf35bf35,0xbf800000,0xbf353f35,0xbf353f35,0x3e483f7b,0x3f6d3ec4,0x3f55bf0e
.long 0x3f800000,0x3ec4bf6d,0xbf35bf35,0xbf6d3ec4,0xbf35bf35,0xbf553f0e,0x3ec43f6d,0x3f7bbe48
.long 0x3f80,0x3f800000,0xbf80,0xbf800000,0x3f35bf35,0xbf55bf0e,0xbec43f6d,0x3f7b3e48
.long 0xbf800000,0x3ec43f6d,0x3f35bf35,0xbf6dbec4,0x3f353f35,0x3e48bf7b,0xbf6d3ec4,0x3f553f0e
.long 0xbf80,0xbf353f35,0x3f800000,0xbf35bf35,0xbf353f35,0x3f7bbe48,0xbf6dbec4,0x3f0e3f55
.long 0x3f800000,0xbf6dbec4,0x3f353f35,0xbec4bf6d,0xbf35bf35,0x3f0e3f55,0xbec4bf6d,0x3e483f7b
.long 0x3f80,0xbf80,0x3f80,0xbf80,0x3f35bf35,0xbf0e3f55,0x3ec4bf6d,0xbe483f7b
.long 0xbf800000,0x3f6dbec4,0xbf353f35,0x3ec4bf6d,0x3f353f35,0xbf7bbe48,0x3f6dbec4,0xbf0e3f55
.long 0xbf80,0x3f353f35,0xbf800000,0x3f35bf35,0xbf353f35,0xbe48bf7b,0x3f6d3ec4,0xbf553f0e
.long 0x3f800000,0xbec43f6d,0xbf35bf35,0x3f6dbec4,0xbf35bf35,0x3f55bf0e,0x3ec43f6d,0xbf7b3e48
.long 0x3f80,0xbf800000,0xbf80,0x3f800000,0x3f35bf35,0x3f553f0e,0xbec43f6d,0xbf7bbe48
.long 0xbf800000,0xbec4bf6d,0x3f35bf35,0x3f6d3ec4,0x3f353f35,0xbe483f7b,0xbf6d3ec4,0xbf55bf0e
.long 0xbf80,0x3f35bf35,0x3f800000,0x3f353f35,0xbf353f35,0xbf7b3e48,0xbf6dbec4,0xbf0ebf55
.long 0x3f800000,0x3f6d3ec4,0x3f353f35,0x3ec43f6d,0xbf35bf35,0xbf0ebf55,0xbec4bf6d,0xbe48bf7b
.long 0x3f80,0x3f80,0x3f80,0x3f80,0xbf80,0xbe48bf7b,0xbec4bf6d,0xbf0ebf55
.long 0x3f80,0x3ec43f6d,0x3f353f35,0x3f6d3ec4,0xbf80,0xbf0ebf55,0xbf6dbec4,0xbf7b3e48
.long 0x3f80,0x3f353f35,0x3f800000,0x3f35bf35,0xbf80,0xbf55bf0e,0xbf6d3ec4,0xbe483f7b
.long 0x3f80,0x3f6d3ec4,0x3f35bf35,0xbec4bf6d,0xbf80,0xbf7bbe48,0xbec43f6d,0x3f553f0e
.long 0x3f80,0x3f800000,0xbf80,0xbf800000,0xbf80,0xbf7b3e48,0x3ec43f6d,0x3f55bf0e
.long 0x3f80,0x3f6dbec4,0xbf35bf35,0xbec43f6d,0xbf80,0xbf553f0e,0x3f6d3ec4,0xbe48bf7b
.long 0x3f80,0x3f35bf35,0xbf800000,0x3f353f35,0xbf80,0xbf0e3f55,0x3f6dbec4,0xbf7bbe48
.long 0x3f80,0x3ec4bf6d,0xbf353f35,0x3f6dbec4,0xbf80,0xbe483f7b,0x3ec4bf6d,0xbf0e3f55
.long 0x3f80,0xbf80,0x3f80,0xbf80,0xbf80,0x3e483f7b,0xbec4bf6d,0x3f0e3f55
.long 0x3f80,0xbec4bf6d,0x3f353f35,0xbf6dbec4,0xbf80,0x3f0e3f55,0xbf6dbec4,0x3f7bbe48
.long 0x3f80,0xbf35bf35,0x3f800000,0xbf353f35,0xbf80,0x3f553f0e,0xbf6d3ec4,0x3e48bf7b
.long 0x3f80,0xbf6dbec4,0x3f35bf35,0x3ec43f6d,0xbf80,0x3f7b3e48,0xbec43f6d,0xbf55bf0e
.long 0x3f80,0xbf800000,0xbf80,0x3f800000,0xbf80,0x3f7bbe48,0x3ec43f6d,0xbf553f0e
.long 0x3f80,0xbf6d3ec4,0xbf35bf35,0x3ec4bf6d,0xbf80,0x3f55bf0e,0x3f6d3ec4,0x3e483f7b
.long 0x3f80,0xbf353f35,0xbf800000,0xbf35bf35,0xbf80,0x3f0ebf55,0x3f6dbec4,0x3f7b3e48
.long 0x3f80,0xbec43f6d,0xbf353f35,0xbf6d3ec4,0xbf80,0x3e48bf7b,0x3ec4bf6d,0x3f0ebf55
.long 0x3f80,0x3f80,0x3f80,0x3f80,0xbf35bf35,0xbf55bf0e,0xbf6dbec4,0xbf7bbe48
.long 0x3f800000,0x3f6dbec4,0x3f35bf35,0x3ec4bf6d,0xbf353f35,0xbe483f7b,0x3ec43f6d,0x3f553f0e
.long 0xbf80,0xbf35bf35,0xbf800000,0xbf353f35,0x3f353f35,0x3f7bbe48,0x3ec4bf6d,0xbf0ebf55
.long 0xbf800000,0xbec43f6d,0x3f353f35,0x3f6dbec4,0x3f35bf35,0xbf0ebf55,0xbf6d3ec4,0x3e483f7b
.long 0x3f80,0x3f800000,0xbf80,0xbf800000,0xbf35bf35,0xbf0e3f55,0x3f6d3ec4,0x3e48bf7b
.long 0x3f800000,0xbec4bf6d,0xbf353f35,0x3f6d3ec4,0xbf353f35,0x3f7b3e48,0xbec4bf6d,0xbf0e3f55
.long 0xbf80,0xbf353f35,0x3f800000,0xbf35bf35,0x3f353f35,0xbe48bf7b,0xbec43f6d,0x3f55bf0e
.long 0xbf800000,0x3f6d3ec4,0xbf35bf35,0x3ec43f6d,0x3f35bf35,0xbf553f0e,0x3f6dbec4,0xbf7b3e48
.long 0x3f80,0xbf80,0x3f80,0xbf80,0xbf35bf35,0x3f553f0e,0xbf6dbec4,0x3f7b3e48
.long 0x3f800000,0xbf6d3ec4,0x3f35bf35,0xbec43f6d,0xbf353f35,0x3e48bf7b,0x3ec43f6d,0xbf55bf0e
.long 0xbf80,0x3f353f35,0xbf800000,0x3f35bf35,0x3f353f35,0xbf7b3e48,0x3ec4bf6d,0x3f0e3f55
.long 0xbf800000,0x3ec4bf6d,0x3f353f35,0xbf6d3ec4,0x3f35bf35,0x3f0e3f55,0xbf6d3ec4,0xbe48bf7b
.long 0x3f80,0xbf800000,0xbf80,0x3f800000,0xbf35bf35,0x3f0ebf55,0x3f6d3ec4,0xbe483f7b
.long 0x3f800000,0x3ec43f6d,0xbf353f35,0xbf6dbec4,0xbf353f35,0xbf7bbe48,0xbec4bf6d,0x3f0ebf55
.long 0xbf80,0x3f35bf35,0x3f800000,0x3f353f35,0x3f353f35,0x3e483f7b,0xbec43f6d,0xbf553f0e
.long 0xbf800000,0xbf6dbec4,0xbf35bf35,0xbec4bf6d,0x3f35bf35,0x3f55bf0e,0x3f6dbec4,0x3f7bbe48
.long 0x3f80,0x3f80,0x3f80,0x3f80,0xbf800000,0xbf7b3e48,0xbf6d3ec4,0xbf553f0e
.long 0xbf80,0xbec4bf6d,0xbf35bf35,0xbf6dbec4,0x3f800000,0x3f55bf0e,0x3ec4bf6d,0xbe48bf7b
.long 0x3f80,0x3f353f35,0x3f800000,0x3f35bf35,0xbf800000,0xbf0e3f55,0x3ec43f6d,0x3f7b3e48
.long 0xbf80,0xbf6dbec4,0xbf353f35,0x3ec43f6d,0x3f800000,0x3e48bf7b,0xbf6dbec4,0xbf0e3f55
.long 0x3f80,0x3f800000,0xbf80,0xbf800000,0xbf800000,0x3e483f7b,0x3f6dbec4,0xbf0ebf55
.long 0xbf80,0xbf6d3ec4,0x3f353f35,0x3ec4bf6d,0x3f800000,0xbf0ebf55,0xbec43f6d,0x3f7bbe48
.long 0x3f80,0x3f35bf35,0xbf800000,0x3f353f35,0xbf800000,0x3f553f0e,0xbec4bf6d,0xbe483f7b
.long 0xbf80,0xbec43f6d,0x3f35bf35,0xbf6d3ec4,0x3f800000,0xbf7bbe48,0x3f6d3ec4,0xbf55bf0e
.long 0x3f80,0xbf80,0x3f80,0xbf80,0xbf800000,0x3f7bbe48,0xbf6d3ec4,0x3f55bf0e
.long 0xbf80,0x3ec43f6d,0xbf35bf35,0x3f6d3ec4,0x3f800000,0xbf553f0e,0x3ec4bf6d,0x3e483f7b
.long 0x3f80,0xbf35bf35,0x3f800000,0xbf353f35,0xbf800000,0x3f0ebf55,0x3ec43f6d,0xbf7bbe48
.long 0xbf80,0x3f6d3ec4,0xbf353f35,0xbec4bf6d,0x3f800000,0xbe483f7b,0xbf6dbec4,0x3f0ebf55
.long 0x3f80,0xbf800000,0xbf80,0x3f800000,0xbf800000,0xbe48bf7b,0x3f6dbec4,0x3f0e3f55
.long 0xbf80,0x3f6dbec4,0x3f353f35,0xbec43f6d,0x3f800000,0x3f0e3f55,0xbec43f6d,0xbf7b3e48
.long 0x3f80,0xbf353f35,0xbf800000,0xbf35bf35,0xbf800000,0xbf55bf0e,0xbec4bf6d,0x3e48bf7b
.long 0xbf80,0x3ec4bf6d,0x3f35bf35,0x3f6dbec4,0x3f800000,0x3f7b3e48,0x3f6d3ec4,0x3f553f0e
.long 0x3f80,0x3f80,0x3f80,0x3f80,0xbf353f35,0xbf0e3f55,0xbec43f6d,0xbe483f7b
.long 0xbf800000,0xbf6d3ec4,0xbf353f35,0xbec43f6d,0xbf35bf35,0xbf7bbe48,0xbf6d3ec4,0xbf0e3f55
.long 0xbf80,0xbf35bf35,0xbf800000,0xbf353f35,0x3f35bf35,0xbe48bf7b,0xbf6dbec4,0xbf553f0e
.long 0x3f800000,0x3ec4bf6d,0xbf35bf35,0xbf6d3ec4,0x3f353f35,0x3f55bf0e,0xbec4bf6d,0xbf7b3e48
.long 0x3f80,0x3f800000,0xbf80,0xbf800000,0xbf353f35,0x3f553f0e,0x3ec4bf6d,0xbf7bbe48
.long 0xbf800000,0x3ec43f6d,0x3f35bf35,0xbf6dbec4,0xbf35bf35,0xbe483f7b,0x3f6dbec4,0xbf55bf0e
.long 0xbf80,0xbf353f35,0x3f800000,0xbf35bf35,0x3f35bf35,0xbf7b3e48,0x3f6d3ec4,0xbf0ebf55
.long 0x3f800000,0xbf6dbec4,0x3f353f35,0xbec4bf6d,0x3f353f35,0xbf0ebf55,0x3ec43f6d,0xbe48bf7b
.long 0x3f80,0xbf80,0x3f80,0xbf80,0xbf353f35,0x3f0ebf55,0xbec43f6d,0x3e48bf7b
.long 0xbf800000,0x3f6dbec4,0xbf353f35,0x3ec4bf6d,0xbf35bf35,0x3f7b3e48,0xbf6d3ec4,0x3f0ebf55
.long 0xbf80,0x3f353f35,0xbf800000,0x3f35bf35,0x3f35bf35,0x3e483f7b,0xbf6dbec4,0x3f55bf0e
.long 0x3f800000,0xbec43f6d,0xbf35bf35,0x3f6dbec4,0x3f353f35,0xbf553f0e,0xbec4bf6d,0x3f7bbe48
.long 0x3f80,0xbf800000,0xbf80,0x3f800000,0xbf353f35,0xbf55bf0e,0x3ec4bf6d,0x3f7b3e48
.long 0xbf800000,0xbec4bf6d,0x3f35bf35,0x3f6d3ec4,0xbf35bf35,0x3e48bf7b,0x3f6dbec4,0x3f553f0e
.long 0xbf80,0x3f35bf35,0x3f800000,0x3f353f35,0x3f35bf35,0x3f7bbe48,0x3f6d3ec4,0x3f0e3f55
.long 0x3f800000,0x3f6d3ec4,0x3f353f35,0x3ec43f6d,0x3f353f35,0x3f0e3f55,0x3ec43f6d,0x3e483f7b
.long 0x3f808000,0x3f808000,0x3f808000,0x3f808000,0x3f808000,0x3f7bbe48,0x3f6dbec4,0x3f55bf0e
.long 0x3f808000,0x3f6dbec4,0x3f35bf35,0x3ec4bf6d,0x3f808000,0x3f55bf0e,0x3ec4bf6d,0xbe48bf7b
.long 0x3f808000,0x3f35bf35,0xbf80,0xbf35bf35,0x3f808000,0x3f0ebf55,0xbec4bf6d,0xbf7bbe48
.long 0x3f808000,0x3ec4bf6d,0xbf35bf35,0xbf6d3ec4,0x3f808000,0x3e48bf7b,0xbf6dbec4,0xbf0e3f55
.long 0x3f808000,0xbf80,0xbf808000,0x3f80,0x3f808000,0xbe48bf7b,0xbf6d3ec4,0x3f0e3f55
.long 0x3f808000,0xbec4bf6d,0xbf353f35,0x3f6d3ec4,0x3f808000,0xbf0ebf55,0xbec43f6d,0x3f7bbe48
.long 0x3f808000,0xbf35bf35,0x3f80,0x3f35bf35,0x3f808000,0xbf55bf0e,0x3ec43f6d,0x3e48bf7b
.long 0x3f808000,0xbf6dbec4,0x3f353f35,0xbec4bf6d,0x3f808000,0xbf7bbe48,0x3f6d3ec4,0xbf55bf0e
.long 0x3f808000,0xbf808000,0x3f808000,0xbf808000,0x3f808000,0xbf7b3e48,0x3f6dbec4,0xbf553f0e
.long 0x3f808000,0xbf6d3ec4,0x3f35bf35,0xbec43f6d,0x3f808000,0xbf553f0e,0x3ec4bf6d,0x3e483f7b
.long 0x3f808000,0xbf353f35,0xbf80,0x3f353f35,0x3f808000,0xbf0e3f55,0xbec4bf6d,0x3f7b3e48
.long 0x3f808000,0xbec43f6d,0xbf35bf35,0x3f6dbec4,0x3f808000,0xbe483f7b,0xbf6dbec4,0x3f0ebf55
.long 0x3f808000,0x3f80,0xbf808000,0xbf80,0x3f808000,0x3e483f7b,0xbf6d3ec4,0xbf0ebf55
.long 0x3f808000,0x3ec43f6d,0xbf353f35,0xbf6dbec4,0x3f808000,0x3f0e3f55,0xbec43f6d,0xbf7b3e48
.long 0x3f808000,0x3f353f35,0x3f80,0xbf353f35,0x3f808000,0x3f553f0e,0x3ec43f6d,0xbe483f7b
.long 0x3f808000,0x3f6d3ec4,0x3f353f35,0x3ec43f6d,0x3f808000,0x3f7b3e48,0x3f6d3ec4,0x3f553f0e
.long 0x3f808000,0x3f808000,0x3f808000,0x3f808000,0x3f35bf35,0x3f0ebf55,0x3ec4bf6d,0x3e48bf7b
.long 0xbf80,0xbec4bf6d,0xbf35bf35,0xbf6dbec4,0xbf35bf35,0xbf7bbe48,0xbf6d3ec4,0xbf0e3f55
.long 0xbf808000,0xbf353f35,0x3f80,0x3f353f35,0xbf353f35,0x3e483f7b,0x3f6d3ec4,0x3f55bf0e
.long 0x3f80,0x3f6d3ec4,0x3f35bf35,0xbec4bf6d,0x3f353f35,0x3f55bf0e,0xbec4bf6d,0xbf7b3e48
.long 0x3f808000,0xbf80,0xbf808000,0x3f80,0x3f35bf35,0xbf55bf0e,0xbec43f6d,0x3f7b3e48
.long 0xbf80,0xbf6d3ec4,0x3f353f35,0x3ec4bf6d,0xbf35bf35,0xbe483f7b,0x3f6dbec4,0xbf55bf0e
.long 0xbf808000,0x3f353f35,0xbf80,0xbf353f35,0xbf353f35,0x3f7bbe48,0xbf6dbec4,0x3f0e3f55
.long 0x3f80,0x3ec4bf6d,0xbf353f35,0x3f6dbec4,0x3f353f35,0xbf0ebf55,0x3ec43f6d,0xbe48bf7b
.long 0x3f808000,0xbf808000,0x3f808000,0xbf808000,0x3f35bf35,0xbf0e3f55,0x3ec4bf6d,0xbe483f7b
.long 0xbf80,0x3ec43f6d,0xbf35bf35,0x3f6d3ec4,0xbf35bf35,0x3f7b3e48,0xbf6d3ec4,0x3f0ebf55
.long 0xbf808000,0x3f35bf35,0x3f80,0xbf35bf35,0xbf353f35,0xbe48bf7b,0x3f6d3ec4,0xbf553f0e
.long 0x3f80,0xbf6dbec4,0x3f35bf35,0x3ec43f6d,0x3f353f35,0xbf553f0e,0xbec4bf6d,0x3f7bbe48
.long 0x3f808000,0x3f80,0xbf808000,0xbf80,0x3f35bf35,0x3f553f0e,0xbec43f6d,0xbf7bbe48
.long 0xbf80,0x3f6dbec4,0x3f353f35,0xbec43f6d,0xbf35bf35,0x3e48bf7b,0x3f6dbec4,0x3f553f0e
.long 0xbf808000,0xbf35bf35,0xbf80,0x3f35bf35,0xbf353f35,0xbf7b3e48,0xbf6dbec4,0xbf0ebf55
.long 0x3f80,0xbec43f6d,0xbf353f35,0xbf6d3ec4,0x3f353f35,0x3f0e3f55,0x3ec43f6d,0x3e483f7b
.long 0x3f808000,0x3f808000,0x3f808000,0x3f808000,0xbf80,0xbe48bf7b,0xbec4bf6d,0xbf0ebf55
.long 0xbf808000,0xbf6d3ec4,0xbf353f35,0xbec43f6d,0x3f80,0x3f0e3f55,0x3f6d3ec4,0x3f7bbe48
.long 0x3f808000,0x3f35bf35,0xbf80,0xbf35bf35,0xbf80,0xbf55bf0e,0xbf6d3ec4,0xbe483f7b
.long 0xbf808000,0xbec43f6d,0x3f353f35,0x3f6dbec4,0x3f80,0x3f7b3e48,0x3ec4bf6d,0xbf55bf0e
.long 0x3f808000,0xbf80,0xbf808000,0x3f80,0xbf80,0xbf7b3e48,0x3ec43f6d,0x3f55bf0e
.long 0xbf808000,0x3ec43f6d,0x3f35bf35,0xbf6dbec4,0x3f80,0x3f55bf0e,0xbf6dbec4,0x3e483f7b
.long 0x3f808000,0xbf35bf35,0x3f80,0x3f35bf35,0xbf80,0xbf0e3f55,0x3f6dbec4,0xbf7bbe48
.long 0xbf808000,0x3f6d3ec4,0xbf35bf35,0x3ec43f6d,0x3f80,0x3e48bf7b,0xbec43f6d,0x3f0ebf55
.long 0x3f808000,0xbf808000,0x3f808000,0xbf808000,0xbf80,0x3e483f7b,0xbec4bf6d,0x3f0e3f55
.long 0xbf808000,0x3f6dbec4,0xbf353f35,0x3ec4bf6d,0x3f80,0xbf0ebf55,0x3f6d3ec4,0xbf7b3e48
.long 0x3f808000,0xbf353f35,0xbf80,0x3f353f35,0xbf80,0x3f553f0e,0xbf6d3ec4,0x3e48bf7b
.long 0xbf808000,0x3ec4bf6d,0x3f353f35,0xbf6d3ec4,0x3f80,0xbf7bbe48,0x3ec4bf6d,0x3f553f0e
.long 0x3f808000,0x3f80,0xbf808000,0xbf80,0xbf80,0x3f7bbe48,0x3ec43f6d,0xbf553f0e
.long 0xbf808000,0xbec4bf6d,0x3f35bf35,0x3f6d3ec4,0x3f80,0xbf553f0e,0xbf6dbec4,0xbe48bf7b
.long 0x3f808000,0x3f353f35,0x3f80,0xbf353f35,0xbf80,0x3f0ebf55,0x3f6dbec4,0x3f7b3e48
.long 0xbf808000,0xbf6dbec4,0xbf35bf35,0xbec4bf6d,0x3f80,0xbe483f7b,0xbec43f6d,0xbf0e3f55
.long 0x3f808000,0x3f808000,0x3f808000,0x3f808000,0xbf35bf35,0xbf55bf0e,0xbf6dbec4,0xbf7bbe48
.long 0x3f80,0x3ec43f6d,0x3f353f35,0x3f6d3ec4,0x3f35bf35,0x3e48bf7b,0xbec4bf6d,0xbf55bf0e
.long 0xbf808000,0xbf353f35,0x3f80,0x3f353f35,0x3f353f35,0x3f7bbe48,0x3ec4bf6d,0xbf0ebf55
.long 0xbf80,0xbf6dbec4,0xbf353f35,0x3ec43f6d,0xbf353f35,0x3f0e3f55,0x3f6dbec4,0xbe48bf7b
.long 0x3f808000,0xbf80,0xbf808000,0x3f80,0xbf35bf35,0xbf0e3f55,0x3f6d3ec4,0x3e48bf7b
.long 0x3f80,0x3f6dbec4,0xbf35bf35,0xbec43f6d,0x3f35bf35,0xbf7bbe48,0x3ec43f6d,0x3f0ebf55
.long 0xbf808000,0x3f353f35,0xbf80,0xbf353f35,0x3f353f35,0xbe48bf7b,0xbec43f6d,0x3f55bf0e
.long 0xbf80,0xbec43f6d,0x3f35bf35,0xbf6d3ec4,0xbf353f35,0x3f55bf0e,0xbf6d3ec4,0x3f7bbe48
.long 0x3f808000,0xbf808000,0x3f808000,0xbf808000,0xbf35bf35,0x3f553f0e,0xbf6dbec4,0x3f7b3e48
.long 0x3f80,0xbec4bf6d,0x3f353f35,0xbf6dbec4,0x3f35bf35,0xbe483f7b,0xbec4bf6d,0x3f553f0e
.long 0xbf808000,0x3f35bf35,0x3f80,0xbf35bf35,0x3f353f35,0xbf7b3e48,0x3ec4bf6d,0x3f0e3f55
.long 0xbf80,0x3f6d3ec4,0xbf353f35,0xbec4bf6d,0xbf353f35,0xbf0ebf55,0x3f6dbec4,0x3e483f7b
.long 0x3f808000,0x3f80,0xbf808000,0xbf80,0xbf35bf35,0x3f0ebf55,0x3f6d3ec4,0xbe483f7b
.long 0x3f80,0xbf6d3ec4,0xbf35bf35,0x3ec4bf6d,0x3f35bf35,0x3f7b3e48,0x3ec43f6d,0xbf0e3f55
.long 0xbf808000,0xbf35bf35,0xbf80,0x3f35bf35,0x3f353f35,0x3e483f7b,0xbec43f6d,0xbf553f0e
.long 0xbf80,0x3ec4bf6d,0x3f35bf35,0x3f6dbec4,0xbf353f35,0xbf553f0e,0xbf6d3ec4,0xbf7b3e48
.long 0x3f808000,0x3f808000,0x3f808000,0x3f808000,0xbf808000,0xbf7b3e48,0xbf6d3ec4,0xbf553f0e
.long 0x3f808000,0x3f6dbec4,0x3f35bf35,0x3ec4bf6d,0xbf808000,0xbf553f0e,0xbec43f6d,0x3e483f7b
.long 0x3f808000,0x3f35bf35,0xbf80,0xbf35bf35,0xbf808000,0xbf0e3f55,0x3ec43f6d,0x3f7b3e48
.long 0x3f808000,0x3ec4bf6d,0xbf35bf35,0xbf6d3ec4,0xbf808000,0xbe483f7b,0x3f6d3ec4,0x3f0ebf55
.long 0x3f808000,0xbf80,0xbf808000,0x3f80,0xbf808000,0x3e483f7b,0x3f6dbec4,0xbf0ebf55
.long 0x3f808000,0xbec4bf6d,0xbf353f35,0x3f6d3ec4,0xbf808000,0x3f0e3f55,0x3ec4bf6d,0xbf7b3e48
.long 0x3f808000,0xbf35bf35,0x3f80,0x3f35bf35,0xbf808000,0x3f553f0e,0xbec4bf6d,0xbe483f7b
.long 0x3f808000,0xbf6dbec4,0x3f353f35,0xbec4bf6d,0xbf808000,0x3f7b3e48,0xbf6dbec4,0x3f553f0e
.long 0x3f808000,0xbf808000,0x3f808000,0xbf808000,0xbf808000,0x3f7bbe48,0xbf6d3ec4,0x3f55bf0e
.long 0x3f808000,0xbf6d3ec4,0x3f35bf35,0xbec43f6d,0xbf808000,0x3f55bf0e,0xbec43f6d,0xbe48bf7b
.long 0x3f808000,0xbf353f35,0xbf80,0x3f353f35,0xbf808000,0x3f0ebf55,0x3ec43f6d,0xbf7bbe48
.long 0x3f808000,0xbec43f6d,0xbf35bf35,0x3f6dbec4,0xbf808000,0x3e48bf7b,0x3f6d3ec4,0xbf0e3f55
.long 0x3f808000,0x3f80,0xbf808000,0xbf80,0xbf808000,0xbe48bf7b,0x3f6dbec4,0x3f0e3f55
.long 0x3f808000,0x3ec43f6d,0xbf353f35,0xbf6dbec4,0xbf808000,0xbf0ebf55,0x3ec4bf6d,0x3f7bbe48
.long 0x3f808000,0x3f353f35,0x3f80,0xbf353f35,0xbf808000,0xbf55bf0e,0xbec4bf6d,0x3e48bf7b
.long 0x3f808000,0x3f6d3ec4,0x3f353f35,0x3ec43f6d,0xbf808000,0xbf7bbe48,0xbf6dbec4,0xbf55bf0e
.long 0x3f808000,0x3f808000,0x3f808000,0x3f808000,0xbf353f35,0xbf0e3f55,0xbec43f6d,0xbe483f7b
.long 0xbf80,0xbec4bf6d,0xbf35bf35,0xbf6dbec4,0x3f353f35,0x3f7b3e48,0x3f6dbec4,0x3f0ebf55
.long 0xbf808000,0xbf353f35,0x3f80,0x3f353f35,0x3f35bf35,0xbe48bf7b,0xbf6dbec4,0xbf553f0e
.long 0x3f80,0x3f6d3ec4,0x3f35bf35,0xbec4bf6d,0xbf35bf35,0xbf553f0e,0x3ec43f6d,0x3f7bbe48
.long 0x3f808000,0xbf80,0xbf808000,0x3f80,0xbf353f35,0x3f553f0e,0x3ec4bf6d,0xbf7bbe48
.long 0xbf80,0xbf6d3ec4,0x3f353f35,0x3ec4bf6d,0x3f353f35,0x3e48bf7b,0xbf6d3ec4,0x3f553f0e
.long 0xbf808000,0x3f353f35,0xbf80,0xbf353f35,0x3f35bf35,0xbf7b3e48,0x3f6d3ec4,0xbf0ebf55
.long 0x3f80,0x3ec4bf6d,0xbf353f35,0x3f6dbec4,0xbf35bf35,0x3f0e3f55,0xbec4bf6d,0x3e483f7b
.long 0x3f808000,0xbf808000,0x3f808000,0xbf808000,0xbf353f35,0x3f0ebf55,0xbec43f6d,0x3e48bf7b
.long 0xbf80,0x3ec43f6d,0xbf35bf35,0x3f6d3ec4,0x3f353f35,0xbf7bbe48,0x3f6dbec4,0xbf0e3f55
.long 0xbf808000,0x3f35bf35,0x3f80,0xbf35bf35,0x3f35bf35,0x3e483f7b,0xbf6dbec4,0x3f55bf0e
.long 0x3f80,0xbf6dbec4,0x3f35bf35,0x3ec43f6d,0xbf35bf35,0x3f55bf0e,0x3ec43f6d,0xbf7b3e48
.long 0x3f808000,0x3f80,0xbf808000,0xbf80,0xbf353f35,0xbf55bf0e,0x3ec4bf6d,0x3f7b3e48
.long 0xbf80,0x3f6dbec4,0x3f353f35,0xbec43f6d,0x3f353f35,0xbe483f7b,0xbf6d3ec4,0xbf55bf0e
.long 0xbf808000,0xbf35bf35,0xbf80,0x3f35bf35,0x3f35bf35,0x3f7bbe48,0x3f6d3ec4,0x3f0e3f55
.long 0x3f80,0xbec43f6d,0xbf353f35,0xbf6d3ec4,0xbf35bf35,0xbf0ebf55,0xbec4bf6d,0xbe48bf7b
.long 0x3f808000,0x3f808000,0x3f808000,0x3f808000,0x3f80,0x3e483f7b,0x3ec43f6d,0x3f0e3f55
.long 0xbf808000,0xbf6d3ec4,0xbf353f35,0xbec43f6d,0xbf80,0xbf0ebf55,0xbf6dbec4,0xbf7b3e48
.long 0x3f808000,0x3f35bf35,0xbf80,0xbf35bf35,0x3f80,0x3f553f0e,0x3f6dbec4,0x3e48bf7b
.long 0xbf808000,0xbec43f6d,0x3f353f35,0x3f6dbec4,0xbf80,0xbf7bbe48,0xbec43f6d,0x3f553f0e
.long 0x3f808000,0xbf80,0xbf808000,0x3f80,0x3f80,0x3f7bbe48,0xbec4bf6d,0xbf553f0e
.long 0xbf808000,0x3ec43f6d,0x3f35bf35,0xbf6dbec4,0xbf80,0xbf553f0e,0x3f6d3ec4,0xbe48bf7b
.long 0x3f808000,0xbf35bf35,0x3f80,0x3f35bf35,0x3f80,0x3f0ebf55,0xbf6d3ec4,0x3f7b3e48
.long 0xbf808000,0x3f6d3ec4,0xbf35bf35,0x3ec43f6d,0xbf80,0xbe483f7b,0x3ec4bf6d,0xbf0e3f55
.long 0x3f808000,0xbf808000,0x3f808000,0xbf808000,0x3f80,0xbe48bf7b,0x3ec43f6d,0xbf0ebf55
.long 0xbf808000,0x3f6dbec4,0xbf353f35,0x3ec4bf6d,0xbf80,0x3f0e3f55,0xbf6dbec4,0x3f7bbe48
.long 0x3f808000,0xbf353f35,0xbf80,0x3f353f35,0x3f80,0xbf55bf0e,0x3f6dbec4,0xbe483f7b
.long 0xbf808000,0x3ec4bf6d,0x3f353f35,0xbf6d3ec4,0xbf80,0x3f7b3e48,0xbec43f6d,0xbf55bf0e
.long 0x3f808000,0x3f80,0xbf808000,0xbf80,0x3f80,0xbf7b3e48,0xbec4bf6d,0x3f55bf0e
.long 0xbf808000,0xbec4bf6d,0x3f35bf35,0x3f6d3ec4,0xbf80,0x3f55bf0e,0x3f6d3ec4,0x3e483f7b
.long 0x3f808000,0x3f353f35,0x3f80,0xbf353f35,0x3f80,0xbf0e3f55,0xbf6d3ec4,0xbf7bbe48
.long 0xbf808000,0xbf6dbec4,0xbf35bf35,0xbec4bf6d,0xbf80,0x3e48bf7b,0x3ec4bf6d,0x3f0ebf55
.long 0x3f808000,0x3f808000,0x3f808000,0x3f808000,0x3f353f35,0x3f553f0e,0x3f6d3ec4,0x3f7b3e48
.long 0x3f80,0x3ec43f6d,0x3f353f35,0x3f6d3ec4,0xbf353f35,0xbe483f7b,0x3ec43f6d,0x3f553f0e
.long 0xbf808000,0xbf353f35,0x3f80,0x3f353f35,0xbf35bf35,0xbf7b3e48,0xbec43f6d,0x3f0e3f55
.long 0xbf80,0xbf6dbec4,0xbf353f35,0x3ec43f6d,0x3f35bf35,0xbf0ebf55,0xbf6d3ec4,0x3e483f7b
.long 0x3f808000,0xbf80,0xbf808000,0x3f80,0x3f353f35,0x3f0ebf55,0xbf6dbec4,0xbe483f7b
.long 0x3f80,0x3f6dbec4,0xbf35bf35,0xbec43f6d,0xbf353f35,0x3f7b3e48,0xbec4bf6d,0xbf0e3f55
.long 0xbf808000,0x3f353f35,0xbf80,0xbf353f35,0xbf35bf35,0x3e483f7b,0x3ec4bf6d,0xbf553f0e
.long 0xbf80,0xbec43f6d,0x3f35bf35,0xbf6d3ec4,0x3f35bf35,0xbf553f0e,0x3f6dbec4,0xbf7b3e48
.long 0x3f808000,0xbf808000,0x3f808000,0xbf808000,0x3f353f35,0xbf55bf0e,0x3f6d3ec4,0xbf7bbe48
.long 0x3f80,0xbec4bf6d,0x3f353f35,0xbf6dbec4,0xbf353f35,0x3e48bf7b,0x3ec43f6d,0xbf55bf0e
.long 0xbf808000,0x3f35bf35,0x3f80,0xbf35bf35,0xbf35bf35,0x3f7bbe48,0xbec43f6d,0xbf0ebf55
.long 0xbf80,0x3f6d3ec4,0xbf353f35,0xbec4bf6d,0x3f35bf35,0x3f0e3f55,0xbf6d3ec4,0xbe48bf7b
.long 0x3f808000,0x3f80,0xbf808000,0xbf80,0x3f353f35,0xbf0e3f55,0xbf6dbec4,0x3e48bf7b
.long 0x3f80,0xbf6d3ec4,0xbf35bf35,0x3ec4bf6d,0xbf353f35,0xbf7bbe48,0xbec4bf6d,0x3f0ebf55
.long 0xbf808000,0xbf35bf35,0xbf80,0x3f35bf35,0xbf35bf35,0xbe48bf7b,0x3ec4bf6d,0x3f55bf0e
.long 0xbf80,0x3ec4bf6d,0x3f35bf35,0x3f6dbec4,0x3f35bf35,0x3f55bf0e,0x3f6dbec4,0x3f7bbe48
.long 0x3f800000,0x3f7f0000,0x3f7b0000,0x3f750000,0x3f800000,0x3f750000,0x3f550000,0x3f220000
.long 0x3f800000,0x3f620000,0x3f0e0000,0x3dc90000,0x3f800000,0x3f460000,0x3e480000,0xbef18000
.long 0x3f800000,0x3f220000,0xbe488000,0xbf628000,0x3f800000,0x3ef10000,0xbf0e8000,0xbf7f8000
.long 0x3f800000,0x3e950000,0xbf558000,0xbf468000,0x3f800000,0x3dc90000,0xbf7b8000,0xbe958000
.long 0x3f800000,0xbdc98000,0xbf7b8000,0x3e950000,0x3f800000,0xbe958000,0xbf558000,0x3f460000
.long 0x3f800000,0xbef18000,0xbf0e8000,0x3f7f0000,0x3f800000,0xbf228000,0xbe488000,0x3f620000
.long 0x3f800000,0xbf468000,0x3e480000,0x3ef10000,0x3f800000,0xbf628000,0x3f0e0000,0xbdc98000
.long 0x3f800000,0xbf758000,0x3f550000,0xbf228000,0x3f800000,0xbf7f8000,0x3f7b0000,0xbf758000
.long 0x3f80,0x8000bf80,0x3f80,0x8000bf80,0x3f80,0x8000bf7b,0x3f6d,0x8000bf55
.long 0x3f80,0x8000bf6d,0x3f35,0x8000bec4,0x3f80,0x8000bf55,0x3ec4,0x3e48
.long 0x3f80,0x8000bf35,0,0x3f35,0x3f80,0x8000bf0e,0x8000bec4,0x3f7b
.long 0x3f80,0x8000bec4,0x8000bf35,0x3f6d,0x3f80,0x8000be48,0x8000bf6d,0x3f0e
.long 0x3f80,0,0x8000bf80,0,0x3f80,0x3e48,0x8000bf6d,0x8000bf0e
.long 0x3f80,0x3ec4,0x8000bf35,0x8000bf6d,0x3f80,0x3f0e,0x8000bec4,0x8000bf7b
.long 0x3f80,0x3f35,0,0x8000bf35,0x3f80,0x3f55,0x3ec4,0x8000be48
.long 0x3f80,0x3f6d,0x3f35,0x3ec4,0x3f80,0x3f7b,0x3f6d,0x3f55
.long 0x3f6d0000,0x3f620000,0x3f550000,0x3f460000,0x3ec40000,0x3dc90000,0xbe488000,0xbef18000
.long 0xbec48000,0xbf468000,0xbf7b8000,0xbf758000,0xbf6d8000,0xbf758000,0xbf0e8000,0x3dc90000
.long 0xbf6d8000,0xbe958000,0x3f0e0000,0x3f7f0000,0xbec48000,0x3f220000,0x3f7b0000,0x3e950000
.long 0x3ec40000,0x3f7f0000,0x3e480000,0xbf628000,0x3f6d0000,0x3ef10000,0xbf558000,0xbf228000
.long 0x3f6d0000,0xbef18000,0xbf558000,0x3f220000,0x3ec40000,0xbf7f8000,0x3e480000,0x3f620000
.long 0xbec48000,0xbf228000,0x3f7b0000,0xbe958000,0xbf6d8000,0x3e950000,0x3f0e0000,0xbf7f8000
.long 0xbf6d8000,0x3f750000,0xbf0e8000,0xbdc98000,0xbec48000,0x3f460000,0xbf7b8000,0x3f750000
.long 0x3ec40000,0xbdc98000,0xbe488000,0x3ef10000,0x3f6d0000,0xbf628000,0x3f550000,0xbf468000
.long 0x3f80,0x8000bf80,0x3f80,0x8000bf80,0x3f35,0x8000bf0e,0x3ec4,0x8000be48
.long 0,0x3ec4,0x8000bf35,0x3f6d,0x8000bf35,0x3f7b,0x8000bf6d,0x3f0e
.long 0x8000bf80,0x3f35,0,0x8000bf35,0x8000bf35,0x8000be48,0x3f6d,0x8000bf55
.long 0,0x8000bf6d,0x3f35,0x3ec4,0x3f35,0x8000bf55,0x8000bec4,0x3f7b
.long 0x3f80,0,0x8000bf80,0,0x3f35,0x3f55,0x8000bec4,0x8000bf7b
.long 0,0x3f6d,0x3f35,0x8000bec4,0x8000bf35,0x3e48,0x3f6d,0x3f55
.long 0x8000bf80,0x8000bf35,0,0x3f35,0x8000bf35,0x8000bf7b,0x8000bf6d,0x8000bf0e
.long 0,0x8000bec4,0x8000bf35,0x8000bf6d,0x3f35,0x3f0e,0x3ec4,0x3e48
.long 0x3f350000,0x3f220000,0x3f0e0000,0x3ef10000,0xbf358000,0xbf628000,0xbf7b8000,0xbf7f8000
.long 0xbf358000,0xbe958000,0x3e480000,0x3f220000,0x3f350000,0x3f7f0000,0x3f550000,0x3e950000
.long 0x3f350000,0xbdc98000,0xbf558000,0xbf758000,0xbf358000,0xbf758000,0xbe488000,0x3f460000
.long 0xbf358000,0x3ef10000,0x3f7b0000,0x3dc90000,0x3f350000,0x3f460000,0xbf0e8000,0xbf628000
.long 0x3f350000,0xbf468000,0xbf0e8000,0x3f620000,0xbf358000,0xbef18000,0x3f7b0000,0xbdc98000
.long 0xbf358000,0x3f750000,0xbe488000,0xbf468000,0x3f350000,0x3dc90000,0xbf558000,0x3f750000
.long 0x3f350000,0xbf7f8000,0x3f550000,0xbe958000,0xbf358000,0x3e950000,0x3e480000,0xbf228000
.long 0xbf358000,0x3f620000,0xbf7b8000,0x3f7f0000,0x3f350000,0xbf228000,0x3f0e0000,0xbef18000
.long 0x3f80,0x8000bf80,0x3f80,0x8000bf80,0,0x3e48,0x8000bec4,0x3f0e
.long 0x8000bf80,0x3f6d,0x8000bf35,0x3ec4,0,0x8000bf0e,0x3f6d,0x8000bf7b
.long 0x3f80,0x8000bf35,0,0x3f35,0,0x3f55,0x8000bf6d,0x3e48
.long 0x8000bf80,0x3ec4,0x3f35,0x8000bf6d,0,0x8000bf7b,0x3ec4,0x3f55
.long 0x3f80,0,0x8000bf80,0,0,0x3f7b,0x3ec4,0x8000bf55
.long 0x8000bf80,0x8000bec4,0x3f35,0x3f6d,0,0x8000bf55,0x8000bf6d,0x8000be48
.long 0x3f80,0x3f35,0,0x8000bf35,0,0x3f0e,0x3f6d,0x3f7b
.long 0x8000bf80,0x8000bf6d,0x8000bf35,0x8000bec4,0,0x8000be48,0x8000bec4,0x8000bf0e
.long 0x3ec40000,0x3e950000,0x3e480000,0x3dc90000,0xbf6d8000,0xbf468000,0xbf0e8000,0xbe958000
.long 0x3f6d0000,0x3f7f0000,0x3f550000,0x3ef10000,0xbec48000,0xbf628000,0xbf7b8000,0xbf228000
.long 0xbec48000,0x3ef10000,0x3f7b0000,0x3f460000,0x3f6d0000,0x3dc90000,0xbf558000,0xbf628000
.long 0xbf6d8000,0xbf228000,0x3f0e0000,0x3f750000,0x3ec40000,0x3f750000,0xbe488000,0xbf7f8000
.long 0x3ec40000,0xbf758000,0xbe488000,0x3f7f0000,0xbf6d8000,0x3f220000,0x3f0e0000,0xbf758000
.long 0x3f6d0000,0xbdc98000,0xbf558000,0x3f620000,0xbec48000,0xbef18000,0x3f7b0000,0xbf468000
.long 0xbec48000,0x3f620000,0xbf7b8000,0x3f220000,0x3f6d0000,0xbf7f8000,0x3f550000,0xbef18000
.long 0xbf6d8000,0x3f460000,0xbf0e8000,0x3e950000,0x3ec40000,0xbe958000,0x3e480000,0xbdc98000
.long 0x3f80,0x8000bf80,0x3f80,0x8000bf80,0x8000bf35,0x3f55,0x8000bf6d,0x3f7b
.long 0,0x8000bec4,0x3f35,0x8000bf6d,0x3f35,0x8000be48,0x8000bec4,0x3f55
.long 0x8000bf80,0x3f35,0,0x8000bf35,0x3f35,0x8000bf7b,0x3ec4,0x3f0e
.long 0,0x3f6d,0x8000bf35,0x8000bec4,0x8000bf35,0x8000bf0e,0x3f6d,0x3e48
.long 0x3f80,0,0x8000bf80,0,0x8000bf35,0x3f0e,0x3f6d,0x8000be48
.long 0,0x8000bf6d,0x8000bf35,0x3ec4,0x3f35,0x3f7b,0x3ec4,0x8000bf0e
.long 0x8000bf80,0x8000bf35,0,0x3f35,0x3f35,0x3e48,0x8000bec4,0x8000bf55
.long 0,0x3ec4,0x3f35,0x3f6d,0x8000bf35,0x8000bf55,0x8000bf6d,0x8000bf7b
.long 0,0xbdc98000,0xbe488000,0xbe958000,0,0x3e950000,0x3f0e0000,0x3f460000
.long 0,0xbef18000,0xbf558000,0xbf7f8000,0,0x3f220000,0x3f7b0000,0x3f620000
.long 0,0xbf468000,0xbf7b8000,0xbef18000,0,0x3f620000,0x3f550000,0xbdc98000
.long 0,0xbf758000,0xbf0e8000,0x3f220000,0,0x3f7f0000,0x3e480000,0xbf758000
.long 0,0xbf7f8000,0x3e480000,0x3f750000,0,0x3f750000,0xbf0e8000,0xbf228000
.long 0,0xbf628000,0x3f550000,0x3dc90000,0,0x3f460000,0xbf7b8000,0x3ef10000
.long 0,0xbf228000,0x3f7b0000,0xbf628000,0,0x3ef10000,0xbf558000,0x3f7f0000
.long 0,0xbe958000,0x3f0e0000,0xbf468000,0,0x3dc90000,0xbe488000,0x3e950000
.long 0x3f80,0x8000bf80,0x3f80,0x8000bf80,0x8000bf80,0x3f7b,0x8000bf6d,0x3f55
.long 0x3f80,0x8000bf6d,0x3f35,0x8000bec4,0x8000bf80,0x3f55,0x8000bec4,0x8000be48
.long 0x3f80,0x8000bf35,0,0x3f35,0x8000bf80,0x3f0e,0x3ec4,0x8000bf7b
.long 0x3f80,0x8000bec4,0x8000bf35,0x3f6d,0x8000bf80,0x3e48,0x3f6d,0x8000bf0e
.long 0x3f80,0,0x8000bf80,0,0x8000bf80,0x8000be48,0x3f6d,0x3f0e
.long 0x3f80,0x3ec4,0x8000bf35,0x8000bf6d,0x8000bf80,0x8000bf0e,0x3ec4,0x3f7b
.long 0x3f80,0x3f35,0,0x8000bf35,0x8000bf80,0x8000bf55,0x8000bec4,0x3e48
.long 0x3f80,0x3f6d,0x3f35,0x3ec4,0x8000bf80,0x8000bf7b,0x8000bf6d,0x8000bf55
.long 0xbec48000,0xbef18000,0xbf0e8000,0xbf228000,0x3f6d0000,0x3f7f0000,0x3f7b0000,0x3f620000
.long 0xbf6d8000,0xbf228000,0xbe488000,0x3e950000,0x3ec40000,0xbe958000,0xbf558000,0xbf7f8000
.long 0x3ec40000,0x3f750000,0x3f550000,0x3dc90000,0xbf6d8000,0xbf468000,0x3e480000,0x3f750000
.long 0x3f6d0000,0xbdc98000,0xbf7b8000,0xbef18000,0xbec48000,0x3f620000,0x3f0e0000,0xbf468000
.long 0xbec48000,0xbf628000,0x3f0e0000,0x3f460000,0x3f6d0000,0x3dc90000,0xbf7b8000,0x3ef10000
.long 0xbf6d8000,0x3f460000,0x3e480000,0xbf758000,0x3ec40000,0xbf758000,0x3f550000,0xbdc98000
.long 0x3ec40000,0x3e950000,0xbf558000,0x3f7f0000,0xbf6d8000,0x3f220000,0xbe488000,0xbe958000
.long 0x3f6d0000,0xbf7f8000,0x3f7b0000,0xbf628000,0xbec48000,0x3ef10000,0xbf0e8000,0x3f220000
.long 0x3f80,0x8000bf80,0x3f80,0x8000bf80,0x8000bf35,0x3f0e,0x8000bec4,0x3e48
.long 0,0x3ec4,0x8000bf35,0x3f6d,0x3f35,0x8000bf7b,0x3f6d,0x8000bf0e
.long 0x8000bf80,0x3f35,0,0x8000bf35,0x3f35,0x3e48,0x8000bf6d,0x3f55
.long 0,0x8000bf6d,0x3f35,0x3ec4,0x8000bf35,0x3f55,0x3ec4,0x8000bf7b
.long 0x3f80,0,0x8000bf80,0,0x8000bf35,0x8000bf55,0x3ec4,0x3f7b
.long 0,0x3f6d,0x3f35,0x8000bec4,0x3f35,0x8000be48,0x8000bf6d,0x8000bf55
.long 0x8000bf80,0x8000bf35,0,0x3f35,0x3f35,0x3f7b,0x3f6d,0x3f0e
.long 0,0x8000bec4,0x8000bf35,0x8000bf6d,0x8000bf35,0x8000bf0e,0x8000bec4,0x8000be48
.long 0xbf358000,0xbf468000,0xbf558000,0xbf628000,0x3f350000,0x3ef10000,0x3e480000,0xbdc98000
.long 0x3f350000,0x3f750000,0x3f7b0000,0x3f460000,0xbf358000,0xbdc98000,0x3f0e0000,0x3f750000
.long 0xbf358000,0xbf7f8000,0xbf0e8000,0x3e950000,0x3f350000,0xbe958000,0xbf7b8000,0xbf228000
.long 0x3f350000,0x3f620000,0xbe488000,0xbf7f8000,0xbf358000,0x3f220000,0x3f550000,0xbef18000
.long 0xbf358000,0xbf228000,0x3f550000,0x3ef10000,0x3f350000,0xbf628000,0xbe488000,0x3f7f0000
.long 0x3f350000,0x3e950000,0xbf7b8000,0x3f220000,0xbf358000,0x3f7f0000,0xbf0e8000,0xbe958000
.long 0xbf358000,0x3dc90000,0x3f0e0000,0xbf758000,0x3f350000,0xbf758000,0x3f7b0000,0xbf468000
.long 0x3f350000,0xbef18000,0x3e480000,0x3dc90000,0xbf358000,0x3f460000,0xbf558000,0x3f620000
.long 0x3f80,0x8000bf80,0x3f80,0x8000bf80,0,0x8000be48,0x3ec4,0x8000bf0e
.long 0x8000bf80,0x3f6d,0x8000bf35,0x3ec4,0,0x3f0e,0x8000bf6d,0x3f7b
.long 0x3f80,0x8000bf35,0,0x3f35,0,0x8000bf55,0x3f6d,0x8000be48
.long 0x8000bf80,0x3ec4,0x3f35,0x8000bf6d,0,0x3f7b,0x8000bec4,0x8000bf55
.long 0x3f80,0,0x8000bf80,0,0,0x8000bf7b,0x8000bec4,0x3f55
.long 0x8000bf80,0x8000bec4,0x3f35,0x3f6d,0,0x3f55,0x3f6d,0x3e48
.long 0x3f80,0x3f35,0,0x8000bf35,0,0x8000bf0e,0x8000bf6d,0x8000bf7b
.long 0x8000bf80,0x8000bf6d,0x8000bf35,0x8000bec4,0,0x3e48,0x3ec4,0x3f0e
.long 0xbf6d8000,0xbf758000,0xbf7b8000,0xbf7f8000,0xbec48000,0xbf228000,0xbf558000,0xbf758000
.long 0x3ec40000,0xbdc98000,0xbf0e8000,0xbf628000,0x3f6d0000,0x3ef10000,0xbe488000,0xbf468000
.long 0x3f6d0000,0x3f620000,0x3e480000,0xbf228000,0x3ec40000,0x3f7f0000,0x3f0e0000,0xbef18000
.long 0xbec48000,0x3f460000,0x3f550000,0xbe958000,0xbf6d8000,0x3e950000,0x3f7b0000,0xbdc98000
.long 0xbf6d8000,0xbe958000,0x3f7b0000,0x3dc90000,0xbec48000,0xbf468000,0x3f550000,0x3e950000
.long 0x3ec40000,0xbf7f8000,0x3f0e0000,0x3ef10000,0x3f6d0000,0xbf628000,0x3e480000,0x3f220000
.long 0x3f6d0000,0xbef18000,0xbe488000,0x3f460000,0x3ec40000,0x3dc90000,0xbf0e8000,0x3f620000
.long 0xbec48000,0x3f220000,0xbf558000,0x3f750000,0xbf6d8000,0x3f750000,0xbf7b8000,0x3f7f0000
.long 0x3f80,0x8000bf80,0x3f80,0x8000bf80,0x3f35,0x8000bf55,0x3f6d,0x8000bf7b
.long 0,0x8000bec4,0x3f35,0x8000bf6d,0x8000bf35,0x3e48,0x3ec4,0x8000bf55
.long 0x8000bf80,0x3f35,0,0x8000bf35,0x8000bf35,0x3f7b,0x8000bec4,0x8000bf0e
.long 0,0x3f6d,0x8000bf35,0x8000bec4,0x3f35,0x3f0e,0x8000bf6d,0x8000be48
.long 0x3f80,0,0x8000bf80,0,0x3f35,0x8000bf0e,0x8000bf6d,0x3e48
.long 0,0x8000bf6d,0x8000bf35,0x3ec4,0x8000bf35,0x8000bf7b,0x8000bec4,0x3f0e
.long 0x8000bf80,0x8000bf35,0,0x3f35,0x8000bf35,0x8000be48,0x3ec4,0x3f55
.long 0,0x3ec4,0x3f35,0x3f6d,0x3f35,0x3f55,0x3f6d,0x3f7b
.long 0x80008000,0xbdc98000,0xbe488000,0xbe958000,0x80008000,0xbe958000,0xbf0e8000,0xbf468000
.long 0x80008000,0xbef18000,0xbf558000,0xbf7f8000,0x80008000,0xbf228000,0xbf7b8000,0xbf628000
.long 0x80008000,0xbf468000,0xbf7b8000,0xbef18000,0x80008000,0xbf628000,0xbf558000,0x3dc90000
.long 0x80008000,0xbf758000,0xbf0e8000,0x3f220000,0x80008000,0xbf7f8000,0xbe488000,0x3f750000
.long 0x80008000,0xbf7f8000,0x3e480000,0x3f750000,0x80008000,0xbf758000,0x3f0e0000,0x3f220000
.long 0x80008000,0xbf628000,0x3f550000,0x3dc90000,0x80008000,0xbf468000,0x3f7b0000,0xbef18000
.long 0x80008000,0xbf228000,0x3f7b0000,0xbf628000,0x80008000,0xbef18000,0x3f550000,0xbf7f8000
.long 0x80008000,0xbe958000,0x3f0e0000,0xbf468000,0x80008000,0xbdc98000,0x3e480000,0xbe958000
.long 0x80008000,0x80008000,0x80008000,0x80008000,0x80008000,0x3e48,0x8000bec4,0x3f0e
.long 0x80008000,0x3ec4,0x8000bf35,0x3f6d,0x80008000,0x3f0e,0x8000bf6d,0x3f7b
.long 0x80008000,0x3f35,0x8000bf80,0x3f35,0x80008000,0x3f55,0x8000bf6d,0x3e48
.long 0x80008000,0x3f6d,0x8000bf35,0x8000bec4,0x80008000,0x3f7b,0x8000bec4,0x8000bf55
.long 0x80008000,0x3f80,0x80008000,0x8000bf80,0x80008000,0x3f7b,0x3ec4,0x8000bf55
.long 0x80008000,0x3f6d,0x3f35,0x8000bec4,0x80008000,0x3f55,0x3f6d,0x3e48
.long 0x80008000,0x3f35,0x3f80,0x3f35,0x80008000,0x3f0e,0x3f6d,0x3f7b
.long 0x80008000,0x3ec4,0x3f35,0x3f6d,0x80008000,0x3e48,0x3ec4,0x3f0e
.long 0xbec48000,0xbef18000,0xbf0e8000,0xbf228000,0xbf6d8000,0xbf7f8000,0xbf7b8000,0xbf628000
.long 0xbf6d8000,0xbf228000,0xbe488000,0x3e950000,0xbec48000,0x3e950000,0x3f550000,0x3f7f0000
.long 0x3ec40000,0x3f750000,0x3f550000,0x3dc90000,0x3f6d0000,0x3f460000,0xbe488000,0xbf758000
.long 0x3f6d0000,0xbdc98000,0xbf7b8000,0xbef18000,0x3ec40000,0xbf628000,0xbf0e8000,0x3f460000
.long 0xbec48000,0xbf628000,0x3f0e0000,0x3f460000,0xbf6d8000,0xbdc98000,0x3f7b0000,0xbef18000
.long 0xbf6d8000,0x3f460000,0x3e480000,0xbf758000,0xbec48000,0x3f750000,0xbf558000,0x3dc90000
.long 0x3ec40000,0x3e950000,0xbf558000,0x3f7f0000,0x3f6d0000,0xbf228000,0x3e480000,0x3e950000
.long 0x3f6d0000,0xbf7f8000,0x3f7b0000,0xbf628000,0x3ec40000,0xbef18000,0x3f0e0000,0xbf228000
.long 0x80008000,0x80008000,0x80008000,0x80008000,0x8000bf35,0x3f55,0x8000bf6d,0x3f7b
.long 0x8000bf80,0x3f6d,0x8000bf35,0x3ec4,0x8000bf35,0x3e48,0x3ec4,0x8000bf55
.long 0x80008000,0x8000bf35,0x3f80,0x8000bf35,0x3f35,0x8000bf7b,0x3ec4,0x3f0e
.long 0x3f80,0x8000bec4,0x8000bf35,0x3f6d,0x3f35,0x3f0e,0x8000bf6d,0x8000be48
.long 0x80008000,0x3f80,0x80008000,0x8000bf80,0x8000bf35,0x3f0e,0x3f6d,0x8000be48
.long 0x8000bf80,0x8000bec4,0x3f35,0x3f6d,0x8000bf35,0x8000bf7b,0x8000bec4,0x3f0e
.long 0x80008000,0x8000bf35,0x8000bf80,0x8000bf35,0x3f35,0x3e48,0x8000bec4,0x8000bf55
.long 0x3f80,0x3f6d,0x3f35,0x3ec4,0x3f35,0x3f55,0x3f6d,0x3f7b
.long 0xbf358000,0xbf468000,0xbf558000,0xbf628000,0xbf358000,0xbef18000,0xbe488000,0x3dc90000
.long 0x3f350000,0x3f750000,0x3f7b0000,0x3f460000,0x3f350000,0x3dc90000,0xbf0e8000,0xbf758000
.long 0xbf358000,0xbf7f8000,0xbf0e8000,0x3e950000,0xbf358000,0x3e950000,0x3f7b0000,0x3f220000
.long 0x3f350000,0x3f620000,0xbe488000,0xbf7f8000,0x3f350000,0xbf228000,0xbf558000,0x3ef10000
.long 0xbf358000,0xbf228000,0x3f550000,0x3ef10000,0xbf358000,0x3f620000,0x3e480000,0xbf7f8000
.long 0x3f350000,0x3e950000,0xbf7b8000,0x3f220000,0x3f350000,0xbf7f8000,0x3f0e0000,0x3e950000
.long 0xbf358000,0x3dc90000,0x3f0e0000,0xbf758000,0xbf358000,0x3f750000,0xbf7b8000,0x3f460000
.long 0x3f350000,0xbef18000,0x3e480000,0x3dc90000,0x3f350000,0xbf468000,0x3f550000,0xbf628000
.long 0x80008000,0x80008000,0x80008000,0x80008000,0x8000bf80,0x3f7b,0x8000bf6d,0x3f55
.long 0x80008000,0x8000bec4,0x3f35,0x8000bf6d,0x3f80,0x8000bf55,0x3ec4,0x3e48
.long 0x80008000,0x3f35,0x8000bf80,0x3f35,0x8000bf80,0x3f0e,0x3ec4,0x8000bf7b
.long 0x80008000,0x8000bf6d,0x3f35,0x3ec4,0x3f80,0x8000be48,0x8000bf6d,0x3f0e
.long 0x80008000,0x3f80,0x80008000,0x8000bf80,0x8000bf80,0x8000be48,0x3f6d,0x3f0e
.long 0x80008000,0x8000bf6d,0x8000bf35,0x3ec4,0x3f80,0x3f0e,0x8000bec4,0x8000bf7b
.long 0x80008000,0x3f35,0x3f80,0x3f35,0x8000bf80,0x8000bf55,0x8000bec4,0x3e48
.long 0x80008000,0x8000bec4,0x8000bf35,0x8000bf6d,0x3f80,0x3f7b,0x3f6d,0x3f55
.long 0xbf6d8000,0xbf758000,0xbf7b8000,0xbf7f8000,0x3ec40000,0x3f220000,0x3f550000,0x3f750000
.long 0x3ec40000,0xbdc98000,0xbf0e8000,0xbf628000,0xbf6d8000,0xbef18000,0x3e480000,0x3f460000
.long 0x3f6d0000,0x3f620000,0x3e480000,0xbf228000,0xbec48000,0xbf7f8000,0xbf0e8000,0x3ef10000
.long 0xbec48000,0x3f460000,0x3f550000,0xbe958000,0x3f6d0000,0xbe958000,0xbf7b8000,0x3dc90000
.long 0xbf6d8000,0xbe958000,0x3f7b0000,0x3dc90000,0x3ec40000,0x3f460000,0xbf558000,0xbe958000
.long 0x3ec40000,0xbf7f8000,0x3f0e0000,0x3ef10000,0xbf6d8000,0x3f620000,0xbe488000,0xbf228000
.long 0x3f6d0000,0xbef18000,0xbe488000,0x3f460000,0xbec48000,0xbdc98000,0x3f0e0000,0xbf628000
.long 0xbec48000,0x3f220000,0xbf558000,0x3f750000,0x3f6d0000,0xbf758000,0x3f7b0000,0xbf7f8000
.long 0x80008000,0x80008000,0x80008000,0x80008000,0x8000bf35,0x3f0e,0x8000bec4,0x3e48
.long 0x3f80,0x8000bf6d,0x3f35,0x8000bec4,0x8000bf35,0x3f7b,0x8000bf6d,0x3f0e
.long 0x80008000,0x8000bf35,0x3f80,0x8000bf35,0x3f35,0x3e48,0x8000bf6d,0x3f55
.long 0x8000bf80,0x3ec4,0x3f35,0x8000bf6d,0x3f35,0x8000bf55,0x8000bec4,0x3f7b
.long 0x80008000,0x3f80,0x80008000,0x8000bf80,0x8000bf35,0x8000bf55,0x3ec4,0x3f7b
.long 0x3f80,0x3ec4,0x8000bf35,0x8000bf6d,0x8000bf35,0x3e48,0x3f6d,0x3f55
.long 0x80008000,0x8000bf35,0x8000bf80,0x8000bf35,0x3f35,0x3f7b,0x3f6d,0x3f0e
.long 0x8000bf80,0x8000bf6d,0x8000bf35,0x8000bec4,0x3f35,0x3f0e,0x3ec4,0x3e48
.long 0xbf808000,0xbf7f8000,0xbf7b8000,0xbf758000,0x3f800000,0x3f750000,0x3f550000,0x3f220000
.long 0xbf808000,0xbf628000,0xbf0e8000,0xbdc98000,0x3f800000,0x3f460000,0x3e480000,0xbef18000
.long 0xbf808000,0xbf228000,0x3e480000,0x3f620000,0x3f800000,0x3ef10000,0xbf0e8000,0xbf7f8000
.long 0xbf808000,0xbe958000,0x3f550000,0x3f460000,0x3f800000,0x3dc90000,0xbf7b8000,0xbe958000
.long 0xbf808000,0x3dc90000,0x3f7b0000,0xbe958000,0x3f800000,0xbe958000,0xbf558000,0x3f460000
.long 0xbf808000,0x3ef10000,0x3f0e0000,0xbf7f8000,0x3f800000,0xbf228000,0xbe488000,0x3f620000
.long 0xbf808000,0x3f460000,0xbe488000,0xbef18000,0x3f800000,0xbf628000,0x3f0e0000,0xbdc98000
.long 0xbf808000,0x3f750000,0xbf558000,0x3f220000,0x3f800000,0xbf7f8000,0x3f7b0000,0xbf758000
.long 0x80008000,0x80008000,0x80008000,0x80008000,0x80008000,0x8000be48,0x3ec4,0x8000bf0e
.long 0x80008000,0x3ec4,0x8000bf35,0x3f6d,0x80008000,0x8000bf0e,0x3f6d,0x8000bf7b
.long 0x80008000,0x3f35,0x8000bf80,0x3f35,0x80008000,0x8000bf55,0x3f6d,0x8000be48
.long 0x80008000,0x3f6d,0x8000bf35,0x8000bec4,0x80008000,0x8000bf7b,0x3ec4,0x3f55
.long 0x80008000,0x3f80,0x80008000,0x8000bf80,0x80008000,0x8000bf7b,0x8000bec4,0x3f55
.long 0x80008000,0x3f6d,0x3f35,0x8000bec4,0x80008000,0x8000bf55,0x8000bf6d,0x8000be48
.long 0x80008000,0x3f35,0x3f80,0x3f35,0x80008000,0x8000bf0e,0x8000bf6d,0x8000bf7b
.long 0x80008000,0x3ec4,0x3f35,0x3f6d,0x80008000,0x8000be48,0x8000bec4,0x8000bf0e
.long 0xbf6d8000,0xbf628000,0xbf558000,0xbf468000,0x3ec40000,0x3dc90000,0xbe488000,0xbef18000
.long 0x3ec40000,0x3f460000,0x3f7b0000,0x3f750000,0xbf6d8000,0xbf758000,0xbf0e8000,0x3dc90000
.long 0x3f6d0000,0x3e950000,0xbf0e8000,0xbf7f8000,0xbec48000,0x3f220000,0x3f7b0000,0x3e950000
.long 0xbec48000,0xbf7f8000,0xbe488000,0x3f620000,0x3f6d0000,0x3ef10000,0xbf558000,0xbf228000
.long 0xbf6d8000,0x3ef10000,0x3f550000,0xbf228000,0x3ec40000,0xbf7f8000,0x3e480000,0x3f620000
.long 0x3ec40000,0x3f220000,0xbf7b8000,0x3e950000,0xbf6d8000,0x3e950000,0x3f0e0000,0xbf7f8000
.long 0x3f6d0000,0xbf758000,0x3f0e0000,0x3dc90000,0xbec48000,0x3f460000,0xbf7b8000,0x3f750000
.long 0xbec48000,0x3dc90000,0x3e480000,0xbef18000,0x3f6d0000,0xbf628000,0x3f550000,0xbf468000
.long 0x80008000,0x80008000,0x80008000,0x80008000,0x3f35,0x8000bf55,0x3f6d,0x8000bf7b
.long 0x8000bf80,0x3f6d,0x8000bf35,0x3ec4,0x3f35,0x8000be48,0x8000bec4,0x3f55
.long 0x80008000,0x8000bf35,0x3f80,0x8000bf35,0x8000bf35,0x3f7b,0x8000bec4,0x8000bf0e
.long 0x3f80,0x8000bec4,0x8000bf35,0x3f6d,0x8000bf35,0x8000bf0e,0x3f6d,0x3e48
.long 0x80008000,0x3f80,0x80008000,0x8000bf80,0x3f35,0x8000bf0e,0x8000bf6d,0x3e48
.long 0x8000bf80,0x8000bec4,0x3f35,0x3f6d,0x3f35,0x3f7b,0x3ec4,0x8000bf0e
.long 0x80008000,0x8000bf35,0x8000bf80,0x8000bf35,0x8000bf35,0x8000be48,0x3ec4,0x3f55
.long 0x3f80,0x3f6d,0x3f35,0x3ec4,0x8000bf35,0x8000bf55,0x8000bf6d,0x8000bf7b
.long 0xbf358000,0xbf228000,0xbf0e8000,0xbef18000,0xbf358000,0xbf628000,0xbf7b8000,0xbf7f8000
.long 0x3f350000,0x3e950000,0xbe488000,0xbf228000,0x3f350000,0x3f7f0000,0x3f550000,0x3e950000
.long 0xbf358000,0x3dc90000,0x3f550000,0x3f750000,0xbf358000,0xbf758000,0xbe488000,0x3f460000
.long 0x3f350000,0xbef18000,0xbf7b8000,0xbdc98000,0x3f350000,0x3f460000,0xbf0e8000,0xbf628000
.long 0xbf358000,0x3f460000,0x3f0e0000,0xbf628000,0xbf358000,0xbef18000,0x3f7b0000,0xbdc98000
.long 0x3f350000,0xbf758000,0x3e480000,0x3f460000,0x3f350000,0x3dc90000,0xbf558000,0x3f750000
.long 0xbf358000,0x3f7f0000,0xbf558000,0x3e950000,0xbf358000,0x3e950000,0x3e480000,0xbf228000
.long 0x3f350000,0xbf628000,0x3f7b0000,0xbf7f8000,0x3f350000,0xbf228000,0x3f0e0000,0xbef18000
.long 0x80008000,0x80008000,0x80008000,0x80008000,0x3f80,0x8000bf7b,0x3f6d,0x8000bf55
.long 0x80008000,0x8000bec4,0x3f35,0x8000bf6d,0x8000bf80,0x3f55,0x8000bec4,0x8000be48
.long 0x80008000,0x3f35,0x8000bf80,0x3f35,0x3f80,0x8000bf0e,0x8000bec4,0x3f7b
.long 0x80008000,0x8000bf6d,0x3f35,0x3ec4,0x8000bf80,0x3e48,0x3f6d,0x8000bf0e
.long 0x80008000,0x3f80,0x80008000,0x8000bf80,0x3f80,0x3e48,0x8000bf6d,0x8000bf0e
.long 0x80008000,0x8000bf6d,0x8000bf35,0x3ec4,0x8000bf80,0x8000bf0e,0x3ec4,0x3f7b
.long 0x80008000,0x3f35,0x3f80,0x3f35,0x3f80,0x3f55,0x3ec4,0x8000be48
.long 0x80008000,0x8000bec4,0x8000bf35,0x8000bf6d,0x8000bf80,0x8000bf7b,0x8000bf6d,0x8000bf55
.long 0xbec48000,0xbe958000,0xbe488000,0xbdc98000,0xbf6d8000,0xbf468000,0xbf0e8000,0xbe958000
.long 0xbf6d8000,0xbf7f8000,0xbf558000,0xbef18000,0xbec48000,0xbf628000,0xbf7b8000,0xbf228000
.long 0x3ec40000,0xbef18000,0xbf7b8000,0xbf468000,0x3f6d0000,0x3dc90000,0xbf558000,0xbf628000
.long 0x3f6d0000,0x3f220000,0xbf0e8000,0xbf758000,0x3ec40000,0x3f750000,0xbe488000,0xbf7f8000
.long 0xbec48000,0x3f750000,0x3e480000,0xbf7f8000,0xbf6d8000,0x3f220000,0x3f0e0000,0xbf758000
.long 0xbf6d8000,0x3dc90000,0x3f550000,0xbf628000,0xbec48000,0xbef18000,0x3f7b0000,0xbf468000
.long 0x3ec40000,0xbf628000,0x3f7b0000,0xbf228000,0x3f6d0000,0xbf7f8000,0x3f550000,0xbef18000
.long 0x3f6d0000,0xbf468000,0x3f0e0000,0xbe958000,0x3ec40000,0xbe958000,0x3e480000,0xbdc98000
.long 0x80008000,0x80008000,0x80008000,0x80008000,0x3f35,0x8000bf0e,0x3ec4,0x8000be48
.long 0x3f80,0x8000bf6d,0x3f35,0x8000bec4,0x3f35,0x8000bf7b,0x3f6d,0x8000bf0e
.long 0x80008000,0x8000bf35,0x3f80,0x8000bf35,0x8000bf35,0x8000be48,0x3f6d,0x8000bf55
.long 0x8000bf80,0x3ec4,0x3f35,0x8000bf6d,0x8000bf35,0x3f55,0x3ec4,0x8000bf7b
.long 0x80008000,0x3f80,0x80008000,0x8000bf80,0x3f35,0x3f55,0x8000bec4,0x8000bf7b
.long 0x3f80,0x3ec4,0x8000bf35,0x8000bf6d,0x3f35,0x8000be48,0x8000bf6d,0x8000bf55
.long 0x80008000,0x8000bf35,0x8000bf80,0x8000bf35,0x8000bf35,0x8000bf7b,0x8000bf6d,0x8000bf0e
.long 0x8000bf80,0x8000bf6d,0x8000bf35,0x8000bec4,0x8000bf35,0x8000bf0e,0x8000bec4,0x8000be48
.long 0x3f803f80,0x3f803f80,0x3f803f80,0x3f803f80,0x3f7b3f80,0x3f553f6d,0x3f0e3f35,0x3e483ec4
.long 0x3f6d3f80,0x3ec43f35,0xbec40000,0xbf6dbf35,0x3f553f80,0xbe483ec4,0xbf7bbf35,0xbf0ebf6d
.long 0x3f353f80,0xbf350000,0xbf35bf80,0x3f350000,0x3f0e3f80,0xbf7bbec4,0x3e48bf35,0x3f553f6d
.long 0x3ec43f80,0xbf6dbf35,0x3f6d0000,0xbec43f35,0x3e483f80,0xbf0ebf6d,0x3f553f35,0xbf7bbec4
.long 0x3f80,0xbf80,0x3f80,0xbf80,0xbe483f80,0x3f0ebf6d,0xbf553f35,0x3f7bbec4
.long 0xbec43f80,0x3f6dbf35,0xbf6d0000,0x3ec43f35,0xbf0e3f80,0x3f7bbec4,0xbe48bf35,0xbf553f6d
.long 0xbf353f80,0x3f350000,0x3f35bf80,0xbf350000,0xbf553f80,0x3e483ec4,0x3f7bbf35,0x3f0ebf6d
.long 0xbf6d3f80,0xbec43f35,0x3ec40000,0x3f6dbf35,0xbf7b3f80,0xbf553f6d,0xbf0e3f35,0xbe483ec4
.long 0xbf803f80,0xbf803f80,0xbf803f80,0xbf803f80,0xbe488000,0xbf0ebec4,0xbf55bf35,0xbf7bbf6d
.long 0xbec48000,0xbf6dbf35,0xbf6dbf80,0xbec4bf35,0xbf0e8000,0xbf7bbf6d,0xbe48bf35,0x3f553ec4
.long 0xbf358000,0xbf35bf80,0x3f358000,0x3f353f80,0xbf558000,0xbe48bf6d,0x3f7b3f35,0xbf0e3ec4
.long 0xbf6d8000,0x3ec4bf35,0x3ec43f80,0xbf6dbf35,0xbf7b8000,0x3f55bec4,0xbf0e3f35,0x3e48bf6d
.long 0xbf808000,0x3f808000,0xbf808000,0x3f808000,0xbf7b8000,0x3f553ec4,0xbf0ebf35,0x3e483f6d
.long 0xbf6d8000,0x3ec43f35,0x3ec4bf80,0xbf6d3f35,0xbf558000,0xbe483f6d,0x3f7bbf35,0xbf0ebec4
.long 0xbf358000,0xbf353f80,0x3f358000,0x3f35bf80,0xbf0e8000,0xbf7b3f6d,0xbe483f35,0x3f55bec4
.long 0xbec48000,0xbf6d3f35,0xbf6d3f80,0xbec43f35,0xbe488000,0xbf0e3ec4,0xbf553f35,0xbf7b3f6d
.long 0x3f803f80,0x3f803f80,0x3f803f80,0x3f803f80,0xbe480000,0xbf0ebec4,0xbf55bf35,0xbf7bbf6d
.long 0xbf6dbf80,0xbec4bf35,0x3ec40000,0x3f6d3f35,0x3f0e0000,0x3f7b3f6d,0x3e483f35,0xbf55bec4
.long 0x3f353f80,0xbf350000,0xbf35bf80,0x3f350000,0xbf550000,0xbe48bf6d,0x3f7b3f35,0xbf0e3ec4
.long 0xbec4bf80,0x3f6d3f35,0xbf6d0000,0x3ec4bf35,0x3f7b0000,0xbf553ec4,0x3f0ebf35,0xbe483f6d
.long 0x3f80,0xbf80,0x3f80,0xbf80,0xbf7b0000,0x3f553ec4,0xbf0ebf35,0x3e483f6d
.long 0x3ec4bf80,0xbf6d3f35,0x3f6d0000,0xbec4bf35,0x3f550000,0x3e48bf6d,0xbf7b3f35,0x3f0e3ec4
.long 0xbf353f80,0x3f350000,0x3f35bf80,0xbf350000,0xbf0e0000,0xbf7b3f6d,0xbe483f35,0x3f55bec4
.long 0x3f6dbf80,0x3ec4bf35,0xbec40000,0xbf6d3f35,0x3e480000,0x3f0ebec4,0x3f55bf35,0x3f7bbf6d
.long 0xbf803f80,0xbf803f80,0xbf803f80,0xbf803f80,0xbf7bbf80,0xbf55bf6d,0xbf0ebf35,0xbe48bec4
.long 0x3ec48000,0x3f6d3f35,0x3f6d3f80,0x3ec43f35,0x3f553f80,0xbe483ec4,0xbf7bbf35,0xbf0ebf6d
.long 0xbf358000,0xbf35bf80,0x3f358000,0x3f353f80,0xbf0ebf80,0x3f7b3ec4,0xbe483f35,0xbf55bf6d
.long 0x3f6d8000,0xbec43f35,0xbec4bf80,0x3f6d3f35,0x3e483f80,0xbf0ebf6d,0x3f553f35,0xbf7bbec4
.long 0xbf808000,0x3f808000,0xbf808000,0x3f808000,0x3e48bf80,0xbf0e3f6d,0x3f55bf35,0xbf7b3ec4
.long 0x3f6d8000,0xbec4bf35,0xbec43f80,0x3f6dbf35,0xbf0e3f80,0x3f7bbec4,0xbe48bf35,0xbf553f6d
.long 0xbf358000,0xbf353f80,0x3f358000,0x3f35bf80,0x3f55bf80,0xbe48bec4,0xbf7b3f35,0xbf0e3f6d
.long 0x3ec48000,0x3f6dbf35,0x3f6dbf80,0x3ec4bf35,0xbf7b3f80,0xbf553f6d,0xbf0e3f35,0xbe483ec4
.long 0x3f803f80,0x3f803f80,0x3f803f80,0x3f803f80,0xbf7bbf80,0xbf55bf6d,0xbf0ebf35,0xbe48bec4
.long 0x3f6d3f80,0x3ec43f35,0xbec40000,0xbf6dbf35,0xbf55bf80,0x3e48bec4,0x3f7b3f35,0x3f0e3f6d
.long 0x3f353f80,0xbf350000,0xbf35bf80,0x3f350000,0xbf0ebf80,0x3f7b3ec4,0xbe483f35,0xbf55bf6d
.long 0x3ec43f80,0xbf6dbf35,0x3f6d0000,0xbec43f35,0xbe48bf80,0x3f0e3f6d,0xbf55bf35,0x3f7b3ec4
.long 0x3f80,0xbf80,0x3f80,0xbf80,0x3e48bf80,0xbf0e3f6d,0x3f55bf35,0xbf7b3ec4
.long 0xbec43f80,0x3f6dbf35,0xbf6d0000,0x3ec43f35,0x3f0ebf80,0xbf7b3ec4,0x3e483f35,0x3f55bf6d
.long 0xbf353f80,0x3f350000,0x3f35bf80,0xbf350000,0x3f55bf80,0xbe48bec4,0xbf7b3f35,0xbf0e3f6d
.long 0xbf6d3f80,0xbec43f35,0x3ec40000,0x3f6dbf35,0x3f7bbf80,0x3f55bf6d,0x3f0ebf35,0x3e48bec4
.long 0xbf803f80,0xbf803f80,0xbf803f80,0xbf803f80,0x3e488000,0x3f0e3ec4,0x3f553f35,0x3f7b3f6d
.long 0xbec48000,0xbf6dbf35,0xbf6dbf80,0xbec4bf35,0x3f0e8000,0x3f7b3f6d,0x3e483f35,0xbf55bec4
.long 0xbf358000,0xbf35bf80,0x3f358000,0x3f353f80,0x3f558000,0x3e483f6d,0xbf7bbf35,0x3f0ebec4
.long 0xbf6d8000,0x3ec4bf35,0x3ec43f80,0xbf6dbf35,0x3f7b8000,0xbf553ec4,0x3f0ebf35,0xbe483f6d
.long 0xbf808000,0x3f808000,0xbf808000,0x3f808000,0x3f7b8000,0xbf55bec4,0x3f0e3f35,0xbe48bf6d
.long 0xbf6d8000,0x3ec43f35,0x3ec4bf80,0xbf6d3f35,0x3f558000,0x3e48bf6d,0xbf7b3f35,0x3f0e3ec4
.long 0xbf358000,0xbf353f80,0x3f358000,0x3f35bf80,0x3f0e8000,0x3f7bbf6d,0x3e48bf35,0xbf553ec4
.long 0xbec48000,0xbf6d3f35,0xbf6d3f80,0xbec43f35,0x3e488000,0x3f0ebec4,0x3f55bf35,0x3f7bbf6d
.long 0x3f803f80,0x3f803f80,0x3f803f80,0x3f803f80,0x3e480000,0x3f0e3ec4,0x3f553f35,0x3f7b3f6d
.long 0xbf6dbf80,0xbec4bf35,0x3ec40000,0x3f6d3f35,0xbf0e0000,0xbf7bbf6d,0xbe48bf35,0x3f553ec4
.long 0x3f353f80,0xbf350000,0xbf35bf80,0x3f350000,0x3f550000,0x3e483f6d,0xbf7bbf35,0x3f0ebec4
.long 0xbec4bf80,0x3f6d3f35,0xbf6d0000,0x3ec4bf35,0xbf7b0000,0x3f55bec4,0xbf0e3f35,0x3e48bf6d
.long 0x3f80,0xbf80,0x3f80,0xbf80,0x3f7b0000,0xbf55bec4,0x3f0e3f35,0xbe48bf6d
.long 0x3ec4bf80,0xbf6d3f35,0x3f6d0000,0xbec4bf35,0xbf550000,0xbe483f6d,0x3f7bbf35,0xbf0ebec4
.long 0xbf353f80,0x3f350000,0x3f35bf80,0xbf350000,0x3f0e0000,0x3f7bbf6d,0x3e48bf35,0xbf553ec4
.long 0x3f6dbf80,0x3ec4bf35,0xbec40000,0xbf6d3f35,0xbe480000,0xbf0e3ec4,0xbf553f35,0xbf7b3f6d
.long 0xbf803f80,0xbf803f80,0xbf803f80,0xbf803f80,0x3f7b3f80,0x3f553f6d,0x3f0e3f35,0x3e483ec4
.long 0x3ec48000,0x3f6d3f35,0x3f6d3f80,0x3ec43f35,0xbf55bf80,0x3e48bec4,0x3f7b3f35,0x3f0e3f6d
.long 0xbf358000,0xbf35bf80,0x3f358000,0x3f353f80,0x3f0e3f80,0xbf7bbec4,0x3e48bf35,0x3f553f6d
.long 0x3f6d8000,0xbec43f35,0xbec4bf80,0x3f6d3f35,0xbe48bf80,0x3f0e3f6d,0xbf55bf35,0x3f7b3ec4
.long 0xbf808000,0x3f808000,0xbf808000,0x3f808000,0xbe483f80,0x3f0ebf6d,0xbf553f35,0x3f7bbec4
.long 0x3f6d8000,0xbec4bf35,0xbec43f80,0x3f6dbf35,0x3f0ebf80,0xbf7b3ec4,0x3e483f35,0x3f55bf6d
.long 0xbf358000,0xbf353f80,0x3f358000,0x3f35bf80,0xbf553f80,0x3e483ec4,0x3f7bbf35,0x3f0ebf6d
.long 0x3ec48000,0x3f6dbf35,0x3f6dbf80,0x3ec4bf35,0x3f7bbf80,0x3f55bf6d,0x3f0ebf35,0x3e48bec4
.long 0,0,0,0,0,0,0,0
.long 0,0,0,0,0,0,0,0
.long 0,0,0,0,0,0,0,0
.long 0,0,0,0,0,0,0,0
.long 0,0,0,0,0,0,0,0
.long 0,0,0,0,0,0,0,0
.long 0,0,0,0,0,0,0,0
.long 0,0,0,0,0,0,0,0
.long 0,0,0,0,0,0,0,0
.long 0,0,0,0,0,0,0,0
.long 0,0,0,0,0,0,0,0
.long 0,0,0,0,0,0,0,0
.long 0,0,0,0,0,0,0,0
.long 0,0,0,0,0,0,0,0
.long 0,0,0,0,0,0,0,0
.long 0,0,0,0,0,0,0,0
.long 0,0,0,0,0,0,0,0
.long 0,0,0,0,0,0,0,0
.long 0,0,0,0,0,0,0,0
.long 0,0,0,0,0,0,0,0
.long 0,0,0,0,0,0,0,0
.long 0,0,0,0,0,0,0,0
.long 0,0,0,0,0,0,0,0
.long 0,0,0,0,0,0,0,0
.long 0,0,0,0,0,0,0,0
.long 0,0,0,0,0,0,0,0
.long 0,0,0,0,0,0,0,0
.long 0,0,0,0,0,0,0,0
.long 0,0,0,0,0,0,0,0
.long 0,0,0,0,0,0,0,0
.long 0,0,0,0,0,0,0,0
.long 0,0,0,0,0,0,0,0
.long 0,0,0,0,0,0,0,0
.long 0,0,0,0,0,0,0,0
.long 0,0,0,0,0,0,0,0
.long 0,0,0,0,0,0,0,0
.long 0,0,0,0,0,0,0,0
.long 0,0,0,0,0,0,0,0
.long 0,0,0,0,0,0,0,0
.long 0,0,0,0,0,0,0,0
.long 0,0,0,0,0,0,0,0
.long 0,0,0,0,0,0,0,0
.long 0,0,0,0,0,0,0,0
.long 0,0,0,0,0,0,0,0
.long 0,0,0,0,0,0,0,0
.long 0,0,0,0,0,0,0,0
.long 0,0,0,0,0,0,0,0
.long 0,0,0,0,0,0,0,0
.long 0,0,0,0,0,0,0,0
.long 0,0,0,0,0,0,0,0
.long 0,0,0,0,0,0,0,0
.long 0,0,0,0,0,0,0,0
.long 0,0,0,0,0,0,0,0
.long 0,0,0,0,0,0,0,0
.long 0,0,0,0,0,0,0,0
.long 0,0,0,0,0,0,0,0
.long 0,0,0,0,0,0,0,0
.long 0,0,0,0,0,0,0,0
.long 0,0,0,0,0,0,0,0
.long 0,0,0,0,0,0,0,0
.long 0,0,0,0,0,0,0,0
.long 0,0,0,0,0,0,0,0
.long 0,0,0,0,0,0,0,0
.long 0,0,0,0,0,0,0,0
.long 0x3f80,0x3f80,0x3f80,0x3f80,0x3f80,0x3e483f7b,0x3ec43f6d,0x3f0e3f55
.long 0x3f80,0x3ec43f6d,0x3f353f35,0x3f6d3ec4,0x3f80,0x3f0e3f55,0x3f6d3ec4,0x3f7bbe48
.long 0x3f80,0x3f353f35,0x3f800000,0x3f35bf35,0x3f80,0x3f553f0e,0x3f6dbec4,0x3e48bf7b
.long 0x3f80,0x3f6d3ec4,0x3f35bf35,0xbec4bf6d,0x3f80,0x3f7b3e48,0x3ec4bf6d,0xbf55bf0e
.long 0x3f80,0x3f800000,0xbf80,0xbf800000,0x3f80,0x3f7bbe48,0xbec4bf6d,0xbf553f0e
.long 0x3f80,0x3f6dbec4,0xbf35bf35,0xbec43f6d,0x3f80,0x3f55bf0e,0xbf6dbec4,0x3e483f7b
.long 0x3f80,0x3f35bf35,0xbf800000,0x3f353f35,0x3f80,0x3f0ebf55,0xbf6d3ec4,0x3f7b3e48
.long 0x3f80,0x3ec4bf6d,0xbf353f35,0x3f6dbec4,0x3f80,0x3e48bf7b,0xbec43f6d,0x3f0ebf55
.long 0x3f80,0xbf80,0x3f80,0xbf80,0x3f80,0xbe48bf7b,0x3ec43f6d,0xbf0ebf55
.long 0x3f80,0xbec4bf6d,0x3f353f35,0xbf6dbec4,0x3f80,0xbf0ebf55,0x3f6d3ec4,0xbf7b3e48
.long 0x3f80,0xbf35bf35,0x3f800000,0xbf353f35,0x3f80,0xbf55bf0e,0x3f6dbec4,0xbe483f7b
.long 0x3f80,0xbf6dbec4,0x3f35bf35,0x3ec43f6d,0x3f80,0xbf7bbe48,0x3ec4bf6d,0x3f553f0e
.long 0x3f80,0xbf800000,0xbf80,0x3f800000,0x3f80,0xbf7b3e48,0xbec4bf6d,0x3f55bf0e
.long 0x3f80,0xbf6d3ec4,0xbf35bf35,0x3ec4bf6d,0x3f80,0xbf553f0e,0xbf6dbec4,0xbe48bf7b
.long 0x3f80,0xbf353f35,0xbf800000,0xbf35bf35,0x3f80,0xbf0e3f55,0xbf6d3ec4,0xbf7bbe48
.long 0x3f80,0xbec43f6d,0xbf353f35,0xbf6d3ec4,0x3f80,0xbe483f7b,0xbec43f6d,0xbf0e3f55
.long 0x3f80,0x3f80,0x3f80,0x3f80,0x3f353f35,0x3f553f0e,0x3f6d3ec4,0x3f7b3e48
.long 0x3f800000,0x3f6dbec4,0x3f35bf35,0x3ec4bf6d,0x3f35bf35,0x3e48bf7b,0xbec4bf6d,0xbf55bf0e
.long 0xbf80,0xbf35bf35,0xbf800000,0xbf353f35,0xbf35bf35,0xbf7b3e48,0xbec43f6d,0x3f0e3f55
.long 0xbf800000,0xbec43f6d,0x3f353f35,0x3f6dbec4,0xbf353f35,0x3f0e3f55,0x3f6dbec4,0xbe48bf7b
.long 0x3f80,0x3f800000,0xbf80,0xbf800000,0x3f353f35,0x3f0ebf55,0xbf6dbec4,0xbe483f7b
.long 0x3f800000,0xbec4bf6d,0xbf353f35,0x3f6d3ec4,0x3f35bf35,0xbf7bbe48,0x3ec43f6d,0x3f0ebf55
.long 0xbf80,0xbf353f35,0x3f800000,0xbf35bf35,0xbf35bf35,0x3e483f7b,0x3ec4bf6d,0xbf553f0e
.long 0xbf800000,0x3f6d3ec4,0xbf35bf35,0x3ec43f6d,0xbf353f35,0x3f55bf0e,0xbf6d3ec4,0x3f7bbe48
.long 0x3f80,0xbf80,0x3f80,0xbf80,0x3f353f35,0xbf55bf0e,0x3f6d3ec4,0xbf7bbe48
.long 0x3f800000,0xbf6d3ec4,0x3f35bf35,0xbec43f6d,0x3f35bf35,0xbe483f7b,0xbec4bf6d,0x3f553f0e
.long 0xbf80,0x3f353f35,0xbf800000,0x3f35bf35,0xbf35bf35,0x3f7bbe48,0xbec43f6d,0xbf0ebf55
.long 0xbf800000,0x3ec4bf6d,0x3f353f35,0xbf6d3ec4,0xbf353f35,0xbf0ebf55,0x3f6dbec4,0x3e483f7b
.long 0x3f80,0xbf800000,0xbf80,0x3f800000,0x3f353f35,0xbf0e3f55,0xbf6dbec4,0x3e48bf7b
.long 0x3f800000,0x3ec43f6d,0xbf353f35,0xbf6dbec4,0x3f35bf35,0x3f7b3e48,0x3ec43f6d,0xbf0e3f55
.long 0xbf80,0x3f35bf35,0x3f800000,0x3f353f35,0xbf35bf35,0xbe48bf7b,0x3ec4bf6d,0x3f55bf0e
.long 0xbf800000,0xbf6dbec4,0xbf35bf35,0xbec4bf6d,0xbf353f35,0xbf553f0e,0xbf6d3ec4,0xbf7b3e48
.long 0x3f80,0x3f80,0x3f80,0x3f80,0x3f800000,0x3f7bbe48,0x3f6dbec4,0x3f55bf0e
.long 0xbf80,0xbec4bf6d,0xbf35bf35,0xbf6dbec4,0xbf800000,0xbf553f0e,0xbec43f6d,0x3e483f7b
.long 0x3f80,0x3f353f35,0x3f800000,0x3f35bf35,0x3f800000,0x3f0ebf55,0xbec4bf6d,0xbf7bbe48
.long 0xbf80,0xbf6dbec4,0xbf353f35,0x3ec43f6d,0xbf800000,0xbe483f7b,0x3f6d3ec4,0x3f0ebf55
.long 0x3f80,0x3f800000,0xbf80,0xbf800000,0x3f800000,0xbe48bf7b,0xbf6d3ec4,0x3f0e3f55
.long 0xbf80,0xbf6d3ec4,0x3f353f35,0x3ec4bf6d,0xbf800000,0x3f0e3f55,0x3ec4bf6d,0xbf7b3e48
.long 0x3f80,0x3f35bf35,0xbf800000,0x3f353f35,0x3f800000,0xbf55bf0e,0x3ec43f6d,0x3e48bf7b
.long 0xbf80,0xbec43f6d,0x3f35bf35,0xbf6d3ec4,0xbf800000,0x3f7b3e48,0xbf6dbec4,0x3f553f0e
.long 0x3f80,0xbf80,0x3f80,0xbf80,0x3f800000,0xbf7b3e48,0x3f6dbec4,0xbf553f0e
.long 0xbf80,0x3ec43f6d,0xbf35bf35,0x3f6d3ec4,0xbf800000,0x3f55bf0e,0xbec43f6d,0xbe48bf7b
.long 0x3f80,0xbf35bf35,0x3f800000,0xbf353f35,0x3f800000,0xbf0e3f55,0xbec4bf6d,0x3f7b3e48
.long 0xbf80,0x3f6d3ec4,0xbf353f35,0xbec4bf6d,0xbf800000,0x3e48bf7b,0x3f6d3ec4,0xbf0e3f55
.long 0x3f80,0xbf800000,0xbf80,0x3f800000,0x3f800000,0x3e483f7b,0xbf6d3ec4,0xbf0ebf55
.long 0xbf80,0x3f6dbec4,0x3f353f35,0xbec43f6d,0xbf800000,0xbf0ebf55,0x3ec4bf6d,0x3f7bbe48
.long 0x3f80,0xbf353f35,0xbf800000,0xbf35bf35,0x3f800000,0x3f553f0e,0x3ec43f6d,0xbe483f7b
.long 0xbf80,0x3ec4bf6d,0x3f35bf35,0x3f6dbec4,0xbf800000,0xbf7bbe48,0xbf6dbec4,0xbf55bf0e
.long 0x3f80,0x3f80,0x3f80,0x3f80,0x3f35bf35,0x3f0ebf55,0x3ec4bf6d,0x3e48bf7b
.long 0xbf800000,0xbf6d3ec4,0xbf353f35,0xbec43f6d,0x3f353f35,0x3f7b3e48,0x3f6dbec4,0x3f0ebf55
.long 0xbf80,0xbf35bf35,0xbf800000,0xbf353f35,0xbf353f35,0x3e483f7b,0x3f6d3ec4,0x3f55bf0e
.long 0x3f800000,0x3ec4bf6d,0xbf35bf35,0xbf6d3ec4,0xbf35bf35,0xbf553f0e,0x3ec43f6d,0x3f7bbe48
.long 0x3f80,0x3f800000,0xbf80,0xbf800000,0x3f35bf35,0xbf55bf0e,0xbec43f6d,0x3f7b3e48
.long 0xbf800000,0x3ec43f6d,0x3f35bf35,0xbf6dbec4,0x3f353f35,0x3e48bf7b,0xbf6d3ec4,0x3f553f0e
.long 0xbf80,0xbf353f35,0x3f800000,0xbf35bf35,0xbf353f35,0x3f7bbe48,0xbf6dbec4,0x3f0e3f55
.long 0x3f800000,0xbf6dbec4,0x3f353f35,0xbec4bf6d,0xbf35bf35,0x3f0e3f55,0xbec4bf6d,0x3e483f7b
.long 0x3f80,0xbf80,0x3f80,0xbf80,0x3f35bf35,0xbf0e3f55,0x3ec4bf6d,0xbe483f7b
.long 0xbf800000,0x3f6dbec4,0xbf353f35,0x3ec4bf6d,0x3f353f35,0xbf7bbe48,0x3f6dbec4,0xbf0e3f55
.long 0xbf80,0x3f353f35,0xbf800000,0x3f35bf35,0xbf353f35,0xbe48bf7b,0x3f6d3ec4,0xbf553f0e
.long 0x3f800000,0xbec43f6d,0xbf35bf35,0x3f6dbec4,0xbf35bf35,0x3f55bf0e,0x3ec43f6d,0xbf7b3e48
.long 0x3f80,0xbf800000,0xbf80,0x3f800000,0x3f35bf35,0x3f553f0e,0xbec43f6d,0xbf7bbe48
.long 0xbf800000,0xbec4bf6d,0x3f35bf35,0x3f6d3ec4,0x3f353f35,0xbe483f7b,0xbf6d3ec4,0xbf55bf0e
.long 0xbf80,0x3f35bf35,0x3f800000,0x3f353f35,0xbf353f35,0xbf7b3e48,0xbf6dbec4,0xbf0ebf55
.long 0x3f800000,0x3f6d3ec4,0x3f353f35,0x3ec43f6d,0xbf35bf35,0xbf0ebf55,0xbec4bf6d,0xbe48bf7b
.long 0x3f80,0x3f80,0x3f80,0x3f80,0xbf80,0xbe48bf7b,0xbec4bf6d,0xbf0ebf55
.long 0x3f80,0x3ec43f6d,0x3f353f35,0x3f6d3ec4,0xbf80,0xbf0ebf55,0xbf6dbec4,0xbf7b3e48
.long 0x3f80,0x3f353f35,0x3f800000,0x3f35bf35,0xbf80,0xbf55bf0e,0xbf6d3ec4,0xbe483f7b
.long 0x3f80,0x3f6d3ec4,0x3f35bf35,0xbec4bf6d,0xbf80,0xbf7bbe48,0xbec43f6d,0x3f553f0e
.long 0x3f80,0x3f800000,0xbf80,0xbf800000,0xbf80,0xbf7b3e48,0x3ec43f6d,0x3f55bf0e
.long 0x3f80,0x3f6dbec4,0xbf35bf35,0xbec43f6d,0xbf80,0xbf553f0e,0x3f6d3ec4,0xbe48bf7b
.long 0x3f80,0x3f35bf35,0xbf800000,0x3f353f35,0xbf80,0xbf0e3f55,0x3f6dbec4,0xbf7bbe48
.long 0x3f80,0x3ec4bf6d,0xbf353f35,0x3f6dbec4,0xbf80,0xbe483f7b,0x3ec4bf6d,0xbf0e3f55
.long 0x3f80,0xbf80,0x3f80,0xbf80,0xbf80,0x3e483f7b,0xbec4bf6d,0x3f0e3f55
.long 0x3f80,0xbec4bf6d,0x3f353f35,0xbf6dbec4,0xbf80,0x3f0e3f55,0xbf6dbec4,0x3f7bbe48
.long 0x3f80,0xbf35bf35,0x3f800000,0xbf353f35,0xbf80,0x3f553f0e,0xbf6d3ec4,0x3e48bf7b
.long 0x3f80,0xbf6dbec4,0x3f35bf35,0x3ec43f6d,0xbf80,0x3f7b3e48,0xbec43f6d,0xbf55bf0e
.long 0x3f80,0xbf800000,0xbf80,0x3f800000,0xbf80,0x3f7bbe48,0x3ec43f6d,0xbf553f0e
.long 0x3f80,0xbf6d3ec4,0xbf35bf35,0x3ec4bf6d,0xbf80,0x3f55bf0e,0x3f6d3ec4,0x3e483f7b
.long 0x3f80,0xbf353f35,0xbf800000,0xbf35bf35,0xbf80,0x3f0ebf55,0x3f6dbec4,0x3f7b3e48
.long 0x3f80,0xbec43f6d,0xbf353f35,0xbf6d3ec4,0xbf80,0x3e48bf7b,0x3ec4bf6d,0x3f0ebf55
.long 0x3f80,0x3f80,0x3f80,0x3f80,0xbf35bf35,0xbf55bf0e,0xbf6dbec4,0xbf7bbe48
.long 0x3f800000,0x3f6dbec4,0x3f35bf35,0x3ec4bf6d,0xbf353f35,0xbe483f7b,0x3ec43f6d,0x3f553f0e
.long 0xbf80,0xbf35bf35,0xbf800000,0xbf353f35,0x3f353f35,0x3f7bbe48,0x3ec4bf6d,0xbf0ebf55
.long 0xbf800000,0xbec43f6d,0x3f353f35,0x3f6dbec4,0x3f35bf35,0xbf0ebf55,0xbf6d3ec4,0x3e483f7b
.long 0x3f80,0x3f800000,0xbf80,0xbf800000,0xbf35bf35,0xbf0e3f55,0x3f6d3ec4,0x3e48bf7b
.long 0x3f800000,0xbec4bf6d,0xbf353f35,0x3f6d3ec4,0xbf353f35,0x3f7b3e48,0xbec4bf6d,0xbf0e3f55
.long 0xbf80,0xbf353f35,0x3f800000,0xbf35bf35,0x3f353f35,0xbe48bf7b,0xbec43f6d,0x3f55bf0e
.long 0xbf800000,0x3f6d3ec4,0xbf35bf35,0x3ec43f6d,0x3f35bf35,0xbf553f0e,0x3f6dbec4,0xbf7b3e48
.long 0x3f80,0xbf80,0x3f80,0xbf80,0xbf35bf35,0x3f553f0e,0xbf6dbec4,0x3f7b3e48
.long 0x3f800000,0xbf6d3ec4,0x3f35bf35,0xbec43f6d,0xbf353f35,0x3e48bf7b,0x3ec43f6d,0xbf55bf0e
.long 0xbf80,0x3f353f35,0xbf800000,0x3f35bf35,0x3f353f35,0xbf7b3e48,0x3ec4bf6d,0x3f0e3f55
.long 0xbf800000,0x3ec4bf6d,0x3f353f35,0xbf6d3ec4,0x3f35bf35,0x3f0e3f55,0xbf6d3ec4,0xbe48bf7b
.long 0x3f80,0xbf800000,0xbf80,0x3f800000,0xbf35bf35,0x3f0ebf55,0x3f6d3ec4,0xbe483f7b
.long 0x3f800000,0x3ec43f6d,0xbf353f35,0xbf6dbec4,0xbf353f35,0xbf7bbe48,0xbec4bf6d,0x3f0ebf55
.long 0xbf80,0x3f35bf35,0x3f800000,0x3f353f35,0x3f353f35,0x3e483f7b,0xbec43f6d,0xbf553f0e
.long 0xbf800000,0xbf6dbec4,0xbf35bf35,0xbec4bf6d,0x3f35bf35,0x3f55bf0e,0x3f6dbec4,0x3f7bbe48
.long 0x3f80,0x3f80,0x3f80,0x3f80,0xbf800000,0xbf7b3e48,0xbf6d3ec4,0xbf553f0e
.long 0xbf80,0xbec4bf6d,0xbf35bf35,0xbf6dbec4,0x3f800000,0x3f55bf0e,0x3ec4bf6d,0xbe48bf7b
.long 0x3f80,0x3f353f35,0x3f800000,0x3f35bf35,0xbf800000,0xbf0e3f55,0x3ec43f6d,0x3f7b3e48
.long 0xbf80,0xbf6dbec4,0xbf353f35,0x3ec43f6d,0x3f800000,0x3e48bf7b,0xbf6dbec4,0xbf0e3f55
.long 0x3f80,0x3f800000,0xbf80,0xbf800000,0xbf800000,0x3e483f7b,0x3f6dbec4,0xbf0ebf55
.long 0xbf80,0xbf6d3ec4,0x3f353f35,0x3ec4bf6d,0x3f800000,0xbf0ebf55,0xbec43f6d,0x3f7bbe48
.long 0x3f80,0x3f35bf35,0xbf800000,0x3f353f35,0xbf800000,0x3f553f0e,0xbec4bf6d,0xbe483f7b
.long 0xbf80,0xbec43f6d,0x3f35bf35,0xbf6d3ec4,0x3f800000,0xbf7bbe48,0x3f6d3ec4,0xbf55bf0e
.long 0x3f80,0xbf80,0x3f80,0xbf80,0xbf800000,0x3f7bbe48,0xbf6d3ec4,0x3f55bf0e
.long 0xbf80,0x3ec43f6d,0xbf35bf35,0x3f6d3ec4,0x3f800000,0xbf553f0e,0x3ec4bf6d,0x3e483f7b
.long 0x3f80,0xbf35bf35,0x3f800000,0xbf353f35,0xbf800000,0x3f0ebf55,0x3ec43f6d,0xbf7bbe48
.long 0xbf80,0x3f6d3ec4,0xbf353f35,0xbec4bf6d,0x3f800000,0xbe483f7b,0xbf6dbec4,0x3f0ebf55
.long 0x3f80,0xbf800000,0xbf80,0x3f800000,0xbf800000,0xbe48bf7b,0x3f6dbec4,0x3f0e3f55
.long 0xbf80,0x3f6dbec4,0x3f353f35,0xbec43f6d,0x3f800000,0x3f0e3f55,0xbec43f6d,0xbf7b3e48
.long 0x3f80,0xbf353f35,0xbf800000,0xbf35bf35,0xbf800000,0xbf55bf0e,0xbec4bf6d,0x3e48bf7b
.long 0xbf80,0x3ec4bf6d,0x3f35bf35,0x3f6dbec4,0x3f800000,0x3f7b3e48,0x3f6d3ec4,0x3f553f0e
.long 0x3f80,0x3f80,0x3f80,0x3f80,0xbf353f35,0xbf0e3f55,0xbec43f6d,0xbe483f7b
.long 0xbf800000,0xbf6d3ec4,0xbf353f35,0xbec43f6d,0xbf35bf35,0xbf7bbe48,0xbf6d3ec4,0xbf0e3f55
.long 0xbf80,0xbf35bf35,0xbf800000,0xbf353f35,0x3f35bf35,0xbe48bf7b,0xbf6dbec4,0xbf553f0e
.long 0x3f800000,0x3ec4bf6d,0xbf35bf35,0xbf6d3ec4,0x3f353f35,0x3f55bf0e,0xbec4bf6d,0xbf7b3e48
.long 0x3f80,0x3f800000,0xbf80,0xbf800000,0xbf353f35,0x3f553f0e,0x3ec4bf6d,0xbf7bbe48
.long 0xbf800000,0x3ec43f6d,0x3f35bf35,0xbf6dbec4,0xbf35bf35,0xbe483f7b,0x3f6dbec4,0xbf55bf0e
.long 0xbf80,0xbf353f35,0x3f800000,0xbf35bf35,0x3f35bf35,0xbf7b3e48,0x3f6d3ec4,0xbf0ebf55
.long 0x3f800000,0xbf6dbec4,0x3f353f35,0xbec4bf6d,0x3f353f35,0xbf0ebf55,0x3ec43f6d,0xbe48bf7b
.long 0x3f80,0xbf80,0x3f80,0xbf80,0xbf353f35,0x3f0ebf55,0xbec43f6d,0x3e48bf7b
.long 0xbf800000,0x3f6dbec4,0xbf353f35,0x3ec4bf6d,0xbf35bf35,0x3f7b3e48,0xbf6d3ec4,0x3f0ebf55
.long 0xbf80,0x3f353f35,0xbf800000,0x3f35bf35,0x3f35bf35,0x3e483f7b,0xbf6dbec4,0x3f55bf0e
.long 0x3f800000,0xbec43f6d,0xbf35bf35,0x3f6dbec4,0x3f353f35,0xbf553f0e,0xbec4bf6d,0x3f7bbe48
.long 0x3f80,0xbf800000,0xbf80,0x3f800000,0xbf353f35,0xbf55bf0e,0x3ec4bf6d,0x3f7b3e48
.long 0xbf800000,0xbec4bf6d,0x3f35bf35,0x3f6d3ec4,0xbf35bf35,0x3e48bf7b,0x3f6dbec4,0x3f553f0e
.long 0xbf80,0x3f35bf35,0x3f800000,0x3f353f35,0x3f35bf35,0x3f7bbe48,0x3f6d3ec4,0x3f0e3f55
.long 0x3f800000,0x3f6d3ec4,0x3f353f35,0x3ec43f6d,0x3f353f35,0x3f0e3f55,0x3ec43f6d,0x3e483f7b
.long 0x3f808000,0x3f808000,0x3f808000,0x3f808000,0x3f808000,0x3f7bbe48,0x3f6dbec4,0x3f55bf0e
.long 0x3f808000,0x3f6dbec4,0x3f35bf35,0x3ec4bf6d,0x3f808000,0x3f55bf0e,0x3ec4bf6d,0xbe48bf7b
.long 0x3f808000,0x3f35bf35,0xbf80,0xbf35bf35,0x3f808000,0x3f0ebf55,0xbec4bf6d,0xbf7bbe48
.long 0x3f808000,0x3ec4bf6d,0xbf35bf35,0xbf6d3ec4,0x3f808000,0x3e48bf7b,0xbf6dbec4,0xbf0e3f55
.long 0x3f808000,0xbf80,0xbf808000,0x3f80,0x3f808000,0xbe48bf7b,0xbf6d3ec4,0x3f0e3f55
.long 0x3f808000,0xbec4bf6d,0xbf353f35,0x3f6d3ec4,0x3f808000,0xbf0ebf55,0xbec43f6d,0x3f7bbe48
.long 0x3f808000,0xbf35bf35,0x3f80,0x3f35bf35,0x3f808000,0xbf55bf0e,0x3ec43f6d,0x3e48bf7b
.long 0x3f808000,0xbf6dbec4,0x3f353f35,0xbec4bf6d,0x3f808000,0xbf7bbe48,0x3f6d3ec4,0xbf55bf0e
.long 0x3f808000,0xbf808000,0x3f808000,0xbf808000,0x3f808000,0xbf7b3e48,0x3f6dbec4,0xbf553f0e
.long 0x3f808000,0xbf6d3ec4,0x3f35bf35,0xbec43f6d,0x3f808000,0xbf553f0e,0x3ec4bf6d,0x3e483f7b
.long 0x3f808000,0xbf353f35,0xbf80,0x3f353f35,0x3f808000,0xbf0e3f55,0xbec4bf6d,0x3f7b3e48
.long 0x3f808000,0xbec43f6d,0xbf35bf35,0x3f6dbec4,0x3f808000,0xbe483f7b,0xbf6dbec4,0x3f0ebf55
.long 0x3f808000,0x3f80,0xbf808000,0xbf80,0x3f808000,0x3e483f7b,0xbf6d3ec4,0xbf0ebf55
.long 0x3f808000,0x3ec43f6d,0xbf353f35,0xbf6dbec4,0x3f808000,0x3f0e3f55,0xbec43f6d,0xbf7b3e48
.long 0x3f808000,0x3f353f35,0x3f80,0xbf353f35,0x3f808000,0x3f553f0e,0x3ec43f6d,0xbe483f7b
.long 0x3f808000,0x3f6d3ec4,0x3f353f35,0x3ec43f6d,0x3f808000,0x3f7b3e48,0x3f6d3ec4,0x3f553f0e
.long 0x3f808000,0x3f808000,0x3f808000,0x3f808000,0x3f35bf35,0x3f0ebf55,0x3ec4bf6d,0x3e48bf7b
.long 0xbf80,0xbec4bf6d,0xbf35bf35,0xbf6dbec4,0xbf35bf35,0xbf7bbe48,0xbf6d3ec4,0xbf0e3f55
.long 0xbf808000,0xbf353f35,0x3f80,0x3f353f35,0xbf353f35,0x3e483f7b,0x3f6d3ec4,0x3f55bf0e
.long 0x3f80,0x3f6d3ec4,0x3f35bf35,0xbec4bf6d,0x3f353f35,0x3f55bf0e,0xbec4bf6d,0xbf7b3e48
.long 0x3f808000,0xbf80,0xbf808000,0x3f80,0x3f35bf35,0xbf55bf0e,0xbec43f6d,0x3f7b3e48
.long 0xbf80,0xbf6d3ec4,0x3f353f35,0x3ec4bf6d,0xbf35bf35,0xbe483f7b,0x3f6dbec4,0xbf55bf0e
.long 0xbf808000,0x3f353f35,0xbf80,0xbf353f35,0xbf353f35,0x3f7bbe48,0xbf6dbec4,0x3f0e3f55
.long 0x3f80,0x3ec4bf6d,0xbf353f35,0x3f6dbec4,0x3f353f35,0xbf0ebf55,0x3ec43f6d,0xbe48bf7b
.long 0x3f808000,0xbf808000,0x3f808000,0xbf808000,0x3f35bf35,0xbf0e3f55,0x3ec4bf6d,0xbe483f7b
.long 0xbf80,0x3ec43f6d,0xbf35bf35,0x3f6d3ec4,0xbf35bf35,0x3f7b3e48,0xbf6d3ec4,0x3f0ebf55
.long 0xbf808000,0x3f35bf35,0x3f80,0xbf35bf35,0xbf353f35,0xbe48bf7b,0x3f6d3ec4,0xbf553f0e
.long 0x3f80,0xbf6dbec4,0x3f35bf35,0x3ec43f6d,0x3f353f35,0xbf553f0e,0xbec4bf6d,0x3f7bbe48
.long 0x3f808000,0x3f80,0xbf808000,0xbf80,0x3f35bf35,0x3f553f0e,0xbec43f6d,0xbf7bbe48
.long 0xbf80,0x3f6dbec4,0x3f353f35,0xbec43f6d,0xbf35bf35,0x3e48bf7b,0x3f6dbec4,0x3f553f0e
.long 0xbf808000,0xbf35bf35,0xbf80,0x3f35bf35,0xbf353f35,0xbf7b3e48,0xbf6dbec4,0xbf0ebf55
.long 0x3f80,0xbec43f6d,0xbf353f35,0xbf6d3ec4,0x3f353f35,0x3f0e3f55,0x3ec43f6d,0x3e483f7b
.long 0x3f808000,0x3f808000,0x3f808000,0x3f808000,0xbf80,0xbe48bf7b,0xbec4bf6d,0xbf0ebf55
.long 0xbf808000,0xbf6d3ec4,0xbf353f35,0xbec43f6d,0x3f80,0x3f0e3f55,0x3f6d3ec4,0x3f7bbe48
.long 0x3f808000,0x3f35bf35,0xbf80,0xbf35bf35,0xbf80,0xbf55bf0e,0xbf6d3ec4,0xbe483f7b
.long 0xbf808000,0xbec43f6d,0x3f353f35,0x3f6dbec4,0x3f80,0x3f7b3e48,0x3ec4bf6d,0xbf55bf0e
.long 0x3f808000,0xbf80,0xbf808000,0x3f80,0xbf80,0xbf7b3e48,0x3ec43f6d,0x3f55bf0e
.long 0xbf808000,0x3ec43f6d,0x3f35bf35,0xbf6dbec4,0x3f80,0x3f55bf0e,0xbf6dbec4,0x3e483f7b
.long 0x3f808000,0xbf35bf35,0x3f80,0x3f35bf35,0xbf80,0xbf0e3f55,0x3f6dbec4,0xbf7bbe48
.long 0xbf808000,0x3f6d3ec4,0xbf35bf35,0x3ec43f6d,0x3f80,0x3e48bf7b,0xbec43f6d,0x3f0ebf55
.long 0x3f808000,0xbf808000,0x3f808000,0xbf808000,0xbf80,0x3e483f7b,0xbec4bf6d,0x3f0e3f55
.long 0xbf808000,0x3f6dbec4,0xbf353f35,0x3ec4bf6d,0x3f80,0xbf0ebf55,0x3f6d3ec4,0xbf7b3e48
.long 0x3f808000,0xbf353f35,0xbf80,0x3f353f35,0xbf80,0x3f553f0e,0xbf6d3ec4,0x3e48bf7b
.long 0xbf808000,0x3ec4bf6d,0x3f353f35,0xbf6d3ec4,0x3f80,0xbf7bbe48,0x3ec4bf6d,0x3f553f0e
.long 0x3f808000,0x3f80,0xbf808000,0xbf80,0xbf80,0x3f7bbe48,0x3ec43f6d,0xbf553f0e
.long 0xbf808000,0xbec4bf6d,0x3f35bf35,0x3f6d3ec4,0x3f80,0xbf553f0e,0xbf6dbec4,0xbe48bf7b
.long 0x3f808000,0x3f353f35,0x3f80,0xbf353f35,0xbf80,0x3f0ebf55,0x3f6dbec4,0x3f7b3e48
.long 0xbf808000,0xbf6dbec4,0xbf35bf35,0xbec4bf6d,0x3f80,0xbe483f7b,0xbec43f6d,0xbf0e3f55
.long 0x3f808000,0x3f808000,0x3f808000,0x3f808000,0xbf35bf35,0xbf55bf0e,0xbf6dbec4,0xbf7bbe48
.long 0x3f80,0x3ec43f6d,0x3f353f35,0x3f6d3ec4,0x3f35bf35,0x3e48bf7b,0xbec4bf6d,0xbf55bf0e
.long 0xbf808000,0xbf353f35,0x3f80,0x3f353f35,0x3f353f35,0x3f7bbe48,0x3ec4bf6d,0xbf0ebf55
.long 0xbf80,0xbf6dbec4,0xbf353f35,0x3ec43f6d,0xbf353f35,0x3f0e3f55,0x3f6dbec4,0xbe48bf7b
.long 0x3f808000,0xbf80,0xbf808000,0x3f80,0xbf35bf35,0xbf0e3f55,0x3f6d3ec4,0x3e48bf7b
.long 0x3f80,0x3f6dbec4,0xbf35bf35,0xbec43f6d,0x3f35bf35,0xbf7bbe48,0x3ec43f6d,0x3f0ebf55
.long 0xbf808000,0x3f353f35,0xbf80,0xbf353f35,0x3f353f35,0xbe48bf7b,0xbec43f6d,0x3f55bf0e
.long 0xbf80,0xbec43f6d,0x3f35bf35,0xbf6d3ec4,0xbf353f35,0x3f55bf0e,0xbf6d3ec4,0x3f7bbe48
.long 0x3f808000,0xbf808000,0x3f808000,0xbf808000,0xbf35bf35,0x3f553f0e,0xbf6dbec4,0x3f7b3e48
.long 0x3f80,0xbec4bf6d,0x3f353f35,0xbf6dbec4,0x3f35bf35,0xbe483f7b,0xbec4bf6d,0x3f553f0e
.long 0xbf808000,0x3f35bf35,0x3f80,0xbf35bf35,0x3f353f35,0xbf7b3e48,0x3ec4bf6d,0x3f0e3f55
.long 0xbf80,0x3f6d3ec4,0xbf353f35,0xbec4bf6d,0xbf353f35,0xbf0ebf55,0x3f6dbec4,0x3e483f7b
.long 0x3f808000,0x3f80,0xbf808000,0xbf80,0xbf35bf35,0x3f0ebf55,0x3f6d3ec4,0xbe483f7b
.long 0x3f80,0xbf6d3ec4,0xbf35bf35,0x3ec4bf6d,0x3f35bf35,0x3f7b3e48,0x3ec43f6d,0xbf0e3f55
.long 0xbf808000,0xbf35bf35,0xbf80,0x3f35bf35,0x3f353f35,0x3e483f7b,0xbec43f6d,0xbf553f0e
.long 0xbf80,0x3ec4bf6d,0x3f35bf35,0x3f6dbec4,0xbf353f35,0xbf553f0e,0xbf6d3ec4,0xbf7b3e48
.long 0x3f808000,0x3f808000,0x3f808000,0x3f808000,0xbf808000,0xbf7b3e48,0xbf6d3ec4,0xbf553f0e
.long 0x3f808000,0x3f6dbec4,0x3f35bf35,0x3ec4bf6d,0xbf808000,0xbf553f0e,0xbec43f6d,0x3e483f7b
.long 0x3f808000,0x3f35bf35,0xbf80,0xbf35bf35,0xbf808000,0xbf0e3f55,0x3ec43f6d,0x3f7b3e48
.long 0x3f808000,0x3ec4bf6d,0xbf35bf35,0xbf6d3ec4,0xbf808000,0xbe483f7b,0x3f6d3ec4,0x3f0ebf55
.long 0x3f808000,0xbf80,0xbf808000,0x3f80,0xbf808000,0x3e483f7b,0x3f6dbec4,0xbf0ebf55
.long 0x3f808000,0xbec4bf6d,0xbf353f35,0x3f6d3ec4,0xbf808000,0x3f0e3f55,0x3ec4bf6d,0xbf7b3e48
.long 0x3f808000,0xbf35bf35,0x3f80,0x3f35bf35,0xbf808000,0x3f553f0e,0xbec4bf6d,0xbe483f7b
.long 0x3f808000,0xbf6dbec4,0x3f353f35,0xbec4bf6d,0xbf808000,0x3f7b3e48,0xbf6dbec4,0x3f553f0e
.long 0x3f808000,0xbf808000,0x3f808000,0xbf808000,0xbf808000,0x3f7bbe48,0xbf6d3ec4,0x3f55bf0e
.long 0x3f808000,0xbf6d3ec4,0x3f35bf35,0xbec43f6d,0xbf808000,0x3f55bf0e,0xbec43f6d,0xbe48bf7b
.long 0x3f808000,0xbf353f35,0xbf80,0x3f353f35,0xbf808000,0x3f0ebf55,0x3ec43f6d,0xbf7bbe48
.long 0x3f808000,0xbec43f6d,0xbf35bf35,0x3f6dbec4,0xbf808000,0x3e48bf7b,0x3f6d3ec4,0xbf0e3f55
.long 0x3f808000,0x3f80,0xbf808000,0xbf80,0xbf808000,0xbe48bf7b,0x3f6dbec4,0x3f0e3f55
.long 0x3f808000,0x3ec43f6d,0xbf353f35,0xbf6dbec4,0xbf808000,0xbf0ebf55,0x3ec4bf6d,0x3f7bbe48
.long 0x3f808000,0x3f353f35,0x3f80,0xbf353f35,0xbf808000,0xbf55bf0e,0xbec4bf6d,0x3e48bf7b
.long 0x3f808000,0x3f6d3ec4,0x3f353f35,0x3ec43f6d,0xbf808000,0xbf7bbe48,0xbf6dbec4,0xbf55bf0e
.long 0x3f808000,0x3f808000,0x3f808000,0x3f808000,0xbf353f35,0xbf0e3f55,0xbec43f6d,0xbe483f7b
.long 0xbf80,0xbec4bf6d,0xbf35bf35,0xbf6dbec4,0x3f353f35,0x3f7b3e48,0x3f6dbec4,0x3f0ebf55
.long 0xbf808000,0xbf353f35,0x3f80,0x3f353f35,0x3f35bf35,0xbe48bf7b,0xbf6dbec4,0xbf553f0e
.long 0x3f80,0x3f6d3ec4,0x3f35bf35,0xbec4bf6d,0xbf35bf35,0xbf553f0e,0x3ec43f6d,0x3f7bbe48
.long 0x3f808000,0xbf80,0xbf808000,0x3f80,0xbf353f35,0x3f553f0e,0x3ec4bf6d,0xbf7bbe48
.long 0xbf80,0xbf6d3ec4,0x3f353f35,0x3ec4bf6d,0x3f353f35,0x3e48bf7b,0xbf6d3ec4,0x3f553f0e
.long 0xbf808000,0x3f353f35,0xbf80,0xbf353f35,0x3f35bf35,0xbf7b3e48,0x3f6d3ec4,0xbf0ebf55
.long 0x3f80,0x3ec4bf6d,0xbf353f35,0x3f6dbec4,0xbf35bf35,0x3f0e3f55,0xbec4bf6d,0x3e483f7b
.long 0x3f808000,0xbf808000,0x3f808000,0xbf808000,0xbf353f35,0x3f0ebf55,0xbec43f6d,0x3e48bf7b
.long 0xbf80,0x3ec43f6d,0xbf35bf35,0x3f6d3ec4,0x3f353f35,0xbf7bbe48,0x3f6dbec4,0xbf0e3f55
.long 0xbf808000,0x3f35bf35,0x3f80,0xbf35bf35,0x3f35bf35,0x3e483f7b,0xbf6dbec4,0x3f55bf0e
.long 0x3f80,0xbf6dbec4,0x3f35bf35,0x3ec43f6d,0xbf35bf35,0x3f55bf0e,0x3ec43f6d,0xbf7b3e48
.long 0x3f808000,0x3f80,0xbf808000,0xbf80,0xbf353f35,0xbf55bf0e,0x3ec4bf6d,0x3f7b3e48
.long 0xbf80,0x3f6dbec4,0x3f353f35,0xbec43f6d,0x3f353f35,0xbe483f7b,0xbf6d3ec4,0xbf55bf0e
.long 0xbf808000,0xbf35bf35,0xbf80,0x3f35bf35,0x3f35bf35,0x3f7bbe48,0x3f6d3ec4,0x3f0e3f55
.long 0x3f80,0xbec43f6d,0xbf353f35,0xbf6d3ec4,0xbf35bf35,0xbf0ebf55,0xbec4bf6d,0xbe48bf7b
.long 0x3f808000,0x3f808000,0x3f808000,0x3f808000,0x3f80,0x3e483f7b,0x3ec43f6d,0x3f0e3f55
.long 0xbf808000,0xbf6d3ec4,0xbf353f35,0xbec43f6d,0xbf80,0xbf0ebf55,0xbf6dbec4,0xbf7b3e48
.long 0x3f808000,0x3f35bf35,0xbf80,0xbf35bf35,0x3f80,0x3f553f0e,0x3f6dbec4,0x3e48bf7b
.long 0xbf808000,0xbec43f6d,0x3f353f35,0x3f6dbec4,0xbf80,0xbf7bbe48,0xbec43f6d,0x3f553f0e
.long 0x3f808000,0xbf80,0xbf808000,0x3f80,0x3f80,0x3f7bbe48,0xbec4bf6d,0xbf553f0e
.long 0xbf808000,0x3ec43f6d,0x3f35bf35,0xbf6dbec4,0xbf80,0xbf553f0e,0x3f6d3ec4,0xbe48bf7b
.long 0x3f808000,0xbf35bf35,0x3f80,0x3f35bf35,0x3f80,0x3f0ebf55,0xbf6d3ec4,0x3f7b3e48
.long 0xbf808000,0x3f6d3ec4,0xbf35bf35,0x3ec43f6d,0xbf80,0xbe483f7b,0x3ec4bf6d,0xbf0e3f55
.long 0x3f808000,0xbf808000,0x3f808000,0xbf808000,0x3f80,0xbe48bf7b,0x3ec43f6d,0xbf0ebf55
.long 0xbf808000,0x3f6dbec4,0xbf353f35,0x3ec4bf6d,0xbf80,0x3f0e3f55,0xbf6dbec4,0x3f7bbe48
.long 0x3f808000,0xbf353f35,0xbf80,0x3f353f35,0x3f80,0xbf55bf0e,0x3f6dbec4,0xbe483f7b
.long 0xbf808000,0x3ec4bf6d,0x3f353f35,0xbf6d3ec4,0xbf80,0x3f7b3e48,0xbec43f6d,0xbf55bf0e
.long 0x3f808000,0x3f80,0xbf808000,0xbf80,0x3f80,0xbf7b3e48,0xbec4bf6d,0x3f55bf0e
.long 0xbf808000,0xbec4bf6d,0x3f35bf35,0x3f6d3ec4,0xbf80,0x3f55bf0e,0x3f6d3ec4,0x3e483f7b
.long 0x3f808000,0x3f353f35,0x3f80,0xbf353f35,0x3f80,0xbf0e3f55,0xbf6d3ec4,0xbf7bbe48
.long 0xbf808000,0xbf6dbec4,0xbf35bf35,0xbec4bf6d,0xbf80,0x3e48bf7b,0x3ec4bf6d,0x3f0ebf55
.long 0x3f808000,0x3f808000,0x3f808000,0x3f808000,0x3f353f35,0x3f553f0e,0x3f6d3ec4,0x3f7b3e48
.long 0x3f80,0x3ec43f6d,0x3f353f35,0x3f6d3ec4,0xbf353f35,0xbe483f7b,0x3ec43f6d,0x3f553f0e
.long 0xbf808000,0xbf353f35,0x3f80,0x3f353f35,0xbf35bf35,0xbf7b3e48,0xbec43f6d,0x3f0e3f55
.long 0xbf80,0xbf6dbec4,0xbf353f35,0x3ec43f6d,0x3f35bf35,0xbf0ebf55,0xbf6d3ec4,0x3e483f7b
.long 0x3f808000,0xbf80,0xbf808000,0x3f80,0x3f353f35,0x3f0ebf55,0xbf6dbec4,0xbe483f7b
.long 0x3f80,0x3f6dbec4,0xbf35bf35,0xbec43f6d,0xbf353f35,0x3f7b3e48,0xbec4bf6d,0xbf0e3f55
.long 0xbf808000,0x3f353f35,0xbf80,0xbf353f35,0xbf35bf35,0x3e483f7b,0x3ec4bf6d,0xbf553f0e
.long 0xbf80,0xbec43f6d,0x3f35bf35,0xbf6d3ec4,0x3f35bf35,0xbf553f0e,0x3f6dbec4,0xbf7b3e48
.long 0x3f808000,0xbf808000,0x3f808000,0xbf808000,0x3f353f35,0xbf55bf0e,0x3f6d3ec4,0xbf7bbe48
.long 0x3f80,0xbec4bf6d,0x3f353f35,0xbf6dbec4,0xbf353f35,0x3e48bf7b,0x3ec43f6d,0xbf55bf0e
.long 0xbf808000,0x3f35bf35,0x3f80,0xbf35bf35,0xbf35bf35,0x3f7bbe48,0xbec43f6d,0xbf0ebf55
.long 0xbf80,0x3f6d3ec4,0xbf353f35,0xbec4bf6d,0x3f35bf35,0x3f0e3f55,0xbf6d3ec4,0xbe48bf7b
.long 0x3f808000,0x3f80,0xbf808000,0xbf80,0x3f353f35,0xbf0e3f55,0xbf6dbec4,0x3e48bf7b
.long 0x3f80,0xbf6d3ec4,0xbf35bf35,0x3ec4bf6d,0xbf353f35,0xbf7bbe48,0xbec4bf6d,0x3f0ebf55
.long 0xbf808000,0xbf35bf35,0xbf80,0x3f35bf35,0xbf35bf35,0xbe48bf7b,0x3ec4bf6d,0x3f55bf0e
.long 0xbf80,0x3ec4bf6d,0x3f35bf35,0x3f6dbec4,0x3f35bf35,0x3f55bf0e,0x3f6dbec4,0x3f7bbe48
.long 0x3f800000,0x3f800000,0x3f800000,0x3f800000,0x3f800000,0x3f7ffec4,0x3f7ffb11,0x3f7ff4e6
.long 0x3f800000,0x3f7ffb11,0x3f7fec43,0x3f7fd397,0x3f800000,0x3f7ff4e6,0x3f7fd397,0x3f7f9c18
.long 0x3f800000,0x3f7fec43,0x3f7fb10f,0x3f7f4e6d,0x3f800000,0x3f7fe129,0x3f7f84ab,0x3f7eea9d
.long 0x3f800000,0x3f7fd397,0x3f7f4e6d,0x3f7e70b0,0x3f800000,0x3f7fc38f,0x3f7f0e58,0x3f7de0b1
.long 0x3f800000,0x3f7fb10f,0x3f7ec46d,0x3f7d3aac,0x3f800000,0x3f7f9c18,0x3f7e70b0,0x3f7c7eb0
.long 0x3f800000,0x3f7f84ab,0x3f7e1324,0x3f7baccd,0x3f800000,0x3f7f6ac7,0x3f7dabcc,0x3f7ac516
.long 0x3f800000,0x3f7f4e6d,0x3f7d3aac,0x3f79c79d,0x3f800000,0x3f7f2f9d,0x3f7cbfc9,0x3f78b47b
.long 0x3f800000,0x3f7f0e58,0x3f7c3b28,0x3f778bc5,0x3f800000,0x3f7eea9d,0x3f7baccd,0x3f764d97
.long 0x3f800000,0x3f7ec46d,0x3f7b14be,0x3f74fa0b,0x3f800000,0x3f7e9bc9,0x3f7a7302,0x3f73913f
.long 0x3f800000,0x3f7e70b0,0x3f79c79d,0x3f721352,0x3f800000,0x3f7e4323,0x3f791298,0x3f708066
.long 0x3f800000,0x3f7e1324,0x3f7853f8,0x3f6ed89e,0x3f800000,0x3f7de0b1,0x3f778bc5,0x3f6d1c1d
.long 0x3f800000,0x3f7dabcc,0x3f76ba07,0x3f6b4b0c,0x3f800000,0x3f7d7474,0x3f75dec6,0x3f696591
.long 0x3f800000,0x3f7d3aac,0x3f74fa0b,0x3f676bd8,0x3f800000,0x3f7cfe73,0x3f740bdd,0x3f655e0b
.long 0x3f800000,0x3f7cbfc9,0x3f731447,0x3f633c5a,0x3f800000,0x3f7c7eb0,0x3f721352,0x3f6106f2
.long 0x3f800000,0x3f7c3b28,0x3f710908,0x3f5ebe05,0x3f800000,0x3f7bf531,0x3f6ff573,0x3f5c61c7
.long 0x3f800000,0x3f7baccd,0x3f6ed89e,0x3f59f26a,0x3f800000,0x3f7b61fc,0x3f6db293,0x3f577026
.long 0x3f800000,0x3f800000,0x3f800000,0x3f800000,0x3f7fec43,0x3f7fe129,0x3f7fd397,0x3f7fc38f
.long 0x3f7fb10f,0x3f7f84ab,0x3f7f4e6d,0x3f7f0e58,0x3f7f4e6d,0x3f7eea9d,0x3f7e70b0,0x3f7de0b1
.long 0x3f7ec46d,0x3f7e1324,0x3f7d3aac,0x3f7c3b28,0x3f7e1324,0x3f7cfe73,0x3f7baccd,0x3f7a1e84
.long 0x3f7d3aac,0x3f7baccd,0x3f79c79d,0x3f778bc5,0x3f7c3b28,0x3f7a1e84,0x3f778bc5,0x3f748422
.long 0x3f7b14be,0x3f7853f8,0x3f74fa0b,0x3f710908,0x3f79c79d,0x3f764d97,0x3f721352,0x3f6d1c1d
.long 0x3f7853f8,0x3f740bdd,0x3f6ed89e,0x3f68bf3c,0x3f76ba07,0x3f718f57,0x3f6b4b0c,0x3f63f473
.long 0x3f74fa0b,0x3f6ed89e,0x3f676bd8,0x3f5ebe05,0x3f731447,0x3f6be858,0x3f633c5a,0x3f591e6a
.long 0x3f710908,0x3f68bf3c,0x3f5ebe05,0x3f531849,0x3f6ed89e,0x3f655e0b,0x3f59f26a,0x3f4cae79
.long 0x3f6c835e,0x3f61c598,0x3f54db31,0x3f45e403,0x3f6a09a7,0x3f5df6be,0x3f4f7a1f,0x3f3ebc1b
.long 0x3f676bd8,0x3f59f26a,0x3f49d112,0x3f373a23,0x3f64aa59,0x3f55b993,0x3f43e200,0x3f2f61a5
.long 0x3f61c598,0x3f514d3d,0x3f3daef9,0x3f273656,0x3f5ebe05,0x3f4cae79,0x3f373a23,0x3f1ebc12
.long 0x3f5b941a,0x3f47de65,0x3f3085bb,0x3f15f6d9,0x3f584853,0x3f42de29,0x3f299415,0x3f0cead0
.long 0x3f54db31,0x3f3daef9,0x3f226799,0x3f039c3d,0x3f514d3d,0x3f385216,0x3f1b02c6,0x3ef41f07
.long 0x3f4d9f02,0x3f32c8c9,0x3f13682a,0x3ee0924f,0x3f49d112,0x3f2d1469,0x3f0b9a6b,0x3ecc9b8b
.long 0x3f45e403,0x3f273656,0x3f039c3d,0x3eb8442a,0x3f41d870,0x3f212ff9,0x3ef6e0cb,0x3ea395c5
.long 0x3f3daef9,0x3f1b02c6,0x3ee63375,0x3e8e9a22,0x3f396842,0x3f14b039,0x3ed53641,0x3e72b651
.long 0x3f800000,0x3f800000,0x3f800000,0x3f800000,0x3f7fb10f,0x3f7f9c18,0x3f7f84ab,0x3f7f6ac7
.long 0x3f7ec46d,0x3f7e70b0,0x3f7e1324,0x3f7dabcc,0x3f7d3aac,0x3f7c7eb0,0x3f7baccd,0x3f7ac516
.long 0x3f7b14be,0x3f79c79d,0x3f7853f8,0x3f76ba07,0x3f7853f8,0x3f764d97,0x3f740bdd,0x3f718f57
.long 0x3f74fa0b,0x3f721352,0x3f6ed89e,0x3f6b4b0c,0x3f710908,0x3f6d1c1d,0x3f68bf3c,0x3f63f473
.long 0x3f6c835e,0x3f676bd8,0x3f61c598,0x3f5b941a,0x3f676bd8,0x3f6106f2,0x3f59f26a,0x3f5233c6
.long 0x3f61c598,0x3f59f26a,0x3f514d3d,0x3f47de65,0x3f5b941a,0x3f5233c6,0x3f47de65,0x3f3ca003
.long 0x3f54db31,0x3f49d112,0x3f3daef9,0x3f3085bb,0x3f4d9f02,0x3f40d0da,0x3f32c8c9,0x3f239da9
.long 0x3f45e403,0x3f373a23,0x3f273656,0x3f15f6d9,0x3f3daef9,0x3f2d1469,0x3f1b02c6,0x3f07a136
.long 0x3f3504f3,0x3f226799,0x3f0e39da,0x3ef15aea,0x3f2beb4a,0x3f173c07,0x3f00e7e4,0x3ed25a09
.long 0x3f226799,0x3f0b9a6b,0x3ee63375,0x3eb263ef,0x3f187fc0,0x3eff17b2,0x3ec9b953,0x3e919ddd
.long 0x3f0e39da,0x3ee63375,0x3eac7cd4,0x3e605c13,0x3f039c3d,0x3ecc9b8b,0x3e8e9a22,0x3e1c76de
.long 0x3ef15aea,0x3eb263ef,0x3e605c13,0x3dafb680,0x3edae880,0x3e97a117,0x3e22abb6,0x3c96c9b6
.long 0x3ec3ef15,0x3e78cfcc,0x3dc8bd36,0xbd48fb30,0x3eac7cd4,0x3e419b37,0x3d16c32c,0xbdee3876
.long 0x3e94a031,0x3e09cf86,0xbcc90ab0,0xbe3b6ecf,0x3e78cfcc,0x3da3308c,0xbdafb680,0xbe7ee6e1
.long 0x3e47c5c2,0x3cc90ab0,0xbe164083,0xbea09ae5,0x3e164083,0xbcfb49ba,0xbe541501,0xbec1071e
.long 0x3dc8bd36,0xbdafb680,0xbe888e93,0xbee0924f,0x3d48fb30,0xbe1008b7,0xbea68f12,0xbeff17b2
.long 0x3f800000,0x3f800000,0x3f800000,0x3f800000,0x3f7f4e6d,0x3f7f2f9d,0x3f7f0e58,0x3f7eea9d
.long 0x3f7d3aac,0x3f7cbfc9,0x3f7c3b28,0x3f7baccd,0x3f79c79d,0x3f78b47b,0x3f778bc5,0x3f764d97
.long 0x3f74fa0b,0x3f731447,0x3f710908,0x3f6ed89e,0x3f6ed89e,0x3f6be858,0x3f68bf3c,0x3f655e0b
.long 0x3f676bd8,0x3f633c5a,0x3f5ebe05,0x3f59f26a,0x3f5ebe05,0x3f591e6a,0x3f531849,0x3f4cae79
.long 0x3f54db31,0x3f4d9f02,0x3f45e403,0x3f3daef9,0x3f49d112,0x3f40d0da,0x3f373a23,0x3f2d1469
.long 0x3f3daef9,0x3f32c8c9,0x3f273656,0x3f1b02c6,0x3f3085bb,0x3f239da9,0x3f15f6d9,0x3f07a136
.long 0x3f226799,0x3f13682a,0x3f039c3d,0x3ee63375,0x3f13682a,0x3f0242b1,0x3ee0924f,0x3ebb31a0
.long 0x3f039c3d,0x3ee0924f,0x3eb8442a,0x3e8e9a22,0x3ee63375,0x3ebb31a0,0x3e8e9a22,0x3e419b37
.long 0x3ec3ef15,0x3e94a031,0x3e47c5c2,0x3dc8bd36,0x3ea09ae5,0x3e5a3997,0x3de1bc2e,0x3bc90f88
.long 0x3e78cfcc,0x3e09cf86,0x3cc90ab0,0xbdafb680,0x3e2f10a2,0x3d621469,0xbd7b2b74,0xbe354098
.long 0x3dc8bd36,0xbcc90ab0,0xbe164083,0xbe888e93,0x3cc90ab0,0xbdd53db9,0xbe6c9a7f,0xbeb554ec
.long 0xbd48fb30,0xbe3b6ecf,0xbea09ae5,0xbee0924f,0xbdfab273,0xbe8586ce,0xbec9b953,0xbf04f484
.long 0xbe47c5c2,0xbeac7cd4,0xbef15aea,0xbf187fc0,0xbe888e93,0xbed25a09,0xbf0b9a6b,0xbf2ac082
.long 0xbeac7cd4,0xbef6e0cb,0xbf1d7fd1,0xbf3b8f3b,0xbecf7bca,0xbf0cead0,0xbf2e3bde,0xbf4ac77f
.long 0xbef15aea,0xbf1d7fd1,0xbf3daef9,0xbf584853,0xbf08f59b,0xbf2d1469,0xbf4bbbf8,0xbf63f473
.long 0xbf187fc0,0xbf3b8f3b,0xbf584853,0xbf6db293,0xbf273656,0xbf48d8b3,0xbf633c5a,0xbf756d97
.long 0x3f800000,0x3f800000,0x3f800000,0x3f800000,0x3f7ec46d,0x3f7e9bc9,0x3f7e70b0,0x3f7e4323
.long 0x3f7b14be,0x3f7a7302,0x3f79c79d,0x3f791298,0x3f74fa0b,0x3f73913f,0x3f721352,0x3f708066
.long 0x3f6c835e,0x3f6a09a7,0x3f676bd8,0x3f64aa59,0x3f61c598,0x3f5df6be,0x3f59f26a,0x3f55b993
.long 0x3f54db31,0x3f4f7a1f,0x3f49d112,0x3f43e200,0x3f45e403,0x3f3ebc1b,0x3f373a23,0x3f2f61a5
.long 0x3f3504f3,0x3f2beb4a,0x3f226799,0x3f187fc0,0x3f226799,0x3f173c07,0x3f0b9a6b,0x3eff17b2
.long 0x3f0e39da,0x3f00e7e4,0x3ee63375,0x3ec9b953,0x3ef15aea,0x3ed25a09,0x3eb263ef,0x3e919ddd
.long 0x3ec3ef15,0x3ea09ae5,0x3e78cfcc,0x3e2f10a2,0x3e94a031,0x3e5a3997,0x3e09cf86,0x3d621469
.long 0x3e47c5c2,0x3de1bc2e,0x3cc90ab0,0xbd7b2b74,0x3dc8bd36,0x3bc90f88,0xbdafb680,0xbe354098
.long 0,0xbdc8bd36,0xbe47c5c2,0xbe94a031,0xbdc8bd36,0xbe4dee60,0xbe9aa086,0xbecc9b8b
.long 0xbe47c5c2,0xbe9aa086,0xbecf7bca,0xbf00e7e4,0xbe94a031,0xbecc9b8b,0xbf00e7e4,0xbf19c200
.long 0xbec3ef15,0xbefc5d27,0xbf187fc0,0xbf3085bb,0xbef15aea,0xbf14b039,0xbf2e3bde,0xbf44e3f5
.long 0xbf0e39da,0xbf299415,0xbf41d870,0xbf5695e5,0xbf226799,0xbf3ca003,0xbf531849,0xbf655e0b
.long 0xbf3504f3,0xbf4d9f02,0xbf61c598,0xbf710908,0xbf45e403,0xbf5c61c7,0xbf6db293,0xbf796e4e
.long 0xbf54db31,0xbf68bf3c,0xbf76ba07,0xbf7e70b0,0xbf61c598,0xbf7294f8,0xbf7cbfc9,0xbf7ffec4
.long 0xbf6c835e,0xbf79c79d,0xbf7fb10f,0xbf7e1324,0xbf74fa0b,0xbf7e4323,0xbf7f84ab,0xbf78b47b
.long 0xbf7b14be,0xbf7ffb11,0xbf7c3b28,0xbf6ff573,0xbf7ec46d,0xbf7eea9d,0xbf75dec6,0xbf63f473
.long 0x3f800000,0x3f800000,0x3f800000,0x3f800000,0x3f7e1324,0x3f7de0b1,0x3f7dabcc,0x3f7d7474
.long 0x3f7853f8,0x3f778bc5,0x3f76ba07,0x3f75dec6,0x3f6ed89e,0x3f6d1c1d,0x3f6b4b0c,0x3f696591
.long 0x3f61c598,0x3f5ebe05,0x3f5b941a,0x3f584853,0x3f514d3d,0x3f4cae79,0x3f47de65,0x3f42de29
.long 0x3f3daef9,0x3f373a23,0x3f3085bb,0x3f299415,0x3f273656,0x3f1ebc12,0x3f15f6d9,0x3f0cead0
.long 0x3f0e39da,0x3f039c3d,0x3ef15aea,0x3edae880,0x3ee63375,0x3ecc9b8b,0x3eb263ef,0x3e97a117
.long 0x3eac7cd4,0x3e8e9a22,0x3e605c13,0x3e22abb6,0x3e605c13,0x3e1c76de,0x3dafb680,0x3c96c9b6
.long 0x3dc8bd36,0x3cc90ab0,0xbd48fb30,0xbdfab273,0xbcc90ab0,0xbdd53db9,0xbe3b6ecf,0xbe8586ce
.long 0xbe164083,0xbe6c9a7f,0xbea09ae5,0xbec9b953,0xbe888e93,0xbeb554ec,0xbee0924f,0xbf04f484
.long 0xbec3ef15,0xbef15aea,0xbf0e39da,0xbf226799,0xbefc5d27,0xbf14b039,0xbf299415,0xbf3ca003
.long 0xbf187fc0,0xbf2e3bde,0xbf41d870,0xbf531849,0xbf3085bb,0xbf44e3f5,0xbf5695e5,0xbf655e0b
.long 0xbf45e403,0xbf584853,0xbf676bd8,0xbf731447,0xbf584853,0xbf6816a8,0xbf740bdd,0xbf7bf531
.long 0xbf676bd8,0xbf740bdd,0xbf7c3b28,0xbf7fd397,0xbf731447,0xbf7bf531,0xbf7fd397,0xbf7e9bc9
.long 0xbf7b14be,0xbf7fb10f,0xbf7ec46d,0xbf7853f8,0xbf7f4e6d,0xbf7f2f9d,0xbf791298,0xbf6d1c1d
.long 0xbf7fb10f,0xbf7a7302,0xbf6ed89e,0xbf5d2d53,0xbf7c3b28,0xbf718f57,0xbf604621,0xbf48d8b3
.long 0xbf74fa0b,0xbf64aa59,0xbf4d9f02,0xbf3085bb,0xbf6a09a7,0xbf53fac3,0xbf373a23,0xbf14b039
.long 0xbf5b941a,0xbf3fc767,0xbf1d7fd1,0xbeebcbbb,0xbf49d112,0xbf286605,0xbf00e7e4,0xbea986c4
.long 0x3f800000,0x3f800000,0x3f800000,0x3f800000,0x3f7d3aac,0x3f7cfe73,0x3f7cbfc9,0x3f7c7eb0
.long 0x3f74fa0b,0x3f740bdd,0x3f731447,0x3f721352,0x3f676bd8,0x3f655e0b,0x3f633c5a,0x3f6106f2
.long 0x3f54db31,0x3f514d3d,0x3f4d9f02,0x3f49d112,0x3f3daef9,0x3f385216,0x3f32c8c9,0x3f2d1469
.long 0x3f226799,0x3f1b02c6,0x3f13682a,0x3f0b9a6b,0x3f039c3d,0x3ef41f07,0x3ee0924f,0x3ecc9b8b
.long 0x3ec3ef15,0x3eac7cd4,0x3e94a031,0x3e78cfcc,0x3e78cfcc,0x3e419b37,0x3e09cf86,0x3da3308c
.long 0x3dc8bd36,0x3d16c32c,0xbcc90ab0,0xbdafb680,0xbd48fb30,0xbdee3876,0xbe3b6ecf,0xbe7ee6e1
.long 0xbe47c5c2,0xbe888e93,0xbeac7cd4,0xbecf7bca,0xbeac7cd4,0xbed25a09,0xbef6e0cb,0xbf0cead0
.long 0xbef15aea,0xbf0b9a6b,0xbf1d7fd1,0xbf2e3bde,0xbf187fc0,0xbf2ac082,0xbf3b8f3b,0xbf4ac77f
.long 0xbf3504f3,0xbf45e403,0xbf54db31,0xbf61c598,0xbf4d9f02,0xbf5c61c7,0xbf68bf3c,0xbf7294f8
.long 0xbf61c598,0xbf6db293,0xbf76ba07,0xbf7cbfc9,0xbf710908,0xbf796e4e,0xbf7e70b0,0xbf7ffec4
.long 0xbf7b14be,0xbf7f4e6d,0xbf7fb10f,0xbf7c3b28,0xbf7fb10f,0xbf7f2f9d,0xbf7a7302,0xbf718f57
.long 0xbf7ec46d,0xbf791298,0xbf6ed89e,0xbf604621,0xbf7853f8,0xbf6d1c1d,0xbf5d2d53,0xbf48d8b3
.long 0xbf6c835e,0xbf5b941a,0xbf45e403,0xbf2beb4a,0xbf5b941a,0xbf44e3f5,0xbf299415,0xbf0a48ad
.long 0xbf45e403,0xbf299415,0xbf08f59b,0xbec9b953,0xbf2beb4a,0xbf0a48ad,0xbec9b953,0xbe72b651
.long 0xbf0e39da,0xbecf7bca,0xbe78cfcc,0xbd96a905,0xbedae880,0xbe8586ce,0xbdafb680,0x3dbc3ac3
.long 0xbe94a031,0xbde1bc2e,0x3d96a905,0x3e827dc0,0xbe164083,0x3d2fe007,0x3e6c9a7f,0x3ed25a09
.long 0x3f800000,0x3f800000,0x3f800000,0x3f800000,0x3f7c3b28,0x3f7bf531,0x3f7baccd,0x3f7b61fc
.long 0x3f710908,0x3f6ff573,0x3f6ed89e,0x3f6db293,0x3f5ebe05,0x3f5c61c7,0x3f59f26a,0x3f577026
.long 0x3f45e403,0x3f41d870,0x3f3daef9,0x3f396842,0x3f273656,0x3f212ff9,0x3f1b02c6,0x3f14b039
.long 0x3f039c3d,0x3ef6e0cb,0x3ee63375,0x3ed53641,0x3eb8442a,0x3ea395c5,0x3e8e9a22,0x3e72b651
.long 0x3e47c5c2,0x3e164083,0x3dc8bd36,0x3d48fb30,0x3cc90ab0,0xbcfb49ba,0xbdafb680,0xbe1008b7
.long 0xbe164083,0xbe541501,0xbe888e93,0xbea68f12,0xbea09ae5,0xbec1071e,0xbee0924f,0xbeff17b2
.long 0xbef15aea,0xbf08f59b,0xbf187fc0,0xbf273656,0xbf1d7fd1,0xbf2d1469,0xbf3b8f3b,0xbf48d8b3
.long 0xbf3daef9,0xbf4bbbf8,0xbf584853,0xbf633c5a,0xbf584853,0xbf63f473,0xbf6db293,0xbf756d97
.long 0xbf6c835e,0xbf74fa0b,0xbf7b14be,0xbf7ec46d,0xbf79c79d,0xbf7e4323,0xbf7ffb11,0xbf7eea9d
.long 0xbf7fb10f,0xbf7f84ab,0xbf7c3b28,0xbf75dec6,0xbf7e1324,0xbf78b47b,0xbf6ff573,0xbf63f473
.long 0xbf74fa0b,0xbf6a09a7,0xbf5b941a,0xbf49d112,0xbf64aa59,0xbf53fac3,0xbf3fc767,0xbf286605
.long 0xbf4d9f02,0xbf373a23,0xbf1d7fd1,0xbf00e7e4,0xbf3085bb,0xbf14b039,0xbeebcbbb,0xbea986c4
.long 0xbf0e39da,0xbedae880,0xbe94a031,0xbe164083,0xbecf7bca,0xbe8586ce,0xbde1bc2e,0x3d2fe007
.long 0xbe78cfcc,0xbdafb680,0x3d96a905,0x3e6c9a7f,0xbd96a905,0x3dbc3ac3,0x3e827dc0,0x3ed25a09
.long 0x3dc8bd36,0x3e888e93,0x3edae880,0x3f13682a,0x3e888e93,0x3eddbe79,0x3f15f6d9,0x3f385216
.long 0x3edae880,0x3f15f6d9,0x3f396842,0x3f5695e5,0x3f13682a,0x3f385216,0x3f5695e5,0x3f6d1c1d
.long 0,0,0,0,0,0x3bc90f88,0x3c490e90,0x3c96c9b6
.long 0,0x3c490e90,0x3cc90ab0,0x3d16c32c,0,0x3c96c9b6,0x3d16c32c,0x3d621469
.long 0,0x3cc90ab0,0x3d48fb30,0x3d96a905,0,0x3cfb49ba,0x3d7b2b74,0x3dbc3ac3
.long 0,0x3d16c32c,0x3d96a905,0x3de1bc2e,0,0x3d2fe007,0x3dafb680,0x3e039502
.long 0,0x3d48fb30,0x3dc8bd36,0x3e164083,0,0x3d621469,0x3de1bc2e,0x3e28defc
.long 0,0x3d7b2b74,0x3dfab273,0x3e3b6ecf,0,0x3d8a200a,0x3e09cf86,0x3e4dee60
.long 0,0x3d96a905,0x3e164083,0x3e605c13,0,0x3da3308c,0x3e22abb6,0x3e72b651
.long 0,0x3dafb680,0x3e2f10a2,0x3e827dc0,0,0x3dbc3ac3,0x3e3b6ecf,0x3e8b9507
.long 0,0x3dc8bd36,0x3e47c5c2,0x3e94a031,0,0x3dd53db9,0x3e541501,0x3e9d9e78
.long 0,0x3de1bc2e,0x3e605c13,0x3ea68f12,0,0x3dee3876,0x3e6c9a7f,0x3eaf713a
.long 0,0x3dfab273,0x3e78cfcc,0x3eb8442a,0,0x3e039502,0x3e827dc0,0x3ec1071e
.long 0,0x3e09cf86,0x3e888e93,0x3ec9b953,0,0x3e1008b7,0x3e8e9a22,0x3ed25a09
.long 0,0x3e164083,0x3e94a031,0x3edae880,0,0x3e1c76de,0x3e9aa086,0x3ee363fa
.long 0,0x3e22abb6,0x3ea09ae5,0x3eebcbbb,0,0x3e28defc,0x3ea68f12,0x3ef41f07
.long 0,0x3e2f10a2,0x3eac7cd4,0x3efc5d27,0,0x3e354098,0x3eb263ef,0x3f0242b1
.long 0,0x3e3b6ecf,0x3eb8442a,0x3f064b82,0,0x3e419b37,0x3ebe1d4a,0x3f0a48ad
.long 0,0,0,0,0x3cc90ab0,0x3cfb49ba,0x3d16c32c,0x3d2fe007
.long 0x3d48fb30,0x3d7b2b74,0x3d96a905,0x3dafb680,0x3d96a905,0x3dbc3ac3,0x3de1bc2e,0x3e039502
.long 0x3dc8bd36,0x3dfab273,0x3e164083,0x3e2f10a2,0x3dfab273,0x3e1c76de,0x3e3b6ecf,0x3e5a3997
.long 0x3e164083,0x3e3b6ecf,0x3e605c13,0x3e827dc0,0x3e2f10a2,0x3e5a3997,0x3e827dc0,0x3e97a117
.long 0x3e47c5c2,0x3e78cfcc,0x3e94a031,0x3eac7cd4,0x3e605c13,0x3e8b9507,0x3ea68f12,0x3ec1071e
.long 0x3e78cfcc,0x3e9aa086,0x3eb8442a,0x3ed53641,0x3e888e93,0x3ea986c4,0x3ec9b953,0x3ee900b7
.long 0x3e94a031,0x3eb8442a,0x3edae880,0x3efc5d27,0x3ea09ae5,0x3ec6d529,0x3eebcbbb,0x3f07a136
.long 0x3eac7cd4,0x3ed53641,0x3efc5d27,0x3f10d3cd,0x3eb8442a,0x3ee363fa,0x3f064b82,0x3f19c200
.long 0x3ec3ef15,0x3ef15aea,0x3f0e39da,0x3f226799,0x3ecf7bca,0x3eff17b2,0x3f15f6d9,0x3f2ac082
.long 0x3edae880,0x3f064b82,0x3f1d7fd1,0x3f32c8c9,0x3ee63375,0x3f0cead0,0x3f24d225,0x3f3a7ca4
.long 0x3ef15aea,0x3f13682a,0x3f2beb4a,0x3f41d870,0x3efc5d27,0x3f19c200,0x3f32c8c9,0x3f48d8b3
.long 0x3f039c3d,0x3f1ff6cb,0x3f396842,0x3f4f7a1f,0x3f08f59b,0x3f26050a,0x3f3fc767,0x3f55b993
.long 0x3f0e39da,0x3f2beb4a,0x3f45e403,0x3f5b941a,0x3f13682a,0x3f31a81d,0x3f4bbbf8,0x3f6106f2
.long 0x3f187fc0,0x3f373a23,0x3f514d3d,0x3f660f88,0x3f1d7fd1,0x3f3ca003,0x3f5695e5,0x3f6aab7b
.long 0x3f226799,0x3f41d870,0x3f5b941a,0x3f6ed89e,0x3f273656,0x3f46e22a,0x3f604621,0x3f7294f8
.long 0x3f2beb4a,0x3f4bbbf8,0x3f64aa59,0x3f75dec6,0x3f3085bb,0x3f5064af,0x3f68bf3c,0x3f78b47b
.long 0,0,0,0,0x3d48fb30,0x3d621469,0x3d7b2b74,0x3d8a200a
.long 0x3dc8bd36,0x3de1bc2e,0x3dfab273,0x3e09cf86,0x3e164083,0x3e28defc,0x3e3b6ecf,0x3e4dee60
.long 0x3e47c5c2,0x3e605c13,0x3e78cfcc,0x3e888e93,0x3e78cfcc,0x3e8b9507,0x3e9aa086,0x3ea986c4
.long 0x3e94a031,0x3ea68f12,0x3eb8442a,0x3ec9b953,0x3eac7cd4,0x3ec1071e,0x3ed53641,0x3ee900b7
.long 0x3ec3ef15,0x3edae880,0x3ef15aea,0x3f039c3d,0x3edae880,0x3ef41f07,0x3f064b82,0x3f121eb0
.long 0x3ef15aea,0x3f064b82,0x3f13682a,0x3f1ff6cb,0x3f039c3d,0x3f121eb0,0x3f1ff6cb,0x3f2d1469
.long 0x3f0e39da,0x3f1d7fd1,0x3f2beb4a,0x3f396842,0x3f187fc0,0x3f286605,0x3f373a23,0x3f44e3f5
.long 0x3f226799,0x3f32c8c9,0x3f41d870,0x3f4f7a1f,0x3f2beb4a,0x3f3ca003,0x3f4bbbf8,0x3f591e6a
.long 0x3f3504f3,0x3f45e403,0x3f54db31,0x3f61c598,0x3f3daef9,0x3f4e8d90,0x3f5d2d53,0x3f696591
.long 0x3f45e403,0x3f5695e5,0x3f64aa59,0x3f6ff573,0x3f4d9f02,0x3f5df6be,0x3f6b4b0c,0x3f756d97
.long 0x3f54db31,0x3f64aa59,0x3f710908,0x3f79c79d,0x3f5b941a,0x3f6aab7b,0x3f75dec6,0x3f7cfe73
.long 0x3f61c598,0x3f6ff573,0x3f79c79d,0x3f7f0e58,0x3f676bd8,0x3f748422,0x3f7cbfc9,0x3f7ff4e6
.long 0x3f6c835e,0x3f7853f8,0x3f7ec46d,0x3f7fb10f,0x3f710908,0x3f7b61fc,0x3f7fd397,0x3f7e4323
.long 0x3f74fa0b,0x3f7dabcc,0x3f7fec43,0x3f7baccd,0x3f7853f8,0x3f7f2f9d,0x3f7f0e58,0x3f77f110
.long 0x3f7b14be,0x3f7fec43,0x3f7d3aac,0x3f731447,0x3f7d3aac,0x3f7fe129,0x3f7a7302,0x3f6d1c1d
.long 0x3f7ec46d,0x3f7f0e58,0x3f76ba07,0x3f660f88,0x3f7fb10f,0x3f7d7474,0x3f721352,0x3f5df6be
.long 0,0,0,0,0x3d96a905,0x3da3308c,0x3dafb680,0x3dbc3ac3
.long 0x3e164083,0x3e22abb6,0x3e2f10a2,0x3e3b6ecf,0x3e605c13,0x3e72b651,0x3e827dc0,0x3e8b9507
.long 0x3e94a031,0x3ea09ae5,0x3eac7cd4,0x3eb8442a,0x3eb8442a,0x3ec6d529,0x3ed53641,0x3ee363fa
.long 0x3edae880,0x3eebcbbb,0x3efc5d27,0x3f064b82,0x3efc5d27,0x3f07a136,0x3f10d3cd,0x3f19c200
.long 0x3f0e39da,0x3f187fc0,0x3f226799,0x3f2beb4a,0x3f1d7fd1,0x3f286605,0x3f32c8c9,0x3f3ca003
.long 0x3f2beb4a,0x3f373a23,0x3f41d870,0x3f4bbbf8,0x3f396842,0x3f44e3f5,0x3f4f7a1f,0x3f591e6a
.long 0x3f45e403,0x3f514d3d,0x3f5b941a,0x3f64aa59,0x3f514d3d,0x3f5c61c7,0x3f660f88,0x3f6e46be
.long 0x3f5b941a,0x3f660f88,0x3f6ed89e,0x3f75dec6,0x3f64aa59,0x3f6e46be,0x3f75dec6,0x3f7b61fc
.long 0x3f6c835e,0x3f74fa0b,0x3f7b14be,0x3f7ec46d,0x3f731447,0x3f7a1e84,0x3f7e70b0,0x3f7ffec4
.long 0x3f7853f8,0x3f7dabcc,0x3f7fec43,0x3f7f0e58,0x3f7c3b28,0x3f7f9c18,0x3f7f84ab,0x3f7bf531
.long 0x3f7ec46d,0x3f7fec43,0x3f7d3aac,0x3f76ba07,0x3f7fec43,0x3f7e9bc9,0x3f791298,0x3f6f6830
.long 0x3f7fb10f,0x3f7baccd,0x3f731447,0x3f660f88,0x3f7e1324,0x3f772417,0x3f6b4b0c,0x3f5ac450
.long 0x3f7b14be,0x3f710908,0x3f61c598,0x3f4d9f02,0x3f76ba07,0x3f696591,0x3f5695e5,0x3f3ebc1b
.long 0x3f710908,0x3f604621,0x3f49d112,0x3f2e3bde,0x3f6a09a7,0x3f55b993,0x3f3b8f3b,0x3f1c420c
.long 0x3f61c598,0x3f49d112,0x3f2beb4a,0x3f08f59b,0x3f584853,0x3f3ca003,0x3f1b02c6,0x3ee900b7
.long 0x3f4d9f02,0x3f2e3bde,0x3f08f59b,0x3ebe1d4a,0x3f41d870,0x3f1ebc12,0x3eebcbbb,0x3e919ddd
.long 0,0,0,0,0x3dc8bd36,0x3dd53db9,0x3de1bc2e,0x3dee3876
.long 0x3e47c5c2,0x3e541501,0x3e605c13,0x3e6c9a7f,0x3e94a031,0x3e9d9e78,0x3ea68f12,0x3eaf713a
.long 0x3ec3ef15,0x3ecf7bca,0x3edae880,0x3ee63375,0x3ef15aea,0x3eff17b2,0x3f064b82,0x3f0cead0
.long 0x3f0e39da,0x3f15f6d9,0x3f1d7fd1,0x3f24d225,0x3f226799,0x3f2ac082,0x3f32c8c9,0x3f3a7ca4
.long 0x3f3504f3,0x3f3daef9,0x3f45e403,0x3f4d9f02,0x3f45e403,0x3f4e8d90,0x3f5695e5,0x3f5df6be
.long 0x3f54db31,0x3f5d2d53,0x3f64aa59,0x3f6b4b0c,0x3f61c598,0x3f696591,0x3f6ff573,0x3f756d97
.long 0x3f6c835e,0x3f731447,0x3f7853f8,0x3f7c3b28,0x3f74fa0b,0x3f7a1e84,0x3f7dabcc,0x3f7f9c18
.long 0x3f7b14be,0x3f7e70b0,0x3f7fec43,0x3f7f84ab,0x3f7ec46d,0x3f7ffec4,0x3f7f0e58,0x3f7bf531
.long 0x3f800000,0x3f7ec46d,0x3f7b14be,0x3f74fa0b,0x3f7ec46d,0x3f7ac516,0x3f740bdd,0x3f6aab7b
.long 0x3f7b14be,0x3f740bdd,0x3f6a09a7,0x3f5d2d53,0x3f74fa0b,0x3f6aab7b,0x3f5d2d53,0x3f4cae79
.long 0x3f6c835e,0x3f5ebe05,0x3f4d9f02,0x3f396842,0x3f61c598,0x3f5064af,0x3f3b8f3b,0x3f239da9
.long 0x3f54db31,0x3f3fc767,0x3f273656,0x3f0b9a6b,0x3f45e403,0x3f2d1469,0x3f10d3cd,0x3ee363fa
.long 0x3f3504f3,0x3f187fc0,0x3ef15aea,0x3eac7cd4,0x3f226799,0x3f0242b1,0x3ebe1d4a,0x3e667c66
.long 0x3f0e39da,0x3ed53641,0x3e888e93,0x3de1bc2e,0x3ef15aea,0x3ea395c5,0x3e22abb6,0xbbc90f88
.long 0x3ec3ef15,0x3e605c13,0x3d48fb30,0xbdfab273,0x3e94a031,0x3dee3876,0xbd7b2b74,0xbe72b651
.long 0x3e47c5c2,0x3c490e90,0xbe2f10a2,0xbeb263ef,0x3dc8bd36,0xbdbc3ac3,0xbe8e9a22,0xbee900b7
.long 0,0,0,0,0x3dfab273,0x3e039502,0x3e09cf86,0x3e1008b7
.long 0x3e78cfcc,0x3e827dc0,0x3e888e93,0x3e8e9a22,0x3eb8442a,0x3ec1071e,0x3ec9b953,0x3ed25a09
.long 0x3ef15aea,0x3efc5d27,0x3f039c3d,0x3f08f59b,0x3f13682a,0x3f19c200,0x3f1ff6cb,0x3f26050a
.long 0x3f2beb4a,0x3f32c8c9,0x3f396842,0x3f3fc767,0x3f41d870,0x3f48d8b3,0x3f4f7a1f,0x3f55b993
.long 0x3f54db31,0x3f5b941a,0x3f61c598,0x3f676bd8,0x3f64aa59,0x3f6aab7b,0x3f6ff573,0x3f748422
.long 0x3f710908,0x3f75dec6,0x3f79c79d,0x3f7cbfc9,0x3f79c79d,0x3f7cfe73,0x3f7f0e58,0x3f7ff4e6
.long 0x3f7ec46d,0x3f7fec43,0x3f7fb10f,0x3f7e1324,0x3f7fec43,0x3f7e9bc9,0x3f7baccd,0x3f772417
.long 0x3f7d3aac,0x3f791298,0x3f731447,0x3f6b4b0c,0x3f76ba07,0x3f6f6830,0x3f660f88,0x3f5ac450
.long 0x3f6c835e,0x3f61c598,0x3f54db31,0x3f45e403,0x3f5ebe05,0x3f5064af,0x3f3fc767,0x3f2d1469
.long 0x3f4d9f02,0x3f3b8f3b,0x3f273656,0x3f10d3cd,0x3f396842,0x3f239da9,0x3f0b9a6b,0x3ee363fa
.long 0x3f226799,0x3f08f59b,0x3edae880,0x3ea09ae5,0x3f08f59b,0x3ed8106b,0x3e9aa086,0x3e354098
.long 0x3edae880,0x3e9aa086,0x3e2f10a2,0x3d16c32c,0x3ea09ae5,0x3e354098,0x3d16c32c,0xbdd53db9
.long 0x3e47c5c2,0x3d48fb30,0xbdc8bd36,0xbe78cfcc,0x3d96a905,0xbda3308c,0xbe6c9a7f,0xbec1071e
.long 0xbd48fb30,0xbe541501,0xbeb8442a,0xbf00e7e4,0xbe2f10a2,0xbea986c4,0xbef6e0cb,0xbf1ebc12
.long 0xbe94a031,0xbee63375,0xbf187fc0,0xbf396842,0xbecf7bca,0xbf0f8784,0xbf32c8c9,0xbf5064af
.long 0xbf039c3d,0xbf299415,0xbf49d112,0xbf633c5a,0xbf1d7fd1,0xbf40d0da,0xbf5d2d53,0xbf718f57
.long 0,0,0,0,0x3e164083,0x3e1c76de,0x3e22abb6,0x3e28defc
.long 0x3e94a031,0x3e9aa086,0x3ea09ae5,0x3ea68f12,0x3edae880,0x3ee363fa,0x3eebcbbb,0x3ef41f07
.long 0x3f0e39da,0x3f13682a,0x3f187fc0,0x3f1d7fd1,0x3f2beb4a,0x3f31a81d,0x3f373a23,0x3f3ca003
.long 0x3f45e403,0x3f4bbbf8,0x3f514d3d,0x3f5695e5,0x3f5b941a,0x3f6106f2,0x3f660f88,0x3f6aab7b
.long 0x3f6c835e,0x3f710908,0x3f74fa0b,0x3f7853f8,0x3f7853f8,0x3f7b61fc,0x3f7dabcc,0x3f7f2f9d
.long 0x3f7ec46d,0x3f7fd397,0x3f7fec43,0x3f7f0e58,0x3f7fb10f,0x3f7e4323,0x3f7baccd,0x3f77f110
.long 0x3f7b14be,0x3f76ba07,0x3f710908,0x3f6a09a7,0x3f710908,0x3f696591,0x3f604621,0x3f55b993
.long 0x3f61c598,0x3f5695e5,0x3f49d112,0x3f3b8f3b,0x3f4d9f02,0x3f3ebc1b,0x3f2e3bde,0x3f1c420c
.long 0x3f3504f3,0x3f226799,0x3f0e39da,0x3ef15aea,0x3f187fc0,0x3f0242b1,0x3ed53641,0x3ea395c5
.long 0x3ef15aea,0x3ebe1d4a,0x3e888e93,0x3e22abb6,0x3eac7cd4,0x3e667c66,0x3de1bc2e,0xbbc90f88
.long 0x3e47c5c2,0x3d96a905,0xbd48fb30,0xbe2f10a2,0x3d48fb30,0xbda3308c,0xbe541501,0xbea986c4
.long 0xbdc8bd36,0xbe6c9a7f,0xbeb8442a,0xbef6e0cb,0xbe78cfcc,0xbec1071e,0xbf00e7e4,0xbf1ebc12
.long 0xbec3ef15,0xbf039c3d,0xbf226799,0xbf3daef9,0xbf039c3d,0xbf239da9,0xbf3fc767,0xbf577026
.long 0xbf226799,0xbf3fc767,0xbf584853,0xbf6b4b0c,0xbf3daef9,0xbf577026,0xbf6b4b0c,0xbf78b47b
.long 0xbf54db31,0xbf6a09a7,0xbf7853f8,0xbf7f4e6d,0xbf676bd8,0xbf772417,0xbf7f0e58,0xbf7eea9d
.long 0xbf74fa0b,0xbf7e70b0,0xbf7f4e6d,0xbf778bc5,0xbf7d3aac,0xbf7fc38f,0xbf791298,0xbf696591
.long 0,0,0,0,0x3e2f10a2,0x3e354098,0x3e3b6ecf,0x3e419b37
.long 0x3eac7cd4,0x3eb263ef,0x3eb8442a,0x3ebe1d4a,0x3efc5d27,0x3f0242b1,0x3f064b82,0x3f0a48ad
.long 0x3f226799,0x3f273656,0x3f2beb4a,0x3f3085bb,0x3f41d870,0x3f46e22a,0x3f4bbbf8,0x3f5064af
.long 0x3f5b941a,0x3f604621,0x3f64aa59,0x3f68bf3c,0x3f6ed89e,0x3f7294f8,0x3f75dec6,0x3f78b47b
.long 0x3f7b14be,0x3f7d3aac,0x3f7ec46d,0x3f7fb10f,0x3f7fec43,0x3f7fe129,0x3f7f0e58,0x3f7d7474
.long 0x3f7d3aac,0x3f7a7302,0x3f76ba07,0x3f721352,0x3f731447,0x3f6d1c1d,0x3f660f88,0x3f5df6be
.long 0x3f61c598,0x3f584853,0x3f4d9f02,0x3f41d870,0x3f49d112,0x3f3ca003,0x3f2e3bde,0x3f1ebc12
.long 0x3f2beb4a,0x3f1b02c6,0x3f08f59b,0x3eebcbbb,0x3f08f59b,0x3ee900b7,0x3ebe1d4a,0x3e919ddd
.long 0x3ec3ef15,0x3e94a031,0x3e47c5c2,0x3dc8bd36,0x3e605c13,0x3dee3876,0x3c490e90,0xbdbc3ac3
.long 0x3d48fb30,0xbd7b2b74,0xbe2f10a2,0xbe8e9a22,0xbdfab273,0xbe72b651,0xbeb263ef,0xbee900b7
.long 0xbe94a031,0xbecf7bca,0xbf039c3d,0xbf1d7fd1,0xbee63375,0xbf0f8784,0xbf299415,0xbf40d0da
.long 0xbf187fc0,0xbf32c8c9,0xbf49d112,0xbf5d2d53,0xbf396842,0xbf5064af,0xbf633c5a,0xbf718f57
.long 0xbf54db31,0xbf676bd8,0xbf74fa0b,0xbf7d3aac,0xbf6a09a7,0xbf772417,0xbf7e70b0,0xbf7fc38f
.long 0xbf7853f8,0xbf7f0e58,0xbf7f4e6d,0xbf791298,0xbf7f4e6d,0xbf7eea9d,0xbf778bc5,0xbf696591
.long 0xbf7ec46d,0xbf76ba07,0xbf676bd8,0xbf514d3d,0xbf76ba07,0xbf66becc,0xbf4f7a1f,0xbf31a81d
.long 0xbf676bd8,0xbf4f7a1f,0xbf3085bb,0xbf0b9a6b,0xbf514d3d,0xbf31a81d,0xbf0b9a6b,0xbec1071e
.long 0x3f80,0x3f80,0x3f80,0x3f80,0x3f80,0x3e483f7b,0x3ec43f6d,0x3f0e3f55
.long 0x3f80,0x3ec43f6d,0x3f353f35,0x3f6d3ec4,0x3f80,0x3f0e3f55,0x3f6d3ec4,0x3f7bbe48
.long 0x3f80,0x3f353f35,0x3f800000,0x3f35bf35,0x3f80,0x3f553f0e,0x3f6dbec4,0x3e48bf7b
.long 0x3f80,0x3f6d3ec4,0x3f35bf35,0xbec4bf6d,0x3f80,0x3f7b3e48,0x3ec4bf6d,0xbf55bf0e
.long 0x3f80,0x3f800000,0xbf80,0xbf800000,0x3f80,0x3f7bbe48,0xbec4bf6d,0xbf553f0e
.long 0x3f80,0x3f6dbec4,0xbf35bf35,0xbec43f6d,0x3f80,0x3f55bf0e,0xbf6dbec4,0x3e483f7b
.long 0x3f80,0x3f35bf35,0xbf800000,0x3f353f35,0x3f80,0x3f0ebf55,0xbf6d3ec4,0x3f7b3e48
.long 0x3f80,0x3ec4bf6d,0xbf353f35,0x3f6dbec4,0x3f80,0x3e48bf7b,0xbec43f6d,0x3f0ebf55
.long 0x3f80,0xbf80,0x3f80,0xbf80,0x3f80,0xbe48bf7b,0x3ec43f6d,0xbf0ebf55
.long 0x3f80,0xbec4bf6d,0x3f353f35,0xbf6dbec4,0x3f80,0xbf0ebf55,0x3f6d3ec4,0xbf7b3e48
.long 0x3f80,0xbf35bf35,0x3f800000,0xbf353f35,0x3f80,0xbf55bf0e,0x3f6dbec4,0xbe483f7b
.long 0x3f80,0xbf6dbec4,0x3f35bf35,0x3ec43f6d,0x3f80,0xbf7bbe48,0x3ec4bf6d,0x3f553f0e
.long 0x3f80,0xbf800000,0xbf80,0x3f800000,0x3f80,0xbf7b3e48,0xbec4bf6d,0x3f55bf0e
.long 0x3f80,0xbf6d3ec4,0xbf35bf35,0x3ec4bf6d,0x3f80,0xbf553f0e,0xbf6dbec4,0xbe48bf7b
.long 0x3f80,0xbf353f35,0xbf800000,0xbf35bf35,0x3f80,0xbf0e3f55,0xbf6d3ec4,0xbf7bbe48
.long 0x3f80,0xbec43f6d,0xbf353f35,0xbf6d3ec4,0x3f80,0xbe483f7b,0xbec43f6d,0xbf0e3f55
.long 0x3f80,0x3f80,0x3f80,0x3f80,0x3f353f35,0x3f553f0e,0x3f6d3ec4,0x3f7b3e48
.long 0x3f800000,0x3f6dbec4,0x3f35bf35,0x3ec4bf6d,0x3f35bf35,0x3e48bf7b,0xbec4bf6d,0xbf55bf0e
.long 0xbf80,0xbf35bf35,0xbf800000,0xbf353f35,0xbf35bf35,0xbf7b3e48,0xbec43f6d,0x3f0e3f55
.long 0xbf800000,0xbec43f6d,0x3f353f35,0x3f6dbec4,0xbf353f35,0x3f0e3f55,0x3f6dbec4,0xbe48bf7b
.long 0x3f80,0x3f800000,0xbf80,0xbf800000,0x3f353f35,0x3f0ebf55,0xbf6dbec4,0xbe483f7b
.long 0x3f800000,0xbec4bf6d,0xbf353f35,0x3f6d3ec4,0x3f35bf35,0xbf7bbe48,0x3ec43f6d,0x3f0ebf55
.long 0xbf80,0xbf353f35,0x3f800000,0xbf35bf35,0xbf35bf35,0x3e483f7b,0x3ec4bf6d,0xbf553f0e
.long 0xbf800000,0x3f6d3ec4,0xbf35bf35,0x3ec43f6d,0xbf353f35,0x3f55bf0e,0xbf6d3ec4,0x3f7bbe48
.long 0x3f80,0xbf80,0x3f80,0xbf80,0x3f353f35,0xbf55bf0e,0x3f6d3ec4,0xbf7bbe48
.long 0x3f800000,0xbf6d3ec4,0x3f35bf35,0xbec43f6d,0x3f35bf35,0xbe483f7b,0xbec4bf6d,0x3f553f0e
.long 0xbf80,0x3f353f35,0xbf800000,0x3f35bf35,0xbf35bf35,0x3f7bbe48,0xbec43f6d,0xbf0ebf55
.long 0xbf800000,0x3ec4bf6d,0x3f353f35,0xbf6d3ec4,0xbf353f35,0xbf0ebf55,0x3f6dbec4,0x3e483f7b
.long 0x3f80,0xbf800000,0xbf80,0x3f800000,0x3f353f35,0xbf0e3f55,0xbf6dbec4,0x3e48bf7b
.long 0x3f800000,0x3ec43f6d,0xbf353f35,0xbf6dbec4,0x3f35bf35,0x3f7b3e48,0x3ec43f6d,0xbf0e3f55
.long 0xbf80,0x3f35bf35,0x3f800000,0x3f353f35,0xbf35bf35,0xbe48bf7b,0x3ec4bf6d,0x3f55bf0e
.long 0xbf800000,0xbf6dbec4,0xbf35bf35,0xbec4bf6d,0xbf353f35,0xbf553f0e,0xbf6d3ec4,0xbf7b3e48
.long 0x3f80,0x3f80,0x3f80,0x3f80,0x3f800000,0x3f7bbe48,0x3f6dbec4,0x3f55bf0e
.long 0xbf80,0xbec4bf6d,0xbf35bf35,0xbf6dbec4,0xbf800000,0xbf553f0e,0xbec43f6d,0x3e483f7b
.long 0x3f80,0x3f353f35,0x3f800000,0x3f35bf35,0x3f800000,0x3f0ebf55,0xbec4bf6d,0xbf7bbe48
.long 0xbf80,0xbf6dbec4,0xbf353f35,0x3ec43f6d,0xbf800000,0xbe483f7b,0x3f6d3ec4,0x3f0ebf55
.long 0x3f80,0x3f800000,0xbf80,0xbf800000,0x3f800000,0xbe48bf7b,0xbf6d3ec4,0x3f0e3f55
.long 0xbf80,0xbf6d3ec4,0x3f353f35,0x3ec4bf6d,0xbf800000,0x3f0e3f55,0x3ec4bf6d,0xbf7b3e48
.long 0x3f80,0x3f35bf35,0xbf800000,0x3f353f35,0x3f800000,0xbf55bf0e,0x3ec43f6d,0x3e48bf7b
.long 0xbf80,0xbec43f6d,0x3f35bf35,0xbf6d3ec4,0xbf800000,0x3f7b3e48,0xbf6dbec4,0x3f553f0e
.long 0x3f80,0xbf80,0x3f80,0xbf80,0x3f800000,0xbf7b3e48,0x3f6dbec4,0xbf553f0e
.long 0xbf80,0x3ec43f6d,0xbf35bf35,0x3f6d3ec4,0xbf800000,0x3f55bf0e,0xbec43f6d,0xbe48bf7b
.long 0x3f80,0xbf35bf35,0x3f800000,0xbf353f35,0x3f800000,0xbf0e3f55,0xbec4bf6d,0x3f7b3e48
.long 0xbf80,0x3f6d3ec4,0xbf353f35,0xbec4bf6d,0xbf800000,0x3e48bf7b,0x3f6d3ec4,0xbf0e3f55
.long 0x3f80,0xbf800000,0xbf80,0x3f800000,0x3f800000,0x3e483f7b,0xbf6d3ec4,0xbf0ebf55
.long 0xbf80,0x3f6dbec4,0x3f353f35,0xbec43f6d,0xbf800000,0xbf0ebf55,0x3ec4bf6d,0x3f7bbe48
.long 0x3f80,0xbf353f35,0xbf800000,0xbf35bf35,0x3f800000,0x3f553f0e,0x3ec43f6d,0xbe483f7b
.long 0xbf80,0x3ec4bf6d,0x3f35bf35,0x3f6dbec4,0xbf800000,0xbf7bbe48,0xbf6dbec4,0xbf55bf0e
.long 0x3f80,0x3f80,0x3f80,0x3f80,0x3f35bf35,0x3f0ebf55,0x3ec4bf6d,0x3e48bf7b
.long 0xbf800000,0xbf6d3ec4,0xbf353f35,0xbec43f6d,0x3f353f35,0x3f7b3e48,0x3f6dbec4,0x3f0ebf55
.long 0xbf80,0xbf35bf35,0xbf800000,0xbf353f35,0xbf353f35,0x3e483f7b,0x3f6d3ec4,0x3f55bf0e
.long 0x3f800000,0x3ec4bf6d,0xbf35bf35,0xbf6d3ec4,0xbf35bf35,0xbf553f0e,0x3ec43f6d,0x3f7bbe48
.long 0x3f80,0x3f800000,0xbf80,0xbf800000,0x3f35bf35,0xbf55bf0e,0xbec43f6d,0x3f7b3e48
.long 0xbf800000,0x3ec43f6d,0x3f35bf35,0xbf6dbec4,0x3f353f35,0x3e48bf7b,0xbf6d3ec4,0x3f553f0e
.long 0xbf80,0xbf353f35,0x3f800000,0xbf35bf35,0xbf353f35,0x3f7bbe48,0xbf6dbec4,0x3f0e3f55
.long 0x3f800000,0xbf6dbec4,0x3f353f35,0xbec4bf6d,0xbf35bf35,0x3f0e3f55,0xbec4bf6d,0x3e483f7b
.long 0x3f80,0xbf80,0x3f80,0xbf80,0x3f35bf35,0xbf0e3f55,0x3ec4bf6d,0xbe483f7b
.long 0xbf800000,0x3f6dbec4,0xbf353f35,0x3ec4bf6d,0x3f353f35,0xbf7bbe48,0x3f6dbec4,0xbf0e3f55
.long 0xbf80,0x3f353f35,0xbf800000,0x3f35bf35,0xbf353f35,0xbe48bf7b,0x3f6d3ec4,0xbf553f0e
.long 0x3f800000,0xbec43f6d,0xbf35bf35,0x3f6dbec4,0xbf35bf35,0x3f55bf0e,0x3ec43f6d,0xbf7b3e48
.long 0x3f80,0xbf800000,0xbf80,0x3f800000,0x3f35bf35,0x3f553f0e,0xbec43f6d,0xbf7bbe48
.long 0xbf800000,0xbec4bf6d,0x3f35bf35,0x3f6d3ec4,0x3f353f35,0xbe483f7b,0xbf6d3ec4,0xbf55bf0e
.long 0xbf80,0x3f35bf35,0x3f800000,0x3f353f35,0xbf353f35,0xbf7b3e48,0xbf6dbec4,0xbf0ebf55
.long 0x3f800000,0x3f6d3ec4,0x3f353f35,0x3ec43f6d,0xbf35bf35,0xbf0ebf55,0xbec4bf6d,0xbe48bf7b
.long 0x3f80,0x3f80,0x3f80,0x3f80,0xbf80,0xbe48bf7b,0xbec4bf6d,0xbf0ebf55
.long 0x3f80,0x3ec43f6d,0x3f353f35,0x3f6d3ec4,0xbf80,0xbf0ebf55,0xbf6dbec4,0xbf7b3e48
.long 0x3f80,0x3f353f35,0x3f800000,0x3f35bf35,0xbf80,0xbf55bf0e,0xbf6d3ec4,0xbe483f7b
.long 0x3f80,0x3f6d3ec4,0x3f35bf35,0xbec4bf6d,0xbf80,0xbf7bbe48,0xbec43f6d,0x3f553f0e
.long 0x3f80,0x3f800000,0xbf80,0xbf800000,0xbf80,0xbf7b3e48,0x3ec43f6d,0x3f55bf0e
.long 0x3f80,0x3f6dbec4,0xbf35bf35,0xbec43f6d,0xbf80,0xbf553f0e,0x3f6d3ec4,0xbe48bf7b
.long 0x3f80,0x3f35bf35,0xbf800000,0x3f353f35,0xbf80,0xbf0e3f55,0x3f6dbec4,0xbf7bbe48
.long 0x3f80,0x3ec4bf6d,0xbf353f35,0x3f6dbec4,0xbf80,0xbe483f7b,0x3ec4bf6d,0xbf0e3f55
.long 0x3f80,0xbf80,0x3f80,0xbf80,0xbf80,0x3e483f7b,0xbec4bf6d,0x3f0e3f55
.long 0x3f80,0xbec4bf6d,0x3f353f35,0xbf6dbec4,0xbf80,0x3f0e3f55,0xbf6dbec4,0x3f7bbe48
.long 0x3f80,0xbf35bf35,0x3f800000,0xbf353f35,0xbf80,0x3f553f0e,0xbf6d3ec4,0x3e48bf7b
.long 0x3f80,0xbf6dbec4,0x3f35bf35,0x3ec43f6d,0xbf80,0x3f7b3e48,0xbec43f6d,0xbf55bf0e
.long 0x3f80,0xbf800000,0xbf80,0x3f800000,0xbf80,0x3f7bbe48,0x3ec43f6d,0xbf553f0e
.long 0x3f80,0xbf6d3ec4,0xbf35bf35,0x3ec4bf6d,0xbf80,0x3f55bf0e,0x3f6d3ec4,0x3e483f7b
.long 0x3f80,0xbf353f35,0xbf800000,0xbf35bf35,0xbf80,0x3f0ebf55,0x3f6dbec4,0x3f7b3e48
.long 0x3f80,0xbec43f6d,0xbf353f35,0xbf6d3ec4,0xbf80,0x3e48bf7b,0x3ec4bf6d,0x3f0ebf55
.long 0x3f80,0x3f80,0x3f80,0x3f80,0xbf35bf35,0xbf55bf0e,0xbf6dbec4,0xbf7bbe48
.long 0x3f800000,0x3f6dbec4,0x3f35bf35,0x3ec4bf6d,0xbf353f35,0xbe483f7b,0x3ec43f6d,0x3f553f0e
.long 0xbf80,0xbf35bf35,0xbf800000,0xbf353f35,0x3f353f35,0x3f7bbe48,0x3ec4bf6d,0xbf0ebf55
.long 0xbf800000,0xbec43f6d,0x3f353f35,0x3f6dbec4,0x3f35bf35,0xbf0ebf55,0xbf6d3ec4,0x3e483f7b
.long 0x3f80,0x3f800000,0xbf80,0xbf800000,0xbf35bf35,0xbf0e3f55,0x3f6d3ec4,0x3e48bf7b
.long 0x3f800000,0xbec4bf6d,0xbf353f35,0x3f6d3ec4,0xbf353f35,0x3f7b3e48,0xbec4bf6d,0xbf0e3f55
.long 0xbf80,0xbf353f35,0x3f800000,0xbf35bf35,0x3f353f35,0xbe48bf7b,0xbec43f6d,0x3f55bf0e
.long 0xbf800000,0x3f6d3ec4,0xbf35bf35,0x3ec43f6d,0x3f35bf35,0xbf553f0e,0x3f6dbec4,0xbf7b3e48
.long 0x3f80,0xbf80,0x3f80,0xbf80,0xbf35bf35,0x3f553f0e,0xbf6dbec4,0x3f7b3e48
.long 0x3f800000,0xbf6d3ec4,0x3f35bf35,0xbec43f6d,0xbf353f35,0x3e48bf7b,0x3ec43f6d,0xbf55bf0e
.long 0xbf80,0x3f353f35,0xbf800000,0x3f35bf35,0x3f353f35,0xbf7b3e48,0x3ec4bf6d,0x3f0e3f55
.long 0xbf800000,0x3ec4bf6d,0x3f353f35,0xbf6d3ec4,0x3f35bf35,0x3f0e3f55,0xbf6d3ec4,0xbe48bf7b
.long 0x3f80,0xbf800000,0xbf80,0x3f800000,0xbf35bf35,0x3f0ebf55,0x3f6d3ec4,0xbe483f7b
.long 0x3f800000,0x3ec43f6d,0xbf353f35,0xbf6dbec4,0xbf353f35,0xbf7bbe48,0xbec4bf6d,0x3f0ebf55
.long 0xbf80,0x3f35bf35,0x3f800000,0x3f353f35,0x3f353f35,0x3e483f7b,0xbec43f6d,0xbf553f0e
.long 0xbf800000,0xbf6dbec4,0xbf35bf35,0xbec4bf6d,0x3f35bf35,0x3f55bf0e,0x3f6dbec4,0x3f7bbe48
.long 0x3f80,0x3f80,0x3f80,0x3f80,0xbf800000,0xbf7b3e48,0xbf6d3ec4,0xbf553f0e
.long 0xbf80,0xbec4bf6d,0xbf35bf35,0xbf6dbec4,0x3f800000,0x3f55bf0e,0x3ec4bf6d,0xbe48bf7b
.long 0x3f80,0x3f353f35,0x3f800000,0x3f35bf35,0xbf800000,0xbf0e3f55,0x3ec43f6d,0x3f7b3e48
.long 0xbf80,0xbf6dbec4,0xbf353f35,0x3ec43f6d,0x3f800000,0x3e48bf7b,0xbf6dbec4,0xbf0e3f55
.long 0x3f80,0x3f800000,0xbf80,0xbf800000,0xbf800000,0x3e483f7b,0x3f6dbec4,0xbf0ebf55
.long 0xbf80,0xbf6d3ec4,0x3f353f35,0x3ec4bf6d,0x3f800000,0xbf0ebf55,0xbec43f6d,0x3f7bbe48
.long 0x3f80,0x3f35bf35,0xbf800000,0x3f353f35,0xbf800000,0x3f553f0e,0xbec4bf6d,0xbe483f7b
.long 0xbf80,0xbec43f6d,0x3f35bf35,0xbf6d3ec4,0x3f800000,0xbf7bbe48,0x3f6d3ec4,0xbf55bf0e
.long 0x3f80,0xbf80,0x3f80,0xbf80,0xbf800000,0x3f7bbe48,0xbf6d3ec4,0x3f55bf0e
.long 0xbf80,0x3ec43f6d,0xbf35bf35,0x3f6d3ec4,0x3f800000,0xbf553f0e,0x3ec4bf6d,0x3e483f7b
.long 0x3f80,0xbf35bf35,0x3f800000,0xbf353f35,0xbf800000,0x3f0ebf55,0x3ec43f6d,0xbf7bbe48
.long 0xbf80,0x3f6d3ec4,0xbf353f35,0xbec4bf6d,0x3f800000,0xbe483f7b,0xbf6dbec4,0x3f0ebf55
.long 0x3f80,0xbf800000,0xbf80,0x3f800000,0xbf800000,0xbe48bf7b,0x3f6dbec4,0x3f0e3f55
.long 0xbf80,0x3f6dbec4,0x3f353f35,0xbec43f6d,0x3f800000,0x3f0e3f55,0xbec43f6d,0xbf7b3e48
.long 0x3f80,0xbf353f35,0xbf800000,0xbf35bf35,0xbf800000,0xbf55bf0e,0xbec4bf6d,0x3e48bf7b
.long 0xbf80,0x3ec4bf6d,0x3f35bf35,0x3f6dbec4,0x3f800000,0x3f7b3e48,0x3f6d3ec4,0x3f553f0e
.long 0x3f80,0x3f80,0x3f80,0x3f80,0xbf353f35,0xbf0e3f55,0xbec43f6d,0xbe483f7b
.long 0xbf800000,0xbf6d3ec4,0xbf353f35,0xbec43f6d,0xbf35bf35,0xbf7bbe48,0xbf6d3ec4,0xbf0e3f55
.long 0xbf80,0xbf35bf35,0xbf800000,0xbf353f35,0x3f35bf35,0xbe48bf7b,0xbf6dbec4,0xbf553f0e
.long 0x3f800000,0x3ec4bf6d,0xbf35bf35,0xbf6d3ec4,0x3f353f35,0x3f55bf0e,0xbec4bf6d,0xbf7b3e48
.long 0x3f80,0x3f800000,0xbf80,0xbf800000,0xbf353f35,0x3f553f0e,0x3ec4bf6d,0xbf7bbe48
.long 0xbf800000,0x3ec43f6d,0x3f35bf35,0xbf6dbec4,0xbf35bf35,0xbe483f7b,0x3f6dbec4,0xbf55bf0e
.long 0xbf80,0xbf353f35,0x3f800000,0xbf35bf35,0x3f35bf35,0xbf7b3e48,0x3f6d3ec4,0xbf0ebf55
.long 0x3f800000,0xbf6dbec4,0x3f353f35,0xbec4bf6d,0x3f353f35,0xbf0ebf55,0x3ec43f6d,0xbe48bf7b
.long 0x3f80,0xbf80,0x3f80,0xbf80,0xbf353f35,0x3f0ebf55,0xbec43f6d,0x3e48bf7b
.long 0xbf800000,0x3f6dbec4,0xbf353f35,0x3ec4bf6d,0xbf35bf35,0x3f7b3e48,0xbf6d3ec4,0x3f0ebf55
.long 0xbf80,0x3f353f35,0xbf800000,0x3f35bf35,0x3f35bf35,0x3e483f7b,0xbf6dbec4,0x3f55bf0e
.long 0x3f800000,0xbec43f6d,0xbf35bf35,0x3f6dbec4,0x3f353f35,0xbf553f0e,0xbec4bf6d,0x3f7bbe48
.long 0x3f80,0xbf800000,0xbf80,0x3f800000,0xbf353f35,0xbf55bf0e,0x3ec4bf6d,0x3f7b3e48
.long 0xbf800000,0xbec4bf6d,0x3f35bf35,0x3f6d3ec4,0xbf35bf35,0x3e48bf7b,0x3f6dbec4,0x3f553f0e
.long 0xbf80,0x3f35bf35,0x3f800000,0x3f353f35,0x3f35bf35,0x3f7bbe48,0x3f6d3ec4,0x3f0e3f55
.long 0x3f800000,0x3f6d3ec4,0x3f353f35,0x3ec43f6d,0x3f353f35,0x3f0e3f55,0x3ec43f6d,0x3e483f7b
.long 0x3f808000,0x3f808000,0x3f808000,0x3f808000,0x3f808000,0x3f7bbe48,0x3f6dbec4,0x3f55bf0e
.long 0x3f808000,0x3f6dbec4,0x3f35bf35,0x3ec4bf6d,0x3f808000,0x3f55bf0e,0x3ec4bf6d,0xbe48bf7b
.long 0x3f808000,0x3f35bf35,0xbf80,0xbf35bf35,0x3f808000,0x3f0ebf55,0xbec4bf6d,0xbf7bbe48
.long 0x3f808000,0x3ec4bf6d,0xbf35bf35,0xbf6d3ec4,0x3f808000,0x3e48bf7b,0xbf6dbec4,0xbf0e3f55
.long 0x3f808000,0xbf80,0xbf808000,0x3f80,0x3f808000,0xbe48bf7b,0xbf6d3ec4,0x3f0e3f55
.long 0x3f808000,0xbec4bf6d,0xbf353f35,0x3f6d3ec4,0x3f808000,0xbf0ebf55,0xbec43f6d,0x3f7bbe48
.long 0x3f808000,0xbf35bf35,0x3f80,0x3f35bf35,0x3f808000,0xbf55bf0e,0x3ec43f6d,0x3e48bf7b
.long 0x3f808000,0xbf6dbec4,0x3f353f35,0xbec4bf6d,0x3f808000,0xbf7bbe48,0x3f6d3ec4,0xbf55bf0e
.long 0x3f808000,0xbf808000,0x3f808000,0xbf808000,0x3f808000,0xbf7b3e48,0x3f6dbec4,0xbf553f0e
.long 0x3f808000,0xbf6d3ec4,0x3f35bf35,0xbec43f6d,0x3f808000,0xbf553f0e,0x3ec4bf6d,0x3e483f7b
.long 0x3f808000,0xbf353f35,0xbf80,0x3f353f35,0x3f808000,0xbf0e3f55,0xbec4bf6d,0x3f7b3e48
.long 0x3f808000,0xbec43f6d,0xbf35bf35,0x3f6dbec4,0x3f808000,0xbe483f7b,0xbf6dbec4,0x3f0ebf55
.long 0x3f808000,0x3f80,0xbf808000,0xbf80,0x3f808000,0x3e483f7b,0xbf6d3ec4,0xbf0ebf55
.long 0x3f808000,0x3ec43f6d,0xbf353f35,0xbf6dbec4,0x3f808000,0x3f0e3f55,0xbec43f6d,0xbf7b3e48
.long 0x3f808000,0x3f353f35,0x3f80,0xbf353f35,0x3f808000,0x3f553f0e,0x3ec43f6d,0xbe483f7b
.long 0x3f808000,0x3f6d3ec4,0x3f353f35,0x3ec43f6d,0x3f808000,0x3f7b3e48,0x3f6d3ec4,0x3f553f0e
.long 0x3f808000,0x3f808000,0x3f808000,0x3f808000,0x3f35bf35,0x3f0ebf55,0x3ec4bf6d,0x3e48bf7b
.long 0xbf80,0xbec4bf6d,0xbf35bf35,0xbf6dbec4,0xbf35bf35,0xbf7bbe48,0xbf6d3ec4,0xbf0e3f55
.long 0xbf808000,0xbf353f35,0x3f80,0x3f353f35,0xbf353f35,0x3e483f7b,0x3f6d3ec4,0x3f55bf0e
.long 0x3f80,0x3f6d3ec4,0x3f35bf35,0xbec4bf6d,0x3f353f35,0x3f55bf0e,0xbec4bf6d,0xbf7b3e48
.long 0x3f808000,0xbf80,0xbf808000,0x3f80,0x3f35bf35,0xbf55bf0e,0xbec43f6d,0x3f7b3e48
.long 0xbf80,0xbf6d3ec4,0x3f353f35,0x3ec4bf6d,0xbf35bf35,0xbe483f7b,0x3f6dbec4,0xbf55bf0e
.long 0xbf808000,0x3f353f35,0xbf80,0xbf353f35,0xbf353f35,0x3f7bbe48,0xbf6dbec4,0x3f0e3f55
.long 0x3f80,0x3ec4bf6d,0xbf353f35,0x3f6dbec4,0x3f353f35,0xbf0ebf55,0x3ec43f6d,0xbe48bf7b
.long 0x3f808000,0xbf808000,0x3f808000,0xbf808000,0x3f35bf35,0xbf0e3f55,0x3ec4bf6d,0xbe483f7b
.long 0xbf80,0x3ec43f6d,0xbf35bf35,0x3f6d3ec4,0xbf35bf35,0x3f7b3e48,0xbf6d3ec4,0x3f0ebf55
.long 0xbf808000,0x3f35bf35,0x3f80,0xbf35bf35,0xbf353f35,0xbe48bf7b,0x3f6d3ec4,0xbf553f0e
.long 0x3f80,0xbf6dbec4,0x3f35bf35,0x3ec43f6d,0x3f353f35,0xbf553f0e,0xbec4bf6d,0x3f7bbe48
.long 0x3f808000,0x3f80,0xbf808000,0xbf80,0x3f35bf35,0x3f553f0e,0xbec43f6d,0xbf7bbe48
.long 0xbf80,0x3f6dbec4,0x3f353f35,0xbec43f6d,0xbf35bf35,0x3e48bf7b,0x3f6dbec4,0x3f553f0e
.long 0xbf808000,0xbf35bf35,0xbf80,0x3f35bf35,0xbf353f35,0xbf7b3e48,0xbf6dbec4,0xbf0ebf55
.long 0x3f80,0xbec43f6d,0xbf353f35,0xbf6d3ec4,0x3f353f35,0x3f0e3f55,0x3ec43f6d,0x3e483f7b
.long 0x3f808000,0x3f808000,0x3f808000,0x3f808000,0xbf80,0xbe48bf7b,0xbec4bf6d,0xbf0ebf55
.long 0xbf808000,0xbf6d3ec4,0xbf353f35,0xbec43f6d,0x3f80,0x3f0e3f55,0x3f6d3ec4,0x3f7bbe48
.long 0x3f808000,0x3f35bf35,0xbf80,0xbf35bf35,0xbf80,0xbf55bf0e,0xbf6d3ec4,0xbe483f7b
.long 0xbf808000,0xbec43f6d,0x3f353f35,0x3f6dbec4,0x3f80,0x3f7b3e48,0x3ec4bf6d,0xbf55bf0e
.long 0x3f808000,0xbf80,0xbf808000,0x3f80,0xbf80,0xbf7b3e48,0x3ec43f6d,0x3f55bf0e
.long 0xbf808000,0x3ec43f6d,0x3f35bf35,0xbf6dbec4,0x3f80,0x3f55bf0e,0xbf6dbec4,0x3e483f7b
.long 0x3f808000,0xbf35bf35,0x3f80,0x3f35bf35,0xbf80,0xbf0e3f55,0x3f6dbec4,0xbf7bbe48
.long 0xbf808000,0x3f6d3ec4,0xbf35bf35,0x3ec43f6d,0x3f80,0x3e48bf7b,0xbec43f6d,0x3f0ebf55
.long 0x3f808000,0xbf808000,0x3f808000,0xbf808000,0xbf80,0x3e483f7b,0xbec4bf6d,0x3f0e3f55
.long 0xbf808000,0x3f6dbec4,0xbf353f35,0x3ec4bf6d,0x3f80,0xbf0ebf55,0x3f6d3ec4,0xbf7b3e48
.long 0x3f808000,0xbf353f35,0xbf80,0x3f353f35,0xbf80,0x3f553f0e,0xbf6d3ec4,0x3e48bf7b
.long 0xbf808000,0x3ec4bf6d,0x3f353f35,0xbf6d3ec4,0x3f80,0xbf7bbe48,0x3ec4bf6d,0x3f553f0e
.long 0x3f808000,0x3f80,0xbf808000,0xbf80,0xbf80,0x3f7bbe48,0x3ec43f6d,0xbf553f0e
.long 0xbf808000,0xbec4bf6d,0x3f35bf35,0x3f6d3ec4,0x3f80,0xbf553f0e,0xbf6dbec4,0xbe48bf7b
.long 0x3f808000,0x3f353f35,0x3f80,0xbf353f35,0xbf80,0x3f0ebf55,0x3f6dbec4,0x3f7b3e48
.long 0xbf808000,0xbf6dbec4,0xbf35bf35,0xbec4bf6d,0x3f80,0xbe483f7b,0xbec43f6d,0xbf0e3f55
.long 0x3f808000,0x3f808000,0x3f808000,0x3f808000,0xbf35bf35,0xbf55bf0e,0xbf6dbec4,0xbf7bbe48
.long 0x3f80,0x3ec43f6d,0x3f353f35,0x3f6d3ec4,0x3f35bf35,0x3e48bf7b,0xbec4bf6d,0xbf55bf0e
.long 0xbf808000,0xbf353f35,0x3f80,0x3f353f35,0x3f353f35,0x3f7bbe48,0x3ec4bf6d,0xbf0ebf55
.long 0xbf80,0xbf6dbec4,0xbf353f35,0x3ec43f6d,0xbf353f35,0x3f0e3f55,0x3f6dbec4,0xbe48bf7b
.long 0x3f808000,0xbf80,0xbf808000,0x3f80,0xbf35bf35,0xbf0e3f55,0x3f6d3ec4,0x3e48bf7b
.long 0x3f80,0x3f6dbec4,0xbf35bf35,0xbec43f6d,0x3f35bf35,0xbf7bbe48,0x3ec43f6d,0x3f0ebf55
.long 0xbf808000,0x3f353f35,0xbf80,0xbf353f35,0x3f353f35,0xbe48bf7b,0xbec43f6d,0x3f55bf0e
.long 0xbf80,0xbec43f6d,0x3f35bf35,0xbf6d3ec4,0xbf353f35,0x3f55bf0e,0xbf6d3ec4,0x3f7bbe48
.long 0x3f808000,0xbf808000,0x3f808000,0xbf808000,0xbf35bf35,0x3f553f0e,0xbf6dbec4,0x3f7b3e48
.long 0x3f80,0xbec4bf6d,0x3f353f35,0xbf6dbec4,0x3f35bf35,0xbe483f7b,0xbec4bf6d,0x3f553f0e
.long 0xbf808000,0x3f35bf35,0x3f80,0xbf35bf35,0x3f353f35,0xbf7b3e48,0x3ec4bf6d,0x3f0e3f55
.long 0xbf80,0x3f6d3ec4,0xbf353f35,0xbec4bf6d,0xbf353f35,0xbf0ebf55,0x3f6dbec4,0x3e483f7b
.long 0x3f808000,0x3f80,0xbf808000,0xbf80,0xbf35bf35,0x3f0ebf55,0x3f6d3ec4,0xbe483f7b
.long 0x3f80,0xbf6d3ec4,0xbf35bf35,0x3ec4bf6d,0x3f35bf35,0x3f7b3e48,0x3ec43f6d,0xbf0e3f55
.long 0xbf808000,0xbf35bf35,0xbf80,0x3f35bf35,0x3f353f35,0x3e483f7b,0xbec43f6d,0xbf553f0e
.long 0xbf80,0x3ec4bf6d,0x3f35bf35,0x3f6dbec4,0xbf353f35,0xbf553f0e,0xbf6d3ec4,0xbf7b3e48
.long 0x3f808000,0x3f808000,0x3f808000,0x3f808000,0xbf808000,0xbf7b3e48,0xbf6d3ec4,0xbf553f0e
.long 0x3f808000,0x3f6dbec4,0x3f35bf35,0x3ec4bf6d,0xbf808000,0xbf553f0e,0xbec43f6d,0x3e483f7b
.long 0x3f808000,0x3f35bf35,0xbf80,0xbf35bf35,0xbf808000,0xbf0e3f55,0x3ec43f6d,0x3f7b3e48
.long 0x3f808000,0x3ec4bf6d,0xbf35bf35,0xbf6d3ec4,0xbf808000,0xbe483f7b,0x3f6d3ec4,0x3f0ebf55
.long 0x3f808000,0xbf80,0xbf808000,0x3f80,0xbf808000,0x3e483f7b,0x3f6dbec4,0xbf0ebf55
.long 0x3f808000,0xbec4bf6d,0xbf353f35,0x3f6d3ec4,0xbf808000,0x3f0e3f55,0x3ec4bf6d,0xbf7b3e48
.long 0x3f808000,0xbf35bf35,0x3f80,0x3f35bf35,0xbf808000,0x3f553f0e,0xbec4bf6d,0xbe483f7b
.long 0x3f808000,0xbf6dbec4,0x3f353f35,0xbec4bf6d,0xbf808000,0x3f7b3e48,0xbf6dbec4,0x3f553f0e
.long 0x3f808000,0xbf808000,0x3f808000,0xbf808000,0xbf808000,0x3f7bbe48,0xbf6d3ec4,0x3f55bf0e
.long 0x3f808000,0xbf6d3ec4,0x3f35bf35,0xbec43f6d,0xbf808000,0x3f55bf0e,0xbec43f6d,0xbe48bf7b
.long 0x3f808000,0xbf353f35,0xbf80,0x3f353f35,0xbf808000,0x3f0ebf55,0x3ec43f6d,0xbf7bbe48
.long 0x3f808000,0xbec43f6d,0xbf35bf35,0x3f6dbec4,0xbf808000,0x3e48bf7b,0x3f6d3ec4,0xbf0e3f55
.long 0x3f808000,0x3f80,0xbf808000,0xbf80,0xbf808000,0xbe48bf7b,0x3f6dbec4,0x3f0e3f55
.long 0x3f808000,0x3ec43f6d,0xbf353f35,0xbf6dbec4,0xbf808000,0xbf0ebf55,0x3ec4bf6d,0x3f7bbe48
.long 0x3f808000,0x3f353f35,0x3f80,0xbf353f35,0xbf808000,0xbf55bf0e,0xbec4bf6d,0x3e48bf7b
.long 0x3f808000,0x3f6d3ec4,0x3f353f35,0x3ec43f6d,0xbf808000,0xbf7bbe48,0xbf6dbec4,0xbf55bf0e
.long 0x3f808000,0x3f808000,0x3f808000,0x3f808000,0xbf353f35,0xbf0e3f55,0xbec43f6d,0xbe483f7b
.long 0xbf80,0xbec4bf6d,0xbf35bf35,0xbf6dbec4,0x3f353f35,0x3f7b3e48,0x3f6dbec4,0x3f0ebf55
.long 0xbf808000,0xbf353f35,0x3f80,0x3f353f35,0x3f35bf35,0xbe48bf7b,0xbf6dbec4,0xbf553f0e
.long 0x3f80,0x3f6d3ec4,0x3f35bf35,0xbec4bf6d,0xbf35bf35,0xbf553f0e,0x3ec43f6d,0x3f7bbe48
.long 0x3f808000,0xbf80,0xbf808000,0x3f80,0xbf353f35,0x3f553f0e,0x3ec4bf6d,0xbf7bbe48
.long 0xbf80,0xbf6d3ec4,0x3f353f35,0x3ec4bf6d,0x3f353f35,0x3e48bf7b,0xbf6d3ec4,0x3f553f0e
.long 0xbf808000,0x3f353f35,0xbf80,0xbf353f35,0x3f35bf35,0xbf7b3e48,0x3f6d3ec4,0xbf0ebf55
.long 0x3f80,0x3ec4bf6d,0xbf353f35,0x3f6dbec4,0xbf35bf35,0x3f0e3f55,0xbec4bf6d,0x3e483f7b
.long 0x3f808000,0xbf808000,0x3f808000,0xbf808000,0xbf353f35,0x3f0ebf55,0xbec43f6d,0x3e48bf7b
.long 0xbf80,0x3ec43f6d,0xbf35bf35,0x3f6d3ec4,0x3f353f35,0xbf7bbe48,0x3f6dbec4,0xbf0e3f55
.long 0xbf808000,0x3f35bf35,0x3f80,0xbf35bf35,0x3f35bf35,0x3e483f7b,0xbf6dbec4,0x3f55bf0e
.long 0x3f80,0xbf6dbec4,0x3f35bf35,0x3ec43f6d,0xbf35bf35,0x3f55bf0e,0x3ec43f6d,0xbf7b3e48
.long 0x3f808000,0x3f80,0xbf808000,0xbf80,0xbf353f35,0xbf55bf0e,0x3ec4bf6d,0x3f7b3e48
.long 0xbf80,0x3f6dbec4,0x3f353f35,0xbec43f6d,0x3f353f35,0xbe483f7b,0xbf6d3ec4,0xbf55bf0e
.long 0xbf808000,0xbf35bf35,0xbf80,0x3f35bf35,0x3f35bf35,0x3f7bbe48,0x3f6d3ec4,0x3f0e3f55
.long 0x3f80,0xbec43f6d,0xbf353f35,0xbf6d3ec4,0xbf35bf35,0xbf0ebf55,0xbec4bf6d,0xbe48bf7b
.long 0x3f808000,0x3f808000,0x3f808000,0x3f808000,0x3f80,0x3e483f7b,0x3ec43f6d,0x3f0e3f55
.long 0xbf808000,0xbf6d3ec4,0xbf353f35,0xbec43f6d,0xbf80,0xbf0ebf55,0xbf6dbec4,0xbf7b3e48
.long 0x3f808000,0x3f35bf35,0xbf80,0xbf35bf35,0x3f80,0x3f553f0e,0x3f6dbec4,0x3e48bf7b
.long 0xbf808000,0xbec43f6d,0x3f353f35,0x3f6dbec4,0xbf80,0xbf7bbe48,0xbec43f6d,0x3f553f0e
.long 0x3f808000,0xbf80,0xbf808000,0x3f80,0x3f80,0x3f7bbe48,0xbec4bf6d,0xbf553f0e
.long 0xbf808000,0x3ec43f6d,0x3f35bf35,0xbf6dbec4,0xbf80,0xbf553f0e,0x3f6d3ec4,0xbe48bf7b
.long 0x3f808000,0xbf35bf35,0x3f80,0x3f35bf35,0x3f80,0x3f0ebf55,0xbf6d3ec4,0x3f7b3e48
.long 0xbf808000,0x3f6d3ec4,0xbf35bf35,0x3ec43f6d,0xbf80,0xbe483f7b,0x3ec4bf6d,0xbf0e3f55
.long 0x3f808000,0xbf808000,0x3f808000,0xbf808000,0x3f80,0xbe48bf7b,0x3ec43f6d,0xbf0ebf55
.long 0xbf808000,0x3f6dbec4,0xbf353f35,0x3ec4bf6d,0xbf80,0x3f0e3f55,0xbf6dbec4,0x3f7bbe48
.long 0x3f808000,0xbf353f35,0xbf80,0x3f353f35,0x3f80,0xbf55bf0e,0x3f6dbec4,0xbe483f7b
.long 0xbf808000,0x3ec4bf6d,0x3f353f35,0xbf6d3ec4,0xbf80,0x3f7b3e48,0xbec43f6d,0xbf55bf0e
.long 0x3f808000,0x3f80,0xbf808000,0xbf80,0x3f80,0xbf7b3e48,0xbec4bf6d,0x3f55bf0e
.long 0xbf808000,0xbec4bf6d,0x3f35bf35,0x3f6d3ec4,0xbf80,0x3f55bf0e,0x3f6d3ec4,0x3e483f7b
.long 0x3f808000,0x3f353f35,0x3f80,0xbf353f35,0x3f80,0xbf0e3f55,0xbf6d3ec4,0xbf7bbe48
.long 0xbf808000,0xbf6dbec4,0xbf35bf35,0xbec4bf6d,0xbf80,0x3e48bf7b,0x3ec4bf6d,0x3f0ebf55
.long 0x3f808000,0x3f808000,0x3f808000,0x3f808000,0x3f353f35,0x3f553f0e,0x3f6d3ec4,0x3f7b3e48
.long 0x3f80,0x3ec43f6d,0x3f353f35,0x3f6d3ec4,0xbf353f35,0xbe483f7b,0x3ec43f6d,0x3f553f0e
.long 0xbf808000,0xbf353f35,0x3f80,0x3f353f35,0xbf35bf35,0xbf7b3e48,0xbec43f6d,0x3f0e3f55
.long 0xbf80,0xbf6dbec4,0xbf353f35,0x3ec43f6d,0x3f35bf35,0xbf0ebf55,0xbf6d3ec4,0x3e483f7b
.long 0x3f808000,0xbf80,0xbf808000,0x3f80,0x3f353f35,0x3f0ebf55,0xbf6dbec4,0xbe483f7b
.long 0x3f80,0x3f6dbec4,0xbf35bf35,0xbec43f6d,0xbf353f35,0x3f7b3e48,0xbec4bf6d,0xbf0e3f55
.long 0xbf808000,0x3f353f35,0xbf80,0xbf353f35,0xbf35bf35,0x3e483f7b,0x3ec4bf6d,0xbf553f0e
.long 0xbf80,0xbec43f6d,0x3f35bf35,0xbf6d3ec4,0x3f35bf35,0xbf553f0e,0x3f6dbec4,0xbf7b3e48
.long 0x3f808000,0xbf808000,0x3f808000,0xbf808000,0x3f353f35,0xbf55bf0e,0x3f6d3ec4,0xbf7bbe48
.long 0x3f80,0xbec4bf6d,0x3f353f35,0xbf6dbec4,0xbf353f35,0x3e48bf7b,0x3ec43f6d,0xbf55bf0e
.long 0xbf808000,0x3f35bf35,0x3f80,0xbf35bf35,0xbf35bf35,0x3f7bbe48,0xbec43f6d,0xbf0ebf55
.long 0xbf80,0x3f6d3ec4,0xbf353f35,0xbec4bf6d,0x3f35bf35,0x3f0e3f55,0xbf6d3ec4,0xbe48bf7b
.long 0x3f808000,0x3f80,0xbf808000,0xbf80,0x3f353f35,0xbf0e3f55,0xbf6dbec4,0x3e48bf7b
.long 0x3f80,0xbf6d3ec4,0xbf35bf35,0x3ec4bf6d,0xbf353f35,0xbf7bbe48,0xbec4bf6d,0x3f0ebf55
.long 0xbf808000,0xbf35bf35,0xbf80,0x3f35bf35,0xbf35bf35,0xbe48bf7b,0x3ec4bf6d,0x3f55bf0e
.long 0xbf80,0x3ec4bf6d,0x3f35bf35,0x3f6dbec4,0x3f35bf35,0x3f55bf0e,0x3f6dbec4,0x3f7bbe48
.long 0x35800000,0x35800000,0x35800000,0x35800000,0x35800000,0x357ffec4,0x357ffb11,0x357ff4e6
.long 0x35800000,0x357ffb11,0x357fec43,0x357fd397,0x35800000,0x357ff4e6,0x357fd397,0x357f9c18
.long 0x35800000,0x357fec43,0x357fb10f,0x357f4e6d,0x35800000,0x357fe129,0x357f84ab,0x357eea9d
.long 0x35800000,0x357fd397,0x357f4e6d,0x357e70b0,0x35800000,0x357fc38f,0x357f0e58,0x357de0b1
.long 0x35800000,0x357fb10f,0x357ec46d,0x357d3aac,0x35800000,0x357f9c18,0x357e70b0,0x357c7eb0
.long 0x35800000,0x357f84ab,0x357e1324,0x357baccd,0x35800000,0x357f6ac7,0x357dabcc,0x357ac516
.long 0x35800000,0x357f4e6d,0x357d3aac,0x3579c79d,0x35800000,0x357f2f9d,0x357cbfc9,0x3578b47b
.long 0x35800000,0x357f0e58,0x357c3b28,0x35778bc5,0x35800000,0x357eea9d,0x357baccd,0x35764d97
.long 0x35800000,0x357ec46d,0x357b14be,0x3574fa0b,0x35800000,0x357e9bc9,0x357a7302,0x3573913f
.long 0x35800000,0x357e70b0,0x3579c79d,0x35721352,0x35800000,0x357e4323,0x35791298,0x35708066
.long 0x35800000,0x357e1324,0x357853f8,0x356ed89e,0x35800000,0x357de0b1,0x35778bc5,0x356d1c1d
.long 0x35800000,0x357dabcc,0x3576ba07,0x356b4b0c,0x35800000,0x357d7474,0x3575dec6,0x35696591
.long 0x35800000,0x357d3aac,0x3574fa0b,0x35676bd8,0x35800000,0x357cfe73,0x35740bdd,0x35655e0b
.long 0x35800000,0x357cbfc9,0x35731447,0x35633c5a,0x35800000,0x357c7eb0,0x35721352,0x356106f2
.long 0x35800000,0x357c3b28,0x35710908,0x355ebe05,0x35800000,0x357bf531,0x356ff573,0x355c61c7
.long 0x35800000,0x357baccd,0x356ed89e,0x3559f26a,0x35800000,0x357b61fc,0x356db293,0x35577026
.long 0x35800000,0x35800000,0x35800000,0x35800000,0x357fec43,0x357fe129,0x357fd397,0x357fc38f
.long 0x357fb10f,0x357f84ab,0x357f4e6d,0x357f0e58,0x357f4e6d,0x357eea9d,0x357e70b0,0x357de0b1
.long 0x357ec46d,0x357e1324,0x357d3aac,0x357c3b28,0x357e1324,0x357cfe73,0x357baccd,0x357a1e84
.long 0x357d3aac,0x357baccd,0x3579c79d,0x35778bc5,0x357c3b28,0x357a1e84,0x35778bc5,0x35748422
.long 0x357b14be,0x357853f8,0x3574fa0b,0x35710908,0x3579c79d,0x35764d97,0x35721352,0x356d1c1d
.long 0x357853f8,0x35740bdd,0x356ed89e,0x3568bf3c,0x3576ba07,0x35718f57,0x356b4b0c,0x3563f473
.long 0x3574fa0b,0x356ed89e,0x35676bd8,0x355ebe05,0x35731447,0x356be858,0x35633c5a,0x35591e6a
.long 0x35710908,0x3568bf3c,0x355ebe05,0x35531849,0x356ed89e,0x35655e0b,0x3559f26a,0x354cae79
.long 0x356c835e,0x3561c598,0x3554db31,0x3545e403,0x356a09a7,0x355df6be,0x354f7a1f,0x353ebc1b
.long 0x35676bd8,0x3559f26a,0x3549d112,0x35373a23,0x3564aa59,0x3555b993,0x3543e200,0x352f61a5
.long 0x3561c598,0x35514d3d,0x353daef9,0x35273656,0x355ebe05,0x354cae79,0x35373a23,0x351ebc12
.long 0x355b941a,0x3547de65,0x353085bb,0x3515f6d9,0x35584853,0x3542de29,0x35299415,0x350cead0
.long 0x3554db31,0x353daef9,0x35226799,0x35039c3d,0x35514d3d,0x35385216,0x351b02c6,0x34f41f07
.long 0x354d9f02,0x3532c8c9,0x3513682a,0x34e0924f,0x3549d112,0x352d1469,0x350b9a6b,0x34cc9b8b
.long 0x3545e403,0x35273656,0x35039c3d,0x34b8442a,0x3541d870,0x35212ff9,0x34f6e0cb,0x34a395c5
.long 0x353daef9,0x351b02c6,0x34e63375,0x348e9a22,0x35396842,0x3514b039,0x34d53641,0x3472b651
.long 0x35800000,0x35800000,0x35800000,0x35800000,0x357fb10f,0x357f9c18,0x357f84ab,0x357f6ac7
.long 0x357ec46d,0x357e70b0,0x357e1324,0x357dabcc,0x357d3aac,0x357c7eb0,0x357baccd,0x357ac516
.long 0x357b14be,0x3579c79d,0x357853f8,0x3576ba07,0x357853f8,0x35764d97,0x35740bdd,0x35718f57
.long 0x3574fa0b,0x35721352,0x356ed89e,0x356b4b0c,0x35710908,0x356d1c1d,0x3568bf3c,0x3563f473
.long 0x356c835e,0x35676bd8,0x3561c598,0x355b941a,0x35676bd8,0x356106f2,0x3559f26a,0x355233c6
.long 0x3561c598,0x3559f26a,0x35514d3d,0x3547de65,0x355b941a,0x355233c6,0x3547de65,0x353ca003
.long 0x3554db31,0x3549d112,0x353daef9,0x353085bb,0x354d9f02,0x3540d0da,0x3532c8c9,0x35239da9
.long 0x3545e403,0x35373a23,0x35273656,0x3515f6d9,0x353daef9,0x352d1469,0x351b02c6,0x3507a136
.long 0x353504f3,0x35226799,0x350e39da,0x34f15aea,0x352beb4a,0x35173c07,0x3500e7e4,0x34d25a09
.long 0x35226799,0x350b9a6b,0x34e63375,0x34b263ef,0x35187fc0,0x34ff17b2,0x34c9b953,0x34919ddd
.long 0x350e39da,0x34e63375,0x34ac7cd4,0x34605c13,0x35039c3d,0x34cc9b8b,0x348e9a22,0x341c76de
.long 0x34f15aea,0x34b263ef,0x34605c13,0x33afb680,0x34dae880,0x3497a117,0x3422abb6,0x3296c9b6
.long 0x34c3ef15,0x3478cfcc,0x33c8bd36,0xb348fb30,0x34ac7cd4,0x34419b37,0x3316c32c,0xb3ee3876
.long 0x3494a031,0x3409cf86,0xb2c90ab0,0xb43b6ecf,0x3478cfcc,0x33a3308c,0xb3afb680,0xb47ee6e1
.long 0x3447c5c2,0x32c90ab0,0xb4164083,0xb4a09ae5,0x34164083,0xb2fb49ba,0xb4541501,0xb4c1071e
.long 0x33c8bd36,0xb3afb680,0xb4888e93,0xb4e0924f,0x3348fb30,0xb41008b7,0xb4a68f12,0xb4ff17b2
.long 0x35800000,0x35800000,0x35800000,0x35800000,0x357f4e6d,0x357f2f9d,0x357f0e58,0x357eea9d
.long 0x357d3aac,0x357cbfc9,0x357c3b28,0x357baccd,0x3579c79d,0x3578b47b,0x35778bc5,0x35764d97
.long 0x3574fa0b,0x35731447,0x35710908,0x356ed89e,0x356ed89e,0x356be858,0x3568bf3c,0x35655e0b
.long 0x35676bd8,0x35633c5a,0x355ebe05,0x3559f26a,0x355ebe05,0x35591e6a,0x35531849,0x354cae79
.long 0x3554db31,0x354d9f02,0x3545e403,0x353daef9,0x3549d112,0x3540d0da,0x35373a23,0x352d1469
.long 0x353daef9,0x3532c8c9,0x35273656,0x351b02c6,0x353085bb,0x35239da9,0x3515f6d9,0x3507a136
.long 0x35226799,0x3513682a,0x35039c3d,0x34e63375,0x3513682a,0x350242b1,0x34e0924f,0x34bb31a0
.long 0x35039c3d,0x34e0924f,0x34b8442a,0x348e9a22,0x34e63375,0x34bb31a0,0x348e9a22,0x34419b37
.long 0x34c3ef15,0x3494a031,0x3447c5c2,0x33c8bd36,0x34a09ae5,0x345a3997,0x33e1bc2e,0x31c90f88
.long 0x3478cfcc,0x3409cf86,0x32c90ab0,0xb3afb680,0x342f10a2,0x33621469,0xb37b2b74,0xb4354098
.long 0x33c8bd36,0xb2c90ab0,0xb4164083,0xb4888e93,0x32c90ab0,0xb3d53db9,0xb46c9a7f,0xb4b554ec
.long 0xb348fb30,0xb43b6ecf,0xb4a09ae5,0xb4e0924f,0xb3fab273,0xb48586ce,0xb4c9b953,0xb504f484
.long 0xb447c5c2,0xb4ac7cd4,0xb4f15aea,0xb5187fc0,0xb4888e93,0xb4d25a09,0xb50b9a6b,0xb52ac082
.long 0xb4ac7cd4,0xb4f6e0cb,0xb51d7fd1,0xb53b8f3b,0xb4cf7bca,0xb50cead0,0xb52e3bde,0xb54ac77f
.long 0xb4f15aea,0xb51d7fd1,0xb53daef9,0xb5584853,0xb508f59b,0xb52d1469,0xb54bbbf8,0xb563f473
.long 0xb5187fc0,0xb53b8f3b,0xb5584853,0xb56db293,0xb5273656,0xb548d8b3,0xb5633c5a,0xb5756d97
.long 0x35800000,0x35800000,0x35800000,0x35800000,0x357ec46d,0x357e9bc9,0x357e70b0,0x357e4323
.long 0x357b14be,0x357a7302,0x3579c79d,0x35791298,0x3574fa0b,0x3573913f,0x35721352,0x35708066
.long 0x356c835e,0x356a09a7,0x35676bd8,0x3564aa59,0x3561c598,0x355df6be,0x3559f26a,0x3555b993
.long 0x3554db31,0x354f7a1f,0x3549d112,0x3543e200,0x3545e403,0x353ebc1b,0x35373a23,0x352f61a5
.long 0x353504f3,0x352beb4a,0x35226799,0x35187fc0,0x35226799,0x35173c07,0x350b9a6b,0x34ff17b2
.long 0x350e39da,0x3500e7e4,0x34e63375,0x34c9b953,0x34f15aea,0x34d25a09,0x34b263ef,0x34919ddd
.long 0x34c3ef15,0x34a09ae5,0x3478cfcc,0x342f10a2,0x3494a031,0x345a3997,0x3409cf86,0x33621469
.long 0x3447c5c2,0x33e1bc2e,0x32c90ab0,0xb37b2b74,0x33c8bd36,0x31c90f88,0xb3afb680,0xb4354098
.long 0,0xb3c8bd36,0xb447c5c2,0xb494a031,0xb3c8bd36,0xb44dee60,0xb49aa086,0xb4cc9b8b
.long 0xb447c5c2,0xb49aa086,0xb4cf7bca,0xb500e7e4,0xb494a031,0xb4cc9b8b,0xb500e7e4,0xb519c200
.long 0xb4c3ef15,0xb4fc5d27,0xb5187fc0,0xb53085bb,0xb4f15aea,0xb514b039,0xb52e3bde,0xb544e3f5
.long 0xb50e39da,0xb5299415,0xb541d870,0xb55695e5,0xb5226799,0xb53ca003,0xb5531849,0xb5655e0b
.long 0xb53504f3,0xb54d9f02,0xb561c598,0xb5710908,0xb545e403,0xb55c61c7,0xb56db293,0xb5796e4e
.long 0xb554db31,0xb568bf3c,0xb576ba07,0xb57e70b0,0xb561c598,0xb57294f8,0xb57cbfc9,0xb57ffec4
.long 0xb56c835e,0xb579c79d,0xb57fb10f,0xb57e1324,0xb574fa0b,0xb57e4323,0xb57f84ab,0xb578b47b
.long 0xb57b14be,0xb57ffb11,0xb57c3b28,0xb56ff573,0xb57ec46d,0xb57eea9d,0xb575dec6,0xb563f473
.long 0x35800000,0x35800000,0x35800000,0x35800000,0x357e1324,0x357de0b1,0x357dabcc,0x357d7474
.long 0x357853f8,0x35778bc5,0x3576ba07,0x3575dec6,0x356ed89e,0x356d1c1d,0x356b4b0c,0x35696591
.long 0x3561c598,0x355ebe05,0x355b941a,0x35584853,0x35514d3d,0x354cae79,0x3547de65,0x3542de29
.long 0x353daef9,0x35373a23,0x353085bb,0x35299415,0x35273656,0x351ebc12,0x3515f6d9,0x350cead0
.long 0x350e39da,0x35039c3d,0x34f15aea,0x34dae880,0x34e63375,0x34cc9b8b,0x34b263ef,0x3497a117
.long 0x34ac7cd4,0x348e9a22,0x34605c13,0x3422abb6,0x34605c13,0x341c76de,0x33afb680,0x3296c9b6
.long 0x33c8bd36,0x32c90ab0,0xb348fb30,0xb3fab273,0xb2c90ab0,0xb3d53db9,0xb43b6ecf,0xb48586ce
.long 0xb4164083,0xb46c9a7f,0xb4a09ae5,0xb4c9b953,0xb4888e93,0xb4b554ec,0xb4e0924f,0xb504f484
.long 0xb4c3ef15,0xb4f15aea,0xb50e39da,0xb5226799,0xb4fc5d27,0xb514b039,0xb5299415,0xb53ca003
.long 0xb5187fc0,0xb52e3bde,0xb541d870,0xb5531849,0xb53085bb,0xb544e3f5,0xb55695e5,0xb5655e0b
.long 0xb545e403,0xb5584853,0xb5676bd8,0xb5731447,0xb5584853,0xb56816a8,0xb5740bdd,0xb57bf531
.long 0xb5676bd8,0xb5740bdd,0xb57c3b28,0xb57fd397,0xb5731447,0xb57bf531,0xb57fd397,0xb57e9bc9
.long 0xb57b14be,0xb57fb10f,0xb57ec46d,0xb57853f8,0xb57f4e6d,0xb57f2f9d,0xb5791298,0xb56d1c1d
.long 0xb57fb10f,0xb57a7302,0xb56ed89e,0xb55d2d53,0xb57c3b28,0xb5718f57,0xb5604621,0xb548d8b3
.long 0xb574fa0b,0xb564aa59,0xb54d9f02,0xb53085bb,0xb56a09a7,0xb553fac3,0xb5373a23,0xb514b039
.long 0xb55b941a,0xb53fc767,0xb51d7fd1,0xb4ebcbbb,0xb549d112,0xb5286605,0xb500e7e4,0xb4a986c4
.long 0x35800000,0x35800000,0x35800000,0x35800000,0x357d3aac,0x357cfe73,0x357cbfc9,0x357c7eb0
.long 0x3574fa0b,0x35740bdd,0x35731447,0x35721352,0x35676bd8,0x35655e0b,0x35633c5a,0x356106f2
.long 0x3554db31,0x35514d3d,0x354d9f02,0x3549d112,0x353daef9,0x35385216,0x3532c8c9,0x352d1469
.long 0x35226799,0x351b02c6,0x3513682a,0x350b9a6b,0x35039c3d,0x34f41f07,0x34e0924f,0x34cc9b8b
.long 0x34c3ef15,0x34ac7cd4,0x3494a031,0x3478cfcc,0x3478cfcc,0x34419b37,0x3409cf86,0x33a3308c
.long 0x33c8bd36,0x3316c32c,0xb2c90ab0,0xb3afb680,0xb348fb30,0xb3ee3876,0xb43b6ecf,0xb47ee6e1
.long 0xb447c5c2,0xb4888e93,0xb4ac7cd4,0xb4cf7bca,0xb4ac7cd4,0xb4d25a09,0xb4f6e0cb,0xb50cead0
.long 0xb4f15aea,0xb50b9a6b,0xb51d7fd1,0xb52e3bde,0xb5187fc0,0xb52ac082,0xb53b8f3b,0xb54ac77f
.long 0xb53504f3,0xb545e403,0xb554db31,0xb561c598,0xb54d9f02,0xb55c61c7,0xb568bf3c,0xb57294f8
.long 0xb561c598,0xb56db293,0xb576ba07,0xb57cbfc9,0xb5710908,0xb5796e4e,0xb57e70b0,0xb57ffec4
.long 0xb57b14be,0xb57f4e6d,0xb57fb10f,0xb57c3b28,0xb57fb10f,0xb57f2f9d,0xb57a7302,0xb5718f57
.long 0xb57ec46d,0xb5791298,0xb56ed89e,0xb5604621,0xb57853f8,0xb56d1c1d,0xb55d2d53,0xb548d8b3
.long 0xb56c835e,0xb55b941a,0xb545e403,0xb52beb4a,0xb55b941a,0xb544e3f5,0xb5299415,0xb50a48ad
.long 0xb545e403,0xb5299415,0xb508f59b,0xb4c9b953,0xb52beb4a,0xb50a48ad,0xb4c9b953,0xb472b651
.long 0xb50e39da,0xb4cf7bca,0xb478cfcc,0xb396a905,0xb4dae880,0xb48586ce,0xb3afb680,0x33bc3ac3
.long 0xb494a031,0xb3e1bc2e,0x3396a905,0x34827dc0,0xb4164083,0x332fe007,0x346c9a7f,0x34d25a09
.long 0x35800000,0x35800000,0x35800000,0x35800000,0x357c3b28,0x357bf531,0x357baccd,0x357b61fc
.long 0x35710908,0x356ff573,0x356ed89e,0x356db293,0x355ebe05,0x355c61c7,0x3559f26a,0x35577026
.long 0x3545e403,0x3541d870,0x353daef9,0x35396842,0x35273656,0x35212ff9,0x351b02c6,0x3514b039
.long 0x35039c3d,0x34f6e0cb,0x34e63375,0x34d53641,0x34b8442a,0x34a395c5,0x348e9a22,0x3472b651
.long 0x3447c5c2,0x34164083,0x33c8bd36,0x3348fb30,0x32c90ab0,0xb2fb49ba,0xb3afb680,0xb41008b7
.long 0xb4164083,0xb4541501,0xb4888e93,0xb4a68f12,0xb4a09ae5,0xb4c1071e,0xb4e0924f,0xb4ff17b2
.long 0xb4f15aea,0xb508f59b,0xb5187fc0,0xb5273656,0xb51d7fd1,0xb52d1469,0xb53b8f3b,0xb548d8b3
.long 0xb53daef9,0xb54bbbf8,0xb5584853,0xb5633c5a,0xb5584853,0xb563f473,0xb56db293,0xb5756d97
.long 0xb56c835e,0xb574fa0b,0xb57b14be,0xb57ec46d,0xb579c79d,0xb57e4323,0xb57ffb11,0xb57eea9d
.long 0xb57fb10f,0xb57f84ab,0xb57c3b28,0xb575dec6,0xb57e1324,0xb578b47b,0xb56ff573,0xb563f473
.long 0xb574fa0b,0xb56a09a7,0xb55b941a,0xb549d112,0xb564aa59,0xb553fac3,0xb53fc767,0xb5286605
.long 0xb54d9f02,0xb5373a23,0xb51d7fd1,0xb500e7e4,0xb53085bb,0xb514b039,0xb4ebcbbb,0xb4a986c4
.long 0xb50e39da,0xb4dae880,0xb494a031,0xb4164083,0xb4cf7bca,0xb48586ce,0xb3e1bc2e,0x332fe007
.long 0xb478cfcc,0xb3afb680,0x3396a905,0x346c9a7f,0xb396a905,0x33bc3ac3,0x34827dc0,0x34d25a09
.long 0x33c8bd36,0x34888e93,0x34dae880,0x3513682a,0x34888e93,0x34ddbe79,0x3515f6d9,0x35385216
.long 0x34dae880,0x3515f6d9,0x35396842,0x355695e5,0x3513682a,0x35385216,0x355695e5,0x356d1c1d
.long 0,0,0,0,0,0x31c90f88,0x32490e90,0x3296c9b6
.long 0,0x32490e90,0x32c90ab0,0x3316c32c,0,0x3296c9b6,0x3316c32c,0x33621469
.long 0,0x32c90ab0,0x3348fb30,0x3396a905,0,0x32fb49ba,0x337b2b74,0x33bc3ac3
.long 0,0x3316c32c,0x3396a905,0x33e1bc2e,0,0x332fe007,0x33afb680,0x34039502
.long 0,0x3348fb30,0x33c8bd36,0x34164083,0,0x33621469,0x33e1bc2e,0x3428defc
.long 0,0x337b2b74,0x33fab273,0x343b6ecf,0,0x338a200a,0x3409cf86,0x344dee60
.long 0,0x3396a905,0x34164083,0x34605c13,0,0x33a3308c,0x3422abb6,0x3472b651
.long 0,0x33afb680,0x342f10a2,0x34827dc0,0,0x33bc3ac3,0x343b6ecf,0x348b9507
.long 0,0x33c8bd36,0x3447c5c2,0x3494a031,0,0x33d53db9,0x34541501,0x349d9e78
.long 0,0x33e1bc2e,0x34605c13,0x34a68f12,0,0x33ee3876,0x346c9a7f,0x34af713a
.long 0,0x33fab273,0x3478cfcc,0x34b8442a,0,0x34039502,0x34827dc0,0x34c1071e
.long 0,0x3409cf86,0x34888e93,0x34c9b953,0,0x341008b7,0x348e9a22,0x34d25a09
.long 0,0x34164083,0x3494a031,0x34dae880,0,0x341c76de,0x349aa086,0x34e363fa
.long 0,0x3422abb6,0x34a09ae5,0x34ebcbbb,0,0x3428defc,0x34a68f12,0x34f41f07
.long 0,0x342f10a2,0x34ac7cd4,0x34fc5d27,0,0x34354098,0x34b263ef,0x350242b1
.long 0,0x343b6ecf,0x34b8442a,0x35064b82,0,0x34419b37,0x34be1d4a,0x350a48ad
.long 0,0,0,0,0x32c90ab0,0x32fb49ba,0x3316c32c,0x332fe007
.long 0x3348fb30,0x337b2b74,0x3396a905,0x33afb680,0x3396a905,0x33bc3ac3,0x33e1bc2e,0x34039502
.long 0x33c8bd36,0x33fab273,0x34164083,0x342f10a2,0x33fab273,0x341c76de,0x343b6ecf,0x345a3997
.long 0x34164083,0x343b6ecf,0x34605c13,0x34827dc0,0x342f10a2,0x345a3997,0x34827dc0,0x3497a117
.long 0x3447c5c2,0x3478cfcc,0x3494a031,0x34ac7cd4,0x34605c13,0x348b9507,0x34a68f12,0x34c1071e
.long 0x3478cfcc,0x349aa086,0x34b8442a,0x34d53641,0x34888e93,0x34a986c4,0x34c9b953,0x34e900b7
.long 0x3494a031,0x34b8442a,0x34dae880,0x34fc5d27,0x34a09ae5,0x34c6d529,0x34ebcbbb,0x3507a136
.long 0x34ac7cd4,0x34d53641,0x34fc5d27,0x3510d3cd,0x34b8442a,0x34e363fa,0x35064b82,0x3519c200
.long 0x34c3ef15,0x34f15aea,0x350e39da,0x35226799,0x34cf7bca,0x34ff17b2,0x3515f6d9,0x352ac082
.long 0x34dae880,0x35064b82,0x351d7fd1,0x3532c8c9,0x34e63375,0x350cead0,0x3524d225,0x353a7ca4
.long 0x34f15aea,0x3513682a,0x352beb4a,0x3541d870,0x34fc5d27,0x3519c200,0x3532c8c9,0x3548d8b3
.long 0x35039c3d,0x351ff6cb,0x35396842,0x354f7a1f,0x3508f59b,0x3526050a,0x353fc767,0x3555b993
.long 0x350e39da,0x352beb4a,0x3545e403,0x355b941a,0x3513682a,0x3531a81d,0x354bbbf8,0x356106f2
.long 0x35187fc0,0x35373a23,0x35514d3d,0x35660f88,0x351d7fd1,0x353ca003,0x355695e5,0x356aab7b
.long 0x35226799,0x3541d870,0x355b941a,0x356ed89e,0x35273656,0x3546e22a,0x35604621,0x357294f8
.long 0x352beb4a,0x354bbbf8,0x3564aa59,0x3575dec6,0x353085bb,0x355064af,0x3568bf3c,0x3578b47b
.long 0,0,0,0,0x3348fb30,0x33621469,0x337b2b74,0x338a200a
.long 0x33c8bd36,0x33e1bc2e,0x33fab273,0x3409cf86,0x34164083,0x3428defc,0x343b6ecf,0x344dee60
.long 0x3447c5c2,0x34605c13,0x3478cfcc,0x34888e93,0x3478cfcc,0x348b9507,0x349aa086,0x34a986c4
.long 0x3494a031,0x34a68f12,0x34b8442a,0x34c9b953,0x34ac7cd4,0x34c1071e,0x34d53641,0x34e900b7
.long 0x34c3ef15,0x34dae880,0x34f15aea,0x35039c3d,0x34dae880,0x34f41f07,0x35064b82,0x35121eb0
.long 0x34f15aea,0x35064b82,0x3513682a,0x351ff6cb,0x35039c3d,0x35121eb0,0x351ff6cb,0x352d1469
.long 0x350e39da,0x351d7fd1,0x352beb4a,0x35396842,0x35187fc0,0x35286605,0x35373a23,0x3544e3f5
.long 0x35226799,0x3532c8c9,0x3541d870,0x354f7a1f,0x352beb4a,0x353ca003,0x354bbbf8,0x35591e6a
.long 0x353504f3,0x3545e403,0x3554db31,0x3561c598,0x353daef9,0x354e8d90,0x355d2d53,0x35696591
.long 0x3545e403,0x355695e5,0x3564aa59,0x356ff573,0x354d9f02,0x355df6be,0x356b4b0c,0x35756d97
.long 0x3554db31,0x3564aa59,0x35710908,0x3579c79d,0x355b941a,0x356aab7b,0x3575dec6,0x357cfe73
.long 0x3561c598,0x356ff573,0x3579c79d,0x357f0e58,0x35676bd8,0x35748422,0x357cbfc9,0x357ff4e6
.long 0x356c835e,0x357853f8,0x357ec46d,0x357fb10f,0x35710908,0x357b61fc,0x357fd397,0x357e4323
.long 0x3574fa0b,0x357dabcc,0x357fec43,0x357baccd,0x357853f8,0x357f2f9d,0x357f0e58,0x3577f110
.long 0x357b14be,0x357fec43,0x357d3aac,0x35731447,0x357d3aac,0x357fe129,0x357a7302,0x356d1c1d
.long 0x357ec46d,0x357f0e58,0x3576ba07,0x35660f88,0x357fb10f,0x357d7474,0x35721352,0x355df6be
.long 0,0,0,0,0x3396a905,0x33a3308c,0x33afb680,0x33bc3ac3
.long 0x34164083,0x3422abb6,0x342f10a2,0x343b6ecf,0x34605c13,0x3472b651,0x34827dc0,0x348b9507
.long 0x3494a031,0x34a09ae5,0x34ac7cd4,0x34b8442a,0x34b8442a,0x34c6d529,0x34d53641,0x34e363fa
.long 0x34dae880,0x34ebcbbb,0x34fc5d27,0x35064b82,0x34fc5d27,0x3507a136,0x3510d3cd,0x3519c200
.long 0x350e39da,0x35187fc0,0x35226799,0x352beb4a,0x351d7fd1,0x35286605,0x3532c8c9,0x353ca003
.long 0x352beb4a,0x35373a23,0x3541d870,0x354bbbf8,0x35396842,0x3544e3f5,0x354f7a1f,0x35591e6a
.long 0x3545e403,0x35514d3d,0x355b941a,0x3564aa59,0x35514d3d,0x355c61c7,0x35660f88,0x356e46be
.long 0x355b941a,0x35660f88,0x356ed89e,0x3575dec6,0x3564aa59,0x356e46be,0x3575dec6,0x357b61fc
.long 0x356c835e,0x3574fa0b,0x357b14be,0x357ec46d,0x35731447,0x357a1e84,0x357e70b0,0x357ffec4
.long 0x357853f8,0x357dabcc,0x357fec43,0x357f0e58,0x357c3b28,0x357f9c18,0x357f84ab,0x357bf531
.long 0x357ec46d,0x357fec43,0x357d3aac,0x3576ba07,0x357fec43,0x357e9bc9,0x35791298,0x356f6830
.long 0x357fb10f,0x357baccd,0x35731447,0x35660f88,0x357e1324,0x35772417,0x356b4b0c,0x355ac450
.long 0x357b14be,0x35710908,0x3561c598,0x354d9f02,0x3576ba07,0x35696591,0x355695e5,0x353ebc1b
.long 0x35710908,0x35604621,0x3549d112,0x352e3bde,0x356a09a7,0x3555b993,0x353b8f3b,0x351c420c
.long 0x3561c598,0x3549d112,0x352beb4a,0x3508f59b,0x35584853,0x353ca003,0x351b02c6,0x34e900b7
.long 0x354d9f02,0x352e3bde,0x3508f59b,0x34be1d4a,0x3541d870,0x351ebc12,0x34ebcbbb,0x34919ddd
.long 0,0,0,0,0x33c8bd36,0x33d53db9,0x33e1bc2e,0x33ee3876
.long 0x3447c5c2,0x34541501,0x34605c13,0x346c9a7f,0x3494a031,0x349d9e78,0x34a68f12,0x34af713a
.long 0x34c3ef15,0x34cf7bca,0x34dae880,0x34e63375,0x34f15aea,0x34ff17b2,0x35064b82,0x350cead0
.long 0x350e39da,0x3515f6d9,0x351d7fd1,0x3524d225,0x35226799,0x352ac082,0x3532c8c9,0x353a7ca4
.long 0x353504f3,0x353daef9,0x3545e403,0x354d9f02,0x3545e403,0x354e8d90,0x355695e5,0x355df6be
.long 0x3554db31,0x355d2d53,0x3564aa59,0x356b4b0c,0x3561c598,0x35696591,0x356ff573,0x35756d97
.long 0x356c835e,0x35731447,0x357853f8,0x357c3b28,0x3574fa0b,0x357a1e84,0x357dabcc,0x357f9c18
.long 0x357b14be,0x357e70b0,0x357fec43,0x357f84ab,0x357ec46d,0x357ffec4,0x357f0e58,0x357bf531
.long 0x35800000,0x357ec46d,0x357b14be,0x3574fa0b,0x357ec46d,0x357ac516,0x35740bdd,0x356aab7b
.long 0x357b14be,0x35740bdd,0x356a09a7,0x355d2d53,0x3574fa0b,0x356aab7b,0x355d2d53,0x354cae79
.long 0x356c835e,0x355ebe05,0x354d9f02,0x35396842,0x3561c598,0x355064af,0x353b8f3b,0x35239da9
.long 0x3554db31,0x353fc767,0x35273656,0x350b9a6b,0x3545e403,0x352d1469,0x3510d3cd,0x34e363fa
.long 0x353504f3,0x35187fc0,0x34f15aea,0x34ac7cd4,0x35226799,0x350242b1,0x34be1d4a,0x34667c66
.long 0x350e39da,0x34d53641,0x34888e93,0x33e1bc2e,0x34f15aea,0x34a395c5,0x3422abb6,0xb1c90f88
.long 0x34c3ef15,0x34605c13,0x3348fb30,0xb3fab273,0x3494a031,0x33ee3876,0xb37b2b74,0xb472b651
.long 0x3447c5c2,0x32490e90,0xb42f10a2,0xb4b263ef,0x33c8bd36,0xb3bc3ac3,0xb48e9a22,0xb4e900b7
.long 0,0,0,0,0x33fab273,0x34039502,0x3409cf86,0x341008b7
.long 0x3478cfcc,0x34827dc0,0x34888e93,0x348e9a22,0x34b8442a,0x34c1071e,0x34c9b953,0x34d25a09
.long 0x34f15aea,0x34fc5d27,0x35039c3d,0x3508f59b,0x3513682a,0x3519c200,0x351ff6cb,0x3526050a
.long 0x352beb4a,0x3532c8c9,0x35396842,0x353fc767,0x3541d870,0x3548d8b3,0x354f7a1f,0x3555b993
.long 0x3554db31,0x355b941a,0x3561c598,0x35676bd8,0x3564aa59,0x356aab7b,0x356ff573,0x35748422
.long 0x35710908,0x3575dec6,0x3579c79d,0x357cbfc9,0x3579c79d,0x357cfe73,0x357f0e58,0x357ff4e6
.long 0x357ec46d,0x357fec43,0x357fb10f,0x357e1324,0x357fec43,0x357e9bc9,0x357baccd,0x35772417
.long 0x357d3aac,0x35791298,0x35731447,0x356b4b0c,0x3576ba07,0x356f6830,0x35660f88,0x355ac450
.long 0x356c835e,0x3561c598,0x3554db31,0x3545e403,0x355ebe05,0x355064af,0x353fc767,0x352d1469
.long 0x354d9f02,0x353b8f3b,0x35273656,0x3510d3cd,0x35396842,0x35239da9,0x350b9a6b,0x34e363fa
.long 0x35226799,0x3508f59b,0x34dae880,0x34a09ae5,0x3508f59b,0x34d8106b,0x349aa086,0x34354098
.long 0x34dae880,0x349aa086,0x342f10a2,0x3316c32c,0x34a09ae5,0x34354098,0x3316c32c,0xb3d53db9
.long 0x3447c5c2,0x3348fb30,0xb3c8bd36,0xb478cfcc,0x3396a905,0xb3a3308c,0xb46c9a7f,0xb4c1071e
.long 0xb348fb30,0xb4541501,0xb4b8442a,0xb500e7e4,0xb42f10a2,0xb4a986c4,0xb4f6e0cb,0xb51ebc12
.long 0xb494a031,0xb4e63375,0xb5187fc0,0xb5396842,0xb4cf7bca,0xb50f8784,0xb532c8c9,0xb55064af
.long 0xb5039c3d,0xb5299415,0xb549d112,0xb5633c5a,0xb51d7fd1,0xb540d0da,0xb55d2d53,0xb5718f57
.long 0,0,0,0,0x34164083,0x341c76de,0x3422abb6,0x3428defc
.long 0x3494a031,0x349aa086,0x34a09ae5,0x34a68f12,0x34dae880,0x34e363fa,0x34ebcbbb,0x34f41f07
.long 0x350e39da,0x3513682a,0x35187fc0,0x351d7fd1,0x352beb4a,0x3531a81d,0x35373a23,0x353ca003
.long 0x3545e403,0x354bbbf8,0x35514d3d,0x355695e5,0x355b941a,0x356106f2,0x35660f88,0x356aab7b
.long 0x356c835e,0x35710908,0x3574fa0b,0x357853f8,0x357853f8,0x357b61fc,0x357dabcc,0x357f2f9d
.long 0x357ec46d,0x357fd397,0x357fec43,0x357f0e58,0x357fb10f,0x357e4323,0x357baccd,0x3577f110
.long 0x357b14be,0x3576ba07,0x35710908,0x356a09a7,0x35710908,0x35696591,0x35604621,0x3555b993
.long 0x3561c598,0x355695e5,0x3549d112,0x353b8f3b,0x354d9f02,0x353ebc1b,0x352e3bde,0x351c420c
.long 0x353504f3,0x35226799,0x350e39da,0x34f15aea,0x35187fc0,0x350242b1,0x34d53641,0x34a395c5
.long 0x34f15aea,0x34be1d4a,0x34888e93,0x3422abb6,0x34ac7cd4,0x34667c66,0x33e1bc2e,0xb1c90f88
.long 0x3447c5c2,0x3396a905,0xb348fb30,0xb42f10a2,0x3348fb30,0xb3a3308c,0xb4541501,0xb4a986c4
.long 0xb3c8bd36,0xb46c9a7f,0xb4b8442a,0xb4f6e0cb,0xb478cfcc,0xb4c1071e,0xb500e7e4,0xb51ebc12
.long 0xb4c3ef15,0xb5039c3d,0xb5226799,0xb53daef9,0xb5039c3d,0xb5239da9,0xb53fc767,0xb5577026
.long 0xb5226799,0xb53fc767,0xb5584853,0xb56b4b0c,0xb53daef9,0xb5577026,0xb56b4b0c,0xb578b47b
.long 0xb554db31,0xb56a09a7,0xb57853f8,0xb57f4e6d,0xb5676bd8,0xb5772417,0xb57f0e58,0xb57eea9d
.long 0xb574fa0b,0xb57e70b0,0xb57f4e6d,0xb5778bc5,0xb57d3aac,0xb57fc38f,0xb5791298,0xb5696591
.long 0,0,0,0,0x342f10a2,0x34354098,0x343b6ecf,0x34419b37
.long 0x34ac7cd4,0x34b263ef,0x34b8442a,0x34be1d4a,0x34fc5d27,0x350242b1,0x35064b82,0x350a48ad
.long 0x35226799,0x35273656,0x352beb4a,0x353085bb,0x3541d870,0x3546e22a,0x354bbbf8,0x355064af
.long 0x355b941a,0x35604621,0x3564aa59,0x3568bf3c,0x356ed89e,0x357294f8,0x3575dec6,0x3578b47b
.long 0x357b14be,0x357d3aac,0x357ec46d,0x357fb10f,0x357fec43,0x357fe129,0x357f0e58,0x357d7474
.long 0x357d3aac,0x357a7302,0x3576ba07,0x35721352,0x35731447,0x356d1c1d,0x35660f88,0x355df6be
.long 0x3561c598,0x35584853,0x354d9f02,0x3541d870,0x3549d112,0x353ca003,0x352e3bde,0x351ebc12
.long 0x352beb4a,0x351b02c6,0x3508f59b,0x34ebcbbb,0x3508f59b,0x34e900b7,0x34be1d4a,0x34919ddd
.long 0x34c3ef15,0x3494a031,0x3447c5c2,0x33c8bd36,0x34605c13,0x33ee3876,0x32490e90,0xb3bc3ac3
.long 0x3348fb30,0xb37b2b74,0xb42f10a2,0xb48e9a22,0xb3fab273,0xb472b651,0xb4b263ef,0xb4e900b7
.long 0xb494a031,0xb4cf7bca,0xb5039c3d,0xb51d7fd1,0xb4e63375,0xb50f8784,0xb5299415,0xb540d0da
.long 0xb5187fc0,0xb532c8c9,0xb549d112,0xb55d2d53,0xb5396842,0xb55064af,0xb5633c5a,0xb5718f57
.long 0xb554db31,0xb5676bd8,0xb574fa0b,0xb57d3aac,0xb56a09a7,0xb5772417,0xb57e70b0,0xb57fc38f
.long 0xb57853f8,0xb57f0e58,0xb57f4e6d,0xb5791298,0xb57f4e6d,0xb57eea9d,0xb5778bc5,0xb5696591
.long 0xb57ec46d,0xb576ba07,0xb5676bd8,0xb5514d3d,0xb576ba07,0xb566becc,0xb54f7a1f,0xb531a81d
.long 0xb5676bd8,0xb54f7a1f,0xb53085bb,0xb50b9a6b,0xb5514d3d,0xb531a81d,0xb50b9a6b,0xb4c1071e
.long 0x3f80,0x3f80,0x3f80,0x3f80,0x3f80,0x3e483f7b,0x3ec43f6d,0x3f0e3f55
.long 0x3f80,0x3ec43f6d,0x3f353f35,0x3f6d3ec4,0x3f80,0x3f0e3f55,0x3f6d3ec4,0x3f7bbe48
.long 0x3f80,0x3f353f35,0x3f800000,0x3f35bf35,0x3f80,0x3f553f0e,0x3f6dbec4,0x3e48bf7b
.long 0x3f80,0x3f6d3ec4,0x3f35bf35,0xbec4bf6d,0x3f80,0x3f7b3e48,0x3ec4bf6d,0xbf55bf0e
.long 0x3f80,0x3f800000,0xbf80,0xbf800000,0x3f80,0x3f7bbe48,0xbec4bf6d,0xbf553f0e
.long 0x3f80,0x3f6dbec4,0xbf35bf35,0xbec43f6d,0x3f80,0x3f55bf0e,0xbf6dbec4,0x3e483f7b
.long 0x3f80,0x3f35bf35,0xbf800000,0x3f353f35,0x3f80,0x3f0ebf55,0xbf6d3ec4,0x3f7b3e48
.long 0x3f80,0x3ec4bf6d,0xbf353f35,0x3f6dbec4,0x3f80,0x3e48bf7b,0xbec43f6d,0x3f0ebf55
.long 0x3f80,0xbf80,0x3f80,0xbf80,0x3f80,0xbe48bf7b,0x3ec43f6d,0xbf0ebf55
.long 0x3f80,0xbec4bf6d,0x3f353f35,0xbf6dbec4,0x3f80,0xbf0ebf55,0x3f6d3ec4,0xbf7b3e48
.long 0x3f80,0xbf35bf35,0x3f800000,0xbf353f35,0x3f80,0xbf55bf0e,0x3f6dbec4,0xbe483f7b
.long 0x3f80,0xbf6dbec4,0x3f35bf35,0x3ec43f6d,0x3f80,0xbf7bbe48,0x3ec4bf6d,0x3f553f0e
.long 0x3f80,0xbf800000,0xbf80,0x3f800000,0x3f80,0xbf7b3e48,0xbec4bf6d,0x3f55bf0e
.long 0x3f80,0xbf6d3ec4,0xbf35bf35,0x3ec4bf6d,0x3f80,0xbf553f0e,0xbf6dbec4,0xbe48bf7b
.long 0x3f80,0xbf353f35,0xbf800000,0xbf35bf35,0x3f80,0xbf0e3f55,0xbf6d3ec4,0xbf7bbe48
.long 0x3f80,0xbec43f6d,0xbf353f35,0xbf6d3ec4,0x3f80,0xbe483f7b,0xbec43f6d,0xbf0e3f55
.long 0x3f80,0x3f80,0x3f80,0x3f80,0x3f353f35,0x3f553f0e,0x3f6d3ec4,0x3f7b3e48
.long 0x3f800000,0x3f6dbec4,0x3f35bf35,0x3ec4bf6d,0x3f35bf35,0x3e48bf7b,0xbec4bf6d,0xbf55bf0e
.long 0xbf80,0xbf35bf35,0xbf800000,0xbf353f35,0xbf35bf35,0xbf7b3e48,0xbec43f6d,0x3f0e3f55
.long 0xbf800000,0xbec43f6d,0x3f353f35,0x3f6dbec4,0xbf353f35,0x3f0e3f55,0x3f6dbec4,0xbe48bf7b
.long 0x3f80,0x3f800000,0xbf80,0xbf800000,0x3f353f35,0x3f0ebf55,0xbf6dbec4,0xbe483f7b
.long 0x3f800000,0xbec4bf6d,0xbf353f35,0x3f6d3ec4,0x3f35bf35,0xbf7bbe48,0x3ec43f6d,0x3f0ebf55
.long 0xbf80,0xbf353f35,0x3f800000,0xbf35bf35,0xbf35bf35,0x3e483f7b,0x3ec4bf6d,0xbf553f0e
.long 0xbf800000,0x3f6d3ec4,0xbf35bf35,0x3ec43f6d,0xbf353f35,0x3f55bf0e,0xbf6d3ec4,0x3f7bbe48
.long 0x3f80,0xbf80,0x3f80,0xbf80,0x3f353f35,0xbf55bf0e,0x3f6d3ec4,0xbf7bbe48
.long 0x3f800000,0xbf6d3ec4,0x3f35bf35,0xbec43f6d,0x3f35bf35,0xbe483f7b,0xbec4bf6d,0x3f553f0e
.long 0xbf80,0x3f353f35,0xbf800000,0x3f35bf35,0xbf35bf35,0x3f7bbe48,0xbec43f6d,0xbf0ebf55
.long 0xbf800000,0x3ec4bf6d,0x3f353f35,0xbf6d3ec4,0xbf353f35,0xbf0ebf55,0x3f6dbec4,0x3e483f7b
.long 0x3f80,0xbf800000,0xbf80,0x3f800000,0x3f353f35,0xbf0e3f55,0xbf6dbec4,0x3e48bf7b
.long 0x3f800000,0x3ec43f6d,0xbf353f35,0xbf6dbec4,0x3f35bf35,0x3f7b3e48,0x3ec43f6d,0xbf0e3f55
.long 0xbf80,0x3f35bf35,0x3f800000,0x3f353f35,0xbf35bf35,0xbe48bf7b,0x3ec4bf6d,0x3f55bf0e
.long 0xbf800000,0xbf6dbec4,0xbf35bf35,0xbec4bf6d,0xbf353f35,0xbf553f0e,0xbf6d3ec4,0xbf7b3e48
.long 0x3f80,0x3f80,0x3f80,0x3f80,0x3f800000,0x3f7bbe48,0x3f6dbec4,0x3f55bf0e
.long 0xbf80,0xbec4bf6d,0xbf35bf35,0xbf6dbec4,0xbf800000,0xbf553f0e,0xbec43f6d,0x3e483f7b
.long 0x3f80,0x3f353f35,0x3f800000,0x3f35bf35,0x3f800000,0x3f0ebf55,0xbec4bf6d,0xbf7bbe48
.long 0xbf80,0xbf6dbec4,0xbf353f35,0x3ec43f6d,0xbf800000,0xbe483f7b,0x3f6d3ec4,0x3f0ebf55
.long 0x3f80,0x3f800000,0xbf80,0xbf800000,0x3f800000,0xbe48bf7b,0xbf6d3ec4,0x3f0e3f55
.long 0xbf80,0xbf6d3ec4,0x3f353f35,0x3ec4bf6d,0xbf800000,0x3f0e3f55,0x3ec4bf6d,0xbf7b3e48
.long 0x3f80,0x3f35bf35,0xbf800000,0x3f353f35,0x3f800000,0xbf55bf0e,0x3ec43f6d,0x3e48bf7b
.long 0xbf80,0xbec43f6d,0x3f35bf35,0xbf6d3ec4,0xbf800000,0x3f7b3e48,0xbf6dbec4,0x3f553f0e
.long 0x3f80,0xbf80,0x3f80,0xbf80,0x3f800000,0xbf7b3e48,0x3f6dbec4,0xbf553f0e
.long 0xbf80,0x3ec43f6d,0xbf35bf35,0x3f6d3ec4,0xbf800000,0x3f55bf0e,0xbec43f6d,0xbe48bf7b
.long 0x3f80,0xbf35bf35,0x3f800000,0xbf353f35,0x3f800000,0xbf0e3f55,0xbec4bf6d,0x3f7b3e48
.long 0xbf80,0x3f6d3ec4,0xbf353f35,0xbec4bf6d,0xbf800000,0x3e48bf7b,0x3f6d3ec4,0xbf0e3f55
.long 0x3f80,0xbf800000,0xbf80,0x3f800000,0x3f800000,0x3e483f7b,0xbf6d3ec4,0xbf0ebf55
.long 0xbf80,0x3f6dbec4,0x3f353f35,0xbec43f6d,0xbf800000,0xbf0ebf55,0x3ec4bf6d,0x3f7bbe48
.long 0x3f80,0xbf353f35,0xbf800000,0xbf35bf35,0x3f800000,0x3f553f0e,0x3ec43f6d,0xbe483f7b
.long 0xbf80,0x3ec4bf6d,0x3f35bf35,0x3f6dbec4,0xbf800000,0xbf7bbe48,0xbf6dbec4,0xbf55bf0e
.long 0x3f80,0x3f80,0x3f80,0x3f80,0x3f35bf35,0x3f0ebf55,0x3ec4bf6d,0x3e48bf7b
.long 0xbf800000,0xbf6d3ec4,0xbf353f35,0xbec43f6d,0x3f353f35,0x3f7b3e48,0x3f6dbec4,0x3f0ebf55
.long 0xbf80,0xbf35bf35,0xbf800000,0xbf353f35,0xbf353f35,0x3e483f7b,0x3f6d3ec4,0x3f55bf0e
.long 0x3f800000,0x3ec4bf6d,0xbf35bf35,0xbf6d3ec4,0xbf35bf35,0xbf553f0e,0x3ec43f6d,0x3f7bbe48
.long 0x3f80,0x3f800000,0xbf80,0xbf800000,0x3f35bf35,0xbf55bf0e,0xbec43f6d,0x3f7b3e48
.long 0xbf800000,0x3ec43f6d,0x3f35bf35,0xbf6dbec4,0x3f353f35,0x3e48bf7b,0xbf6d3ec4,0x3f553f0e
.long 0xbf80,0xbf353f35,0x3f800000,0xbf35bf35,0xbf353f35,0x3f7bbe48,0xbf6dbec4,0x3f0e3f55
.long 0x3f800000,0xbf6dbec4,0x3f353f35,0xbec4bf6d,0xbf35bf35,0x3f0e3f55,0xbec4bf6d,0x3e483f7b
.long 0x3f80,0xbf80,0x3f80,0xbf80,0x3f35bf35,0xbf0e3f55,0x3ec4bf6d,0xbe483f7b
.long 0xbf800000,0x3f6dbec4,0xbf353f35,0x3ec4bf6d,0x3f353f35,0xbf7bbe48,0x3f6dbec4,0xbf0e3f55
.long 0xbf80,0x3f353f35,0xbf800000,0x3f35bf35,0xbf353f35,0xbe48bf7b,0x3f6d3ec4,0xbf553f0e
.long 0x3f800000,0xbec43f6d,0xbf35bf35,0x3f6dbec4,0xbf35bf35,0x3f55bf0e,0x3ec43f6d,0xbf7b3e48
.long 0x3f80,0xbf800000,0xbf80,0x3f800000,0x3f35bf35,0x3f553f0e,0xbec43f6d,0xbf7bbe48
.long 0xbf800000,0xbec4bf6d,0x3f35bf35,0x3f6d3ec4,0x3f353f35,0xbe483f7b,0xbf6d3ec4,0xbf55bf0e
.long 0xbf80,0x3f35bf35,0x3f800000,0x3f353f35,0xbf353f35,0xbf7b3e48,0xbf6dbec4,0xbf0ebf55
.long 0x3f800000,0x3f6d3ec4,0x3f353f35,0x3ec43f6d,0xbf35bf35,0xbf0ebf55,0xbec4bf6d,0xbe48bf7b
.long 0x3f80,0x3f80,0x3f80,0x3f80,0xbf80,0xbe48bf7b,0xbec4bf6d,0xbf0ebf55
.long 0x3f80,0x3ec43f6d,0x3f353f35,0x3f6d3ec4,0xbf80,0xbf0ebf55,0xbf6dbec4,0xbf7b3e48
.long 0x3f80,0x3f353f35,0x3f800000,0x3f35bf35,0xbf80,0xbf55bf0e,0xbf6d3ec4,0xbe483f7b
.long 0x3f80,0x3f6d3ec4,0x3f35bf35,0xbec4bf6d,0xbf80,0xbf7bbe48,0xbec43f6d,0x3f553f0e
.long 0x3f80,0x3f800000,0xbf80,0xbf800000,0xbf80,0xbf7b3e48,0x3ec43f6d,0x3f55bf0e
.long 0x3f80,0x3f6dbec4,0xbf35bf35,0xbec43f6d,0xbf80,0xbf553f0e,0x3f6d3ec4,0xbe48bf7b
.long 0x3f80,0x3f35bf35,0xbf800000,0x3f353f35,0xbf80,0xbf0e3f55,0x3f6dbec4,0xbf7bbe48
.long 0x3f80,0x3ec4bf6d,0xbf353f35,0x3f6dbec4,0xbf80,0xbe483f7b,0x3ec4bf6d,0xbf0e3f55
.long 0x3f80,0xbf80,0x3f80,0xbf80,0xbf80,0x3e483f7b,0xbec4bf6d,0x3f0e3f55
.long 0x3f80,0xbec4bf6d,0x3f353f35,0xbf6dbec4,0xbf80,0x3f0e3f55,0xbf6dbec4,0x3f7bbe48
.long 0x3f80,0xbf35bf35,0x3f800000,0xbf353f35,0xbf80,0x3f553f0e,0xbf6d3ec4,0x3e48bf7b
.long 0x3f80,0xbf6dbec4,0x3f35bf35,0x3ec43f6d,0xbf80,0x3f7b3e48,0xbec43f6d,0xbf55bf0e
.long 0x3f80,0xbf800000,0xbf80,0x3f800000,0xbf80,0x3f7bbe48,0x3ec43f6d,0xbf553f0e
.long 0x3f80,0xbf6d3ec4,0xbf35bf35,0x3ec4bf6d,0xbf80,0x3f55bf0e,0x3f6d3ec4,0x3e483f7b
.long 0x3f80,0xbf353f35,0xbf800000,0xbf35bf35,0xbf80,0x3f0ebf55,0x3f6dbec4,0x3f7b3e48
.long 0x3f80,0xbec43f6d,0xbf353f35,0xbf6d3ec4,0xbf80,0x3e48bf7b,0x3ec4bf6d,0x3f0ebf55
.long 0x3f80,0x3f80,0x3f80,0x3f80,0xbf35bf35,0xbf55bf0e,0xbf6dbec4,0xbf7bbe48
.long 0x3f800000,0x3f6dbec4,0x3f35bf35,0x3ec4bf6d,0xbf353f35,0xbe483f7b,0x3ec43f6d,0x3f553f0e
.long 0xbf80,0xbf35bf35,0xbf800000,0xbf353f35,0x3f353f35,0x3f7bbe48,0x3ec4bf6d,0xbf0ebf55
.long 0xbf800000,0xbec43f6d,0x3f353f35,0x3f6dbec4,0x3f35bf35,0xbf0ebf55,0xbf6d3ec4,0x3e483f7b
.long 0x3f80,0x3f800000,0xbf80,0xbf800000,0xbf35bf35,0xbf0e3f55,0x3f6d3ec4,0x3e48bf7b
.long 0x3f800000,0xbec4bf6d,0xbf353f35,0x3f6d3ec4,0xbf353f35,0x3f7b3e48,0xbec4bf6d,0xbf0e3f55
.long 0xbf80,0xbf353f35,0x3f800000,0xbf35bf35,0x3f353f35,0xbe48bf7b,0xbec43f6d,0x3f55bf0e
.long 0xbf800000,0x3f6d3ec4,0xbf35bf35,0x3ec43f6d,0x3f35bf35,0xbf553f0e,0x3f6dbec4,0xbf7b3e48
.long 0x3f80,0xbf80,0x3f80,0xbf80,0xbf35bf35,0x3f553f0e,0xbf6dbec4,0x3f7b3e48
.long 0x3f800000,0xbf6d3ec4,0x3f35bf35,0xbec43f6d,0xbf353f35,0x3e48bf7b,0x3ec43f6d,0xbf55bf0e
.long 0xbf80,0x3f353f35,0xbf800000,0x3f35bf35,0x3f353f35,0xbf7b3e48,0x3ec4bf6d,0x3f0e3f55
.long 0xbf800000,0x3ec4bf6d,0x3f353f35,0xbf6d3ec4,0x3f35bf35,0x3f0e3f55,0xbf6d3ec4,0xbe48bf7b
.long 0x3f80,0xbf800000,0xbf80,0x3f800000,0xbf35bf35,0x3f0ebf55,0x3f6d3ec4,0xbe483f7b
.long 0x3f800000,0x3ec43f6d,0xbf353f35,0xbf6dbec4,0xbf353f35,0xbf7bbe48,0xbec4bf6d,0x3f0ebf55
.long 0xbf80,0x3f35bf35,0x3f800000,0x3f353f35,0x3f353f35,0x3e483f7b,0xbec43f6d,0xbf553f0e
.long 0xbf800000,0xbf6dbec4,0xbf35bf35,0xbec4bf6d,0x3f35bf35,0x3f55bf0e,0x3f6dbec4,0x3f7bbe48
.long 0x3f80,0x3f80,0x3f80,0x3f80,0xbf800000,0xbf7b3e48,0xbf6d3ec4,0xbf553f0e
.long 0xbf80,0xbec4bf6d,0xbf35bf35,0xbf6dbec4,0x3f800000,0x3f55bf0e,0x3ec4bf6d,0xbe48bf7b
.long 0x3f80,0x3f353f35,0x3f800000,0x3f35bf35,0xbf800000,0xbf0e3f55,0x3ec43f6d,0x3f7b3e48
.long 0xbf80,0xbf6dbec4,0xbf353f35,0x3ec43f6d,0x3f800000,0x3e48bf7b,0xbf6dbec4,0xbf0e3f55
.long 0x3f80,0x3f800000,0xbf80,0xbf800000,0xbf800000,0x3e483f7b,0x3f6dbec4,0xbf0ebf55
.long 0xbf80,0xbf6d3ec4,0x3f353f35,0x3ec4bf6d,0x3f800000,0xbf0ebf55,0xbec43f6d,0x3f7bbe48
.long 0x3f80,0x3f35bf35,0xbf800000,0x3f353f35,0xbf800000,0x3f553f0e,0xbec4bf6d,0xbe483f7b
.long 0xbf80,0xbec43f6d,0x3f35bf35,0xbf6d3ec4,0x3f800000,0xbf7bbe48,0x3f6d3ec4,0xbf55bf0e
.long 0x3f80,0xbf80,0x3f80,0xbf80,0xbf800000,0x3f7bbe48,0xbf6d3ec4,0x3f55bf0e
.long 0xbf80,0x3ec43f6d,0xbf35bf35,0x3f6d3ec4,0x3f800000,0xbf553f0e,0x3ec4bf6d,0x3e483f7b
.long 0x3f80,0xbf35bf35,0x3f800000,0xbf353f35,0xbf800000,0x3f0ebf55,0x3ec43f6d,0xbf7bbe48
.long 0xbf80,0x3f6d3ec4,0xbf353f35,0xbec4bf6d,0x3f800000,0xbe483f7b,0xbf6dbec4,0x3f0ebf55
.long 0x3f80,0xbf800000,0xbf80,0x3f800000,0xbf800000,0xbe48bf7b,0x3f6dbec4,0x3f0e3f55
.long 0xbf80,0x3f6dbec4,0x3f353f35,0xbec43f6d,0x3f800000,0x3f0e3f55,0xbec43f6d,0xbf7b3e48
.long 0x3f80,0xbf353f35,0xbf800000,0xbf35bf35,0xbf800000,0xbf55bf0e,0xbec4bf6d,0x3e48bf7b
.long 0xbf80,0x3ec4bf6d,0x3f35bf35,0x3f6dbec4,0x3f800000,0x3f7b3e48,0x3f6d3ec4,0x3f553f0e
.long 0x3f80,0x3f80,0x3f80,0x3f80,0xbf353f35,0xbf0e3f55,0xbec43f6d,0xbe483f7b
.long 0xbf800000,0xbf6d3ec4,0xbf353f35,0xbec43f6d,0xbf35bf35,0xbf7bbe48,0xbf6d3ec4,0xbf0e3f55
.long 0xbf80,0xbf35bf35,0xbf800000,0xbf353f35,0x3f35bf35,0xbe48bf7b,0xbf6dbec4,0xbf553f0e
.long 0x3f800000,0x3ec4bf6d,0xbf35bf35,0xbf6d3ec4,0x3f353f35,0x3f55bf0e,0xbec4bf6d,0xbf7b3e48
.long 0x3f80,0x3f800000,0xbf80,0xbf800000,0xbf353f35,0x3f553f0e,0x3ec4bf6d,0xbf7bbe48
.long 0xbf800000,0x3ec43f6d,0x3f35bf35,0xbf6dbec4,0xbf35bf35,0xbe483f7b,0x3f6dbec4,0xbf55bf0e
.long 0xbf80,0xbf353f35,0x3f800000,0xbf35bf35,0x3f35bf35,0xbf7b3e48,0x3f6d3ec4,0xbf0ebf55
.long 0x3f800000,0xbf6dbec4,0x3f353f35,0xbec4bf6d,0x3f353f35,0xbf0ebf55,0x3ec43f6d,0xbe48bf7b
.long 0x3f80,0xbf80,0x3f80,0xbf80,0xbf353f35,0x3f0ebf55,0xbec43f6d,0x3e48bf7b
.long 0xbf800000,0x3f6dbec4,0xbf353f35,0x3ec4bf6d,0xbf35bf35,0x3f7b3e48,0xbf6d3ec4,0x3f0ebf55
.long 0xbf80,0x3f353f35,0xbf800000,0x3f35bf35,0x3f35bf35,0x3e483f7b,0xbf6dbec4,0x3f55bf0e
.long 0x3f800000,0xbec43f6d,0xbf35bf35,0x3f6dbec4,0x3f353f35,0xbf553f0e,0xbec4bf6d,0x3f7bbe48
.long 0x3f80,0xbf800000,0xbf80,0x3f800000,0xbf353f35,0xbf55bf0e,0x3ec4bf6d,0x3f7b3e48
.long 0xbf800000,0xbec4bf6d,0x3f35bf35,0x3f6d3ec4,0xbf35bf35,0x3e48bf7b,0x3f6dbec4,0x3f553f0e
.long 0xbf80,0x3f35bf35,0x3f800000,0x3f353f35,0x3f35bf35,0x3f7bbe48,0x3f6d3ec4,0x3f0e3f55
.long 0x3f800000,0x3f6d3ec4,0x3f353f35,0x3ec43f6d,0x3f353f35,0x3f0e3f55,0x3ec43f6d,0x3e483f7b
.long 0x3f808000,0x3f808000,0x3f808000,0x3f808000,0x3f808000,0x3f7bbe48,0x3f6dbec4,0x3f55bf0e
.long 0x3f808000,0x3f6dbec4,0x3f35bf35,0x3ec4bf6d,0x3f808000,0x3f55bf0e,0x3ec4bf6d,0xbe48bf7b
.long 0x3f808000,0x3f35bf35,0xbf80,0xbf35bf35,0x3f808000,0x3f0ebf55,0xbec4bf6d,0xbf7bbe48
.long 0x3f808000,0x3ec4bf6d,0xbf35bf35,0xbf6d3ec4,0x3f808000,0x3e48bf7b,0xbf6dbec4,0xbf0e3f55
.long 0x3f808000,0xbf80,0xbf808000,0x3f80,0x3f808000,0xbe48bf7b,0xbf6d3ec4,0x3f0e3f55
.long 0x3f808000,0xbec4bf6d,0xbf353f35,0x3f6d3ec4,0x3f808000,0xbf0ebf55,0xbec43f6d,0x3f7bbe48
.long 0x3f808000,0xbf35bf35,0x3f80,0x3f35bf35,0x3f808000,0xbf55bf0e,0x3ec43f6d,0x3e48bf7b
.long 0x3f808000,0xbf6dbec4,0x3f353f35,0xbec4bf6d,0x3f808000,0xbf7bbe48,0x3f6d3ec4,0xbf55bf0e
.long 0x3f808000,0xbf808000,0x3f808000,0xbf808000,0x3f808000,0xbf7b3e48,0x3f6dbec4,0xbf553f0e
.long 0x3f808000,0xbf6d3ec4,0x3f35bf35,0xbec43f6d,0x3f808000,0xbf553f0e,0x3ec4bf6d,0x3e483f7b
.long 0x3f808000,0xbf353f35,0xbf80,0x3f353f35,0x3f808000,0xbf0e3f55,0xbec4bf6d,0x3f7b3e48
.long 0x3f808000,0xbec43f6d,0xbf35bf35,0x3f6dbec4,0x3f808000,0xbe483f7b,0xbf6dbec4,0x3f0ebf55
.long 0x3f808000,0x3f80,0xbf808000,0xbf80,0x3f808000,0x3e483f7b,0xbf6d3ec4,0xbf0ebf55
.long 0x3f808000,0x3ec43f6d,0xbf353f35,0xbf6dbec4,0x3f808000,0x3f0e3f55,0xbec43f6d,0xbf7b3e48
.long 0x3f808000,0x3f353f35,0x3f80,0xbf353f35,0x3f808000,0x3f553f0e,0x3ec43f6d,0xbe483f7b
.long 0x3f808000,0x3f6d3ec4,0x3f353f35,0x3ec43f6d,0x3f808000,0x3f7b3e48,0x3f6d3ec4,0x3f553f0e
.long 0x3f808000,0x3f808000,0x3f808000,0x3f808000,0x3f35bf35,0x3f0ebf55,0x3ec4bf6d,0x3e48bf7b
.long 0xbf80,0xbec4bf6d,0xbf35bf35,0xbf6dbec4,0xbf35bf35,0xbf7bbe48,0xbf6d3ec4,0xbf0e3f55
.long 0xbf808000,0xbf353f35,0x3f80,0x3f353f35,0xbf353f35,0x3e483f7b,0x3f6d3ec4,0x3f55bf0e
.long 0x3f80,0x3f6d3ec4,0x3f35bf35,0xbec4bf6d,0x3f353f35,0x3f55bf0e,0xbec4bf6d,0xbf7b3e48
.long 0x3f808000,0xbf80,0xbf808000,0x3f80,0x3f35bf35,0xbf55bf0e,0xbec43f6d,0x3f7b3e48
.long 0xbf80,0xbf6d3ec4,0x3f353f35,0x3ec4bf6d,0xbf35bf35,0xbe483f7b,0x3f6dbec4,0xbf55bf0e
.long 0xbf808000,0x3f353f35,0xbf80,0xbf353f35,0xbf353f35,0x3f7bbe48,0xbf6dbec4,0x3f0e3f55
.long 0x3f80,0x3ec4bf6d,0xbf353f35,0x3f6dbec4,0x3f353f35,0xbf0ebf55,0x3ec43f6d,0xbe48bf7b
.long 0x3f808000,0xbf808000,0x3f808000,0xbf808000,0x3f35bf35,0xbf0e3f55,0x3ec4bf6d,0xbe483f7b
.long 0xbf80,0x3ec43f6d,0xbf35bf35,0x3f6d3ec4,0xbf35bf35,0x3f7b3e48,0xbf6d3ec4,0x3f0ebf55
.long 0xbf808000,0x3f35bf35,0x3f80,0xbf35bf35,0xbf353f35,0xbe48bf7b,0x3f6d3ec4,0xbf553f0e
.long 0x3f80,0xbf6dbec4,0x3f35bf35,0x3ec43f6d,0x3f353f35,0xbf553f0e,0xbec4bf6d,0x3f7bbe48
.long 0x3f808000,0x3f80,0xbf808000,0xbf80,0x3f35bf35,0x3f553f0e,0xbec43f6d,0xbf7bbe48
.long 0xbf80,0x3f6dbec4,0x3f353f35,0xbec43f6d,0xbf35bf35,0x3e48bf7b,0x3f6dbec4,0x3f553f0e
.long 0xbf808000,0xbf35bf35,0xbf80,0x3f35bf35,0xbf353f35,0xbf7b3e48,0xbf6dbec4,0xbf0ebf55
.long 0x3f80,0xbec43f6d,0xbf353f35,0xbf6d3ec4,0x3f353f35,0x3f0e3f55,0x3ec43f6d,0x3e483f7b
.long 0x3f808000,0x3f808000,0x3f808000,0x3f808000,0xbf80,0xbe48bf7b,0xbec4bf6d,0xbf0ebf55
.long 0xbf808000,0xbf6d3ec4,0xbf353f35,0xbec43f6d,0x3f80,0x3f0e3f55,0x3f6d3ec4,0x3f7bbe48
.long 0x3f808000,0x3f35bf35,0xbf80,0xbf35bf35,0xbf80,0xbf55bf0e,0xbf6d3ec4,0xbe483f7b
.long 0xbf808000,0xbec43f6d,0x3f353f35,0x3f6dbec4,0x3f80,0x3f7b3e48,0x3ec4bf6d,0xbf55bf0e
.long 0x3f808000,0xbf80,0xbf808000,0x3f80,0xbf80,0xbf7b3e48,0x3ec43f6d,0x3f55bf0e
.long 0xbf808000,0x3ec43f6d,0x3f35bf35,0xbf6dbec4,0x3f80,0x3f55bf0e,0xbf6dbec4,0x3e483f7b
.long 0x3f808000,0xbf35bf35,0x3f80,0x3f35bf35,0xbf80,0xbf0e3f55,0x3f6dbec4,0xbf7bbe48
.long 0xbf808000,0x3f6d3ec4,0xbf35bf35,0x3ec43f6d,0x3f80,0x3e48bf7b,0xbec43f6d,0x3f0ebf55
.long 0x3f808000,0xbf808000,0x3f808000,0xbf808000,0xbf80,0x3e483f7b,0xbec4bf6d,0x3f0e3f55
.long 0xbf808000,0x3f6dbec4,0xbf353f35,0x3ec4bf6d,0x3f80,0xbf0ebf55,0x3f6d3ec4,0xbf7b3e48
.long 0x3f808000,0xbf353f35,0xbf80,0x3f353f35,0xbf80,0x3f553f0e,0xbf6d3ec4,0x3e48bf7b
.long 0xbf808000,0x3ec4bf6d,0x3f353f35,0xbf6d3ec4,0x3f80,0xbf7bbe48,0x3ec4bf6d,0x3f553f0e
.long 0x3f808000,0x3f80,0xbf808000,0xbf80,0xbf80,0x3f7bbe48,0x3ec43f6d,0xbf553f0e
.long 0xbf808000,0xbec4bf6d,0x3f35bf35,0x3f6d3ec4,0x3f80,0xbf553f0e,0xbf6dbec4,0xbe48bf7b
.long 0x3f808000,0x3f353f35,0x3f80,0xbf353f35,0xbf80,0x3f0ebf55,0x3f6dbec4,0x3f7b3e48
.long 0xbf808000,0xbf6dbec4,0xbf35bf35,0xbec4bf6d,0x3f80,0xbe483f7b,0xbec43f6d,0xbf0e3f55
.long 0x3f808000,0x3f808000,0x3f808000,0x3f808000,0xbf35bf35,0xbf55bf0e,0xbf6dbec4,0xbf7bbe48
.long 0x3f80,0x3ec43f6d,0x3f353f35,0x3f6d3ec4,0x3f35bf35,0x3e48bf7b,0xbec4bf6d,0xbf55bf0e
.long 0xbf808000,0xbf353f35,0x3f80,0x3f353f35,0x3f353f35,0x3f7bbe48,0x3ec4bf6d,0xbf0ebf55
.long 0xbf80,0xbf6dbec4,0xbf353f35,0x3ec43f6d,0xbf353f35,0x3f0e3f55,0x3f6dbec4,0xbe48bf7b
.long 0x3f808000,0xbf80,0xbf808000,0x3f80,0xbf35bf35,0xbf0e3f55,0x3f6d3ec4,0x3e48bf7b
.long 0x3f80,0x3f6dbec4,0xbf35bf35,0xbec43f6d,0x3f35bf35,0xbf7bbe48,0x3ec43f6d,0x3f0ebf55
.long 0xbf808000,0x3f353f35,0xbf80,0xbf353f35,0x3f353f35,0xbe48bf7b,0xbec43f6d,0x3f55bf0e
.long 0xbf80,0xbec43f6d,0x3f35bf35,0xbf6d3ec4,0xbf353f35,0x3f55bf0e,0xbf6d3ec4,0x3f7bbe48
.long 0x3f808000,0xbf808000,0x3f808000,0xbf808000,0xbf35bf35,0x3f553f0e,0xbf6dbec4,0x3f7b3e48
.long 0x3f80,0xbec4bf6d,0x3f353f35,0xbf6dbec4,0x3f35bf35,0xbe483f7b,0xbec4bf6d,0x3f553f0e
.long 0xbf808000,0x3f35bf35,0x3f80,0xbf35bf35,0x3f353f35,0xbf7b3e48,0x3ec4bf6d,0x3f0e3f55
.long 0xbf80,0x3f6d3ec4,0xbf353f35,0xbec4bf6d,0xbf353f35,0xbf0ebf55,0x3f6dbec4,0x3e483f7b
.long 0x3f808000,0x3f80,0xbf808000,0xbf80,0xbf35bf35,0x3f0ebf55,0x3f6d3ec4,0xbe483f7b
.long 0x3f80,0xbf6d3ec4,0xbf35bf35,0x3ec4bf6d,0x3f35bf35,0x3f7b3e48,0x3ec43f6d,0xbf0e3f55
.long 0xbf808000,0xbf35bf35,0xbf80,0x3f35bf35,0x3f353f35,0x3e483f7b,0xbec43f6d,0xbf553f0e
.long 0xbf80,0x3ec4bf6d,0x3f35bf35,0x3f6dbec4,0xbf353f35,0xbf553f0e,0xbf6d3ec4,0xbf7b3e48
.long 0x3f808000,0x3f808000,0x3f808000,0x3f808000,0xbf808000,0xbf7b3e48,0xbf6d3ec4,0xbf553f0e
.long 0x3f808000,0x3f6dbec4,0x3f35bf35,0x3ec4bf6d,0xbf808000,0xbf553f0e,0xbec43f6d,0x3e483f7b
.long 0x3f808000,0x3f35bf35,0xbf80,0xbf35bf35,0xbf808000,0xbf0e3f55,0x3ec43f6d,0x3f7b3e48
.long 0x3f808000,0x3ec4bf6d,0xbf35bf35,0xbf6d3ec4,0xbf808000,0xbe483f7b,0x3f6d3ec4,0x3f0ebf55
.long 0x3f808000,0xbf80,0xbf808000,0x3f80,0xbf808000,0x3e483f7b,0x3f6dbec4,0xbf0ebf55
.long 0x3f808000,0xbec4bf6d,0xbf353f35,0x3f6d3ec4,0xbf808000,0x3f0e3f55,0x3ec4bf6d,0xbf7b3e48
.long 0x3f808000,0xbf35bf35,0x3f80,0x3f35bf35,0xbf808000,0x3f553f0e,0xbec4bf6d,0xbe483f7b
.long 0x3f808000,0xbf6dbec4,0x3f353f35,0xbec4bf6d,0xbf808000,0x3f7b3e48,0xbf6dbec4,0x3f553f0e
.long 0x3f808000,0xbf808000,0x3f808000,0xbf808000,0xbf808000,0x3f7bbe48,0xbf6d3ec4,0x3f55bf0e
.long 0x3f808000,0xbf6d3ec4,0x3f35bf35,0xbec43f6d,0xbf808000,0x3f55bf0e,0xbec43f6d,0xbe48bf7b
.long 0x3f808000,0xbf353f35,0xbf80,0x3f353f35,0xbf808000,0x3f0ebf55,0x3ec43f6d,0xbf7bbe48
.long 0x3f808000,0xbec43f6d,0xbf35bf35,0x3f6dbec4,0xbf808000,0x3e48bf7b,0x3f6d3ec4,0xbf0e3f55
.long 0x3f808000,0x3f80,0xbf808000,0xbf80,0xbf808000,0xbe48bf7b,0x3f6dbec4,0x3f0e3f55
.long 0x3f808000,0x3ec43f6d,0xbf353f35,0xbf6dbec4,0xbf808000,0xbf0ebf55,0x3ec4bf6d,0x3f7bbe48
.long 0x3f808000,0x3f353f35,0x3f80,0xbf353f35,0xbf808000,0xbf55bf0e,0xbec4bf6d,0x3e48bf7b
.long 0x3f808000,0x3f6d3ec4,0x3f353f35,0x3ec43f6d,0xbf808000,0xbf7bbe48,0xbf6dbec4,0xbf55bf0e
.long 0x3f808000,0x3f808000,0x3f808000,0x3f808000,0xbf353f35,0xbf0e3f55,0xbec43f6d,0xbe483f7b
.long 0xbf80,0xbec4bf6d,0xbf35bf35,0xbf6dbec4,0x3f353f35,0x3f7b3e48,0x3f6dbec4,0x3f0ebf55
.long 0xbf808000,0xbf353f35,0x3f80,0x3f353f35,0x3f35bf35,0xbe48bf7b,0xbf6dbec4,0xbf553f0e
.long 0x3f80,0x3f6d3ec4,0x3f35bf35,0xbec4bf6d,0xbf35bf35,0xbf553f0e,0x3ec43f6d,0x3f7bbe48
.long 0x3f808000,0xbf80,0xbf808000,0x3f80,0xbf353f35,0x3f553f0e,0x3ec4bf6d,0xbf7bbe48
.long 0xbf80,0xbf6d3ec4,0x3f353f35,0x3ec4bf6d,0x3f353f35,0x3e48bf7b,0xbf6d3ec4,0x3f553f0e
.long 0xbf808000,0x3f353f35,0xbf80,0xbf353f35,0x3f35bf35,0xbf7b3e48,0x3f6d3ec4,0xbf0ebf55
.long 0x3f80,0x3ec4bf6d,0xbf353f35,0x3f6dbec4,0xbf35bf35,0x3f0e3f55,0xbec4bf6d,0x3e483f7b
.long 0x3f808000,0xbf808000,0x3f808000,0xbf808000,0xbf353f35,0x3f0ebf55,0xbec43f6d,0x3e48bf7b
.long 0xbf80,0x3ec43f6d,0xbf35bf35,0x3f6d3ec4,0x3f353f35,0xbf7bbe48,0x3f6dbec4,0xbf0e3f55
.long 0xbf808000,0x3f35bf35,0x3f80,0xbf35bf35,0x3f35bf35,0x3e483f7b,0xbf6dbec4,0x3f55bf0e
.long 0x3f80,0xbf6dbec4,0x3f35bf35,0x3ec43f6d,0xbf35bf35,0x3f55bf0e,0x3ec43f6d,0xbf7b3e48
.long 0x3f808000,0x3f80,0xbf808000,0xbf80,0xbf353f35,0xbf55bf0e,0x3ec4bf6d,0x3f7b3e48
.long 0xbf80,0x3f6dbec4,0x3f353f35,0xbec43f6d,0x3f353f35,0xbe483f7b,0xbf6d3ec4,0xbf55bf0e
.long 0xbf808000,0xbf35bf35,0xbf80,0x3f35bf35,0x3f35bf35,0x3f7bbe48,0x3f6d3ec4,0x3f0e3f55
.long 0x3f80,0xbec43f6d,0xbf353f35,0xbf6d3ec4,0xbf35bf35,0xbf0ebf55,0xbec4bf6d,0xbe48bf7b
.long 0x3f808000,0x3f808000,0x3f808000,0x3f808000,0x3f80,0x3e483f7b,0x3ec43f6d,0x3f0e3f55
.long 0xbf808000,0xbf6d3ec4,0xbf353f35,0xbec43f6d,0xbf80,0xbf0ebf55,0xbf6dbec4,0xbf7b3e48
.long 0x3f808000,0x3f35bf35,0xbf80,0xbf35bf35,0x3f80,0x3f553f0e,0x3f6dbec4,0x3e48bf7b
.long 0xbf808000,0xbec43f6d,0x3f353f35,0x3f6dbec4,0xbf80,0xbf7bbe48,0xbec43f6d,0x3f553f0e
.long 0x3f808000,0xbf80,0xbf808000,0x3f80,0x3f80,0x3f7bbe48,0xbec4bf6d,0xbf553f0e
.long 0xbf808000,0x3ec43f6d,0x3f35bf35,0xbf6dbec4,0xbf80,0xbf553f0e,0x3f6d3ec4,0xbe48bf7b
.long 0x3f808000,0xbf35bf35,0x3f80,0x3f35bf35,0x3f80,0x3f0ebf55,0xbf6d3ec4,0x3f7b3e48
.long 0xbf808000,0x3f6d3ec4,0xbf35bf35,0x3ec43f6d,0xbf80,0xbe483f7b,0x3ec4bf6d,0xbf0e3f55
.long 0x3f808000,0xbf808000,0x3f808000,0xbf808000,0x3f80,0xbe48bf7b,0x3ec43f6d,0xbf0ebf55
.long 0xbf808000,0x3f6dbec4,0xbf353f35,0x3ec4bf6d,0xbf80,0x3f0e3f55,0xbf6dbec4,0x3f7bbe48
.long 0x3f808000,0xbf353f35,0xbf80,0x3f353f35,0x3f80,0xbf55bf0e,0x3f6dbec4,0xbe483f7b
.long 0xbf808000,0x3ec4bf6d,0x3f353f35,0xbf6d3ec4,0xbf80,0x3f7b3e48,0xbec43f6d,0xbf55bf0e
.long 0x3f808000,0x3f80,0xbf808000,0xbf80,0x3f80,0xbf7b3e48,0xbec4bf6d,0x3f55bf0e
.long 0xbf808000,0xbec4bf6d,0x3f35bf35,0x3f6d3ec4,0xbf80,0x3f55bf0e,0x3f6d3ec4,0x3e483f7b
.long 0x3f808000,0x3f353f35,0x3f80,0xbf353f35,0x3f80,0xbf0e3f55,0xbf6d3ec4,0xbf7bbe48
.long 0xbf808000,0xbf6dbec4,0xbf35bf35,0xbec4bf6d,0xbf80,0x3e48bf7b,0x3ec4bf6d,0x3f0ebf55
.long 0x3f808000,0x3f808000,0x3f808000,0x3f808000,0x3f353f35,0x3f553f0e,0x3f6d3ec4,0x3f7b3e48
.long 0x3f80,0x3ec43f6d,0x3f353f35,0x3f6d3ec4,0xbf353f35,0xbe483f7b,0x3ec43f6d,0x3f553f0e
.long 0xbf808000,0xbf353f35,0x3f80,0x3f353f35,0xbf35bf35,0xbf7b3e48,0xbec43f6d,0x3f0e3f55
.long 0xbf80,0xbf6dbec4,0xbf353f35,0x3ec43f6d,0x3f35bf35,0xbf0ebf55,0xbf6d3ec4,0x3e483f7b
.long 0x3f808000,0xbf80,0xbf808000,0x3f80,0x3f353f35,0x3f0ebf55,0xbf6dbec4,0xbe483f7b
.long 0x3f80,0x3f6dbec4,0xbf35bf35,0xbec43f6d,0xbf353f35,0x3f7b3e48,0xbec4bf6d,0xbf0e3f55
.long 0xbf808000,0x3f353f35,0xbf80,0xbf353f35,0xbf35bf35,0x3e483f7b,0x3ec4bf6d,0xbf553f0e
.long 0xbf80,0xbec43f6d,0x3f35bf35,0xbf6d3ec4,0x3f35bf35,0xbf553f0e,0x3f6dbec4,0xbf7b3e48
.long 0x3f808000,0xbf808000,0x3f808000,0xbf808000,0x3f353f35,0xbf55bf0e,0x3f6d3ec4,0xbf7bbe48
.long 0x3f80,0xbec4bf6d,0x3f353f35,0xbf6dbec4,0xbf353f35,0x3e48bf7b,0x3ec43f6d,0xbf55bf0e
.long 0xbf808000,0x3f35bf35,0x3f80,0xbf35bf35,0xbf35bf35,0x3f7bbe48,0xbec43f6d,0xbf0ebf55
.long 0xbf80,0x3f6d3ec4,0xbf353f35,0xbec4bf6d,0x3f35bf35,0x3f0e3f55,0xbf6d3ec4,0xbe48bf7b
.long 0x3f808000,0x3f80,0xbf808000,0xbf80,0x3f353f35,0xbf0e3f55,0xbf6dbec4,0x3e48bf7b
.long 0x3f80,0xbf6d3ec4,0xbf35bf35,0x3ec4bf6d,0xbf353f35,0xbf7bbe48,0xbec4bf6d,0x3f0ebf55
.long 0xbf808000,0xbf35bf35,0xbf80,0x3f35bf35,0xbf35bf35,0xbe48bf7b,0x3ec4bf6d,0x3f55bf0e
.long 0xbf80,0x3ec4bf6d,0x3f35bf35,0x3f6dbec4,0x3f35bf35,0x3f55bf0e,0x3f6dbec4,0x3f7bbe48
.long 0x3f80,0x3dc93f7f,0x3e483f7b,0x3e953f75,0x3f80,0x3e953f75,0x3f0e3f55,0x3f463f22
.long 0x3f80,0x3ef13f62,0x3f553f0e,0x3f7f3dc9,0x3f80,0x3f223f46,0x3f7b3e48,0x3f62bef1
.long 0x3f80,0x3f463f22,0x3f7bbe48,0x3ef1bf62,0x3f80,0x3f623ef1,0x3f55bf0e,0xbdc9bf7f
.long 0x3f80,0x3f753e95,0x3f0ebf55,0xbf22bf46,0x3f80,0x3f7f3dc9,0x3e48bf7b,0xbf75be95
.long 0x3f80,0x3f7fbdc9,0xbe48bf7b,0xbf753e95,0x3f80,0x3f75be95,0xbf0ebf55,0xbf223f46
.long 0x3f80,0x3f62bef1,0xbf55bf0e,0xbdc93f7f,0x3f80,0x3f46bf22,0xbf7bbe48,0x3ef13f62
.long 0x3f80,0x3f22bf46,0xbf7b3e48,0x3f623ef1,0x3f80,0x3ef1bf62,0xbf553f0e,0x3f7fbdc9
.long 0x3f80,0x3e95bf75,0xbf0e3f55,0x3f46bf22,0x3f80,0x3dc9bf7f,0xbe483f7b,0x3e95bf75
.long 0x3f80,0xbdc9bf7f,0x3e483f7b,0xbe95bf75,0x3f80,0xbe95bf75,0x3f0e3f55,0xbf46bf22
.long 0x3f80,0xbef1bf62,0x3f553f0e,0xbf7fbdc9,0x3f80,0xbf22bf46,0x3f7b3e48,0xbf623ef1
.long 0x3f80,0xbf46bf22,0x3f7bbe48,0xbef13f62,0x3f80,0xbf62bef1,0x3f55bf0e,0x3dc93f7f
.long 0x3f80,0xbf75be95,0x3f0ebf55,0x3f223f46,0x3f80,0xbf7fbdc9,0x3e48bf7b,0x3f753e95
.long 0x3f80,0xbf7f3dc9,0xbe48bf7b,0x3f75be95,0x3f80,0xbf753e95,0xbf0ebf55,0x3f22bf46
.long 0x3f80,0xbf623ef1,0xbf55bf0e,0x3dc9bf7f,0x3f80,0xbf463f22,0xbf7bbe48,0xbef1bf62
.long 0x3f80,0xbf223f46,0xbf7b3e48,0xbf62bef1,0x3f80,0xbef13f62,0xbf553f0e,0xbf7f3dc9
.long 0x3f80,0xbe953f75,0xbf0e3f55,0xbf463f22,0x3f80,0xbdc93f7f,0xbe483f7b,0xbe953f75
.long 0x3ec43f6d,0x3ef13f62,0x3f0e3f55,0x3f223f46,0x3f6d3ec4,0x3f7f3dc9,0x3f7bbe48,0x3f62bef1
.long 0x3f6dbec4,0x3f22bf46,0x3e48bf7b,0xbe95bf75,0x3ec4bf6d,0xbe95bf75,0xbf55bf0e,0xbf7f3dc9
.long 0xbec4bf6d,0xbf75be95,0xbf553f0e,0xbdc93f7f,0xbf6dbec4,0xbf463f22,0x3e483f7b,0x3f753e95
.long 0xbf6d3ec4,0x3dc93f7f,0x3f7b3e48,0x3ef1bf62,0xbec43f6d,0x3f623ef1,0x3f0ebf55,0xbf46bf22
.long 0x3ec43f6d,0x3f62bef1,0xbf0ebf55,0xbf463f22,0x3f6d3ec4,0x3dc9bf7f,0xbf7b3e48,0x3ef13f62
.long 0x3f6dbec4,0xbf46bf22,0xbe483f7b,0x3f75be95,0x3ec4bf6d,0xbf753e95,0x3f553f0e,0xbdc9bf7f
.long 0xbec4bf6d,0xbe953f75,0x3f55bf0e,0xbf7fbdc9,0xbf6dbec4,0x3f223f46,0xbe48bf7b,0xbe953f75
.long 0xbf6d3ec4,0x3f7fbdc9,0xbf7bbe48,0x3f623ef1,0xbec43f6d,0x3ef1bf62,0xbf0e3f55,0x3f22bf46
.long 0x3ec43f6d,0xbef1bf62,0x3f0e3f55,0xbf22bf46,0x3f6d3ec4,0xbf7fbdc9,0x3f7bbe48,0xbf623ef1
.long 0x3f6dbec4,0xbf223f46,0x3e48bf7b,0x3e953f75,0x3ec4bf6d,0x3e953f75,0xbf55bf0e,0x3f7fbdc9
.long 0xbec4bf6d,0x3f753e95,0xbf553f0e,0x3dc9bf7f,0xbf6dbec4,0x3f46bf22,0x3e483f7b,0xbf75be95
.long 0xbf6d3ec4,0xbdc9bf7f,0x3f7b3e48,0xbef13f62,0xbec43f6d,0xbf62bef1,0x3f0ebf55,0x3f463f22
.long 0x3ec43f6d,0xbf623ef1,0xbf0ebf55,0x3f46bf22,0x3f6d3ec4,0xbdc93f7f,0xbf7b3e48,0xbef1bf62
.long 0x3f6dbec4,0x3f463f22,0xbe483f7b,0xbf753e95,0x3ec4bf6d,0x3f75be95,0x3f553f0e,0x3dc93f7f
.long 0xbec4bf6d,0x3e95bf75,0x3f55bf0e,0x3f7f3dc9,0xbf6dbec4,0xbf22bf46,0xbe48bf7b,0x3e95bf75
.long 0xbf6d3ec4,0xbf7f3dc9,0xbf7bbe48,0xbf62bef1,0xbec43f6d,0xbef13f62,0xbf0e3f55,0xbf223f46
.long 0x3f353f35,0x3f463f22,0x3f553f0e,0x3f623ef1,0x3f35bf35,0x3ef1bf62,0x3e48bf7b,0xbdc9bf7f
.long 0xbf35bf35,0xbf75be95,0xbf7b3e48,0xbf463f22,0xbf353f35,0xbdc93f7f,0x3f0e3f55,0x3f753e95
.long 0x3f353f35,0x3f7fbdc9,0x3f0ebf55,0xbe95bf75,0x3f35bf35,0xbe95bf75,0xbf7bbe48,0xbf223f46
.long 0xbf35bf35,0xbf623ef1,0x3e483f7b,0x3f7f3dc9,0xbf353f35,0x3f223f46,0x3f55bf0e,0xbef1bf62
.long 0x3f353f35,0x3f22bf46,0xbf55bf0e,0xbef13f62,0x3f35bf35,0xbf62bef1,0xbe483f7b,0x3f7fbdc9
.long 0xbf35bf35,0xbe953f75,0x3f7bbe48,0xbf22bf46,0xbf353f35,0x3f7f3dc9,0xbf0ebf55,0xbe953f75
.long 0x3f353f35,0xbdc9bf7f,0xbf0e3f55,0x3f75be95,0x3f35bf35,0xbf753e95,0x3f7b3e48,0xbf46bf22
.long 0xbf35bf35,0x3ef13f62,0xbe48bf7b,0xbdc93f7f,0xbf353f35,0x3f46bf22,0xbf553f0e,0x3f62bef1
.long 0x3f353f35,0xbf46bf22,0x3f553f0e,0xbf62bef1,0x3f35bf35,0xbef13f62,0x3e48bf7b,0x3dc93f7f
.long 0xbf35bf35,0x3f753e95,0xbf7b3e48,0x3f46bf22,0xbf353f35,0x3dc9bf7f,0x3f0e3f55,0xbf75be95
.long 0x3f353f35,0xbf7f3dc9,0x3f0ebf55,0x3e953f75,0x3f35bf35,0x3e953f75,0xbf7bbe48,0x3f22bf46
.long 0xbf35bf35,0x3f62bef1,0x3e483f7b,0xbf7fbdc9,0xbf353f35,0xbf22bf46,0x3f55bf0e,0x3ef13f62
.long 0x3f353f35,0xbf223f46,0xbf55bf0e,0x3ef1bf62,0x3f35bf35,0x3f623ef1,0xbe483f7b,0xbf7f3dc9
.long 0xbf35bf35,0x3e95bf75,0x3f7bbe48,0x3f223f46,0xbf353f35,0xbf7fbdc9,0xbf0ebf55,0x3e95bf75
.long 0x3f353f35,0x3dc93f7f,0xbf0e3f55,0xbf753e95,0x3f35bf35,0x3f75be95,0x3f7b3e48,0x3f463f22
.long 0xbf35bf35,0xbef1bf62,0xbe48bf7b,0x3dc9bf7f,0xbf353f35,0xbf463f22,0xbf553f0e,0xbf623ef1
.long 0x3f6d3ec4,0x3f753e95,0x3f7b3e48,0x3f7f3dc9,0xbec4bf6d,0xbf22bf46,0xbf55bf0e,0xbf75be95
.long 0xbec43f6d,0x3dc93f7f,0x3f0e3f55,0x3f623ef1,0x3f6dbec4,0x3ef1bf62,0xbe48bf7b,0xbf46bf22
.long 0xbf6dbec4,0xbf623ef1,0xbe483f7b,0x3f223f46,0x3ec43f6d,0x3f7f3dc9,0x3f0ebf55,0xbef1bf62
.long 0x3ec4bf6d,0xbf46bf22,0xbf553f0e,0x3e953f75,0xbf6d3ec4,0x3e953f75,0x3f7bbe48,0xbdc9bf7f
.long 0x3f6d3ec4,0x3e95bf75,0xbf7bbe48,0xbdc93f7f,0xbec4bf6d,0xbf463f22,0x3f553f0e,0x3e95bf75
.long 0xbec43f6d,0x3f7fbdc9,0xbf0ebf55,0xbef13f62,0x3f6dbec4,0xbf62bef1,0x3e483f7b,0x3f22bf46
.long 0xbf6dbec4,0x3ef13f62,0x3e48bf7b,0xbf463f22,0x3ec43f6d,0x3dc9bf7f,0xbf0e3f55,0x3f62bef1
.long 0x3ec4bf6d,0xbf223f46,0x3f55bf0e,0xbf753e95,0xbf6d3ec4,0x3f75be95,0xbf7b3e48,0x3f7fbdc9
.long 0x3f6d3ec4,0xbf75be95,0x3f7b3e48,0xbf7fbdc9,0xbec4bf6d,0x3f223f46,0xbf55bf0e,0x3f753e95
.long 0xbec43f6d,0xbdc9bf7f,0x3f0e3f55,0xbf62bef1,0x3f6dbec4,0xbef13f62,0xbe48bf7b,0x3f463f22
.long 0xbf6dbec4,0x3f62bef1,0xbe483f7b,0xbf22bf46,0x3ec43f6d,0xbf7fbdc9,0x3f0ebf55,0x3ef13f62
.long 0x3ec4bf6d,0x3f463f22,0xbf553f0e,0xbe95bf75,0xbf6d3ec4,0xbe95bf75,0x3f7bbe48,0x3dc93f7f
.long 0x3f6d3ec4,0xbe953f75,0xbf7bbe48,0x3dc9bf7f,0xbec4bf6d,0x3f46bf22,0x3f553f0e,0xbe953f75
.long 0xbec43f6d,0xbf7f3dc9,0xbf0ebf55,0x3ef1bf62,0x3f6dbec4,0x3f623ef1,0x3e483f7b,0xbf223f46
.long 0xbf6dbec4,0xbef1bf62,0x3e48bf7b,0x3f46bf22,0x3ec43f6d,0xbdc93f7f,0xbf0e3f55,0xbf623ef1
.long 0x3ec4bf6d,0x3f22bf46,0x3f55bf0e,0x3f75be95,0xbf6d3ec4,0xbf753e95,0xbf7b3e48,0xbf7f3dc9
.long 0x3f800000,0x3f7fbdc9,0x3f7bbe48,0x3f75be95,0xbf800000,0xbf753e95,0xbf553f0e,0xbf223f46
.long 0x3f800000,0x3f62bef1,0x3f0ebf55,0x3dc9bf7f,0xbf800000,0xbf463f22,0xbe483f7b,0x3ef13f62
.long 0x3f800000,0x3f22bf46,0xbe48bf7b,0xbf62bef1,0xbf800000,0xbef13f62,0x3f0e3f55,0x3f7fbdc9
.long 0x3f800000,0x3e95bf75,0xbf55bf0e,0xbf463f22,0xbf800000,0xbdc93f7f,0x3f7b3e48,0x3e95bf75
.long 0x3f800000,0xbdc9bf7f,0xbf7b3e48,0x3e953f75,0xbf800000,0x3e953f75,0x3f55bf0e,0xbf46bf22
.long 0x3f800000,0xbef1bf62,0xbf0e3f55,0x3f7f3dc9,0xbf800000,0x3f223f46,0x3e48bf7b,0xbf623ef1
.long 0x3f800000,0xbf46bf22,0x3e483f7b,0x3ef1bf62,0xbf800000,0x3f623ef1,0xbf0ebf55,0x3dc93f7f
.long 0x3f800000,0xbf75be95,0x3f553f0e,0xbf22bf46,0xbf800000,0x3f7f3dc9,0xbf7bbe48,0x3f753e95
.long 0x3f800000,0xbf7f3dc9,0x3f7bbe48,0xbf753e95,0xbf800000,0x3f75be95,0xbf553f0e,0x3f22bf46
.long 0x3f800000,0xbf623ef1,0x3f0ebf55,0xbdc93f7f,0xbf800000,0x3f46bf22,0xbe483f7b,0xbef1bf62
.long 0x3f800000,0xbf223f46,0xbe48bf7b,0x3f623ef1,0xbf800000,0x3ef1bf62,0x3f0e3f55,0xbf7f3dc9
.long 0x3f800000,0xbe953f75,0xbf55bf0e,0x3f46bf22,0xbf800000,0x3dc9bf7f,0x3f7b3e48,0xbe953f75
.long 0x3f800000,0x3dc93f7f,0xbf7b3e48,0xbe95bf75,0xbf800000,0xbe95bf75,0x3f55bf0e,0x3f463f22
.long 0x3f800000,0x3ef13f62,0xbf0e3f55,0xbf7fbdc9,0xbf800000,0xbf22bf46,0x3e48bf7b,0x3f62bef1
.long 0x3f800000,0x3f463f22,0x3e483f7b,0xbef13f62,0xbf800000,0xbf62bef1,0xbf0ebf55,0xbdc9bf7f
.long 0x3f800000,0x3f753e95,0x3f553f0e,0x3f223f46,0xbf800000,0xbf7fbdc9,0xbf7bbe48,0xbf75be95
.long 0x3f6dbec4,0x3f62bef1,0x3f55bf0e,0x3f46bf22,0xbec43f6d,0xbdc93f7f,0x3e483f7b,0x3ef13f62
.long 0xbec4bf6d,0xbf46bf22,0xbf7bbe48,0xbf753e95,0x3f6d3ec4,0x3f75be95,0x3f0ebf55,0xbdc9bf7f
.long 0xbf6d3ec4,0xbe953f75,0x3f0e3f55,0x3f7f3dc9,0x3ec4bf6d,0xbf22bf46,0xbf7b3e48,0xbe953f75
.long 0x3ec43f6d,0x3f7fbdc9,0x3e48bf7b,0xbf62bef1,0xbf6dbec4,0xbef13f62,0x3f553f0e,0x3f22bf46
.long 0x3f6dbec4,0xbef1bf62,0xbf553f0e,0x3f223f46,0xbec43f6d,0x3f7f3dc9,0xbe48bf7b,0xbf623ef1
.long 0xbec4bf6d,0xbf223f46,0x3f7b3e48,0xbe95bf75,0x3f6d3ec4,0xbe95bf75,0xbf0e3f55,0x3f7fbdc9
.long 0xbf6d3ec4,0x3f753e95,0xbf0ebf55,0xbdc93f7f,0x3ec4bf6d,0xbf463f22,0x3f7bbe48,0xbf75be95
.long 0x3ec43f6d,0xbdc9bf7f,0xbe483f7b,0x3ef1bf62,0xbf6dbec4,0x3f623ef1,0xbf55bf0e,0x3f463f22
.long 0x3f6dbec4,0xbf623ef1,0x3f55bf0e,0xbf463f22,0xbec43f6d,0x3dc9bf7f,0x3e483f7b,0xbef1bf62
.long 0xbec4bf6d,0x3f463f22,0xbf7bbe48,0x3f75be95,0x3f6d3ec4,0xbf753e95,0x3f0ebf55,0x3dc93f7f
.long 0xbf6d3ec4,0x3e95bf75,0x3f0e3f55,0xbf7fbdc9,0x3ec4bf6d,0x3f223f46,0xbf7b3e48,0x3e95bf75
.long 0x3ec43f6d,0xbf7f3dc9,0x3e48bf7b,0x3f623ef1,0xbf6dbec4,0x3ef1bf62,0x3f553f0e,0xbf223f46
.long 0x3f6dbec4,0x3ef13f62,0xbf553f0e,0xbf22bf46,0xbec43f6d,0xbf7fbdc9,0xbe48bf7b,0x3f62bef1
.long 0xbec4bf6d,0x3f22bf46,0x3f7b3e48,0x3e953f75,0x3f6d3ec4,0x3e953f75,0xbf0e3f55,0xbf7f3dc9
.long 0xbf6d3ec4,0xbf75be95,0xbf0ebf55,0x3dc9bf7f,0x3ec4bf6d,0x3f46bf22,0x3f7bbe48,0x3f753e95
.long 0x3ec43f6d,0x3dc93f7f,0xbe483f7b,0xbef13f62,0xbf6dbec4,0xbf62bef1,0xbf55bf0e,0xbf46bf22
.long 0x3f35bf35,0x3f22bf46,0x3f0ebf55,0x3ef1bf62,0x3f353f35,0x3f623ef1,0x3f7b3e48,0x3f7fbdc9
.long 0xbf353f35,0xbe953f75,0x3e483f7b,0x3f223f46,0xbf35bf35,0xbf7fbdc9,0xbf553f0e,0xbe953f75
.long 0x3f35bf35,0xbdc9bf7f,0xbf55bf0e,0xbf753e95,0x3f353f35,0x3f75be95,0x3e48bf7b,0xbf46bf22
.long 0xbf353f35,0x3ef13f62,0x3f7bbe48,0x3dc9bf7f,0xbf35bf35,0xbf463f22,0x3f0e3f55,0x3f62bef1
.long 0x3f35bf35,0xbf46bf22,0xbf0e3f55,0x3f623ef1,0x3f353f35,0x3ef1bf62,0xbf7bbe48,0x3dc93f7f
.long 0xbf353f35,0x3f753e95,0xbe48bf7b,0xbf463f22,0xbf35bf35,0xbdc93f7f,0x3f55bf0e,0xbf75be95
.long 0x3f35bf35,0xbf7f3dc9,0x3f553f0e,0xbe95bf75,0x3f353f35,0xbe95bf75,0xbe483f7b,0x3f22bf46
.long 0xbf353f35,0x3f62bef1,0xbf7b3e48,0x3f7f3dc9,0xbf35bf35,0x3f223f46,0xbf0ebf55,0x3ef13f62
.long 0x3f35bf35,0xbf223f46,0x3f0ebf55,0xbef13f62,0x3f353f35,0xbf62bef1,0x3f7b3e48,0xbf7f3dc9
.long 0xbf353f35,0x3e95bf75,0x3e483f7b,0xbf22bf46,0xbf35bf35,0x3f7f3dc9,0xbf553f0e,0x3e95bf75
.long 0x3f35bf35,0x3dc93f7f,0xbf55bf0e,0x3f75be95,0x3f353f35,0xbf753e95,0x3e48bf7b,0x3f463f22
.long 0xbf353f35,0xbef1bf62,0x3f7bbe48,0xbdc93f7f,0xbf35bf35,0x3f46bf22,0x3f0e3f55,0xbf623ef1
.long 0x3f35bf35,0x3f463f22,0xbf0e3f55,0xbf62bef1,0x3f353f35,0xbef13f62,0xbf7bbe48,0xbdc9bf7f
.long 0xbf353f35,0xbf75be95,0xbe48bf7b,0x3f46bf22,0xbf35bf35,0x3dc9bf7f,0x3f55bf0e,0x3f753e95
.long 0x3f35bf35,0x3f7fbdc9,0x3f553f0e,0x3e953f75,0x3f353f35,0x3e953f75,0xbe483f7b,0xbf223f46
.long 0xbf353f35,0xbf623ef1,0xbf7b3e48,0xbf7fbdc9,0xbf35bf35,0xbf22bf46,0xbf0ebf55,0xbef1bf62
.long 0x3ec4bf6d,0x3e95bf75,0x3e48bf7b,0x3dc9bf7f,0x3f6dbec4,0x3f46bf22,0x3f0ebf55,0x3e95bf75
.long 0x3f6d3ec4,0x3f7fbdc9,0x3f55bf0e,0x3ef1bf62,0x3ec43f6d,0x3f623ef1,0x3f7bbe48,0x3f22bf46
.long 0xbec43f6d,0x3ef13f62,0x3f7b3e48,0x3f46bf22,0xbf6d3ec4,0xbdc93f7f,0x3f553f0e,0x3f62bef1
.long 0xbf6dbec4,0xbf223f46,0x3f0e3f55,0x3f75be95,0xbec4bf6d,0xbf753e95,0x3e483f7b,0x3f7fbdc9
.long 0x3ec4bf6d,0xbf75be95,0xbe483f7b,0x3f7f3dc9,0x3f6dbec4,0xbf22bf46,0xbf0e3f55,0x3f753e95
.long 0x3f6d3ec4,0xbdc9bf7f,0xbf553f0e,0x3f623ef1,0x3ec43f6d,0x3ef1bf62,0xbf7b3e48,0x3f463f22
.long 0xbec43f6d,0x3f62bef1,0xbf7bbe48,0x3f223f46,0xbf6d3ec4,0x3f7f3dc9,0xbf55bf0e,0x3ef13f62
.long 0xbf6dbec4,0x3f463f22,0xbf0ebf55,0x3e953f75,0xbec4bf6d,0x3e953f75,0xbe48bf7b,0x3dc93f7f
.long 0x3ec4bf6d,0xbe953f75,0x3e48bf7b,0xbdc93f7f,0x3f6dbec4,0xbf463f22,0x3f0ebf55,0xbe953f75
.long 0x3f6d3ec4,0xbf7f3dc9,0x3f55bf0e,0xbef13f62,0x3ec43f6d,0xbf62bef1,0x3f7bbe48,0xbf223f46
.long 0xbec43f6d,0xbef1bf62,0x3f7b3e48,0xbf463f22,0xbf6d3ec4,0x3dc9bf7f,0x3f553f0e,0xbf623ef1
.long 0xbf6dbec4,0x3f22bf46,0x3f0e3f55,0xbf753e95,0xbec4bf6d,0x3f75be95,0x3e483f7b,0xbf7f3dc9
.long 0x3ec4bf6d,0x3f753e95,0xbe483f7b,0xbf7fbdc9,0x3f6dbec4,0x3f223f46,0xbf0e3f55,0xbf75be95
.long 0x3f6d3ec4,0x3dc93f7f,0xbf553f0e,0xbf62bef1,0x3ec43f6d,0xbef13f62,0xbf7b3e48,0xbf46bf22
.long 0xbec43f6d,0xbf623ef1,0xbf7bbe48,0xbf22bf46,0xbf6d3ec4,0xbf7fbdc9,0xbf55bf0e,0xbef1bf62
.long 0xbf6dbec4,0xbf46bf22,0xbf0ebf55,0xbe95bf75,0xbec4bf6d,0xbe95bf75,0xbe48bf7b,0xbdc9bf7f
.long 0x3f808000,0x3f7fbdc9,0x3f7bbe48,0x3f75be95,0x3f808000,0x3f75be95,0x3f55bf0e,0x3f22bf46
.long 0x3f808000,0x3f62bef1,0x3f0ebf55,0x3dc9bf7f,0x3f808000,0x3f46bf22,0x3e48bf7b,0xbef1bf62
.long 0x3f808000,0x3f22bf46,0xbe48bf7b,0xbf62bef1,0x3f808000,0x3ef1bf62,0xbf0ebf55,0xbf7f3dc9
.long 0x3f808000,0x3e95bf75,0xbf55bf0e,0xbf463f22,0x3f808000,0x3dc9bf7f,0xbf7bbe48,0xbe953f75
.long 0x3f808000,0xbdc9bf7f,0xbf7b3e48,0x3e953f75,0x3f808000,0xbe95bf75,0xbf553f0e,0x3f463f22
.long 0x3f808000,0xbef1bf62,0xbf0e3f55,0x3f7f3dc9,0x3f808000,0xbf22bf46,0xbe483f7b,0x3f62bef1
.long 0x3f808000,0xbf46bf22,0x3e483f7b,0x3ef1bf62,0x3f808000,0xbf62bef1,0x3f0e3f55,0xbdc9bf7f
.long 0x3f808000,0xbf75be95,0x3f553f0e,0xbf22bf46,0x3f808000,0xbf7fbdc9,0x3f7b3e48,0xbf75be95
.long 0x3f808000,0xbf7f3dc9,0x3f7bbe48,0xbf753e95,0x3f808000,0xbf753e95,0x3f55bf0e,0xbf223f46
.long 0x3f808000,0xbf623ef1,0x3f0ebf55,0xbdc93f7f,0x3f808000,0xbf463f22,0x3e48bf7b,0x3ef13f62
.long 0x3f808000,0xbf223f46,0xbe48bf7b,0x3f623ef1,0x3f808000,0xbef13f62,0xbf0ebf55,0x3f7fbdc9
.long 0x3f808000,0xbe953f75,0xbf55bf0e,0x3f46bf22,0x3f808000,0xbdc93f7f,0xbf7bbe48,0x3e95bf75
.long 0x3f808000,0x3dc93f7f,0xbf7b3e48,0xbe95bf75,0x3f808000,0x3e953f75,0xbf553f0e,0xbf46bf22
.long 0x3f808000,0x3ef13f62,0xbf0e3f55,0xbf7fbdc9,0x3f808000,0x3f223f46,0xbe483f7b,0xbf623ef1
.long 0x3f808000,0x3f463f22,0x3e483f7b,0xbef13f62,0x3f808000,0x3f623ef1,0x3f0e3f55,0x3dc93f7f
.long 0x3f808000,0x3f753e95,0x3f553f0e,0x3f223f46,0x3f808000,0x3f7f3dc9,0x3f7b3e48,0x3f753e95
.long 0x3f6dbec4,0x3f62bef1,0x3f55bf0e,0x3f46bf22,0x3ec4bf6d,0x3dc9bf7f,0xbe48bf7b,0xbef1bf62
.long 0xbec4bf6d,0xbf46bf22,0xbf7bbe48,0xbf753e95,0xbf6dbec4,0xbf753e95,0xbf0e3f55,0x3dc93f7f
.long 0xbf6d3ec4,0xbe953f75,0x3f0e3f55,0x3f7f3dc9,0xbec43f6d,0x3f223f46,0x3f7bbe48,0x3e95bf75
.long 0x3ec43f6d,0x3f7fbdc9,0x3e48bf7b,0xbf62bef1,0x3f6d3ec4,0x3ef1bf62,0xbf55bf0e,0xbf223f46
.long 0x3f6dbec4,0xbef1bf62,0xbf553f0e,0x3f223f46,0x3ec4bf6d,0xbf7fbdc9,0x3e483f7b,0x3f62bef1
.long 0xbec4bf6d,0xbf223f46,0x3f7b3e48,0xbe95bf75,0xbf6dbec4,0x3e953f75,0x3f0ebf55,0xbf7f3dc9
.long 0xbf6d3ec4,0x3f753e95,0xbf0ebf55,0xbdc93f7f,0xbec43f6d,0x3f46bf22,0xbf7b3e48,0x3f753e95
.long 0x3ec43f6d,0xbdc9bf7f,0xbe483f7b,0x3ef1bf62,0x3f6d3ec4,0xbf62bef1,0x3f553f0e,0xbf46bf22
.long 0x3f6dbec4,0xbf623ef1,0x3f55bf0e,0xbf463f22,0x3ec4bf6d,0xbdc93f7f,0xbe48bf7b,0x3ef13f62
.long 0xbec4bf6d,0x3f463f22,0xbf7bbe48,0x3f75be95,0xbf6dbec4,0x3f75be95,0xbf0e3f55,0xbdc9bf7f
.long 0xbf6d3ec4,0x3e95bf75,0x3f0e3f55,0xbf7fbdc9,0xbec43f6d,0xbf22bf46,0x3f7bbe48,0xbe953f75
.long 0x3ec43f6d,0xbf7f3dc9,0x3e48bf7b,0x3f623ef1,0x3f6d3ec4,0xbef13f62,0xbf55bf0e,0x3f22bf46
.long 0x3f6dbec4,0x3ef13f62,0xbf553f0e,0xbf22bf46,0x3ec4bf6d,0x3f7f3dc9,0x3e483f7b,0xbf623ef1
.long 0xbec4bf6d,0x3f22bf46,0x3f7b3e48,0x3e953f75,0xbf6dbec4,0xbe95bf75,0x3f0ebf55,0x3f7fbdc9
.long 0xbf6d3ec4,0xbf75be95,0xbf0ebf55,0x3dc9bf7f,0xbec43f6d,0xbf463f22,0xbf7b3e48,0xbf75be95
.long 0x3ec43f6d,0x3dc93f7f,0xbe483f7b,0xbef13f62,0x3f6d3ec4,0x3f623ef1,0x3f553f0e,0x3f463f22
.long 0x3f35bf35,0x3f22bf46,0x3f0ebf55,0x3ef1bf62,0xbf35bf35,0xbf62bef1,0xbf7bbe48,0xbf7f3dc9
.long 0xbf353f35,0xbe953f75,0x3e483f7b,0x3f223f46,0x3f353f35,0x3f7f3dc9,0x3f55bf0e,0x3e95bf75
.long 0x3f35bf35,0xbdc9bf7f,0xbf55bf0e,0xbf753e95,0xbf35bf35,0xbf753e95,0xbe483f7b,0x3f463f22
.long 0xbf353f35,0x3ef13f62,0x3f7bbe48,0x3dc9bf7f,0x3f353f35,0x3f46bf22,0xbf0ebf55,0xbf623ef1
.long 0x3f35bf35,0xbf46bf22,0xbf0e3f55,0x3f623ef1,0xbf35bf35,0xbef13f62,0x3f7b3e48,0xbdc9bf7f
.long 0xbf353f35,0x3f753e95,0xbe48bf7b,0xbf463f22,0x3f353f35,0x3dc9bf7f,0xbf553f0e,0x3f753e95
.long 0x3f35bf35,0xbf7f3dc9,0x3f553f0e,0xbe95bf75,0xbf35bf35,0x3e953f75,0x3e48bf7b,0xbf223f46
.long 0xbf353f35,0x3f62bef1,0xbf7b3e48,0x3f7f3dc9,0x3f353f35,0xbf22bf46,0x3f0e3f55,0xbef1bf62
.long 0x3f35bf35,0xbf223f46,0x3f0ebf55,0xbef13f62,0xbf35bf35,0x3f623ef1,0xbf7bbe48,0x3f7fbdc9
.long 0xbf353f35,0x3e95bf75,0x3e483f7b,0xbf22bf46,0x3f353f35,0xbf7fbdc9,0x3f55bf0e,0xbe953f75
.long 0x3f35bf35,0x3dc93f7f,0xbf55bf0e,0x3f75be95,0xbf35bf35,0x3f75be95,0xbe483f7b,0xbf46bf22
.long 0xbf353f35,0xbef1bf62,0x3f7bbe48,0xbdc93f7f,0x3f353f35,0xbf463f22,0xbf0ebf55,0x3f62bef1
.long 0x3f35bf35,0x3f463f22,0xbf0e3f55,0xbf62bef1,0xbf35bf35,0x3ef1bf62,0x3f7b3e48,0x3dc93f7f
.long 0xbf353f35,0xbf75be95,0xbe48bf7b,0x3f46bf22,0x3f353f35,0xbdc93f7f,0xbf553f0e,0xbf75be95
.long 0x3f35bf35,0x3f7fbdc9,0x3f553f0e,0x3e953f75,0xbf35bf35,0xbe95bf75,0x3e48bf7b,0x3f22bf46
.long 0xbf353f35,0xbf623ef1,0xbf7b3e48,0xbf7fbdc9,0x3f353f35,0x3f223f46,0x3f0e3f55,0x3ef13f62
.long 0x3ec4bf6d,0x3e95bf75,0x3e48bf7b,0x3dc9bf7f,0xbf6d3ec4,0xbf463f22,0xbf0e3f55,0xbe953f75
.long 0x3f6d3ec4,0x3f7fbdc9,0x3f55bf0e,0x3ef1bf62,0xbec4bf6d,0xbf62bef1,0xbf7b3e48,0xbf223f46
.long 0xbec43f6d,0x3ef13f62,0x3f7b3e48,0x3f46bf22,0x3f6dbec4,0x3dc9bf7f,0xbf55bf0e,0xbf623ef1
.long 0xbf6dbec4,0xbf223f46,0x3f0e3f55,0x3f75be95,0x3ec43f6d,0x3f75be95,0xbe48bf7b,0xbf7f3dc9
.long 0x3ec4bf6d,0xbf75be95,0xbe483f7b,0x3f7f3dc9,0xbf6d3ec4,0x3f223f46,0x3f0ebf55,0xbf75be95
.long 0x3f6d3ec4,0xbdc9bf7f,0xbf553f0e,0x3f623ef1,0xbec4bf6d,0xbef13f62,0x3f7bbe48,0xbf46bf22
.long 0xbec43f6d,0x3f62bef1,0xbf7bbe48,0x3f223f46,0x3f6dbec4,0xbf7fbdc9,0x3f553f0e,0xbef1bf62
.long 0xbf6dbec4,0x3f463f22,0xbf0ebf55,0x3e953f75,0x3ec43f6d,0xbe95bf75,0x3e483f7b,0xbdc9bf7f
.long 0x3ec4bf6d,0xbe953f75,0x3e48bf7b,0xbdc93f7f,0xbf6d3ec4,0x3f46bf22,0xbf0e3f55,0x3e95bf75
.long 0x3f6d3ec4,0xbf7f3dc9,0x3f55bf0e,0xbef13f62,0xbec4bf6d,0x3f623ef1,0xbf7b3e48,0x3f22bf46
.long 0xbec43f6d,0xbef1bf62,0x3f7b3e48,0xbf463f22,0x3f6dbec4,0xbdc93f7f,0xbf55bf0e,0x3f62bef1
.long 0xbf6dbec4,0x3f22bf46,0x3f0e3f55,0xbf753e95,0x3ec43f6d,0xbf753e95,0xbe48bf7b,0x3f7fbdc9
.long 0x3ec4bf6d,0x3f753e95,0xbe483f7b,0xbf7fbdc9,0xbf6d3ec4,0xbf22bf46,0x3f0ebf55,0x3f753e95
.long 0x3f6d3ec4,0x3dc93f7f,0xbf553f0e,0xbf62bef1,0xbec4bf6d,0x3ef1bf62,0x3f7bbe48,0x3f463f22
.long 0xbec43f6d,0xbf623ef1,0xbf7bbe48,0xbf22bf46,0x3f6dbec4,0x3f7f3dc9,0x3f553f0e,0x3ef13f62
.long 0xbf6dbec4,0xbf46bf22,0xbf0ebf55,0xbe95bf75,0x3ec43f6d,0x3e953f75,0x3e483f7b,0x3dc93f7f
.long 0xbf80,0xbdc9bf7f,0xbe48bf7b,0xbe95bf75,0x3f80,0x3e953f75,0x3f0e3f55,0x3f463f22
.long 0xbf80,0xbef1bf62,0xbf55bf0e,0xbf7fbdc9,0x3f80,0x3f223f46,0x3f7b3e48,0x3f62bef1
.long 0xbf80,0xbf46bf22,0xbf7b3e48,0xbef13f62,0x3f80,0x3f623ef1,0x3f55bf0e,0xbdc9bf7f
.long 0xbf80,0xbf75be95,0xbf0e3f55,0x3f223f46,0x3f80,0x3f7f3dc9,0x3e48bf7b,0xbf75be95
.long 0xbf80,0xbf7f3dc9,0x3e483f7b,0x3f75be95,0x3f80,0x3f75be95,0xbf0ebf55,0xbf223f46
.long 0xbf80,0xbf623ef1,0x3f553f0e,0x3dc9bf7f,0x3f80,0x3f46bf22,0xbf7bbe48,0x3ef13f62
.long 0xbf80,0xbf223f46,0x3f7bbe48,0xbf62bef1,0x3f80,0x3ef1bf62,0xbf553f0e,0x3f7fbdc9
.long 0xbf80,0xbe953f75,0x3f0ebf55,0xbf463f22,0x3f80,0x3dc9bf7f,0xbe483f7b,0x3e95bf75
.long 0xbf80,0x3dc93f7f,0xbe48bf7b,0x3e953f75,0x3f80,0xbe95bf75,0x3f0e3f55,0xbf46bf22
.long 0xbf80,0x3ef13f62,0xbf55bf0e,0x3f7f3dc9,0x3f80,0xbf22bf46,0x3f7b3e48,0xbf623ef1
.long 0xbf80,0x3f463f22,0xbf7b3e48,0x3ef1bf62,0x3f80,0xbf62bef1,0x3f55bf0e,0x3dc93f7f
.long 0xbf80,0x3f753e95,0xbf0e3f55,0xbf22bf46,0x3f80,0xbf7fbdc9,0x3e48bf7b,0x3f753e95
.long 0xbf80,0x3f7fbdc9,0x3e483f7b,0xbf753e95,0x3f80,0xbf753e95,0xbf0ebf55,0x3f22bf46
.long 0xbf80,0x3f62bef1,0x3f553f0e,0xbdc93f7f,0x3f80,0xbf463f22,0xbf7bbe48,0xbef1bf62
.long 0xbf80,0x3f22bf46,0x3f7bbe48,0x3f623ef1,0x3f80,0xbef13f62,0xbf553f0e,0xbf7f3dc9
.long 0xbf80,0x3e95bf75,0x3f0ebf55,0x3f46bf22,0x3f80,0xbdc93f7f,0xbe483f7b,0xbe953f75
.long 0xbec4bf6d,0xbef1bf62,0xbf0ebf55,0xbf22bf46,0x3f6d3ec4,0x3f7f3dc9,0x3f7bbe48,0x3f62bef1
.long 0xbf6d3ec4,0xbf223f46,0xbe483f7b,0x3e953f75,0x3ec4bf6d,0xbe95bf75,0xbf55bf0e,0xbf7f3dc9
.long 0x3ec43f6d,0x3f753e95,0x3f55bf0e,0x3dc9bf7f,0xbf6dbec4,0xbf463f22,0x3e483f7b,0x3f753e95
.long 0x3f6dbec4,0xbdc9bf7f,0xbf7bbe48,0xbef13f62,0xbec43f6d,0x3f623ef1,0x3f0ebf55,0xbf46bf22
.long 0xbec4bf6d,0xbf623ef1,0x3f0e3f55,0x3f46bf22,0x3f6d3ec4,0x3dc9bf7f,0xbf7b3e48,0x3ef13f62
.long 0xbf6d3ec4,0x3f463f22,0x3e48bf7b,0xbf753e95,0x3ec4bf6d,0xbf753e95,0x3f553f0e,0xbdc9bf7f
.long 0x3ec43f6d,0x3e95bf75,0xbf553f0e,0x3f7f3dc9,0xbf6dbec4,0x3f223f46,0xbe48bf7b,0xbe953f75
.long 0x3f6dbec4,0xbf7f3dc9,0x3f7b3e48,0xbf62bef1,0xbec43f6d,0x3ef1bf62,0xbf0e3f55,0x3f22bf46
.long 0xbec4bf6d,0x3ef13f62,0xbf0ebf55,0x3f223f46,0x3f6d3ec4,0xbf7fbdc9,0x3f7bbe48,0xbf623ef1
.long 0xbf6d3ec4,0x3f22bf46,0xbe483f7b,0xbe95bf75,0x3ec4bf6d,0x3e953f75,0xbf55bf0e,0x3f7fbdc9
.long 0x3ec43f6d,0xbf75be95,0x3f55bf0e,0xbdc93f7f,0xbf6dbec4,0x3f46bf22,0x3e483f7b,0xbf75be95
.long 0x3f6dbec4,0x3dc93f7f,0xbf7bbe48,0x3ef1bf62,0xbec43f6d,0xbf62bef1,0x3f0ebf55,0x3f463f22
.long 0xbec4bf6d,0x3f62bef1,0x3f0e3f55,0xbf463f22,0x3f6d3ec4,0xbdc93f7f,0xbf7b3e48,0xbef1bf62
.long 0xbf6d3ec4,0xbf46bf22,0x3e48bf7b,0x3f75be95,0x3ec4bf6d,0x3f75be95,0x3f553f0e,0x3dc93f7f
.long 0x3ec43f6d,0xbe953f75,0xbf553f0e,0xbf7fbdc9,0xbf6dbec4,0xbf22bf46,0xbe48bf7b,0x3e95bf75
.long 0x3f6dbec4,0x3f7fbdc9,0x3f7b3e48,0x3f623ef1,0xbec43f6d,0xbef13f62,0xbf0e3f55,0xbf223f46
.long 0xbf35bf35,0xbf46bf22,0xbf55bf0e,0xbf62bef1,0x3f35bf35,0x3ef1bf62,0x3e48bf7b,0xbdc9bf7f
.long 0x3f353f35,0x3f753e95,0x3f7bbe48,0x3f46bf22,0xbf353f35,0xbdc93f7f,0x3f0e3f55,0x3f753e95
.long 0xbf35bf35,0xbf7f3dc9,0xbf0e3f55,0x3e953f75,0x3f35bf35,0xbe95bf75,0xbf7bbe48,0xbf223f46
.long 0x3f353f35,0x3f62bef1,0xbe48bf7b,0xbf7fbdc9,0xbf353f35,0x3f223f46,0x3f55bf0e,0xbef1bf62
.long 0xbf35bf35,0xbf223f46,0x3f553f0e,0x3ef1bf62,0x3f35bf35,0xbf62bef1,0xbe483f7b,0x3f7fbdc9
.long 0x3f353f35,0x3e95bf75,0xbf7b3e48,0x3f223f46,0xbf353f35,0x3f7f3dc9,0xbf0ebf55,0xbe953f75
.long 0xbf35bf35,0x3dc93f7f,0x3f0ebf55,0xbf753e95,0x3f35bf35,0xbf753e95,0x3f7b3e48,0xbf46bf22
.long 0x3f353f35,0xbef1bf62,0x3e483f7b,0x3dc9bf7f,0xbf353f35,0x3f46bf22,0xbf553f0e,0x3f62bef1
.long 0xbf35bf35,0x3f463f22,0xbf55bf0e,0x3f623ef1,0x3f35bf35,0xbef13f62,0x3e48bf7b,0x3dc93f7f
.long 0x3f353f35,0xbf75be95,0x3f7bbe48,0xbf463f22,0xbf353f35,0x3dc9bf7f,0x3f0e3f55,0xbf75be95
.long 0xbf35bf35,0x3f7fbdc9,0xbf0e3f55,0xbe95bf75,0x3f35bf35,0x3e953f75,0xbf7bbe48,0x3f22bf46
.long 0x3f353f35,0xbf623ef1,0xbe48bf7b,0x3f7f3dc9,0xbf353f35,0xbf22bf46,0x3f55bf0e,0x3ef13f62
.long 0xbf35bf35,0x3f22bf46,0x3f553f0e,0xbef13f62,0x3f35bf35,0x3f623ef1,0xbe483f7b,0xbf7f3dc9
.long 0x3f353f35,0xbe953f75,0xbf7b3e48,0xbf22bf46,0xbf353f35,0xbf7fbdc9,0xbf0ebf55,0x3e95bf75
.long 0xbf35bf35,0xbdc9bf7f,0x3f0ebf55,0x3f75be95,0x3f35bf35,0x3f75be95,0x3f7b3e48,0x3f463f22
.long 0x3f353f35,0x3ef13f62,0x3e483f7b,0xbdc93f7f,0xbf353f35,0xbf463f22,0xbf553f0e,0xbf623ef1
.long 0xbf6dbec4,0xbf75be95,0xbf7bbe48,0xbf7fbdc9,0xbec4bf6d,0xbf22bf46,0xbf55bf0e,0xbf75be95
.long 0x3ec4bf6d,0xbdc9bf7f,0xbf0ebf55,0xbf62bef1,0x3f6dbec4,0x3ef1bf62,0xbe48bf7b,0xbf46bf22
.long 0x3f6d3ec4,0x3f62bef1,0x3e48bf7b,0xbf22bf46,0x3ec43f6d,0x3f7f3dc9,0x3f0ebf55,0xbef1bf62
.long 0xbec43f6d,0x3f463f22,0x3f55bf0e,0xbe95bf75,0xbf6d3ec4,0x3e953f75,0x3f7bbe48,0xbdc9bf7f
.long 0xbf6dbec4,0xbe953f75,0x3f7b3e48,0x3dc9bf7f,0xbec4bf6d,0xbf463f22,0x3f553f0e,0x3e95bf75
.long 0x3ec4bf6d,0xbf7f3dc9,0x3f0e3f55,0x3ef1bf62,0x3f6dbec4,0xbf62bef1,0x3e483f7b,0x3f22bf46
.long 0x3f6d3ec4,0xbef1bf62,0xbe483f7b,0x3f46bf22,0x3ec43f6d,0x3dc9bf7f,0xbf0e3f55,0x3f62bef1
.long 0xbec43f6d,0x3f22bf46,0xbf553f0e,0x3f75be95,0xbf6d3ec4,0x3f75be95,0xbf7b3e48,0x3f7fbdc9
.long 0xbf6dbec4,0x3f753e95,0xbf7bbe48,0x3f7f3dc9,0xbec4bf6d,0x3f223f46,0xbf55bf0e,0x3f753e95
.long 0x3ec4bf6d,0x3dc93f7f,0xbf0ebf55,0x3f623ef1,0x3f6dbec4,0xbef13f62,0xbe48bf7b,0x3f463f22
.long 0x3f6d3ec4,0xbf623ef1,0x3e48bf7b,0x3f223f46,0x3ec43f6d,0xbf7fbdc9,0x3f0ebf55,0x3ef13f62
.long 0xbec43f6d,0xbf46bf22,0x3f55bf0e,0x3e953f75,0xbf6d3ec4,0xbe95bf75,0x3f7bbe48,0x3dc93f7f
.long 0xbf6dbec4,0x3e95bf75,0x3f7b3e48,0xbdc93f7f,0xbec4bf6d,0x3f46bf22,0x3f553f0e,0xbe953f75
.long 0x3ec4bf6d,0x3f7fbdc9,0x3f0e3f55,0xbef13f62,0x3f6dbec4,0x3f623ef1,0x3e483f7b,0xbf223f46
.long 0x3f6d3ec4,0x3ef13f62,0xbe483f7b,0xbf463f22,0x3ec43f6d,0xbdc93f7f,0xbf0e3f55,0xbf623ef1
.long 0xbec43f6d,0xbf223f46,0xbf553f0e,0xbf753e95,0xbf6d3ec4,0xbf753e95,0xbf7b3e48,0xbf7f3dc9
.long 0x3f800000,0x3f7fffb1,0x3f7ffec4,0x3f7ffd39,0x3f800000,0x3f7ffd39,0x3f7ff4e6,0x3f7fe705
.long 0x3f800000,0x3f7ff84a,0x3f7fe129,0x3f7fba9e,0x3f800000,0x3f7ff0e3,0x3f7fc38f,0x3f7f7808
.long 0x3f800000,0x3f7fe705,0x3f7f9c18,0x3f7f1f49,0x3f800000,0x3f7fdaaf,0x3f7f6ac7,0x3f7eb069
.long 0x3f800000,0x3f7fcbe2,0x3f7f2f9d,0x3f7e2b72,0x3f800000,0x3f7fba9e,0x3f7eea9d,0x3f7d906e
.long 0x3f800000,0x3f7fa6e3,0x3f7e9bc9,0x3f7cdf6c,0x3f800000,0x3f7f90b1,0x3f7e4323,0x3f7c187a
.long 0x3f800000,0x3f7f7808,0x3f7de0b1,0x3f7b3bab,0x3f800000,0x3f7f5ce9,0x3f7d7474,0x3f7a4910
.long 0x3f800000,0x3f7f3f54,0x3f7cfe73,0x3f7940c0,0x3f800000,0x3f7f1f49,0x3f7c7eb0,0x3f7822d1
.long 0x3f800000,0x3f7efcc9,0x3f7bf531,0x3f76ef5b,0x3f800000,0x3f7ed7d4,0x3f7b61fc,0x3f75a67b
.long 0x3f800000,0x3f7eb069,0x3f7ac516,0x3f74484b,0x3f800000,0x3f7e868b,0x3f7a1e84,0x3f72d4eb
.long 0x3f800000,0x3f7e5a38,0x3f796e4e,0x3f714c7a,0x3f800000,0x3f7e2b72,0x3f78b47b,0x3f6faf1b
.long 0x3f800000,0x3f7dfa38,0x3f77f110,0x3f6dfcf2,0x3f800000,0x3f7dc68c,0x3f772417,0x3f6c3624
.long 0x3f800000,0x3f7d906e,0x3f764d97,0x3f6a5ad9,0x3f800000,0x3f7d57de,0x3f756d97,0x3f686b39
.long 0x3f800000,0x3f7d1cdd,0x3f748422,0x3f666771,0x3f800000,0x3f7cdf6c,0x3f73913f,0x3f644fac
.long 0x3f800000,0x3f7c9f8a,0x3f7294f8,0x3f62241a,0x3f800000,0x3f7c5d3a,0x3f718f57,0x3f5fe4e9
.long 0x3f800000,0x3f7c187a,0x3f708066,0x3f5d924d,0x3f800000,0x3f7bd14d,0x3f6f6830,0x3f5b2c79
.long 0x3f800000,0x3f7b87b2,0x3f6e46be,0x3f58b3a1,0x3f800000,0x3f7b3bab,0x3f6d1c1d,0x3f5627fe
.long 0x3f7ffb11,0x3f7ff84a,0x3f7ff4e6,0x3f7ff0e3,0x3f7fd397,0x3f7fba9e,0x3f7f9c18,0x3f7f7808
.long 0x3f7f84ab,0x3f7f3f54,0x3f7eea9d,0x3f7e868b,0x3f7f0e58,0x3f7e868b,0x3f7de0b1,0x3f7d1cdd
.long 0x3f7e70b0,0x3f7d906e,0x3f7c7eb0,0x3f7b3bab,0x3f7dabcc,0x3f7c5d3a,0x3f7ac516,0x3f78e3d6
.long 0x3f7cbfc9,0x3f7aed37,0x3f78b47b,0x3f76167a,0x3f7baccd,0x3f7940c0,0x3f764d97,0x3f72d4eb
.long 0x3f7a7302,0x3f77583a,0x3f73913f,0x3f6f20b0,0x3f791298,0x3f75341d,0x3f708066,0x3f6afb8c
.long 0x3f778bc5,0x3f72d4eb,0x3f6d1c1d,0x3f666771,0x3f75dec6,0x3f703b37,0x3f696591,0x3f61668a
.long 0x3f740bdd,0x3f6d67a1,0x3f655e0b,0x3f5bfb34,0x3f721352,0x3f6a5ad9,0x3f6106f2,0x3f5627fe
.long 0x3f6ff573,0x3f671599,0x3f5c61c7,0x3f4fefa8,0x3f6db293,0x3f6398ac,0x3f577026,0x3f495521
.long 0x3f6b4b0c,0x3f5fe4e9,0x3f5233c6,0x3f425b89,0x3f68bf3c,0x3f5bfb34,0x3f4cae79,0x3f3b0629
.long 0x3f660f88,0x3f57dc7f,0x3f46e22a,0x3f33587a,0x3f633c5a,0x3f5389c7,0x3f40d0da,0x3f2b561b
.long 0x3f604621,0x3f4f0417,0x3f3a7ca4,0x3f2302d3,0x3f5d2d53,0x3f4a4c87,0x3f33e7bc,0x3f1a6293
.long 0x3f59f26a,0x3f456439,0x3f2d1469,0x3f11796b,0x3f5695e5,0x3f404c5c,0x3f26050a,0x3f084b92
.long 0x3f531849,0x3f3b0629,0x3f1ebc12,0x3efdbabb,0x3f4f7a1f,0x3f3592e7,0x3f173c07,0x3eea6681
.long 0x3f4bbbf8,0x3f2ff3e6,0x3f0f8784,0x3ed6a399,0x3f47de65,0x3f2a2a80,0x3f07a136,0x3ec27b55
.long 0x3f43e200,0x3f24381a,0x3eff17b2,0x3eadf73c,0x3f3fc767,0x3f1e1e22,0x3eee9479,0x3e9920fe
.long 0x3f3b8f3b,0x3f17de12,0x3eddbe79,0x3e840270,0x3f373a23,0x3f11796b,0x3ecc9b8b,0x3e5d4b1a
.long 0x3f7fec43,0x3f7fe705,0x3f7fe129,0x3f7fdaaf,0x3f7f4e6d,0x3f7f1f49,0x3f7eea9d,0x3f7eb069
.long 0x3f7e1324,0x3f7d906e,0x3f7cfe73,0x3f7c5d3a,0x3f7c3b28,0x3f7b3bab,0x3f7a1e84,0x3f78e3d6
.long 0x3f79c79d,0x3f7822d1,0x3f764d97,0x3f74484b,0x3f76ba07,0x3f74484b,0x3f718f57,0x3f6e8ff8
.long 0x3f731447,0x3f6faf1b,0x3f6be858,0x3f67c187,0x3f6ed89e,0x3f6a5ad9,0x3f655e0b,0x3f5fe4e9
.long 0x3f6a09a7,0x3f644fac,0x3f5df6be,0x3f570348,0x3f64aa59,0x3f5d924d,0x3f55b993,0x3f4d26fd
.long 0x3f5ebe05,0x3f5627fe,0x3f4cae79,0x3f425b89,0x3f584853,0x3f4e1689,0x3f42de29,0x3f36ad7f
.long 0x3f514d3d,0x3f456439,0x3f385216,0x3f2a2a80,0x3f49d112,0x3f3c17d9,0x3f2d1469,0x3f1ce11f
.long 0x3f41d870,0x3f3238aa,0x3f212ff9,0x3f0ee0db,0x3f396842,0x3f27ce61,0x3f14b039,0x3f003a06
.long 0x3f3085bb,0x3f1ce11f,0x3f07a136,0x3ee1fb6a,0x3f273656,0x3f11796b,0x3ef41f07,0x3ec27b55
.long 0x3f1d7fd1,0x3f05a02c,0x3ed8106b,0x3ea21887,0x3f13682a,0x3ef2bd43,0x3ebb31a0,0x3e80f8c0
.long 0x3f08f59b,0x3ed97cb9,0x3e9d9e78,0x3e3e853e,0x3efc5d27,0x3ebf926f,0x3e7ee6e1,0x3df475c0
.long 0x3ee63375,0x3ea5129f,0x3e419b37,0x3d55880e,0x3ecf7bca,0x3e8a11f7,0x3e039502,0xbc7b514b
.long 0x3eb8442a,0x3e5d4b1a,0x3d8a200a,0xbda973ba,0x3ea09ae5,0x3e25c58c,0x3bc90f88,0xbe195be0
.long 0x3e888e93,0x3ddb7d37,0xbd621469,0xbe5d4b1a,0x3e605c13,0x3d55880e,0xbdee3876,0xbe901c2c
.long 0x3e2f10a2,0xbb490fc6,0xbe354098,0xbeb0eacb,0x3dfab273,0xbd6ea038,0xbe72b651,0xbed0eb2a
.long 0x3d96a905,0xbde7fa9a,0xbe97a117,0xbeeff7fb,0x3cc90ab0,0xbe2bf804,0xbeb554ec,0xbf06f686
.long 0x3f7fd397,0x3f7fcbe2,0x3f7fc38f,0x3f7fba9e,0x3f7e70b0,0x3f7e2b72,0x3f7de0b1,0x3f7d906e
.long 0x3f7baccd,0x3f7aed37,0x3f7a1e84,0x3f7940c0,0x3f778bc5,0x3f76167a,0x3f748422,0x3f72d4eb
.long 0x3f721352,0x3f6faf1b,0x3f6d1c1d,0x3f6a5ad9,0x3f6b4b0c,0x3f67c187,0x3f63f473,0x3f5fe4e9
.long 0x3f633c5a,0x3f5e5aa6,0x3f591e6a,0x3f5389c7,0x3f59f26a,0x3f5389c7,0x3f4cae79,0x3f456439
.long 0x3f4f7a1f,0x3f476085,0x3f3ebc1b,0x3f3592e7,0x3f43e200,0x3f39f2ac,0x3f2f61a5,0x3f24381a
.long 0x3f373a23,0x3f2b561b,0x3f1ebc12,0x3f11796b,0x3f299415,0x3f1ba299,0x3f0cead0,0x3efafef7
.long 0x3f1b02c6,0x3f0af1b7,0x3ef41f07,0x3ed0eb2a,0x3f0b9a6b,0x3ef2bd43,0x3ecc9b8b,0x3ea5129f
.long 0x3ef6e0cb,0x3ece0bea,0x3ea395c5,0x3e6fa8b2,0x3ed53641,0x3ea80b1f,0x3e72b651,0x3e1324ca
.long 0x3eb263ef,0x3e80f8c0,0x3e1c76de,0x3d55880e,0x3e8e9a22,0x3e3228d4,0x3d8a200a,0xbd2351cb
.long 0x3e541501,0x3dc27c39,0xbc96c9b6,0xbe06b26e,0x3e09cf86,0x3c7b514b,0xbdd53db9,0xbe636c83
.long 0x3d7b2b74,0xbd83db0a,0xbe419b37,0xbe9f1cdf,0xbc490e90,0xbe1324ca,0xbe8b9507,0xbecb2aae
.long 0xbdafb680,0xbe636c83,0xbeb554ec,0xbef58035,0xbe22abb6,0xbe9920fe,0xbeddbe79,0xbf0ee0db
.long 0xbe6c9a7f,0xbebf926f,0xbf0242b1,0xbf21cbfb,0xbe9aa086,0xbee4cbfe,0xbf14b039,0xbf33587a
.long 0xbebe1d4a,0xbf044889,0xbf26050a,0xbf436051,0xbee0924f,0xbf1553b7,0xbf36206c,0xbf51c0c2
.long 0xbf00e7e4,0xbf256bcb,0xbf44e3f5,0xbf5e5aa6,0xbf10d3cd,0xbf34768f,0xbf5233c6,0xbf6912ae
.long 0xbf1ff6cb,0xbf425b89,0xbf5df6be,0xbf71d19f,0xbf2e3bde,0xbf4f0417,0xbf6816a8,0xbf788486
.long 0x3f7fb10f,0x3f7fa6e3,0x3f7f9c18,0x3f7f90b1,0x3f7d3aac,0x3f7cdf6c,0x3f7c7eb0,0x3f7c187a
.long 0x3f7853f8,0x3f77583a,0x3f764d97,0x3f75341d,0x3f710908,0x3f6f20b0,0x3f6d1c1d,0x3f6afb8c
.long 0x3f676bd8,0x3f644fac,0x3f6106f2,0x3f5d924d,0x3f5b941a,0x3f570348,0x3f5233c6,0x3f4d26fd
.long 0x3f4d9f02,0x3f476085,0x3f40d0da,0x3f39f2ac,0x3f3daef9,0x3f3592e7,0x3f2d1469,0x3f24381a
.long 0x3f2beb4a,0x3f21cbfb,0x3f173c07,0x3f0c42c9,0x3f187fc0,0x3f0c42c9,0x3eff17b2,0x3ee4cbfe
.long 0x3f039c3d,0x3eea6681,0x3ecc9b8b,0x3eadf73c,0x3edae880,0x3eb9bb1e,0x3e97a117,0x3e698bba
.long 0x3eac7cd4,0x3e870ada,0x3e419b37,0x3de7fa9a,0x3e78cfcc,0x3e25c58c,0x3da3308c,0xbb490fc6
.long 0x3e164083,0x3d6ea038,0xbcfb49ba,0xbdf475c0,0x3d48fb30,0xbd3c6dd5,0xbe1008b7,0xbe6fa8b2
.long 0xbd48fb30,0xbe195be0,0xbe7ee6e1,0xbeb0eacb,0xbe164083,0xbe80f8c0,0xbeb554ec,0xbee79a5d
.long 0xbe78cfcc,0xbeb3dca5,0xbee900b7,0xbf0d9281,0xbeac7cd4,0xbee4cbfe,0xbf0cead0,0xbf256bcb
.long 0xbedae880,0xbf099f4e,0xbf239da9,0xbf3b0629,0xbf039c3d,0xbf1f599f,0xbf385216,0xbf4e1689
.long 0xbf187fc0,0xbf33587a,0xbf4ac77f,0xbf5e5aa6,0xbf2beb4a,0xbf456439,0xbf5ac450,0xbf6b99fb
.long 0xbf3daef9,0xbf554aa4,0xbf6816a8,0xbf75a67b,0xbf4d9f02,0xbf62df7b,0xbf7294f8,0xbf7c5d3a
.long 0xbf5b941a,0xbf6dfcf2,0xbf7a1e84,0xbf7fa6e3,0xbf676bd8,0xbf76841b,0xbf7e9bc9,0xbf7f7808
.long 0xbf710908,0xbf7c5d3a,0xbf7ffec4,0xbf7bd14d,0xbf7853f8,0xbf7f7808,0xbf7e4323,0xbf74bf62
.long 0xbf7d3aac,0xbf7fcbe2,0xbf796e4e,0xbf6a5ad9,0xbf7fb10f,0xbf7d57de,0xbf718f57,0xbf5cc7d1
.long 0x3f7f84ab,0x3f7f7808,0x3f7f6ac7,0x3f7f5ce9,0x3f7baccd,0x3f7b3bab,0x3f7ac516,0x3f7a4910
.long 0x3f740bdd,0x3f72d4eb,0x3f718f57,0x3f703b37,0x3f68bf3c,0x3f666771,0x3f63f473,0x3f61668a
.long 0x3f59f26a,0x3f5627fe,0x3f5233c6,0x3f4e1689,0x3f47de65,0x3f425b89,0x3f3ca003,0x3f36ad7f
.long 0x3f32c8c9,0x3f2b561b,0x3f239da9,0x3f1ba299,0x3f1b02c6,0x3f11796b,0x3f07a136,0x3efafef7
.long 0x3f00e7e4,0x3eea6681,0x3ed25a09,0x3eb9bb1e,0x3ec9b953,0x3eadf73c,0x3e919ddd,0x3e698bba
.long 0x3e8e9a22,0x3e5d4b1a,0x3e1c76de,0x3db5f8da,0x3e22abb6,0x3db5f8da,0x3c96c9b6,0xbd55880e
.long 0x3d16c32c,0xbd2351cb,0xbdee3876,0xbe44b0b9,0xbdafb680,0xbe2bf804,0xbe7ee6e1,0xbea80b1f
.long 0xbe541501,0xbe9620d2,0xbec1071e,0xbeea6681,0xbea68f12,0xbed3c867,0xbeff17b2,0xbf140c5f
.long 0xbee0924f,0xbf06f686,0xbf1c420c,0xbf2ff3e6,0xbf0b9a6b,0xbf21cbfb,0xbf36206c,0xbf485bca
.long 0xbf24d225,0xbf39f2ac,0xbf4cae79,0xbf5cc7d1,0xbf3b8f3b,0xbf4f0417,0xbf5f8327,0xbf6cd007
.long 0xbf4f7a1f,0xbf60a6cf,0xbf6e46be,0xbf7822d1,0xbf604621,0xbf6e8ff8,0xbf78b47b,0xbf7e868b
.long 0xbf6db293,0xbf788486,0xbf7e9bc9,0xbf7fdaaf,0xbf778bc5,0xbf7e5a38,0xbf7fe129,0xbf7c187a
.long 0xbf7dabcc,0xbf7ff84a,0xbf7c7eb0,0xbf73530e,0xbf7ffb11,0xbf7d57de,0xbf748422,0xbf65b710
.long 0xbf7e70b0,0xbf76841b,0xbf6816a8,0xbf5389c7,0xbf791298,0xbf6b99fb,0xbf577026,0xbf3d27b8
.long 0xbf6ff573,0xbf5cc7d1,0xbf42de29,0xbf2302d3,0xbf633c5a,0xbf4a4c87,0xbf2ac082,0xbf05a02c
.long 0xbf531849,0xbf34768f,0xbf0f8784,0xbecb2aae,0xbf3fc767,0xbf1ba299,0xbee363fa,0xbe870ada
.long 0x3f7f4e6d,0x3f7f3f54,0x3f7f2f9d,0x3f7f1f49,0x3f79c79d,0x3f7940c0,0x3f78b47b,0x3f7822d1
.long 0x3f6ed89e,0x3f6d67a1,0x3f6be858,0x3f6a5ad9,0x3f5ebe05,0x3f5bfb34,0x3f591e6a,0x3f5627fe
.long 0x3f49d112,0x3f456439,0x3f40d0da,0x3f3c17d9,0x3f3085bb,0x3f2a2a80,0x3f239da9,0x3f1ce11f
.long 0x3f13682a,0x3f0af1b7,0x3f0242b1,0x3ef2bd43,0x3ee63375,0x3ed0eb2a,0x3ebb31a0,0x3ea5129f
.long 0x3ea09ae5,0x3e870ada,0x3e5a3997,0x3e25c58c,0x3e2f10a2,0x3de7fa9a,0x3d621469,0xbb490fc6
.long 0x3cc90ab0,0xbd2351cb,0xbdd53db9,0xbe2bf804,0xbdfab273,0xbe44b0b9,0xbe8586ce,0xbea80b1f
.long 0xbe888e93,0xbeadf73c,0xbed25a09,0xbef58035,0xbecf7bca,0xbef58035,0xbf0cead0,0xbf1e1e22
.long 0xbf08f59b,0xbf1ba299,0xbf2d1469,0xbf3d27b8,0xbf273656,0xbf38dd65,0xbf48d8b3,0xbf570348
.long 0xbf41d870,0xbf51c0c2,0xbf5f8327,0xbf6afb8c,0xbf584853,0xbf65b710,0xbf708066,0xbf788486
.long 0xbf6a09a7,0xbf74484b,0xbf7b61fc,0xbf7f3f54,0xbf76ba07,0xbf7d1cdd,0xbf7fe129,0xbf7efcc9
.long 0xbf7e1324,0xbf7fffb1,0xbf7de0b1,0xbf77beb7,0xbf7fec43,0xbf7cdf6c,0xbf756d97,0xbf69b7e4
.long 0xbf7c3b28,0xbf73ced9,0xbf66becc,0xbf554aa4,0xbf731447,0xbf650479,0xbf5233c6,0xbf3b0629
.long 0xbf64aa59,0xbf50d937,0xbf385216,0xbf1ba299,0xbf514d3d,0xbf37c655,0xbf19c200,0xbeeff7fb
.long 0xbf396842,0xbf1a6293,0xbeee9479,0xbea21887,0xbf1d7fd1,0xbef2bd43,0xbea395c5,0xbe1f917b
.long 0xbefc5d27,0xbeab0201,0xbe28defc,0x3c16cb58,0xbeb8442a,0xbe3e853e,0xbbc90f88,0x3e3228d4
.long 0xbe605c13,0xbd0a342f,0x3e1c76de,0x3eab0201,0xbd96a905,0x3df475c0,0x3e9d9e78,0x3ef840c8
.long 0x3f7f0e58,0x3f7efcc9,0x3f7eea9d,0x3f7ed7d4,0x3f778bc5,0x3f76ef5b,0x3f764d97,0x3f75a67b
.long 0x3f68bf3c,0x3f671599,0x3f655e0b,0x3f6398ac,0x3f531849,0x3f4fefa8,0x3f4cae79,0x3f495521
.long 0x3f373a23,0x3f3238aa,0x3f2d1469,0x3f27ce61,0x3f15f6d9,0x3f0ee0db,0x3f07a136,0x3f003a06
.long 0x3ee0924f,0x3ece0bea,0x3ebb31a0,0x3ea80b1f,0x3e8e9a22,0x3e6fa8b2,0x3e419b37,0x3e1324ca
.long 0x3de1bc2e,0x3d6ea038,0x3bc90f88,0xbd3c6dd5,0xbd7b2b74,0xbdf475c0,0xbe354098,0xbe6fa8b2
.long 0xbe6c9a7f,0xbe9620d2,0xbeb554ec,0xbed3c867,0xbec9b953,0xbeea6681,0xbf04f484,0xbf140c5f
.long 0xbf0b9a6b,0xbf1ba299,0xbf2ac082,0xbf38dd65,0xbf2e3bde,0xbf3d27b8,0xbf4ac77f,0xbf570348
.long 0xbf4bbbf8,0xbf58b3a1,0xbf63f473,0xbf6d67a1,0xbf633c5a,0xbf6d67a1,0xbf756d97,0xbf7b3bab
.long 0xbf740bdd,0xbf7a9c59,0xbf7e9bc9,0xbf7fffb1,0xbf7dabcc,0xbf7fe705,0xbf7f2f9d,0xbf7b87b2
.long 0xbf7fd397,0xbf7d1cdd,0xbf772417,0xbf6dfcf2,0xbf7a7302,0xbf725470,0xbf66becc,0xbf57dc7f
.long 0xbf6db293,0xbf5fe4e9,0xbf4e8d90,0xbf39f2ac,0xbf59f26a,0xbf466354,0xbf2f61a5,0xbf1553b7
.long 0xbf3fc767,0xbf269de3,0xbf0a48ad,0xbed6a399,0xbf1ff6cb,0xbf019573,0xbec1071e,0xbe75c35a
.long 0xbef6e0cb,0xbeb0eacb,0xbe4dee60,0xbd55880e,0xbea68f12,0xbe3228d4,0xbc96c9b6,0x3e0cec4a
.long 0xbe22abb6,0x3b490fc6,0x3e28defc,0x3ea5129f,0x3c490e90,0x3e3857ec,0x3eaf713a,0x3efdbabb
.long 0x3e3b6ecf,0x3eb3dca5,0x3f0242b1,0x3f269de3,0x3eb263ef,0x3f02ef9f,0x3f286605,0x3f485bca
.long 0x3f00e7e4,0x3f27ce61,0x3f48d8b3,0x3f62df7b,0x3f24d225,0x3f476085,0x3f628210,0x3f75341d
.long 0,0x3b490fc6,0x3bc90f88,0x3c16cb58,0,0x3c16cb58,0x3c96c9b6,0x3ce22a7a
.long 0,0x3c7b514b,0x3cfb49ba,0x3d3c6dd5,0,0x3cafea69,0x3d2fe007,0x3d83db0a
.long 0,0x3ce22a7a,0x3d621469,0x3da973ba,0,0x3d0a342f,0x3d8a200a,0x3dcefdb7
.long 0,0x3d2351cb,0x3da3308c,0x3df475c0,0,0x3d3c6dd5,0x3dbc3ac3,0x3e0cec4a
.long 0,0x3d55880e,0x3dd53db9,0x3e1f917b,0,0x3d6ea038,0x3dee3876,0x3e3228d4
.long 0,0x3d83db0a,0x3e039502,0x3e44b0b9,0,0x3d9064b4,0x3e1008b7,0x3e57278f
.long 0,0x3d9cecf9,0x3e1c76de,0x3e698bba,0,0x3da973ba,0x3e28defc,0x3e7bdba4
.long 0,0x3db5f8da,0x3e354098,0x3e870ada,0,0x3dc27c39,0x3e419b37,0x3e901c2c
.long 0,0x3dcefdb7,0x3e4dee60,0x3e9920fe,0,0x3ddb7d37,0x3e5a3997,0x3ea21887
.long 0,0x3de7fa9a,0x3e667c66,0x3eab0201,0,0x3df475c0,0x3e72b651,0x3eb3dca5
.long 0,0x3e007745,0x3e7ee6e1,0x3ebca7af,0,0x3e06b26e,0x3e8586ce,0x3ec5625c
.long 0,0x3e0cec4a,0x3e8b9507,0x3ece0bea,0,0x3e1324ca,0x3e919ddd,0x3ed6a399
.long 0,0x3e195be0,0x3e97a117,0x3edf28a9,0,0x3e1f917b,0x3e9d9e78,0x3ee79a5d
.long 0,0x3e25c58c,0x3ea395c5,0x3eeff7fb,0,0x3e2bf804,0x3ea986c4,0x3ef840c8
.long 0,0x3e3228d4,0x3eaf713a,0x3f003a06,0,0x3e3857ec,0x3eb554ec,0x3f044889
.long 0,0x3e3e853e,0x3ebb31a0,0x3f084b92,0,0x3e44b0b9,0x3ec1071e,0x3f0c42c9
.long 0x3c490e90,0x3c7b514b,0x3c96c9b6,0x3cafea69,0x3d16c32c,0x3d3c6dd5,0x3d621469,0x3d83db0a
.long 0x3d7b2b74,0x3d9cecf9,0x3dbc3ac3,0x3ddb7d37,0x3dafb680,0x3ddb7d37,0x3e039502,0x3e195be0
.long 0x3de1bc2e,0x3e0cec4a,0x3e28defc,0x3e44b0b9,0x3e09cf86,0x3e2bf804,0x3e4dee60,0x3e6fa8b2
.long 0x3e22abb6,0x3e4ada4f,0x3e72b651,0x3e8d17c0,0x3e3b6ecf,0x3e698bba,0x3e8b9507,0x3ea21887
.long 0x3e541501,0x3e840270,0x3e9d9e78,0x3eb6ccc3,0x3e6c9a7f,0x3e931f35,0x3eaf713a,0x3ecb2aae
.long 0x3e827dc0,0x3ea21887,0x3ec1071e,0x3edf28a9,0x3e8e9a22,0x3eb0eacb,0x3ed25a09,0x3ef2bd43
.long 0x3e9aa086,0x3ebf926f,0x3ee363fa,0x3f02ef9f,0x3ea68f12,0x3ece0bea,0x3ef41f07,0x3f0c42c9
.long 0x3eb263ef,0x3edc53c1,0x3f0242b1,0x3f1553b7,0x3ebe1d4a,0x3eea6681,0x3f0a48ad,0x3f1e1e22
.long 0x3ec9b953,0x3ef840c8,0x3f121eb0,0x3f269de3,0x3ed53641,0x3f02ef9f,0x3f19c200,0x3f2ecef7
.long 0x3ee0924f,0x3f099f4e,0x3f212ff9,0x3f36ad7f,0x3eebcbbb,0x3f102dd5,0x3f286605,0x3f3e35c5
.long 0x3ef6e0cb,0x3f16999f,0x3f2f61a5,0x3f456439,0x3f00e7e4,0x3f1ce11f,0x3f36206c,0x3f4c3578
.long 0x3f064b82,0x3f2302d3,0x3f3ca003,0x3f52a649,0x3f0b9a6b,0x3f28fd41,0x3f42de29,0x3f58b3a1
.long 0x3f10d3cd,0x3f2ecef7,0x3f48d8b3,0x3f5e5aa6,0x3f15f6d9,0x3f34768f,0x3f4e8d90,0x3f6398ac
.long 0x3f1b02c6,0x3f39f2ac,0x3f53fac3,0x3f686b39,0x3f1ff6cb,0x3f3f41fc,0x3f591e6a,0x3f6cd007
.long 0x3f24d225,0x3f446337,0x3f5df6be,0x3f70c501,0x3f299415,0x3f495521,0x3f628210,0x3f74484b
.long 0x3f2e3bde,0x3f4e1689,0x3f66becc,0x3f77583a,0x3f32c8c9,0x3f52a649,0x3f6aab7b,0x3f79f35e
.long 0x3cc90ab0,0x3ce22a7a,0x3cfb49ba,0x3d0a342f,0x3d96a905,0x3da973ba,0x3dbc3ac3,0x3dcefdb7
.long 0x3dfab273,0x3e0cec4a,0x3e1c76de,0x3e2bf804,0x3e2f10a2,0x3e44b0b9,0x3e5a3997,0x3e6fa8b2
.long 0x3e605c13,0x3e7bdba4,0x3e8b9507,0x3e9920fe,0x3e888e93,0x3e9920fe,0x3ea986c4,0x3eb9bb1e
.long 0x3ea09ae5,0x3eb3dca5,0x3ec6d529,0x3ed97cb9,0x3eb8442a,0x3ece0bea,0x3ee363fa,0x3ef840c8
.long 0x3ecf7bca,0x3ee79a5d,0x3eff17b2,0x3f0af1b7,0x3ee63375,0x3f003a06,0x3f0cead0,0x3f19210f
.long 0x3efc5d27,0x3f0c42c9,0x3f19c200,0x3f269de3,0x3f08f59b,0x3f17de12,0x3f26050a,0x3f33587a
.long 0x3f13682a,0x3f2302d3,0x3f31a81d,0x3f3f41fc,0x3f1d7fd1,0x3f2da859,0x3f3ca003,0x3f4a4c87
.long 0x3f273656,0x3f37c655,0x3f46e22a,0x3f546b3b,0x3f3085bb,0x3f4154e1,0x3f5064af,0x3f5d924d
.long 0x3f396842,0x3f4a4c87,0x3f591e6a,0x3f65b710,0x3f41d870,0x3f52a649,0x3f6106f2,0x3f6cd007
.long 0x3f49d112,0x3f5a5ba0,0x3f6816a8,0x3f72d4eb,0x3f514d3d,0x3f61668a,0x3f6e46be,0x3f77beb7
.long 0x3f584853,0x3f67c187,0x3f73913f,0x3f7b87b2,0x3f5ebe05,0x3f6d67a1,0x3f77f110,0x3f7e2b72
.long 0x3f64aa59,0x3f725470,0x3f7b61fc,0x3f7fa6e3,0x3f6a09a7,0x3f76841b,0x3f7de0b1,0x3f7ff84a
.long 0x3f6ed89e,0x3f79f35e,0x3f7f6ac7,0x3f7f1f49,0x3f731447,0x3f7c9f8a,0x3f7ffec4,0x3f7d1cdd
.long 0x3f76ba07,0x3f7e868b,0x3f7f9c18,0x3f79f35e,0x3f79c79d,0x3f7fa6e3,0x3f7e4323,0x3f75a67b
.long 0x3f7c3b28,0x3f7fffb1,0x3f7bf531,0x3f703b37,0x3f7e1324,0x3f7f90b1,0x3f78b47b,0x3f69b7e4
.long 0x3f7f4e6d,0x3f7e5a38,0x3f748422,0x3f62241a,0x3f7fec43,0x3f7c5d3a,0x3f6f6830,0x3f5988ad
.long 0x3d16c32c,0x3d2351cb,0x3d2fe007,0x3d3c6dd5,0x3de1bc2e,0x3df475c0,0x3e039502,0x3e0cec4a
.long 0x3e3b6ecf,0x3e4ada4f,0x3e5a3997,0x3e698bba,0x3e827dc0,0x3e8d17c0,0x3e97a117,0x3ea21887
.long 0x3ea68f12,0x3eb3dca5,0x3ec1071e,0x3ece0bea,0x3ec9b953,0x3ed97cb9,0x3ee900b7,0x3ef840c8
.long 0x3eebcbbb,0x3efdbabb,0x3f07a136,0x3f102dd5,0x3f064b82,0x3f102dd5,0x3f19c200,0x3f2302d3
.long 0x3f15f6d9,0x3f209393,0x3f2ac082,0x3f34768f,0x3f24d225,0x3f2ff3e6,0x3f3a7ca4,0x3f446337
.long 0x3f32c8c9,0x3f3e35c5,0x3f48d8b3,0x3f52a649,0x3f3fc767,0x3f4b41fa,0x3f55b993,0x3f5f20db
.long 0x3f4bbbf8,0x3f570348,0x3f6106f2,0x3f69b7e4,0x3f5695e5,0x3f61668a,0x3f6aab7b,0x3f725470
.long 0x3f604621,0x3f6a5ad9,0x3f7294f8,0x3f78e3d6,0x3f68bf3c,0x3f71d19f,0x3f78b47b,0x3f7d57de
.long 0x3f6ff573,0x3f77beb7,0x3f7cfe73,0x3f7fa6e3,0x3f75dec6,0x3f7c187a,0x3f7f6ac7,0x3f7fcbe2
.long 0x3f7a7302,0x3f7ed7d4,0x3f7ff4e6,0x3f7dc68c,0x3f7dabcc,0x3f7ff84a,0x3f7e9bc9,0x3f799b43
.long 0x3f7f84ab,0x3f7f7808,0x3f7b61fc,0x3f73530e,0x3f7ffb11,0x3f7d57de,0x3f764d97,0x3f6afb8c
.long 0x3f7f0e58,0x3f799b43,0x3f6f6830,0x3f60a6cf,0x3f7cbfc9,0x3f74484b,0x3f66becc,0x3f546b3b
.long 0x3f791298,0x3f6d67a1,0x3f5c61c7,0x3f466354,0x3f740bdd,0x3f650479,0x3f5064af,0x3f36ad7f
.long 0x3f6db293,0x3f5b2c79,0x3f42de29,0x3f256bcb,0x3f660f88,0x3f4fefa8,0x3f33e7bc,0x3f12c39a
.long 0x3f5d2d53,0x3f436051,0x3f239da9,0x3efdbabb,0x3f531849,0x3f3592e7,0x3f121eb0,0x3ed3c867
.long 0x3f47de65,0x3f269de3,0x3eff17b2,0x3ea80b1f,0x3f3b8f3b,0x3f16999f,0x3ed8106b,0x3e75c35a
.long 0x3d48fb30,0x3d55880e,0x3d621469,0x3d6ea038,0x3e164083,0x3e1f917b,0x3e28defc,0x3e3228d4
.long 0x3e78cfcc,0x3e840270,0x3e8b9507,0x3e931f35,0x3eac7cd4,0x3eb6ccc3,0x3ec1071e,0x3ecb2aae
.long 0x3edae880,0x3ee79a5d,0x3ef41f07,0x3f003a06,0x3f039c3d,0x3f0af1b7,0x3f121eb0,0x3f19210f
.long 0x3f187fc0,0x3f209393,0x3f286605,0x3f2ff3e6,0x3f2beb4a,0x3f34768f,0x3f3ca003,0x3f446337
.long 0x3f3daef9,0x3f466354,0x3f4e8d90,0x3f5627fe,0x3f4d9f02,0x3f5627fe,0x3f5df6be,0x3f650479
.long 0x3f5b941a,0x3f6398ac,0x3f6aab7b,0x3f70c501,0x3f676bd8,0x3f6e8ff8,0x3f748422,0x3f7940c0
.long 0x3f710908,0x3f76ef5b,0x3f7b61fc,0x3f7e5a38,0x3f7853f8,0x3f7c9f8a,0x3f7f2f9d,0x3f7fffb1
.long 0x3f7d3aac,0x3f7f90b1,0x3f7fe129,0x3f7e2b72,0x3f7fb10f,0x3f7fba9e,0x3f7d7474,0x3f78e3d6
.long 0x3f7fb10f,0x3f7d1cdd,0x3f77f110,0x3f703b37,0x3f7d3aac,0x3f77beb7,0x3f6f6830,0x3f644fac
.long 0x3f7853f8,0x3f6faf1b,0x3f63f473,0x3f554aa4,0x3f710908,0x3f650479,0x3f55b993,0x3f436051
.long 0x3f676bd8,0x3f57dc7f,0x3f44e3f5,0x3f2ecef7,0x3f5b941a,0x3f485bca,0x3f31a81d,0x3f17de12
.long 0x3f4d9f02,0x3f36ad7f,0x3f1c420c,0x3efdbabb,0x3f3daef9,0x3f2302d3,0x3f04f484,0x3ec8477c
.long 0x3f2beb4a,0x3f0d9281,0x3ed8106b,0x3e901c2c,0x3f187fc0,0x3eed3063,0x3ea395c5,0x3e2bf804
.long 0x3f039c3d,0x3ebca7af,0x3e5a3997,0x3d55880e,0x3edae880,0x3e8a11f7,0x3dd53db9,0xbd83db0a
.long 0x3eac7cd4,0x3e2bf804,0xbbc90f88,0xbe3857ec,0x3e78cfcc,0x3d83db0a,0xbdee3876,0xbe9620d2
.long 0x3e164083,0xbd2351cb,0xbe667c66,0xbece0bea,0x3d48fb30,0xbe1324ca,0xbea986c4,0xbf019573
.long 0x3d7b2b74,0x3d83db0a,0x3d8a200a,0x3d9064b4,0x3e3b6ecf,0x3e44b0b9,0x3e4dee60,0x3e57278f
.long 0x3e9aa086,0x3ea21887,0x3ea986c4,0x3eb0eacb,0x3ed53641,0x3edf28a9,0x3ee900b7,0x3ef2bd43
.long 0x3f064b82,0x3f0c42c9,0x3f121eb0,0x3f17de12,0x3f1ff6cb,0x3f269de3,0x3f2d1469,0x3f33587a
.long 0x3f373a23,0x3f3e35c5,0x3f44e3f5,0x3f4b41fa,0x3f4bbbf8,0x3f52a649,0x3f591e6a,0x3f5f20db
.long 0x3f5d2d53,0x3f6398ac,0x3f696591,0x3f6e8ff8,0x3f6b4b0c,0x3f70c501,0x3f756d97,0x3f7940c0
.long 0x3f75dec6,0x3f79f35e,0x3f7cfe73,0x3f7efcc9,0x3f7cbfc9,0x3f7efcc9,0x3f7ff4e6,0x3f7fa6e3
.long 0x3f7fd397,0x3f7fcbe2,0x3f7e4323,0x3f7b3bab,0x3f7f0e58,0x3f7c5d3a,0x3f77f110,0x3f71d19f
.long 0x3f7a7302,0x3f74bf62,0x3f6d1c1d,0x3f6398ac,0x3f721352,0x3f6912ae,0x3f5df6be,0x3f50d937
.long 0x3f660f88,0x3f5988ad,0x3f4ac77f,0x3f39f2ac,0x3f5695e5,0x3f466354,0x3f33e7bc,0x3f1f599f
.long 0x3f43e200,0x3f2ff3e6,0x3f19c200,0x3f019573,0x3f2e3bde,0x3f16999f,0x3ef9a02d,0x3ec27b55
.long 0x3f15f6d9,0x3ef58035,0x3ebb31a0,0x3e7bdba4,0x3ef6e0cb,0x3eb9bb1e,0x3e72b651,0x3ddb7d37
.long 0x3ebe1d4a,0x3e75c35a,0x3dd53db9,0xbd0a342f,0x3e827dc0,0x3de7fa9a,0xbcfb49ba,0xbe3228d4
.long 0x3e09cf86,0xbc7b514b,0xbe28defc,0xbe9f1cdf,0x3c490e90,0xbe1324ca,0xbe97a117,0xbee1fb6a
.long 0xbde1bc2e,0xbe8a11f7,0xbed8106b,0xbf102dd5,0xbe6c9a7f,0xbec8477c,0xbf0a48ad,0xbf2c800f
.long 0xbeb263ef,0xbf019573,0xbf26050a,0xbf456439,0xbeebcbbb,0xbf1ce11f,0xbf3ebc1b,0xbf5a5ba0
.long 0xbf10d3cd,0xbf3592e7,0xbf53fac3,0xbf6afb8c,0xbf299415,0xbf4b41fa,0xbf655e0b,0xbf76ef5b
.long 0x3d96a905,0x3d9cecf9,0x3da3308c,0x3da973ba,0x3e605c13,0x3e698bba,0x3e72b651,0x3e7bdba4
.long 0x3eb8442a,0x3ebf926f,0x3ec6d529,0x3ece0bea,0x3efc5d27,0x3f02ef9f,0x3f07a136,0x3f0c42c9
.long 0x3f1d7fd1,0x3f2302d3,0x3f286605,0x3f2da859,0x3f396842,0x3f3f41fc,0x3f44e3f5,0x3f4a4c87
.long 0x3f514d3d,0x3f570348,0x3f5c61c7,0x3f61668a,0x3f64aa59,0x3f69b7e4,0x3f6e46be,0x3f725470
.long 0x3f731447,0x3f76ef5b,0x3f7a1e84,0x3f7c9f8a,0x3f7c3b28,0x3f7e5a38,0x3f7f9c18,0x3f7fffb1
.long 0x3f7fec43,0x3f7fcbe2,0x3f7e9bc9,0x3f7c5d3a,0x3f7e1324,0x3f7b3bab,0x3f772417,0x3f71d19f
.long 0x3f76ba07,0x3f70c501,0x3f696591,0x3f60a6cf,0x3f6a09a7,0x3f60a6cf,0x3f55b993,0x3f495521
.long 0x3f584853,0x3f4b41fa,0x3f3ca003,0x3f2c800f,0x3f41d870,0x3f311722,0x3f1ebc12,0x3f0af1b7
.long 0x3f273656,0x3f12c39a,0x3ef9a02d,0x3ecb2aae,0x3f08f59b,0x3ee1fb6a,0x3eaf713a,0x3e75c35a
.long 0x3ecf7bca,0x3e9920fe,0x3e419b37,0x3d9cecf9,0x3e888e93,0x3e195be0,0x3cfb49ba,0xbdb5f8da
.long 0x3dfab273,0xbb490fc6,0xbe039502,0xbe80f8c0,0xbcc90ab0,0xbe1f917b,0xbe919ddd,0xbed0eb2a
.long 0xbe2f10a2,0xbe9c1faf,0xbeddbe79,0xbf0d9281,0xbea09ae5,0xbee4cbfe,0xbf121eb0,0xbf2ecef7
.long 0xbee63375,0xbf140c5f,0xbf31a81d,0xbf4b41fa,0xbf13682a,0xbf3238aa,0xbf4cae79,0xbf62241a
.long 0xbf3085bb,0xbf4c3578,0xbf628210,0xbf72d4eb,0xbf49d112,0xbf61668a,0xbf7294f8,0xbf7cdf6c
.long 0xbf5ebe05,0xbf714c7a,0xbf7c7eb0,0xbf7ffd39,0xbf6ed89e,0xbf7b87b2,0xbf7ffec4,0xbf7c187a
.long 0xbf79c79d,0xbf7fdaaf,0xbf7cfe73,0xbf714c7a,0xbf7f4e6d,0xbf7e2b72,0xbf73913f,0xbf5fe4e9
.long 0x3dafb680,0x3db5f8da,0x3dbc3ac3,0x3dc27c39,0x3e827dc0,0x3e870ada,0x3e8b9507,0x3e901c2c
.long 0x3ed53641,0x3edc53c1,0x3ee363fa,0x3eea6681,0x3f10d3cd,0x3f1553b7,0x3f19c200,0x3f1e1e22
.long 0x3f32c8c9,0x3f37c655,0x3f3ca003,0x3f4154e1,0x3f4f7a1f,0x3f546b3b,0x3f591e6a,0x3f5d924d
.long 0x3f660f88,0x3f6a5ad9,0x3f6e46be,0x3f71d19f,0x3f75dec6,0x3f78e3d6,0x3f7b61fc,0x3f7d57de
.long 0x3f7e70b0,0x3f7f90b1,0x3f7ffec4,0x3f7fba9e,0x3f7f84ab,0x3f7e2b72,0x3f7bf531,0x3f78e3d6
.long 0x3f791298,0x3f74bf62,0x3f6f6830,0x3f6912ae,0x3f6b4b0c,0x3f6398ac,0x3f5ac450,0x3f50d937
.long 0x3f5695e5,0x3f4b41fa,0x3f3ebc1b,0x3f311722,0x3f3b8f3b,0x3f2c800f,0x3f1c420c,0x3f0af1b7
.long 0x3f1b02c6,0x3f084b92,0x3ee900b7,0x3ebf926f,0x3eebcbbb,0x3ebf926f,0x3e919ddd,0x3e44b0b9
.long 0x3e9aa086,0x3e5101f1,0x3dd53db9,0x3b490fc6,0x3e09cf86,0x3ce22a7a,0xbda3308c,0xbe3e853e
.long 0xbd16c32c,0xbe195be0,0xbe8586ce,0xbebca7af,0xbe541501,0xbea5129f,0xbeddbe79,0xbf099f4e
.long 0xbebe1d4a,0xbef840c8,0xbf173c07,0xbf2ff3e6,0xbf064b82,0xbf21cbfb,0xbf3a7ca4,0xbf4fefa8
.long 0xbf299415,0xbf425b89,0xbf577026,0xbf686b39,0xbf47de65,0xbf5cc7d1,0xbf6d1c1d,0xbf788486
.long 0xbf604621,0xbf703b37,0xbf7ac516,0xbf7fa6e3,0xbf721352,0xbf7c187a,0xbf7ff4e6,0xbf7d906e
.long 0xbf7cbfc9,0xbf7fffb1,0xbf7c7eb0,0xbf725470,0xbf7ffb11,0xbf7bd14d,0xbf708066,0xbf5e5aa6
.long 0xbf7baccd,0xbf6faf1b,0xbf5c61c7,0xbf425b89,0xbf6ff573,0xbf5bfb34,0xbf40d0da,0xbf1f599f
.long 0xbf5d2d53,0xbf4154e1,0xbf1ebc12,0xbeed3063,0xbf43e200,0xbf209393,0xbeee9479,0xbe931f35
.long 0x3f80,0x3f80,0x3f80,0x3f80,0x3f80,0x3e483f7b,0x3ec43f6d,0x3f0e3f55
.long 0x3f80,0x3ec43f6d,0x3f353f35,0x3f6d3ec4,0x3f80,0x3f0e3f55,0x3f6d3ec4,0x3f7bbe48
.long 0x3f80,0x3f353f35,0x3f800000,0x3f35bf35,0x3f80,0x3f553f0e,0x3f6dbec4,0x3e48bf7b
.long 0x3f80,0x3f6d3ec4,0x3f35bf35,0xbec4bf6d,0x3f80,0x3f7b3e48,0x3ec4bf6d,0xbf55bf0e
.long 0x3f80,0x3f800000,0xbf80,0xbf800000,0x3f80,0x3f7bbe48,0xbec4bf6d,0xbf553f0e
.long 0x3f80,0x3f6dbec4,0xbf35bf35,0xbec43f6d,0x3f80,0x3f55bf0e,0xbf6dbec4,0x3e483f7b
.long 0x3f80,0x3f35bf35,0xbf800000,0x3f353f35,0x3f80,0x3f0ebf55,0xbf6d3ec4,0x3f7b3e48
.long 0x3f80,0x3ec4bf6d,0xbf353f35,0x3f6dbec4,0x3f80,0x3e48bf7b,0xbec43f6d,0x3f0ebf55
.long 0x3f80,0xbf80,0x3f80,0xbf80,0x3f80,0xbe48bf7b,0x3ec43f6d,0xbf0ebf55
.long 0x3f80,0xbec4bf6d,0x3f353f35,0xbf6dbec4,0x3f80,0xbf0ebf55,0x3f6d3ec4,0xbf7b3e48
.long 0x3f80,0xbf35bf35,0x3f800000,0xbf353f35,0x3f80,0xbf55bf0e,0x3f6dbec4,0xbe483f7b
.long 0x3f80,0xbf6dbec4,0x3f35bf35,0x3ec43f6d,0x3f80,0xbf7bbe48,0x3ec4bf6d,0x3f553f0e
.long 0x3f80,0xbf800000,0xbf80,0x3f800000,0x3f80,0xbf7b3e48,0xbec4bf6d,0x3f55bf0e
.long 0x3f80,0xbf6d3ec4,0xbf35bf35,0x3ec4bf6d,0x3f80,0xbf553f0e,0xbf6dbec4,0xbe48bf7b
.long 0x3f80,0xbf353f35,0xbf800000,0xbf35bf35,0x3f80,0xbf0e3f55,0xbf6d3ec4,0xbf7bbe48
.long 0x3f80,0xbec43f6d,0xbf353f35,0xbf6d3ec4,0x3f80,0xbe483f7b,0xbec43f6d,0xbf0e3f55
.long 0x3f80,0x3f80,0x3f80,0x3f80,0x3f353f35,0x3f553f0e,0x3f6d3ec4,0x3f7b3e48
.long 0x3f800000,0x3f6dbec4,0x3f35bf35,0x3ec4bf6d,0x3f35bf35,0x3e48bf7b,0xbec4bf6d,0xbf55bf0e
.long 0xbf80,0xbf35bf35,0xbf800000,0xbf353f35,0xbf35bf35,0xbf7b3e48,0xbec43f6d,0x3f0e3f55
.long 0xbf800000,0xbec43f6d,0x3f353f35,0x3f6dbec4,0xbf353f35,0x3f0e3f55,0x3f6dbec4,0xbe48bf7b
.long 0x3f80,0x3f800000,0xbf80,0xbf800000,0x3f353f35,0x3f0ebf55,0xbf6dbec4,0xbe483f7b
.long 0x3f800000,0xbec4bf6d,0xbf353f35,0x3f6d3ec4,0x3f35bf35,0xbf7bbe48,0x3ec43f6d,0x3f0ebf55
.long 0xbf80,0xbf353f35,0x3f800000,0xbf35bf35,0xbf35bf35,0x3e483f7b,0x3ec4bf6d,0xbf553f0e
.long 0xbf800000,0x3f6d3ec4,0xbf35bf35,0x3ec43f6d,0xbf353f35,0x3f55bf0e,0xbf6d3ec4,0x3f7bbe48
.long 0x3f80,0xbf80,0x3f80,0xbf80,0x3f353f35,0xbf55bf0e,0x3f6d3ec4,0xbf7bbe48
.long 0x3f800000,0xbf6d3ec4,0x3f35bf35,0xbec43f6d,0x3f35bf35,0xbe483f7b,0xbec4bf6d,0x3f553f0e
.long 0xbf80,0x3f353f35,0xbf800000,0x3f35bf35,0xbf35bf35,0x3f7bbe48,0xbec43f6d,0xbf0ebf55
.long 0xbf800000,0x3ec4bf6d,0x3f353f35,0xbf6d3ec4,0xbf353f35,0xbf0ebf55,0x3f6dbec4,0x3e483f7b
.long 0x3f80,0xbf800000,0xbf80,0x3f800000,0x3f353f35,0xbf0e3f55,0xbf6dbec4,0x3e48bf7b
.long 0x3f800000,0x3ec43f6d,0xbf353f35,0xbf6dbec4,0x3f35bf35,0x3f7b3e48,0x3ec43f6d,0xbf0e3f55
.long 0xbf80,0x3f35bf35,0x3f800000,0x3f353f35,0xbf35bf35,0xbe48bf7b,0x3ec4bf6d,0x3f55bf0e
.long 0xbf800000,0xbf6dbec4,0xbf35bf35,0xbec4bf6d,0xbf353f35,0xbf553f0e,0xbf6d3ec4,0xbf7b3e48
.long 0x3f80,0x3f80,0x3f80,0x3f80,0x3f800000,0x3f7bbe48,0x3f6dbec4,0x3f55bf0e
.long 0xbf80,0xbec4bf6d,0xbf35bf35,0xbf6dbec4,0xbf800000,0xbf553f0e,0xbec43f6d,0x3e483f7b
.long 0x3f80,0x3f353f35,0x3f800000,0x3f35bf35,0x3f800000,0x3f0ebf55,0xbec4bf6d,0xbf7bbe48
.long 0xbf80,0xbf6dbec4,0xbf353f35,0x3ec43f6d,0xbf800000,0xbe483f7b,0x3f6d3ec4,0x3f0ebf55
.long 0x3f80,0x3f800000,0xbf80,0xbf800000,0x3f800000,0xbe48bf7b,0xbf6d3ec4,0x3f0e3f55
.long 0xbf80,0xbf6d3ec4,0x3f353f35,0x3ec4bf6d,0xbf800000,0x3f0e3f55,0x3ec4bf6d,0xbf7b3e48
.long 0x3f80,0x3f35bf35,0xbf800000,0x3f353f35,0x3f800000,0xbf55bf0e,0x3ec43f6d,0x3e48bf7b
.long 0xbf80,0xbec43f6d,0x3f35bf35,0xbf6d3ec4,0xbf800000,0x3f7b3e48,0xbf6dbec4,0x3f553f0e
.long 0x3f80,0xbf80,0x3f80,0xbf80,0x3f800000,0xbf7b3e48,0x3f6dbec4,0xbf553f0e
.long 0xbf80,0x3ec43f6d,0xbf35bf35,0x3f6d3ec4,0xbf800000,0x3f55bf0e,0xbec43f6d,0xbe48bf7b
.long 0x3f80,0xbf35bf35,0x3f800000,0xbf353f35,0x3f800000,0xbf0e3f55,0xbec4bf6d,0x3f7b3e48
.long 0xbf80,0x3f6d3ec4,0xbf353f35,0xbec4bf6d,0xbf800000,0x3e48bf7b,0x3f6d3ec4,0xbf0e3f55
.long 0x3f80,0xbf800000,0xbf80,0x3f800000,0x3f800000,0x3e483f7b,0xbf6d3ec4,0xbf0ebf55
.long 0xbf80,0x3f6dbec4,0x3f353f35,0xbec43f6d,0xbf800000,0xbf0ebf55,0x3ec4bf6d,0x3f7bbe48
.long 0x3f80,0xbf353f35,0xbf800000,0xbf35bf35,0x3f800000,0x3f553f0e,0x3ec43f6d,0xbe483f7b
.long 0xbf80,0x3ec4bf6d,0x3f35bf35,0x3f6dbec4,0xbf800000,0xbf7bbe48,0xbf6dbec4,0xbf55bf0e
.long 0x3f80,0x3f80,0x3f80,0x3f80,0x3f35bf35,0x3f0ebf55,0x3ec4bf6d,0x3e48bf7b
.long 0xbf800000,0xbf6d3ec4,0xbf353f35,0xbec43f6d,0x3f353f35,0x3f7b3e48,0x3f6dbec4,0x3f0ebf55
.long 0xbf80,0xbf35bf35,0xbf800000,0xbf353f35,0xbf353f35,0x3e483f7b,0x3f6d3ec4,0x3f55bf0e
.long 0x3f800000,0x3ec4bf6d,0xbf35bf35,0xbf6d3ec4,0xbf35bf35,0xbf553f0e,0x3ec43f6d,0x3f7bbe48
.long 0x3f80,0x3f800000,0xbf80,0xbf800000,0x3f35bf35,0xbf55bf0e,0xbec43f6d,0x3f7b3e48
.long 0xbf800000,0x3ec43f6d,0x3f35bf35,0xbf6dbec4,0x3f353f35,0x3e48bf7b,0xbf6d3ec4,0x3f553f0e
.long 0xbf80,0xbf353f35,0x3f800000,0xbf35bf35,0xbf353f35,0x3f7bbe48,0xbf6dbec4,0x3f0e3f55
.long 0x3f800000,0xbf6dbec4,0x3f353f35,0xbec4bf6d,0xbf35bf35,0x3f0e3f55,0xbec4bf6d,0x3e483f7b
.long 0x3f80,0xbf80,0x3f80,0xbf80,0x3f35bf35,0xbf0e3f55,0x3ec4bf6d,0xbe483f7b
.long 0xbf800000,0x3f6dbec4,0xbf353f35,0x3ec4bf6d,0x3f353f35,0xbf7bbe48,0x3f6dbec4,0xbf0e3f55
.long 0xbf80,0x3f353f35,0xbf800000,0x3f35bf35,0xbf353f35,0xbe48bf7b,0x3f6d3ec4,0xbf553f0e
.long 0x3f800000,0xbec43f6d,0xbf35bf35,0x3f6dbec4,0xbf35bf35,0x3f55bf0e,0x3ec43f6d,0xbf7b3e48
.long 0x3f80,0xbf800000,0xbf80,0x3f800000,0x3f35bf35,0x3f553f0e,0xbec43f6d,0xbf7bbe48
.long 0xbf800000,0xbec4bf6d,0x3f35bf35,0x3f6d3ec4,0x3f353f35,0xbe483f7b,0xbf6d3ec4,0xbf55bf0e
.long 0xbf80,0x3f35bf35,0x3f800000,0x3f353f35,0xbf353f35,0xbf7b3e48,0xbf6dbec4,0xbf0ebf55
.long 0x3f800000,0x3f6d3ec4,0x3f353f35,0x3ec43f6d,0xbf35bf35,0xbf0ebf55,0xbec4bf6d,0xbe48bf7b
.long 0x3f80,0x3f80,0x3f80,0x3f80,0xbf80,0xbe48bf7b,0xbec4bf6d,0xbf0ebf55
.long 0x3f80,0x3ec43f6d,0x3f353f35,0x3f6d3ec4,0xbf80,0xbf0ebf55,0xbf6dbec4,0xbf7b3e48
.long 0x3f80,0x3f353f35,0x3f800000,0x3f35bf35,0xbf80,0xbf55bf0e,0xbf6d3ec4,0xbe483f7b
.long 0x3f80,0x3f6d3ec4,0x3f35bf35,0xbec4bf6d,0xbf80,0xbf7bbe48,0xbec43f6d,0x3f553f0e
.long 0x3f80,0x3f800000,0xbf80,0xbf800000,0xbf80,0xbf7b3e48,0x3ec43f6d,0x3f55bf0e
.long 0x3f80,0x3f6dbec4,0xbf35bf35,0xbec43f6d,0xbf80,0xbf553f0e,0x3f6d3ec4,0xbe48bf7b
.long 0x3f80,0x3f35bf35,0xbf800000,0x3f353f35,0xbf80,0xbf0e3f55,0x3f6dbec4,0xbf7bbe48
.long 0x3f80,0x3ec4bf6d,0xbf353f35,0x3f6dbec4,0xbf80,0xbe483f7b,0x3ec4bf6d,0xbf0e3f55
.long 0x3f80,0xbf80,0x3f80,0xbf80,0xbf80,0x3e483f7b,0xbec4bf6d,0x3f0e3f55
.long 0x3f80,0xbec4bf6d,0x3f353f35,0xbf6dbec4,0xbf80,0x3f0e3f55,0xbf6dbec4,0x3f7bbe48
.long 0x3f80,0xbf35bf35,0x3f800000,0xbf353f35,0xbf80,0x3f553f0e,0xbf6d3ec4,0x3e48bf7b
.long 0x3f80,0xbf6dbec4,0x3f35bf35,0x3ec43f6d,0xbf80,0x3f7b3e48,0xbec43f6d,0xbf55bf0e
.long 0x3f80,0xbf800000,0xbf80,0x3f800000,0xbf80,0x3f7bbe48,0x3ec43f6d,0xbf553f0e
.long 0x3f80,0xbf6d3ec4,0xbf35bf35,0x3ec4bf6d,0xbf80,0x3f55bf0e,0x3f6d3ec4,0x3e483f7b
.long 0x3f80,0xbf353f35,0xbf800000,0xbf35bf35,0xbf80,0x3f0ebf55,0x3f6dbec4,0x3f7b3e48
.long 0x3f80,0xbec43f6d,0xbf353f35,0xbf6d3ec4,0xbf80,0x3e48bf7b,0x3ec4bf6d,0x3f0ebf55
.long 0x3f80,0x3f80,0x3f80,0x3f80,0xbf35bf35,0xbf55bf0e,0xbf6dbec4,0xbf7bbe48
.long 0x3f800000,0x3f6dbec4,0x3f35bf35,0x3ec4bf6d,0xbf353f35,0xbe483f7b,0x3ec43f6d,0x3f553f0e
.long 0xbf80,0xbf35bf35,0xbf800000,0xbf353f35,0x3f353f35,0x3f7bbe48,0x3ec4bf6d,0xbf0ebf55
.long 0xbf800000,0xbec43f6d,0x3f353f35,0x3f6dbec4,0x3f35bf35,0xbf0ebf55,0xbf6d3ec4,0x3e483f7b
.long 0x3f80,0x3f800000,0xbf80,0xbf800000,0xbf35bf35,0xbf0e3f55,0x3f6d3ec4,0x3e48bf7b
.long 0x3f800000,0xbec4bf6d,0xbf353f35,0x3f6d3ec4,0xbf353f35,0x3f7b3e48,0xbec4bf6d,0xbf0e3f55
.long 0xbf80,0xbf353f35,0x3f800000,0xbf35bf35,0x3f353f35,0xbe48bf7b,0xbec43f6d,0x3f55bf0e
.long 0xbf800000,0x3f6d3ec4,0xbf35bf35,0x3ec43f6d,0x3f35bf35,0xbf553f0e,0x3f6dbec4,0xbf7b3e48
.long 0x3f80,0xbf80,0x3f80,0xbf80,0xbf35bf35,0x3f553f0e,0xbf6dbec4,0x3f7b3e48
.long 0x3f800000,0xbf6d3ec4,0x3f35bf35,0xbec43f6d,0xbf353f35,0x3e48bf7b,0x3ec43f6d,0xbf55bf0e
.long 0xbf80,0x3f353f35,0xbf800000,0x3f35bf35,0x3f353f35,0xbf7b3e48,0x3ec4bf6d,0x3f0e3f55
.long 0xbf800000,0x3ec4bf6d,0x3f353f35,0xbf6d3ec4,0x3f35bf35,0x3f0e3f55,0xbf6d3ec4,0xbe48bf7b
.long 0x3f80,0xbf800000,0xbf80,0x3f800000,0xbf35bf35,0x3f0ebf55,0x3f6d3ec4,0xbe483f7b
.long 0x3f800000,0x3ec43f6d,0xbf353f35,0xbf6dbec4,0xbf353f35,0xbf7bbe48,0xbec4bf6d,0x3f0ebf55
.long 0xbf80,0x3f35bf35,0x3f800000,0x3f353f35,0x3f353f35,0x3e483f7b,0xbec43f6d,0xbf553f0e
.long 0xbf800000,0xbf6dbec4,0xbf35bf35,0xbec4bf6d,0x3f35bf35,0x3f55bf0e,0x3f6dbec4,0x3f7bbe48
.long 0x3f80,0x3f80,0x3f80,0x3f80,0xbf800000,0xbf7b3e48,0xbf6d3ec4,0xbf553f0e
.long 0xbf80,0xbec4bf6d,0xbf35bf35,0xbf6dbec4,0x3f800000,0x3f55bf0e,0x3ec4bf6d,0xbe48bf7b
.long 0x3f80,0x3f353f35,0x3f800000,0x3f35bf35,0xbf800000,0xbf0e3f55,0x3ec43f6d,0x3f7b3e48
.long 0xbf80,0xbf6dbec4,0xbf353f35,0x3ec43f6d,0x3f800000,0x3e48bf7b,0xbf6dbec4,0xbf0e3f55
.long 0x3f80,0x3f800000,0xbf80,0xbf800000,0xbf800000,0x3e483f7b,0x3f6dbec4,0xbf0ebf55
.long 0xbf80,0xbf6d3ec4,0x3f353f35,0x3ec4bf6d,0x3f800000,0xbf0ebf55,0xbec43f6d,0x3f7bbe48
.long 0x3f80,0x3f35bf35,0xbf800000,0x3f353f35,0xbf800000,0x3f553f0e,0xbec4bf6d,0xbe483f7b
.long 0xbf80,0xbec43f6d,0x3f35bf35,0xbf6d3ec4,0x3f800000,0xbf7bbe48,0x3f6d3ec4,0xbf55bf0e
.long 0x3f80,0xbf80,0x3f80,0xbf80,0xbf800000,0x3f7bbe48,0xbf6d3ec4,0x3f55bf0e
.long 0xbf80,0x3ec43f6d,0xbf35bf35,0x3f6d3ec4,0x3f800000,0xbf553f0e,0x3ec4bf6d,0x3e483f7b
.long 0x3f80,0xbf35bf35,0x3f800000,0xbf353f35,0xbf800000,0x3f0ebf55,0x3ec43f6d,0xbf7bbe48
.long 0xbf80,0x3f6d3ec4,0xbf353f35,0xbec4bf6d,0x3f800000,0xbe483f7b,0xbf6dbec4,0x3f0ebf55
.long 0x3f80,0xbf800000,0xbf80,0x3f800000,0xbf800000,0xbe48bf7b,0x3f6dbec4,0x3f0e3f55
.long 0xbf80,0x3f6dbec4,0x3f353f35,0xbec43f6d,0x3f800000,0x3f0e3f55,0xbec43f6d,0xbf7b3e48
.long 0x3f80,0xbf353f35,0xbf800000,0xbf35bf35,0xbf800000,0xbf55bf0e,0xbec4bf6d,0x3e48bf7b
.long 0xbf80,0x3ec4bf6d,0x3f35bf35,0x3f6dbec4,0x3f800000,0x3f7b3e48,0x3f6d3ec4,0x3f553f0e
.long 0x3f80,0x3f80,0x3f80,0x3f80,0xbf353f35,0xbf0e3f55,0xbec43f6d,0xbe483f7b
.long 0xbf800000,0xbf6d3ec4,0xbf353f35,0xbec43f6d,0xbf35bf35,0xbf7bbe48,0xbf6d3ec4,0xbf0e3f55
.long 0xbf80,0xbf35bf35,0xbf800000,0xbf353f35,0x3f35bf35,0xbe48bf7b,0xbf6dbec4,0xbf553f0e
.long 0x3f800000,0x3ec4bf6d,0xbf35bf35,0xbf6d3ec4,0x3f353f35,0x3f55bf0e,0xbec4bf6d,0xbf7b3e48
.long 0x3f80,0x3f800000,0xbf80,0xbf800000,0xbf353f35,0x3f553f0e,0x3ec4bf6d,0xbf7bbe48
.long 0xbf800000,0x3ec43f6d,0x3f35bf35,0xbf6dbec4,0xbf35bf35,0xbe483f7b,0x3f6dbec4,0xbf55bf0e
.long 0xbf80,0xbf353f35,0x3f800000,0xbf35bf35,0x3f35bf35,0xbf7b3e48,0x3f6d3ec4,0xbf0ebf55
.long 0x3f800000,0xbf6dbec4,0x3f353f35,0xbec4bf6d,0x3f353f35,0xbf0ebf55,0x3ec43f6d,0xbe48bf7b
.long 0x3f80,0xbf80,0x3f80,0xbf80,0xbf353f35,0x3f0ebf55,0xbec43f6d,0x3e48bf7b
.long 0xbf800000,0x3f6dbec4,0xbf353f35,0x3ec4bf6d,0xbf35bf35,0x3f7b3e48,0xbf6d3ec4,0x3f0ebf55
.long 0xbf80,0x3f353f35,0xbf800000,0x3f35bf35,0x3f35bf35,0x3e483f7b,0xbf6dbec4,0x3f55bf0e
.long 0x3f800000,0xbec43f6d,0xbf35bf35,0x3f6dbec4,0x3f353f35,0xbf553f0e,0xbec4bf6d,0x3f7bbe48
.long 0x3f80,0xbf800000,0xbf80,0x3f800000,0xbf353f35,0xbf55bf0e,0x3ec4bf6d,0x3f7b3e48
.long 0xbf800000,0xbec4bf6d,0x3f35bf35,0x3f6d3ec4,0xbf35bf35,0x3e48bf7b,0x3f6dbec4,0x3f553f0e
.long 0xbf80,0x3f35bf35,0x3f800000,0x3f353f35,0x3f35bf35,0x3f7bbe48,0x3f6d3ec4,0x3f0e3f55
.long 0x3f800000,0x3f6d3ec4,0x3f353f35,0x3ec43f6d,0x3f353f35,0x3f0e3f55,0x3ec43f6d,0x3e483f7b
.long 0x3f808000,0x3f808000,0x3f808000,0x3f808000,0x3f808000,0x3f7bbe48,0x3f6dbec4,0x3f55bf0e
.long 0x3f808000,0x3f6dbec4,0x3f35bf35,0x3ec4bf6d,0x3f808000,0x3f55bf0e,0x3ec4bf6d,0xbe48bf7b
.long 0x3f808000,0x3f35bf35,0xbf80,0xbf35bf35,0x3f808000,0x3f0ebf55,0xbec4bf6d,0xbf7bbe48
.long 0x3f808000,0x3ec4bf6d,0xbf35bf35,0xbf6d3ec4,0x3f808000,0x3e48bf7b,0xbf6dbec4,0xbf0e3f55
.long 0x3f808000,0xbf80,0xbf808000,0x3f80,0x3f808000,0xbe48bf7b,0xbf6d3ec4,0x3f0e3f55
.long 0x3f808000,0xbec4bf6d,0xbf353f35,0x3f6d3ec4,0x3f808000,0xbf0ebf55,0xbec43f6d,0x3f7bbe48
.long 0x3f808000,0xbf35bf35,0x3f80,0x3f35bf35,0x3f808000,0xbf55bf0e,0x3ec43f6d,0x3e48bf7b
.long 0x3f808000,0xbf6dbec4,0x3f353f35,0xbec4bf6d,0x3f808000,0xbf7bbe48,0x3f6d3ec4,0xbf55bf0e
.long 0x3f808000,0xbf808000,0x3f808000,0xbf808000,0x3f808000,0xbf7b3e48,0x3f6dbec4,0xbf553f0e
.long 0x3f808000,0xbf6d3ec4,0x3f35bf35,0xbec43f6d,0x3f808000,0xbf553f0e,0x3ec4bf6d,0x3e483f7b
.long 0x3f808000,0xbf353f35,0xbf80,0x3f353f35,0x3f808000,0xbf0e3f55,0xbec4bf6d,0x3f7b3e48
.long 0x3f808000,0xbec43f6d,0xbf35bf35,0x3f6dbec4,0x3f808000,0xbe483f7b,0xbf6dbec4,0x3f0ebf55
.long 0x3f808000,0x3f80,0xbf808000,0xbf80,0x3f808000,0x3e483f7b,0xbf6d3ec4,0xbf0ebf55
.long 0x3f808000,0x3ec43f6d,0xbf353f35,0xbf6dbec4,0x3f808000,0x3f0e3f55,0xbec43f6d,0xbf7b3e48
.long 0x3f808000,0x3f353f35,0x3f80,0xbf353f35,0x3f808000,0x3f553f0e,0x3ec43f6d,0xbe483f7b
.long 0x3f808000,0x3f6d3ec4,0x3f353f35,0x3ec43f6d,0x3f808000,0x3f7b3e48,0x3f6d3ec4,0x3f553f0e
.long 0x3f808000,0x3f808000,0x3f808000,0x3f808000,0x3f35bf35,0x3f0ebf55,0x3ec4bf6d,0x3e48bf7b
.long 0xbf80,0xbec4bf6d,0xbf35bf35,0xbf6dbec4,0xbf35bf35,0xbf7bbe48,0xbf6d3ec4,0xbf0e3f55
.long 0xbf808000,0xbf353f35,0x3f80,0x3f353f35,0xbf353f35,0x3e483f7b,0x3f6d3ec4,0x3f55bf0e
.long 0x3f80,0x3f6d3ec4,0x3f35bf35,0xbec4bf6d,0x3f353f35,0x3f55bf0e,0xbec4bf6d,0xbf7b3e48
.long 0x3f808000,0xbf80,0xbf808000,0x3f80,0x3f35bf35,0xbf55bf0e,0xbec43f6d,0x3f7b3e48
.long 0xbf80,0xbf6d3ec4,0x3f353f35,0x3ec4bf6d,0xbf35bf35,0xbe483f7b,0x3f6dbec4,0xbf55bf0e
.long 0xbf808000,0x3f353f35,0xbf80,0xbf353f35,0xbf353f35,0x3f7bbe48,0xbf6dbec4,0x3f0e3f55
.long 0x3f80,0x3ec4bf6d,0xbf353f35,0x3f6dbec4,0x3f353f35,0xbf0ebf55,0x3ec43f6d,0xbe48bf7b
.long 0x3f808000,0xbf808000,0x3f808000,0xbf808000,0x3f35bf35,0xbf0e3f55,0x3ec4bf6d,0xbe483f7b
.long 0xbf80,0x3ec43f6d,0xbf35bf35,0x3f6d3ec4,0xbf35bf35,0x3f7b3e48,0xbf6d3ec4,0x3f0ebf55
.long 0xbf808000,0x3f35bf35,0x3f80,0xbf35bf35,0xbf353f35,0xbe48bf7b,0x3f6d3ec4,0xbf553f0e
.long 0x3f80,0xbf6dbec4,0x3f35bf35,0x3ec43f6d,0x3f353f35,0xbf553f0e,0xbec4bf6d,0x3f7bbe48
.long 0x3f808000,0x3f80,0xbf808000,0xbf80,0x3f35bf35,0x3f553f0e,0xbec43f6d,0xbf7bbe48
.long 0xbf80,0x3f6dbec4,0x3f353f35,0xbec43f6d,0xbf35bf35,0x3e48bf7b,0x3f6dbec4,0x3f553f0e
.long 0xbf808000,0xbf35bf35,0xbf80,0x3f35bf35,0xbf353f35,0xbf7b3e48,0xbf6dbec4,0xbf0ebf55
.long 0x3f80,0xbec43f6d,0xbf353f35,0xbf6d3ec4,0x3f353f35,0x3f0e3f55,0x3ec43f6d,0x3e483f7b
.long 0x3f808000,0x3f808000,0x3f808000,0x3f808000,0xbf80,0xbe48bf7b,0xbec4bf6d,0xbf0ebf55
.long 0xbf808000,0xbf6d3ec4,0xbf353f35,0xbec43f6d,0x3f80,0x3f0e3f55,0x3f6d3ec4,0x3f7bbe48
.long 0x3f808000,0x3f35bf35,0xbf80,0xbf35bf35,0xbf80,0xbf55bf0e,0xbf6d3ec4,0xbe483f7b
.long 0xbf808000,0xbec43f6d,0x3f353f35,0x3f6dbec4,0x3f80,0x3f7b3e48,0x3ec4bf6d,0xbf55bf0e
.long 0x3f808000,0xbf80,0xbf808000,0x3f80,0xbf80,0xbf7b3e48,0x3ec43f6d,0x3f55bf0e
.long 0xbf808000,0x3ec43f6d,0x3f35bf35,0xbf6dbec4,0x3f80,0x3f55bf0e,0xbf6dbec4,0x3e483f7b
.long 0x3f808000,0xbf35bf35,0x3f80,0x3f35bf35,0xbf80,0xbf0e3f55,0x3f6dbec4,0xbf7bbe48
.long 0xbf808000,0x3f6d3ec4,0xbf35bf35,0x3ec43f6d,0x3f80,0x3e48bf7b,0xbec43f6d,0x3f0ebf55
.long 0x3f808000,0xbf808000,0x3f808000,0xbf808000,0xbf80,0x3e483f7b,0xbec4bf6d,0x3f0e3f55
.long 0xbf808000,0x3f6dbec4,0xbf353f35,0x3ec4bf6d,0x3f80,0xbf0ebf55,0x3f6d3ec4,0xbf7b3e48
.long 0x3f808000,0xbf353f35,0xbf80,0x3f353f35,0xbf80,0x3f553f0e,0xbf6d3ec4,0x3e48bf7b
.long 0xbf808000,0x3ec4bf6d,0x3f353f35,0xbf6d3ec4,0x3f80,0xbf7bbe48,0x3ec4bf6d,0x3f553f0e
.long 0x3f808000,0x3f80,0xbf808000,0xbf80,0xbf80,0x3f7bbe48,0x3ec43f6d,0xbf553f0e
.long 0xbf808000,0xbec4bf6d,0x3f35bf35,0x3f6d3ec4,0x3f80,0xbf553f0e,0xbf6dbec4,0xbe48bf7b
.long 0x3f808000,0x3f353f35,0x3f80,0xbf353f35,0xbf80,0x3f0ebf55,0x3f6dbec4,0x3f7b3e48
.long 0xbf808000,0xbf6dbec4,0xbf35bf35,0xbec4bf6d,0x3f80,0xbe483f7b,0xbec43f6d,0xbf0e3f55
.long 0x3f808000,0x3f808000,0x3f808000,0x3f808000,0xbf35bf35,0xbf55bf0e,0xbf6dbec4,0xbf7bbe48
.long 0x3f80,0x3ec43f6d,0x3f353f35,0x3f6d3ec4,0x3f35bf35,0x3e48bf7b,0xbec4bf6d,0xbf55bf0e
.long 0xbf808000,0xbf353f35,0x3f80,0x3f353f35,0x3f353f35,0x3f7bbe48,0x3ec4bf6d,0xbf0ebf55
.long 0xbf80,0xbf6dbec4,0xbf353f35,0x3ec43f6d,0xbf353f35,0x3f0e3f55,0x3f6dbec4,0xbe48bf7b
.long 0x3f808000,0xbf80,0xbf808000,0x3f80,0xbf35bf35,0xbf0e3f55,0x3f6d3ec4,0x3e48bf7b
.long 0x3f80,0x3f6dbec4,0xbf35bf35,0xbec43f6d,0x3f35bf35,0xbf7bbe48,0x3ec43f6d,0x3f0ebf55
.long 0xbf808000,0x3f353f35,0xbf80,0xbf353f35,0x3f353f35,0xbe48bf7b,0xbec43f6d,0x3f55bf0e
.long 0xbf80,0xbec43f6d,0x3f35bf35,0xbf6d3ec4,0xbf353f35,0x3f55bf0e,0xbf6d3ec4,0x3f7bbe48
.long 0x3f808000,0xbf808000,0x3f808000,0xbf808000,0xbf35bf35,0x3f553f0e,0xbf6dbec4,0x3f7b3e48
.long 0x3f80,0xbec4bf6d,0x3f353f35,0xbf6dbec4,0x3f35bf35,0xbe483f7b,0xbec4bf6d,0x3f553f0e
.long 0xbf808000,0x3f35bf35,0x3f80,0xbf35bf35,0x3f353f35,0xbf7b3e48,0x3ec4bf6d,0x3f0e3f55
.long 0xbf80,0x3f6d3ec4,0xbf353f35,0xbec4bf6d,0xbf353f35,0xbf0ebf55,0x3f6dbec4,0x3e483f7b
.long 0x3f808000,0x3f80,0xbf808000,0xbf80,0xbf35bf35,0x3f0ebf55,0x3f6d3ec4,0xbe483f7b
.long 0x3f80,0xbf6d3ec4,0xbf35bf35,0x3ec4bf6d,0x3f35bf35,0x3f7b3e48,0x3ec43f6d,0xbf0e3f55
.long 0xbf808000,0xbf35bf35,0xbf80,0x3f35bf35,0x3f353f35,0x3e483f7b,0xbec43f6d,0xbf553f0e
.long 0xbf80,0x3ec4bf6d,0x3f35bf35,0x3f6dbec4,0xbf353f35,0xbf553f0e,0xbf6d3ec4,0xbf7b3e48
.long 0x3f808000,0x3f808000,0x3f808000,0x3f808000,0xbf808000,0xbf7b3e48,0xbf6d3ec4,0xbf553f0e
.long 0x3f808000,0x3f6dbec4,0x3f35bf35,0x3ec4bf6d,0xbf808000,0xbf553f0e,0xbec43f6d,0x3e483f7b
.long 0x3f808000,0x3f35bf35,0xbf80,0xbf35bf35,0xbf808000,0xbf0e3f55,0x3ec43f6d,0x3f7b3e48
.long 0x3f808000,0x3ec4bf6d,0xbf35bf35,0xbf6d3ec4,0xbf808000,0xbe483f7b,0x3f6d3ec4,0x3f0ebf55
.long 0x3f808000,0xbf80,0xbf808000,0x3f80,0xbf808000,0x3e483f7b,0x3f6dbec4,0xbf0ebf55
.long 0x3f808000,0xbec4bf6d,0xbf353f35,0x3f6d3ec4,0xbf808000,0x3f0e3f55,0x3ec4bf6d,0xbf7b3e48
.long 0x3f808000,0xbf35bf35,0x3f80,0x3f35bf35,0xbf808000,0x3f553f0e,0xbec4bf6d,0xbe483f7b
.long 0x3f808000,0xbf6dbec4,0x3f353f35,0xbec4bf6d,0xbf808000,0x3f7b3e48,0xbf6dbec4,0x3f553f0e
.long 0x3f808000,0xbf808000,0x3f808000,0xbf808000,0xbf808000,0x3f7bbe48,0xbf6d3ec4,0x3f55bf0e
.long 0x3f808000,0xbf6d3ec4,0x3f35bf35,0xbec43f6d,0xbf808000,0x3f55bf0e,0xbec43f6d,0xbe48bf7b
.long 0x3f808000,0xbf353f35,0xbf80,0x3f353f35,0xbf808000,0x3f0ebf55,0x3ec43f6d,0xbf7bbe48
.long 0x3f808000,0xbec43f6d,0xbf35bf35,0x3f6dbec4,0xbf808000,0x3e48bf7b,0x3f6d3ec4,0xbf0e3f55
.long 0x3f808000,0x3f80,0xbf808000,0xbf80,0xbf808000,0xbe48bf7b,0x3f6dbec4,0x3f0e3f55
.long 0x3f808000,0x3ec43f6d,0xbf353f35,0xbf6dbec4,0xbf808000,0xbf0ebf55,0x3ec4bf6d,0x3f7bbe48
.long 0x3f808000,0x3f353f35,0x3f80,0xbf353f35,0xbf808000,0xbf55bf0e,0xbec4bf6d,0x3e48bf7b
.long 0x3f808000,0x3f6d3ec4,0x3f353f35,0x3ec43f6d,0xbf808000,0xbf7bbe48,0xbf6dbec4,0xbf55bf0e
.long 0x3f808000,0x3f808000,0x3f808000,0x3f808000,0xbf353f35,0xbf0e3f55,0xbec43f6d,0xbe483f7b
.long 0xbf80,0xbec4bf6d,0xbf35bf35,0xbf6dbec4,0x3f353f35,0x3f7b3e48,0x3f6dbec4,0x3f0ebf55
.long 0xbf808000,0xbf353f35,0x3f80,0x3f353f35,0x3f35bf35,0xbe48bf7b,0xbf6dbec4,0xbf553f0e
.long 0x3f80,0x3f6d3ec4,0x3f35bf35,0xbec4bf6d,0xbf35bf35,0xbf553f0e,0x3ec43f6d,0x3f7bbe48
.long 0x3f808000,0xbf80,0xbf808000,0x3f80,0xbf353f35,0x3f553f0e,0x3ec4bf6d,0xbf7bbe48
.long 0xbf80,0xbf6d3ec4,0x3f353f35,0x3ec4bf6d,0x3f353f35,0x3e48bf7b,0xbf6d3ec4,0x3f553f0e
.long 0xbf808000,0x3f353f35,0xbf80,0xbf353f35,0x3f35bf35,0xbf7b3e48,0x3f6d3ec4,0xbf0ebf55
.long 0x3f80,0x3ec4bf6d,0xbf353f35,0x3f6dbec4,0xbf35bf35,0x3f0e3f55,0xbec4bf6d,0x3e483f7b
.long 0x3f808000,0xbf808000,0x3f808000,0xbf808000,0xbf353f35,0x3f0ebf55,0xbec43f6d,0x3e48bf7b
.long 0xbf80,0x3ec43f6d,0xbf35bf35,0x3f6d3ec4,0x3f353f35,0xbf7bbe48,0x3f6dbec4,0xbf0e3f55
.long 0xbf808000,0x3f35bf35,0x3f80,0xbf35bf35,0x3f35bf35,0x3e483f7b,0xbf6dbec4,0x3f55bf0e
.long 0x3f80,0xbf6dbec4,0x3f35bf35,0x3ec43f6d,0xbf35bf35,0x3f55bf0e,0x3ec43f6d,0xbf7b3e48
.long 0x3f808000,0x3f80,0xbf808000,0xbf80,0xbf353f35,0xbf55bf0e,0x3ec4bf6d,0x3f7b3e48
.long 0xbf80,0x3f6dbec4,0x3f353f35,0xbec43f6d,0x3f353f35,0xbe483f7b,0xbf6d3ec4,0xbf55bf0e
.long 0xbf808000,0xbf35bf35,0xbf80,0x3f35bf35,0x3f35bf35,0x3f7bbe48,0x3f6d3ec4,0x3f0e3f55
.long 0x3f80,0xbec43f6d,0xbf353f35,0xbf6d3ec4,0xbf35bf35,0xbf0ebf55,0xbec4bf6d,0xbe48bf7b
.long 0x3f808000,0x3f808000,0x3f808000,0x3f808000,0x3f80,0x3e483f7b,0x3ec43f6d,0x3f0e3f55
.long 0xbf808000,0xbf6d3ec4,0xbf353f35,0xbec43f6d,0xbf80,0xbf0ebf55,0xbf6dbec4,0xbf7b3e48
.long 0x3f808000,0x3f35bf35,0xbf80,0xbf35bf35,0x3f80,0x3f553f0e,0x3f6dbec4,0x3e48bf7b
.long 0xbf808000,0xbec43f6d,0x3f353f35,0x3f6dbec4,0xbf80,0xbf7bbe48,0xbec43f6d,0x3f553f0e
.long 0x3f808000,0xbf80,0xbf808000,0x3f80,0x3f80,0x3f7bbe48,0xbec4bf6d,0xbf553f0e
.long 0xbf808000,0x3ec43f6d,0x3f35bf35,0xbf6dbec4,0xbf80,0xbf553f0e,0x3f6d3ec4,0xbe48bf7b
.long 0x3f808000,0xbf35bf35,0x3f80,0x3f35bf35,0x3f80,0x3f0ebf55,0xbf6d3ec4,0x3f7b3e48
.long 0xbf808000,0x3f6d3ec4,0xbf35bf35,0x3ec43f6d,0xbf80,0xbe483f7b,0x3ec4bf6d,0xbf0e3f55
.long 0x3f808000,0xbf808000,0x3f808000,0xbf808000,0x3f80,0xbe48bf7b,0x3ec43f6d,0xbf0ebf55
.long 0xbf808000,0x3f6dbec4,0xbf353f35,0x3ec4bf6d,0xbf80,0x3f0e3f55,0xbf6dbec4,0x3f7bbe48
.long 0x3f808000,0xbf353f35,0xbf80,0x3f353f35,0x3f80,0xbf55bf0e,0x3f6dbec4,0xbe483f7b
.long 0xbf808000,0x3ec4bf6d,0x3f353f35,0xbf6d3ec4,0xbf80,0x3f7b3e48,0xbec43f6d,0xbf55bf0e
.long 0x3f808000,0x3f80,0xbf808000,0xbf80,0x3f80,0xbf7b3e48,0xbec4bf6d,0x3f55bf0e
.long 0xbf808000,0xbec4bf6d,0x3f35bf35,0x3f6d3ec4,0xbf80,0x3f55bf0e,0x3f6d3ec4,0x3e483f7b
.long 0x3f808000,0x3f353f35,0x3f80,0xbf353f35,0x3f80,0xbf0e3f55,0xbf6d3ec4,0xbf7bbe48
.long 0xbf808000,0xbf6dbec4,0xbf35bf35,0xbec4bf6d,0xbf80,0x3e48bf7b,0x3ec4bf6d,0x3f0ebf55
.long 0x3f808000,0x3f808000,0x3f808000,0x3f808000,0x3f353f35,0x3f553f0e,0x3f6d3ec4,0x3f7b3e48
.long 0x3f80,0x3ec43f6d,0x3f353f35,0x3f6d3ec4,0xbf353f35,0xbe483f7b,0x3ec43f6d,0x3f553f0e
.long 0xbf808000,0xbf353f35,0x3f80,0x3f353f35,0xbf35bf35,0xbf7b3e48,0xbec43f6d,0x3f0e3f55
.long 0xbf80,0xbf6dbec4,0xbf353f35,0x3ec43f6d,0x3f35bf35,0xbf0ebf55,0xbf6d3ec4,0x3e483f7b
.long 0x3f808000,0xbf80,0xbf808000,0x3f80,0x3f353f35,0x3f0ebf55,0xbf6dbec4,0xbe483f7b
.long 0x3f80,0x3f6dbec4,0xbf35bf35,0xbec43f6d,0xbf353f35,0x3f7b3e48,0xbec4bf6d,0xbf0e3f55
.long 0xbf808000,0x3f353f35,0xbf80,0xbf353f35,0xbf35bf35,0x3e483f7b,0x3ec4bf6d,0xbf553f0e
.long 0xbf80,0xbec43f6d,0x3f35bf35,0xbf6d3ec4,0x3f35bf35,0xbf553f0e,0x3f6dbec4,0xbf7b3e48
.long 0x3f808000,0xbf808000,0x3f808000,0xbf808000,0x3f353f35,0xbf55bf0e,0x3f6d3ec4,0xbf7bbe48
.long 0x3f80,0xbec4bf6d,0x3f353f35,0xbf6dbec4,0xbf353f35,0x3e48bf7b,0x3ec43f6d,0xbf55bf0e
.long 0xbf808000,0x3f35bf35,0x3f80,0xbf35bf35,0xbf35bf35,0x3f7bbe48,0xbec43f6d,0xbf0ebf55
.long 0xbf80,0x3f6d3ec4,0xbf353f35,0xbec4bf6d,0x3f35bf35,0x3f0e3f55,0xbf6d3ec4,0xbe48bf7b
.long 0x3f808000,0x3f80,0xbf808000,0xbf80,0x3f353f35,0xbf0e3f55,0xbf6dbec4,0x3e48bf7b
.long 0x3f80,0xbf6d3ec4,0xbf35bf35,0x3ec4bf6d,0xbf353f35,0xbf7bbe48,0xbec4bf6d,0x3f0ebf55
.long 0xbf808000,0xbf35bf35,0xbf80,0x3f35bf35,0xbf35bf35,0xbe48bf7b,0x3ec4bf6d,0x3f55bf0e
.long 0xbf80,0x3ec4bf6d,0x3f35bf35,0x3f6dbec4,0x3f35bf35,0x3f55bf0e,0x3f6dbec4,0x3f7bbe48
.long 0x35800000,0x35800000,0x35800000,0x35800000,0x357fffb1,0x357ffd39,0x357ff84a,0x357ff0e3
.long 0x357ffec4,0x357ff4e6,0x357fe129,0x357fc38f,0x357ffd39,0x357fe705,0x357fba9e,0x357f7808
.long 0x357ffb11,0x357fd397,0x357f84ab,0x357f0e58,0x357ff84a,0x357fba9e,0x357f3f54,0x357e868b
.long 0x357ff4e6,0x357f9c18,0x357eea9d,0x357de0b1,0x357ff0e3,0x357f7808,0x357e868b,0x357d1cdd
.long 0x357fec43,0x357f4e6d,0x357e1324,0x357c3b28,0x357fe705,0x357f1f49,0x357d906e,0x357b3bab
.long 0x357fe129,0x357eea9d,0x357cfe73,0x357a1e84,0x357fdaaf,0x357eb069,0x357c5d3a,0x3578e3d6
.long 0x357fd397,0x357e70b0,0x357baccd,0x35778bc5,0x357fcbe2,0x357e2b72,0x357aed37,0x3576167a
.long 0x357fc38f,0x357de0b1,0x357a1e84,0x35748422,0x357fba9e,0x357d906e,0x357940c0,0x3572d4eb
.long 0x357fb10f,0x357d3aac,0x357853f8,0x35710908,0x357fa6e3,0x357cdf6c,0x3577583a,0x356f20b0
.long 0x357f9c18,0x357c7eb0,0x35764d97,0x356d1c1d,0x357f90b1,0x357c187a,0x3575341d,0x356afb8c
.long 0x357f84ab,0x357baccd,0x35740bdd,0x3568bf3c,0x357f7808,0x357b3bab,0x3572d4eb,0x35666771
.long 0x357f6ac7,0x357ac516,0x35718f57,0x3563f473,0x357f5ce9,0x357a4910,0x35703b37,0x3561668a
.long 0x357f4e6d,0x3579c79d,0x356ed89e,0x355ebe05,0x357f3f54,0x357940c0,0x356d67a1,0x355bfb34
.long 0x357f2f9d,0x3578b47b,0x356be858,0x35591e6a,0x357f1f49,0x357822d1,0x356a5ad9,0x355627fe
.long 0x357f0e58,0x35778bc5,0x3568bf3c,0x35531849,0x357efcc9,0x3576ef5b,0x35671599,0x354fefa8
.long 0x357eea9d,0x35764d97,0x35655e0b,0x354cae79,0x357ed7d4,0x3575a67b,0x356398ac,0x35495521
.long 0x35800000,0x35800000,0x35800000,0x35800000,0x357fe705,0x357fdaaf,0x357fcbe2,0x357fba9e
.long 0x357f9c18,0x357f6ac7,0x357f2f9d,0x357eea9d,0x357f1f49,0x357eb069,0x357e2b72,0x357d906e
.long 0x357e70b0,0x357dabcc,0x357cbfc9,0x357baccd,0x357d906e,0x357c5d3a,0x357aed37,0x357940c0
.long 0x357c7eb0,0x357ac516,0x3578b47b,0x35764d97,0x357b3bab,0x3578e3d6,0x3576167a,0x3572d4eb
.long 0x3579c79d,0x3576ba07,0x35731447,0x356ed89e,0x357822d1,0x3574484b,0x356faf1b,0x356a5ad9
.long 0x35764d97,0x35718f57,0x356be858,0x35655e0b,0x3574484b,0x356e8ff8,0x3567c187,0x355fe4e9
.long 0x35721352,0x356b4b0c,0x35633c5a,0x3559f26a,0x356faf1b,0x3567c187,0x355e5aa6,0x355389c7
.long 0x356d1c1d,0x3563f473,0x35591e6a,0x354cae79,0x356a5ad9,0x355fe4e9,0x355389c7,0x35456439
.long 0x35676bd8,0x355b941a,0x354d9f02,0x353daef9,0x35644fac,0x35570348,0x35476085,0x353592e7
.long 0x356106f2,0x355233c6,0x3540d0da,0x352d1469,0x355d924d,0x354d26fd,0x3539f2ac,0x3524381a
.long 0x3559f26a,0x3547de65,0x3532c8c9,0x351b02c6,0x355627fe,0x35425b89,0x352b561b,0x3511796b
.long 0x355233c6,0x353ca003,0x35239da9,0x3507a136,0x354e1689,0x3536ad7f,0x351ba299,0x34fafef7
.long 0x3549d112,0x353085bb,0x3513682a,0x34e63375,0x35456439,0x352a2a80,0x350af1b7,0x34d0eb2a
.long 0x3540d0da,0x35239da9,0x350242b1,0x34bb31a0,0x353c17d9,0x351ce11f,0x34f2bd43,0x34a5129f
.long 0x35373a23,0x3515f6d9,0x34e0924f,0x348e9a22,0x353238aa,0x350ee0db,0x34ce0bea,0x346fa8b2
.long 0x352d1469,0x3507a136,0x34bb31a0,0x34419b37,0x3527ce61,0x35003a06,0x34a80b1f,0x341324ca
.long 0x35800000,0x35800000,0x35800000,0x35800000,0x357fa6e3,0x357f90b1,0x357f7808,0x357f5ce9
.long 0x357e9bc9,0x357e4323,0x357de0b1,0x357d7474,0x357cdf6c,0x357c187a,0x357b3bab,0x357a4910
.long 0x357a7302,0x35791298,0x35778bc5,0x3575dec6,0x3577583a,0x3575341d,0x3572d4eb,0x35703b37
.long 0x3573913f,0x35708066,0x356d1c1d,0x35696591,0x356f20b0,0x356afb8c,0x35666771,0x3561668a
.long 0x356a09a7,0x3564aa59,0x355ebe05,0x35584853,0x35644fac,0x355d924d,0x355627fe,0x354e1689
.long 0x355df6be,0x3555b993,0x354cae79,0x3542de29,0x35570348,0x354d26fd,0x35425b89,0x3536ad7f
.long 0x354f7a1f,0x3543e200,0x35373a23,0x35299415,0x35476085,0x3539f2ac,0x352b561b,0x351ba299
.long 0x353ebc1b,0x352f61a5,0x351ebc12,0x350cead0,0x353592e7,0x3524381a,0x3511796b,0x34fafef7
.long 0x352beb4a,0x35187fc0,0x35039c3d,0x34dae880,0x3521cbfb,0x350c42c9,0x34ea6681,0x34b9bb1e
.long 0x35173c07,0x34ff17b2,0x34cc9b8b,0x3497a117,0x350c42c9,0x34e4cbfe,0x34adf73c,0x34698bba
.long 0x3500e7e4,0x34c9b953,0x348e9a22,0x3422abb6,0x34ea6681,0x34adf73c,0x345d4b1a,0x33b5f8da
.long 0x34d25a09,0x34919ddd,0x341c76de,0x3296c9b6,0x34b9bb1e,0x34698bba,0x33b5f8da,0xb355880e
.long 0x34a09ae5,0x342f10a2,0x32c90ab0,0xb3fab273,0x34870ada,0x33e7fa9a,0xb32351cb,0xb444b0b9
.long 0x345a3997,0x33621469,0xb3d53db9,0xb48586ce,0x3425c58c,0xb1490fc6,0xb42bf804,0xb4a80b1f
.long 0x33e1bc2e,0xb37b2b74,0xb46c9a7f,0xb4c9b953,0x336ea038,0xb3f475c0,0xb49620d2,0xb4ea6681
.long 0x31c90f88,0xb4354098,0xb4b554ec,0xb504f484,0xb33c6dd5,0xb46fa8b2,0xb4d3c867,0xb5140c5f
.long 0x35800000,0x35800000,0x35800000,0x35800000,0x357f3f54,0x357f1f49,0x357efcc9,0x357ed7d4
.long 0x357cfe73,0x357c7eb0,0x357bf531,0x357b61fc,0x357940c0,0x357822d1,0x3576ef5b,0x3575a67b
.long 0x35740bdd,0x35721352,0x356ff573,0x356db293,0x356d67a1,0x356a5ad9,0x35671599,0x356398ac
.long 0x35655e0b,0x356106f2,0x355c61c7,0x35577026,0x355bfb34,0x355627fe,0x354fefa8,0x35495521
.long 0x35514d3d,0x3549d112,0x3541d870,0x35396842,0x35456439,0x353c17d9,0x353238aa,0x3527ce61
.long 0x35385216,0x352d1469,0x35212ff9,0x3514b039,0x352a2a80,0x351ce11f,0x350ee0db,0x35003a06
.long 0x351b02c6,0x350b9a6b,0x34f6e0cb,0x34d53641,0x350af1b7,0x34f2bd43,0x34ce0bea,0x34a80b1f
.long 0x34f41f07,0x34cc9b8b,0x34a395c5,0x3472b651,0x34d0eb2a,0x34a5129f,0x346fa8b2,0x341324ca
.long 0x34ac7cd4,0x3478cfcc,0x34164083,0x3348fb30,0x34870ada,0x3425c58c,0x336ea038,0xb33c6dd5
.long 0x34419b37,0x33a3308c,0xb2fb49ba,0xb41008b7,0x33e7fa9a,0xb1490fc6,0xb3f475c0,0xb46fa8b2
.long 0x3316c32c,0xb3afb680,0xb4541501,0xb4a68f12,0xb32351cb,0xb42bf804,0xb49620d2,0xb4d3c867
.long 0xb3ee3876,0xb47ee6e1,0xb4c1071e,0xb4ff17b2,0xb444b0b9,0xb4a80b1f,0xb4ea6681,0xb5140c5f
.long 0xb4888e93,0xb4cf7bca,0xb508f59b,0xb5273656,0xb4adf73c,0xb4f58035,0xb51ba299,0xb538dd65
.long 0xb4d25a09,0xb50cead0,0xb52d1469,0xb548d8b3,0xb4f58035,0xb51e1e22,0xb53d27b8,0xb5570348
.long 0xb50b9a6b,0xb52e3bde,0xb54bbbf8,0xb5633c5a,0xb51ba299,0xb53d27b8,0xb558b3a1,0xb56d67a1
.long 0xb52ac082,0xb54ac77f,0xb563f473,0xb5756d97,0xb538dd65,0xb5570348,0xb56d67a1,0xb57b3bab
.long 0x35800000,0x35800000,0x35800000,0x35800000,0x357eb069,0x357e868b,0x357e5a38,0x357e2b72
.long 0x357ac516,0x357a1e84,0x35796e4e,0x3578b47b,0x3574484b,0x3572d4eb,0x35714c7a,0x356faf1b
.long 0x356b4b0c,0x3568bf3c,0x35660f88,0x35633c5a,0x355fe4e9,0x355bfb34,0x3557dc7f,0x355389c7
.long 0x355233c6,0x354cae79,0x3546e22a,0x3540d0da,0x35425b89,0x353b0629,0x3533587a,0x352b561b
.long 0x353085bb,0x35273656,0x351d7fd1,0x3513682a,0x351ce11f,0x3511796b,0x3505a02c,0x34f2bd43
.long 0x3507a136,0x34f41f07,0x34d8106b,0x34bb31a0,0x34e1fb6a,0x34c27b55,0x34a21887,0x3480f8c0
.long 0x34b263ef,0x348e9a22,0x34541501,0x3409cf86,0x3480f8c0,0x343228d4,0x33c27c39,0x327b514b
.long 0x341c76de,0x338a200a,0xb296c9b6,0xb3d53db9,0x3355880e,0xb32351cb,0xb406b26e,0xb4636c83
.long 0xb348fb30,0xb4164083,0xb478cfcc,0xb4ac7cd4,0xb4195be0,0xb480f8c0,0xb4b3dca5,0xb4e4cbfe
.long 0xb47ee6e1,0xb4b554ec,0xb4e900b7,0xb50cead0,0xb4b0eacb,0xb4e79a5d,0xb50d9281,0xb5256bcb
.long 0xb4e0924f,0xb50b9a6b,0xb524d225,0xb53b8f3b,0xb506f686,0xb521cbfb,0xb539f2ac,0xb54f0417
.long 0xb51c420c,0xb536206c,0xb54cae79,0xb55f8327,0xb52ff3e6,0xb5485bca,0xb55cc7d1,0xb56cd007
.long 0xb541d870,0xb5584853,0xb56a09a7,0xb576ba07,0xb551c0c2,0xb565b710,0xb574484b,0xb57d1cdd
.long 0xb55f8327,0xb5708066,0xb57b61fc,0xb57fe129,0xb56afb8c,0xb5788486,0xb57f3f54,0xb57efcc9
.long 0xb5740bdd,0xb57dabcc,0xb57fd397,0xb57a7302,0xb57a9c59,0xb57fe705,0xb57d1cdd,0xb5725470
.long 0xb57e9bc9,0xb57f2f9d,0xb5772417,0xb566becc,0xb57fffb1,0xb57b87b2,0xb56dfcf2,0xb557dc7f
.long 0x35800000,0x35800000,0x35800000,0x35800000,0x357dfa38,0x357dc68c,0x357d906e,0x357d57de
.long 0x3577f110,0x35772417,0x35764d97,0x35756d97,0x356dfcf2,0x356c3624,0x356a5ad9,0x35686b39
.long 0x35604621,0x355d2d53,0x3559f26a,0x355695e5,0x354f0417,0x354a4c87,0x35456439,0x35404c5c
.long 0x353a7ca4,0x3533e7bc,0x352d1469,0x3526050a,0x352302d3,0x351a6293,0x3511796b,0x35084b92
.long 0x3508f59b,0x34fc5d27,0x34e63375,0x34cf7bca,0x34d97cb9,0x34bf926f,0x34a5129f,0x348a11f7
.long 0x349d9e78,0x347ee6e1,0x34419b37,0x34039502,0x343e853e,0x33f475c0,0x3355880e,0xb27b514b
.long 0x337b2b74,0xb2490e90,0xb3afb680,0xb422abb6,0xb383db0a,0xb41324ca,0xb4636c83,0xb49920fe
.long 0xb4419b37,0xb48b9507,0xb4b554ec,0xb4ddbe79,0xb49f1cdf,0xb4cb2aae,0xb4f58035,0xb50ee0db
.long 0xb4dae880,0xb5039c3d,0xb5187fc0,0xb52beb4a,0xb5099f4e,0xb51f599f,0xb533587a,0xb5456439
.long 0xb5239da9,0xb5385216,0xb54ac77f,0xb55ac450,0xb53b0629,0xb54e1689,0xb55e5aa6,0xb56b99fb
.long 0xb54f7a1f,0xb5604621,0xb56db293,0xb5778bc5,0xb560a6cf,0xb56e8ff8,0xb5788486,0xb57e5a38
.long 0xb56e46be,0xb578b47b,0xb57e9bc9,0xb57fe129,0xb57822d1,0xb57e868b,0xb57fdaaf,0xb57c187a
.long 0xb57e1324,0xb57fec43,0xb57c3b28,0xb5731447,0xb57fffb1,0xb57cdf6c,0xb573ced9,0xb5650479
.long 0xb57de0b1,0xb5756d97,0xb566becc,0xb55233c6,0xb577beb7,0xb569b7e4,0xb5554aa4,0xb53b0629
.long 0xb56db293,0xb559f26a,0xb53fc767,0xb51ff6cb,0xb55fe4e9,0xb5466354,0xb5269de3,0xb5019573
.long 0xb54e8d90,0xb52f61a5,0xb50a48ad,0xb4c1071e,0xb539f2ac,0xb51553b7,0xb4d6a399,0xb475c35a
.long 0x35800000,0x35800000,0x35800000,0x35800000,0x357d1cdd,0x357cdf6c,0x357c9f8a,0x357c5d3a
.long 0x35748422,0x3573913f,0x357294f8,0x35718f57,0x35666771,0x35644fac,0x3562241a,0x355fe4e9
.long 0x35531849,0x354f7a1f,0x354bbbf8,0x3547de65,0x353b0629,0x353592e7,0x352ff3e6,0x352a2a80
.long 0x351ebc12,0x35173c07,0x350f8784,0x3507a136,0x34fdbabb,0x34ea6681,0x34d6a399,0x34c27b55
.long 0x34b8442a,0x34a09ae5,0x34888e93,0x34605c13,0x345d4b1a,0x3425c58c,0x33db7d37,0x3355880e
.long 0x338a200a,0x31c90f88,0xb3621469,0xb3ee3876,0xb3a973ba,0xb4195be0,0xb45d4b1a,0xb4901c2c
.long 0xb46c9a7f,0xb49aa086,0xb4be1d4a,0xb4e0924f,0xb4bf926f,0xb4e4cbfe,0xb5044889,0xb51553b7
.long 0xb50242b1,0xb514b039,0xb526050a,0xb536206c,0xb521cbfb,0xb533587a,0xb5436051,0xb551c0c2
.long 0xb53daef9,0xb54d9f02,0xb55b941a,0xb5676bd8,0xb5554aa4,0xb562df7b,0xb56dfcf2,0xb576841b
.long 0xb56816a8,0xb57294f8,0xb57a1e84,0xb57e9bc9,0xb575a67b,0xb57c5d3a,0xb57fa6e3,0xb57f7808
.long 0xb57dabcc,0xb57ffb11,0xb57e70b0,0xb5791298,0xb57ff84a,0xb57d57de,0xb576841b,0xb56b99fb
.long 0xb57c7eb0,0xb5748422,0xb56816a8,0xb5577026,0xb573530e,0xb565b710,0xb55389c7,0xb53d27b8
.long 0xb564aa59,0xb5514d3d,0xb5396842,0xb51d7fd1,0xb550d937,0xb537c655,0xb51a6293,0xb4f2bd43
.long 0xb5385216,0xb519c200,0xb4ee9479,0xb4a395c5,0xb51ba299,0xb4eff7fb,0xb4a21887,0xb41f917b
.long 0xb4f6e0cb,0xb4a68f12,0xb422abb6,0x32490e90,0xb4b0eacb,0xb43228d4,0x31490fc6,0x343857ec
.long 0xb44dee60,0xb296c9b6,0x3428defc,0x34af713a,0xb355880e,0x340cec4a,0x34a5129f,0x34fdbabb
.long 0x35800000,0x35800000,0x35800000,0x35800000,0x357c187a,0x357bd14d,0x357b87b2,0x357b3bab
.long 0x35708066,0x356f6830,0x356e46be,0x356d1c1d,0x355d924d,0x355b2c79,0x3558b3a1,0x355627fe
.long 0x3543e200,0x353fc767,0x353b8f3b,0x35373a23,0x3524381a,0x351e1e22,0x3517de12,0x3511796b
.long 0x34ff17b2,0x34ee9479,0x34ddbe79,0x34cc9b8b,0x34adf73c,0x349920fe,0x34840270,0x345d4b1a
.long 0x342f10a2,0x33fab273,0x3396a905,0x32c90ab0,0xb1490fc6,0xb36ea038,0xb3e7fa9a,0xb42bf804
.long 0xb4354098,0xb472b651,0xb497a117,0xb4b554ec,0xb4b0eacb,0xb4d0eb2a,0xb4eff7fb,0xb506f686
.long 0xb500e7e4,0xb510d3cd,0xb51ff6cb,0xb52e3bde,0xb5256bcb,0xb534768f,0xb5425b89,0xb54f0417
.long 0xb544e3f5,0xb55233c6,0xb55df6be,0xb56816a8,0xb55e5aa6,0xb56912ae,0xb571d19f,0xb5788486
.long 0xb5710908,0xb57853f8,0xb57d3aac,0xb57fb10f,0xb57c5d3a,0xb57f7808,0xb57fcbe2,0xb57d57de
.long 0xb57ffec4,0xb57e4323,0xb5796e4e,0xb5718f57,0xb57bd14d,0xb574bf62,0xb56a5ad9,0xb55cc7d1
.long 0xb56ff573,0xb5633c5a,0xb5531849,0xb53fc767,0xb55cc7d1,0xb54a4c87,0xb534768f,0xb51ba299
.long 0xb542de29,0xb52ac082,0xb50f8784,0xb4e363fa,0xb52302d3,0xb505a02c,0xb4cb2aae,0xb4870ada
.long 0xb4fc5d27,0xb4b8442a,0xb4605c13,0xb396a905,0xb4ab0201,0xb43e853e,0xb30a342f,0x33f475c0
.long 0xb428defc,0xb1c90f88,0x341c76de,0x349d9e78,0x3216cb58,0x343228d4,0x34ab0201,0x34f840c8
.long 0x343b6ecf,0x34b263ef,0x3500e7e4,0x3524d225,0x34b3dca5,0x3502ef9f,0x3527ce61,0x35476085
.long 0x350242b1,0x35286605,0x3548d8b3,0x35628210,0x35269de3,0x35485bca,0x3562df7b,0x3575341d
.long 0,0,0,0,0x31490fc6,0x3216cb58,0x327b514b,0x32afea69
.long 0x31c90f88,0x3296c9b6,0x32fb49ba,0x332fe007,0x3216cb58,0x32e22a7a,0x333c6dd5,0x3383db0a
.long 0x32490e90,0x3316c32c,0x337b2b74,0x33afb680,0x327b514b,0x333c6dd5,0x339cecf9,0x33db7d37
.long 0x3296c9b6,0x33621469,0x33bc3ac3,0x34039502,0x32afea69,0x3383db0a,0x33db7d37,0x34195be0
.long 0x32c90ab0,0x3396a905,0x33fab273,0x342f10a2,0x32e22a7a,0x33a973ba,0x340cec4a,0x3444b0b9
.long 0x32fb49ba,0x33bc3ac3,0x341c76de,0x345a3997,0x330a342f,0x33cefdb7,0x342bf804,0x346fa8b2
.long 0x3316c32c,0x33e1bc2e,0x343b6ecf,0x34827dc0,0x332351cb,0x33f475c0,0x344ada4f,0x348d17c0
.long 0x332fe007,0x34039502,0x345a3997,0x3497a117,0x333c6dd5,0x340cec4a,0x34698bba,0x34a21887
.long 0x3348fb30,0x34164083,0x3478cfcc,0x34ac7cd4,0x3355880e,0x341f917b,0x34840270,0x34b6ccc3
.long 0x33621469,0x3428defc,0x348b9507,0x34c1071e,0x336ea038,0x343228d4,0x34931f35,0x34cb2aae
.long 0x337b2b74,0x343b6ecf,0x349aa086,0x34d53641,0x3383db0a,0x3444b0b9,0x34a21887,0x34df28a9
.long 0x338a200a,0x344dee60,0x34a986c4,0x34e900b7,0x339064b4,0x3457278f,0x34b0eacb,0x34f2bd43
.long 0x3396a905,0x34605c13,0x34b8442a,0x34fc5d27,0x339cecf9,0x34698bba,0x34bf926f,0x3502ef9f
.long 0x33a3308c,0x3472b651,0x34c6d529,0x3507a136,0x33a973ba,0x347bdba4,0x34ce0bea,0x350c42c9
.long 0x33afb680,0x34827dc0,0x34d53641,0x3510d3cd,0x33b5f8da,0x34870ada,0x34dc53c1,0x351553b7
.long 0x33bc3ac3,0x348b9507,0x34e363fa,0x3519c200,0x33c27c39,0x34901c2c,0x34ea6681,0x351e1e22
.long 0,0,0,0,0x32e22a7a,0x330a342f,0x332351cb,0x333c6dd5
.long 0x33621469,0x338a200a,0x33a3308c,0x33bc3ac3,0x33a973ba,0x33cefdb7,0x33f475c0,0x340cec4a
.long 0x33e1bc2e,0x3409cf86,0x3422abb6,0x343b6ecf,0x340cec4a,0x342bf804,0x344ada4f,0x34698bba
.long 0x3428defc,0x344dee60,0x3472b651,0x348b9507,0x3444b0b9,0x346fa8b2,0x348d17c0,0x34a21887
.long 0x34605c13,0x34888e93,0x34a09ae5,0x34b8442a,0x347bdba4,0x349920fe,0x34b3dca5,0x34ce0bea
.long 0x348b9507,0x34a986c4,0x34c6d529,0x34e363fa,0x349920fe,0x34b9bb1e,0x34d97cb9,0x34f840c8
.long 0x34a68f12,0x34c9b953,0x34ebcbbb,0x35064b82,0x34b3dca5,0x34d97cb9,0x34fdbabb,0x35102dd5
.long 0x34c1071e,0x34e900b7,0x3507a136,0x3519c200,0x34ce0bea,0x34f840c8,0x35102dd5,0x352302d3
.long 0x34dae880,0x35039c3d,0x35187fc0,0x352beb4a,0x34e79a5d,0x350af1b7,0x35209393,0x3534768f
.long 0x34f41f07,0x35121eb0,0x35286605,0x353ca003,0x35003a06,0x3519210f,0x352ff3e6,0x35446337
.long 0x35064b82,0x351ff6cb,0x35373a23,0x354bbbf8,0x350c42c9,0x35269de3,0x353e35c5,0x3552a649
.long 0x35121eb0,0x352d1469,0x3544e3f5,0x35591e6a,0x3517de12,0x3533587a,0x354b41fa,0x355f20db
.long 0x351d7fd1,0x35396842,0x35514d3d,0x3564aa59,0x352302d3,0x353f41fc,0x35570348,0x3569b7e4
.long 0x35286605,0x3544e3f5,0x355c61c7,0x356e46be,0x352da859,0x354a4c87,0x3561668a,0x35725470
.long 0x3532c8c9,0x354f7a1f,0x35660f88,0x3575dec6,0x3537c655,0x35546b3b,0x356a5ad9,0x3578e3d6
.long 0x353ca003,0x35591e6a,0x356e46be,0x357b61fc,0x354154e1,0x355d924d,0x3571d19f,0x357d57de
.long 0,0,0,0,0x3355880e,0x336ea038,0x3383db0a,0x339064b4
.long 0x33d53db9,0x33ee3876,0x34039502,0x341008b7,0x341f917b,0x343228d4,0x3444b0b9,0x3457278f
.long 0x34541501,0x346c9a7f,0x34827dc0,0x348e9a22,0x34840270,0x34931f35,0x34a21887,0x34b0eacb
.long 0x349d9e78,0x34af713a,0x34c1071e,0x34d25a09,0x34b6ccc3,0x34cb2aae,0x34df28a9,0x34f2bd43
.long 0x34cf7bca,0x34e63375,0x34fc5d27,0x3508f59b,0x34e79a5d,0x35003a06,0x350c42c9,0x3517de12
.long 0x34ff17b2,0x350cead0,0x3519c200,0x3526050a,0x350af1b7,0x3519210f,0x35269de3,0x3533587a
.long 0x3515f6d9,0x3524d225,0x3532c8c9,0x353fc767,0x35209393,0x352ff3e6,0x353e35c5,0x354b41fa
.long 0x352ac082,0x353a7ca4,0x3548d8b3,0x3555b993,0x3534768f,0x35446337,0x3552a649,0x355f20db
.long 0x353daef9,0x354d9f02,0x355b941a,0x35676bd8,0x35466354,0x355627fe,0x356398ac,0x356e8ff8
.long 0x354e8d90,0x355df6be,0x356aab7b,0x35748422,0x355627fe,0x35650479,0x3570c501,0x357940c0
.long 0x355d2d53,0x356b4b0c,0x3575dec6,0x357cbfc9,0x356398ac,0x3570c501,0x3579f35e,0x357efcc9
.long 0x35696591,0x35756d97,0x357cfe73,0x357ff4e6,0x356e8ff8,0x357940c0,0x357efcc9,0x357fa6e3
.long 0x35731447,0x357c3b28,0x357fec43,0x357e1324,0x3576ef5b,0x357e5a38,0x357fcbe2,0x357b3bab
.long 0x357a1e84,0x357f9c18,0x357e9bc9,0x35772417,0x357c9f8a,0x357fffb1,0x357c5d3a,0x3571d19f
.long 0x357e70b0,0x357f84ab,0x35791298,0x356b4b0c,0x357f90b1,0x357e2b72,0x3574bf62,0x356398ac
.long 0x357ffec4,0x357bf531,0x356f6830,0x355ac450,0x357fba9e,0x3578e3d6,0x356912ae,0x3550d937
.long 0,0,0,0,0x339cecf9,0x33a973ba,0x33b5f8da,0x33c27c39
.long 0x341c76de,0x3428defc,0x34354098,0x34419b37,0x34698bba,0x347bdba4,0x34870ada,0x34901c2c
.long 0x349aa086,0x34a68f12,0x34b263ef,0x34be1d4a,0x34bf926f,0x34ce0bea,0x34dc53c1,0x34ea6681
.long 0x34e363fa,0x34f41f07,0x350242b1,0x350a48ad,0x3502ef9f,0x350c42c9,0x351553b7,0x351e1e22
.long 0x3513682a,0x351d7fd1,0x35273656,0x353085bb,0x352302d3,0x352da859,0x3537c655,0x354154e1
.long 0x3531a81d,0x353ca003,0x3546e22a,0x355064af,0x353f41fc,0x354a4c87,0x35546b3b,0x355d924d
.long 0x354bbbf8,0x355695e5,0x35604621,0x3568bf3c,0x35570348,0x3561668a,0x356a5ad9,0x3571d19f
.long 0x356106f2,0x356aab7b,0x357294f8,0x3578b47b,0x3569b7e4,0x35725470,0x3578e3d6,0x357d57de
.long 0x35710908,0x357853f8,0x357d3aac,0x357fb10f,0x3576ef5b,0x357c9f8a,0x357f90b1,0x357fba9e
.long 0x357b61fc,0x357f2f9d,0x357fe129,0x357d7474,0x357e5a38,0x357fffb1,0x357e2b72,0x3578e3d6
.long 0x357fd397,0x357f0e58,0x357a7302,0x35721352,0x357fcbe2,0x357c5d3a,0x3574bf62,0x356912ae
.long 0x357e4323,0x3577f110,0x356d1c1d,0x355df6be,0x357b3bab,0x3571d19f,0x356398ac,0x3550d937
.long 0x3576ba07,0x356a09a7,0x35584853,0x3541d870,0x3570c501,0x3560a6cf,0x354b41fa,0x35311722
.long 0x35696591,0x3555b993,0x353ca003,0x351ebc12,0x3560a6cf,0x35495521,0x352c800f,0x350af1b7
.long 0x355695e5,0x353b8f3b,0x351b02c6,0x34ebcbbb,0x354b41fa,0x352c800f,0x35084b92,0x34bf926f
.long 0x353ebc1b,0x351c420c,0x34e900b7,0x34919ddd,0x35311722,0x350af1b7,0x34bf926f,0x3444b0b9
.long 0,0,0,0,0x33cefdb7,0x33db7d37,0x33e7fa9a,0x33f475c0
.long 0x344dee60,0x345a3997,0x34667c66,0x3472b651,0x349920fe,0x34a21887,0x34ab0201,0x34b3dca5
.long 0x34c9b953,0x34d53641,0x34e0924f,0x34ebcbbb,0x34f840c8,0x3502ef9f,0x35099f4e,0x35102dd5
.long 0x35121eb0,0x3519c200,0x35212ff9,0x35286605,0x35269de3,0x352ecef7,0x3536ad7f,0x353e35c5
.long 0x35396842,0x3541d870,0x3549d112,0x35514d3d,0x354a4c87,0x3552a649,0x355a5ba0,0x3561668a
.long 0x35591e6a,0x356106f2,0x356816a8,0x356e46be,0x3565b710,0x356cd007,0x3572d4eb,0x3577beb7
.long 0x356ff573,0x3575dec6,0x357a7302,0x357dabcc,0x3577beb7,0x357c187a,0x357ed7d4,0x357ff84a
.long 0x357cfe73,0x357f6ac7,0x357ff4e6,0x357e9bc9,0x357fa6e3,0x357fcbe2,0x357dc68c,0x35799b43
.long 0x357fb10f,0x357d3aac,0x357853f8,0x35710908,0x357d1cdd,0x3577beb7,0x356faf1b,0x35650479
.long 0x3577f110,0x356f6830,0x3563f473,0x3555b993,0x35703b37,0x35644fac,0x35554aa4,0x35436051
.long 0x35660f88,0x355695e5,0x3543e200,0x352e3bde,0x355988ad,0x35466354,0x352ff3e6,0x3516999f
.long 0x354ac77f,0x3533e7bc,0x3519c200,0x34f9a02d,0x3539f2ac,0x351f599f,0x35019573,0x34c27b55
.long 0x35273656,0x3508f59b,0x34cf7bca,0x34888e93,0x3512c39a,0x34e1fb6a,0x349920fe,0x34195be0
.long 0x34f9a02d,0x34af713a,0x34419b37,0x32fb49ba,0x34cb2aae,0x3475c35a,0x339cecf9,0xb3b5f8da
.long 0x349aa086,0x3409cf86,0xb316c32c,0xb4541501,0x345101f1,0x32e22a7a,0xb4195be0,0xb4a5129f
.long 0x33d53db9,0xb3a3308c,0xb48586ce,0xb4ddbe79,0x31490fc6,0xb43e853e,0xb4bca7af,0xb5099f4e
.long 0,0,0,0,0x34007745,0x3406b26e,0x340cec4a,0x341324ca
.long 0x347ee6e1,0x348586ce,0x348b9507,0x34919ddd,0x34bca7af,0x34c5625c,0x34ce0bea,0x34d6a399
.long 0x34f6e0cb,0x3500e7e4,0x35064b82,0x350b9a6b,0x3516999f,0x351ce11f,0x352302d3,0x3528fd41
.long 0x352f61a5,0x3536206c,0x353ca003,0x3542de29,0x35456439,0x354c3578,0x3552a649,0x3558b3a1
.long 0x35584853,0x355ebe05,0x3564aa59,0x356a09a7,0x3567c187,0x356d67a1,0x35725470,0x3576841b
.long 0x3573913f,0x3577f110,0x357b61fc,0x357de0b1,0x357b87b2,0x357e2b72,0x357fa6e3,0x357ff84a
.long 0x357f84ab,0x357ffb11,0x357f0e58,0x357cbfc9,0x357f7808,0x357d57de,0x35799b43,0x3574484b
.long 0x357b61fc,0x35764d97,0x356f6830,0x3566becc,0x3573530e,0x356afb8c,0x3560a6cf,0x35546b3b
.long 0x35676bd8,0x355b941a,0x354d9f02,0x353daef9,0x3557dc7f,0x35485bca,0x3536ad7f,0x352302d3
.long 0x3544e3f5,0x3531a81d,0x351c420c,0x3504f484,0x352ecef7,0x3517de12,0x34fdbabb,0x34c8477c
.long 0x3515f6d9,0x34f6e0cb,0x34be1d4a,0x34827dc0,0x34f58035,0x34b9bb1e,0x3475c35a,0x33e7fa9a
.long 0x34bb31a0,0x3472b651,0x33d53db9,0xb2fb49ba,0x347bdba4,0x33db7d37,0xb30a342f,0xb43228d4
.long 0x33fab273,0xb2c90ab0,0xb42f10a2,0xb4a09ae5,0xb1490fc6,0xb41f917b,0xb49c1faf,0xb4e4cbfe
.long 0xb4039502,0xb4919ddd,0xb4ddbe79,0xb5121eb0,0xb480f8c0,0xb4d0eb2a,0xb50d9281,0xb52ecef7
.long 0xb4be1d4a,0xb5064b82,0xb5299415,0xb547de65,0xb4f840c8,0xb521cbfb,0xb5425b89,0xb55cc7d1
.long 0xb5173c07,0xb53a7ca4,0xb5577026,0xb56d1c1d,0xb52ff3e6,0xb54fefa8,0xb5686b39,0xb5788486
.long 0,0,0,0,0x34195be0,0x341f917b,0x3425c58c,0x342bf804
.long 0x3497a117,0x349d9e78,0x34a395c5,0x34a986c4,0x34df28a9,0x34e79a5d,0x34eff7fb,0x34f840c8
.long 0x3510d3cd,0x3515f6d9,0x351b02c6,0x351ff6cb,0x352ecef7,0x3534768f,0x3539f2ac,0x353f41fc
.long 0x3548d8b3,0x354e8d90,0x3553fac3,0x35591e6a,0x355e5aa6,0x356398ac,0x35686b39,0x356cd007
.long 0x356ed89e,0x35731447,0x3576ba07,0x3579c79d,0x3579f35e,0x357c9f8a,0x357e868b,0x357fa6e3
.long 0x357f6ac7,0x357ffec4,0x357f9c18,0x357e4323,0x357f1f49,0x357d1cdd,0x3579f35e,0x3575a67b
.long 0x35791298,0x35740bdd,0x356db293,0x35660f88,0x356d67a1,0x35650479,0x355b2c79,0x354fefa8
.long 0x355c61c7,0x355064af,0x3542de29,0x3533e7bc,0x35466354,0x3536ad7f,0x35256bcb,0x3512c39a
.long 0x352beb4a,0x35187fc0,0x35039c3d,0x34dae880,0x350d9281,0x34ed3063,0x34bca7af,0x348a11f7
.long 0x34d8106b,0x34a395c5,0x345a3997,0x33d53db9,0x34901c2c,0x342bf804,0x3355880e,0xb383db0a
.long 0x3409cf86,0x32490e90,0xb3e1bc2e,0xb46c9a7f,0xb27b514b,0xb41324ca,0xb48a11f7,0xb4c8477c
.long 0xb428defc,0xb497a117,0xb4d8106b,0xb50a48ad,0xb49f1cdf,0xb4e1fb6a,0xb5102dd5,0xb52c800f
.long 0xb4e63375,0xb513682a,0xb53085bb,0xb549d112,0xb5140c5f,0xb53238aa,0xb54c3578,0xb561668a
.long 0xb531a81d,0xb54cae79,0xb5628210,0xb57294f8,0xb54b41fa,0xb562241a,0xb572d4eb,0xb57cdf6c
.long 0xb5604621,0xb5721352,0xb57cbfc9,0xb57ffb11,0xb5703b37,0xb57c187a,0xb57fffb1,0xb57bd14d
.long 0xb57ac516,0xb57ff4e6,0xb57c7eb0,0xb5708066,0xb57fa6e3,0xb57d906e,0xb5725470,0xb55e5aa6
.long 0,0,0,0,0x343228d4,0x343857ec,0x343e853e,0x3444b0b9
.long 0x34af713a,0x34b554ec,0x34bb31a0,0x34c1071e,0x35003a06,0x35044889,0x35084b92,0x350c42c9
.long 0x3524d225,0x35299415,0x352e3bde,0x3532c8c9,0x35446337,0x35495521,0x354e1689,0x3552a649
.long 0x355df6be,0x35628210,0x3566becc,0x356aab7b,0x3570c501,0x3574484b,0x3577583a,0x3579f35e
.long 0x357c3b28,0x357e1324,0x357f4e6d,0x357fec43,0x357fffb1,0x357f90b1,0x357e5a38,0x357c5d3a
.long 0x357bf531,0x3578b47b,0x35748422,0x356f6830,0x35703b37,0x3569b7e4,0x3562241a,0x355988ad
.long 0x355d2d53,0x35531849,0x3547de65,0x353b8f3b,0x35436051,0x353592e7,0x35269de3,0x3516999f
.long 0x35239da9,0x35121eb0,0x34ff17b2,0x34d8106b,0x34fdbabb,0x34d3c867,0x34a80b1f,0x3475c35a
.long 0x34ac7cd4,0x3478cfcc,0x34164083,0x3348fb30,0x342bf804,0x3383db0a,0xb32351cb,0xb41324ca
.long 0xb1c90f88,0xb3ee3876,0xb4667c66,0xb4a986c4,0xb43857ec,0xb49620d2,0xb4ce0bea,0xb5019573
.long 0xb4b263ef,0xb4ebcbbb,0xb510d3cd,0xb5299415,0xb5019573,0xb51ce11f,0xb53592e7,0xb54b41fa
.long 0xb526050a,0xb53ebc1b,0xb553fac3,0xb5655e0b,0xb5456439,0xb55a5ba0,0xb56afb8c,0xb576ef5b
.long 0xb55ebe05,0xb56ed89e,0xb579c79d,0xb57f4e6d,0xb5714c7a,0xb57b87b2,0xb57fdaaf,0xb57e2b72
.long 0xb57c7eb0,0xb57ffec4,0xb57cfe73,0xb573913f,0xb57ffd39,0xb57c187a,0xb5714c7a,0xb55fe4e9
.long 0xb57baccd,0xb56ff573,0xb55d2d53,0xb543e200,0xb56faf1b,0xb55bfb34,0xb54154e1,0xb5209393
.long 0xb55c61c7,0xb540d0da,0xb51ebc12,0xb4ee9479,0xb5425b89,0xb51f599f,0xb4ed3063,0xb4931f35
.long 0x3f80,0x3f80,0x3f80,0x3f80,0x3dc93f7f,0x3e953f75,0x3ef13f62,0x3f223f46
.long 0x3e483f7b,0x3f0e3f55,0x3f553f0e,0x3f7b3e48,0x3e953f75,0x3f463f22,0x3f7f3dc9,0x3f62bef1
.long 0x3ec43f6d,0x3f6d3ec4,0x3f6dbec4,0x3ec4bf6d,0x3ef13f62,0x3f7f3dc9,0x3f22bf46,0xbe95bf75
.long 0x3f0e3f55,0x3f7bbe48,0x3e48bf7b,0xbf55bf0e,0x3f223f46,0x3f62bef1,0xbe95bf75,0xbf7f3dc9
.long 0x3f353f35,0x3f35bf35,0xbf35bf35,0xbf353f35,0x3f463f22,0x3ef1bf62,0xbf75be95,0xbdc93f7f
.long 0x3f553f0e,0x3e48bf7b,0xbf7b3e48,0x3f0e3f55,0x3f623ef1,0xbdc9bf7f,0xbf463f22,0x3f753e95
.long 0x3f6d3ec4,0xbec4bf6d,0xbec43f6d,0x3f6dbec4,0x3f753e95,0xbf22bf46,0x3dc93f7f,0x3ef1bf62
.long 0x3f7b3e48,0xbf55bf0e,0x3f0e3f55,0xbe48bf7b,0x3f7f3dc9,0xbf75be95,0x3f623ef1,0xbf46bf22
.long 0x3f800000,0xbf800000,0x3f800000,0xbf800000,0x3f7fbdc9,0xbf753e95,0x3f62bef1,0xbf463f22
.long 0x3f7bbe48,0xbf553f0e,0x3f0ebf55,0xbe483f7b,0x3f75be95,0xbf223f46,0x3dc9bf7f,0x3ef13f62
.long 0x3f6dbec4,0xbec43f6d,0xbec4bf6d,0x3f6d3ec4,0x3f62bef1,0xbdc93f7f,0xbf46bf22,0x3f75be95
.long 0x3f55bf0e,0x3e483f7b,0xbf7bbe48,0x3f0ebf55,0x3f46bf22,0x3ef13f62,0xbf753e95,0xbdc9bf7f
.long 0x3f35bf35,0x3f353f35,0xbf353f35,0xbf35bf35,0x3f22bf46,0x3f623ef1,0xbe953f75,0xbf7fbdc9
.long 0x3f0ebf55,0x3f7b3e48,0x3e483f7b,0xbf553f0e,0x3ef1bf62,0x3f7fbdc9,0x3f223f46,0xbe953f75
.long 0x3ec4bf6d,0x3f6dbec4,0x3f6d3ec4,0x3ec43f6d,0x3e95bf75,0x3f46bf22,0x3f7fbdc9,0x3f623ef1
.long 0x3e48bf7b,0x3f0ebf55,0x3f55bf0e,0x3f7bbe48,0x3dc9bf7f,0x3e95bf75,0x3ef1bf62,0x3f22bf46
.long 0x3f80,0x3f80,0x3f80,0x3f80,0x3f463f22,0x3f623ef1,0x3f753e95,0x3f7f3dc9
.long 0x3f7bbe48,0x3f55bf0e,0x3f0ebf55,0x3e48bf7b,0x3ef1bf62,0xbdc9bf7f,0xbf22bf46,0xbf75be95
.long 0xbec4bf6d,0xbf6dbec4,0xbf6d3ec4,0xbec43f6d,0xbf75be95,0xbf463f22,0x3dc93f7f,0x3f623ef1
.long 0xbf553f0e,0x3e483f7b,0x3f7b3e48,0x3f0ebf55,0xbdc93f7f,0x3f753e95,0x3ef1bf62,0xbf46bf22
.long 0x3f353f35,0x3f35bf35,0xbf35bf35,0xbf353f35,0x3f7fbdc9,0xbe95bf75,0xbf623ef1,0x3f223f46
.long 0x3f0ebf55,0xbf7bbe48,0x3e483f7b,0x3f55bf0e,0xbe95bf75,0xbf223f46,0x3f7f3dc9,0xbef1bf62
.long 0xbf6dbec4,0x3ec43f6d,0x3ec4bf6d,0xbf6d3ec4,0xbf623ef1,0x3f7f3dc9,0xbf46bf22,0x3e953f75
.long 0xbe483f7b,0x3f0ebf55,0xbf553f0e,0x3f7bbe48,0x3f223f46,0xbef1bf62,0x3e953f75,0xbdc9bf7f
.long 0x3f800000,0xbf800000,0x3f800000,0xbf800000,0x3f22bf46,0xbef13f62,0x3e95bf75,0xbdc93f7f
.long 0xbe48bf7b,0x3f0e3f55,0xbf55bf0e,0x3f7b3e48,0xbf62bef1,0x3f7fbdc9,0xbf463f22,0x3e95bf75
.long 0xbf6d3ec4,0x3ec4bf6d,0x3ec43f6d,0xbf6dbec4,0xbe953f75,0xbf22bf46,0x3f7fbdc9,0xbef13f62
.long 0x3f0e3f55,0xbf7b3e48,0x3e48bf7b,0x3f553f0e,0x3f7f3dc9,0xbe953f75,0xbf62bef1,0x3f22bf46
.long 0x3f35bf35,0x3f353f35,0xbf353f35,0xbf35bf35,0xbdc9bf7f,0x3f75be95,0x3ef13f62,0xbf463f22
.long 0xbf55bf0e,0x3e48bf7b,0x3f7bbe48,0x3f0e3f55,0xbf753e95,0xbf46bf22,0x3dc9bf7f,0x3f62bef1
.long 0xbec43f6d,0xbf6d3ec4,0xbf6dbec4,0xbec4bf6d,0x3ef13f62,0xbdc93f7f,0xbf223f46,0xbf753e95
.long 0x3f7b3e48,0x3f553f0e,0x3f0e3f55,0x3e483f7b,0x3f46bf22,0x3f62bef1,0x3f75be95,0x3f7fbdc9
.long 0x3f80,0x3f80,0x3f80,0x3f80,0x3f7fbdc9,0x3f75be95,0x3f62bef1,0x3f46bf22
.long 0xbe48bf7b,0xbf0ebf55,0xbf55bf0e,0xbf7bbe48,0xbf753e95,0xbf223f46,0xbdc93f7f,0x3ef13f62
.long 0x3ec43f6d,0x3f6d3ec4,0x3f6dbec4,0x3ec4bf6d,0x3f62bef1,0x3dc9bf7f,0xbf46bf22,0xbf753e95
.long 0xbf0ebf55,0xbf7b3e48,0xbe483f7b,0x3f553f0e,0xbf463f22,0x3ef13f62,0x3f75be95,0xbdc9bf7f
.long 0x3f353f35,0x3f35bf35,0xbf35bf35,0xbf353f35,0x3f22bf46,0xbf62bef1,0xbe953f75,0x3f7f3dc9
.long 0xbf55bf0e,0xbe483f7b,0x3f7bbe48,0xbf0ebf55,0xbef13f62,0x3f7fbdc9,0xbf22bf46,0xbe953f75
.long 0x3f6d3ec4,0xbec4bf6d,0xbec43f6d,0x3f6dbec4,0x3e95bf75,0xbf463f22,0x3f7fbdc9,0xbf62bef1
.long 0xbf7bbe48,0x3f553f0e,0xbf0ebf55,0x3e483f7b,0xbdc93f7f,0x3e95bf75,0xbef13f62,0x3f22bf46
.long 0x3f800000,0xbf800000,0x3f800000,0xbf800000,0xbdc9bf7f,0x3e953f75,0xbef1bf62,0x3f223f46
.long 0xbf7b3e48,0x3f55bf0e,0xbf0e3f55,0x3e48bf7b,0x3e953f75,0xbf46bf22,0x3f7f3dc9,0xbf623ef1
.long 0x3f6dbec4,0xbec43f6d,0xbec4bf6d,0x3f6d3ec4,0xbef1bf62,0x3f7f3dc9,0xbf223f46,0xbe95bf75
.long 0xbf553f0e,0xbe48bf7b,0x3f7b3e48,0xbf0e3f55,0x3f223f46,0xbf623ef1,0xbe95bf75,0x3f7fbdc9
.long 0x3f35bf35,0x3f353f35,0xbf353f35,0xbf35bf35,0xbf46bf22,0x3ef1bf62,0x3f753e95,0xbdc93f7f
.long 0xbf0e3f55,0xbf7bbe48,0xbe48bf7b,0x3f55bf0e,0x3f623ef1,0x3dc93f7f,0xbf463f22,0xbf75be95
.long 0x3ec4bf6d,0x3f6dbec4,0x3f6d3ec4,0x3ec43f6d,0xbf75be95,0xbf22bf46,0xbdc9bf7f,0x3ef1bf62
.long 0xbe483f7b,0xbf0e3f55,0xbf553f0e,0xbf7b3e48,0x3f7f3dc9,0x3f753e95,0x3f623ef1,0x3f463f22
.long 0x3f80,0x3f80,0x3f80,0x3f80,0x3f22bf46,0x3ef1bf62,0x3e95bf75,0x3dc9bf7f
.long 0xbf7b3e48,0xbf553f0e,0xbf0e3f55,0xbe483f7b,0x3f623ef1,0x3f7fbdc9,0x3f46bf22,0x3e95bf75
.long 0xbec4bf6d,0xbf6dbec4,0xbf6d3ec4,0xbec43f6d,0xbe953f75,0x3f223f46,0x3f7fbdc9,0x3ef1bf62
.long 0x3f55bf0e,0xbe48bf7b,0xbf7bbe48,0xbf0e3f55,0xbf7fbdc9,0xbe953f75,0x3f623ef1,0x3f22bf46
.long 0x3f353f35,0x3f35bf35,0xbf35bf35,0xbf353f35,0xbdc9bf7f,0xbf753e95,0x3ef13f62,0x3f46bf22
.long 0xbf0e3f55,0x3f7b3e48,0xbe48bf7b,0xbf553f0e,0x3f75be95,0xbf46bf22,0xbdc93f7f,0x3f62bef1
.long 0xbf6dbec4,0x3ec43f6d,0x3ec4bf6d,0xbf6d3ec4,0x3ef13f62,0x3dc9bf7f,0xbf223f46,0x3f75be95
.long 0x3e48bf7b,0xbf0e3f55,0x3f55bf0e,0xbf7b3e48,0xbf463f22,0x3f62bef1,0xbf753e95,0x3f7fbdc9
.long 0x3f800000,0xbf800000,0x3f800000,0xbf800000,0xbf46bf22,0x3f623ef1,0xbf75be95,0x3f7f3dc9
.long 0x3e483f7b,0xbf0ebf55,0x3f553f0e,0xbf7bbe48,0x3ef1bf62,0x3dc93f7f,0xbf22bf46,0x3f753e95
.long 0xbf6d3ec4,0x3ec4bf6d,0x3ec43f6d,0xbf6dbec4,0x3f753e95,0xbf463f22,0xbdc9bf7f,0x3f623ef1
.long 0xbf0ebf55,0x3f7bbe48,0xbe483f7b,0xbf55bf0e,0xbdc93f7f,0xbf75be95,0x3ef1bf62,0x3f463f22
.long 0x3f35bf35,0x3f353f35,0xbf353f35,0xbf35bf35,0xbf7f3dc9,0xbe95bf75,0x3f62bef1,0x3f223f46
.long 0x3f553f0e,0xbe483f7b,0xbf7b3e48,0xbf0ebf55,0xbe95bf75,0x3f22bf46,0x3f7f3dc9,0x3ef13f62
.long 0xbec43f6d,0xbf6d3ec4,0xbf6dbec4,0xbec4bf6d,0x3f62bef1,0x3f7f3dc9,0x3f463f22,0x3e953f75
.long 0xbf7bbe48,0xbf55bf0e,0xbf0ebf55,0xbe48bf7b,0x3f223f46,0x3ef13f62,0x3e953f75,0x3dc93f7f
.long 0x3f80,0x3f80,0x3f80,0x3f80,0xbdc9bf7f,0xbe95bf75,0xbef1bf62,0xbf22bf46
.long 0x3e483f7b,0x3f0e3f55,0x3f553f0e,0x3f7b3e48,0xbe95bf75,0xbf46bf22,0xbf7fbdc9,0xbf623ef1
.long 0x3ec43f6d,0x3f6d3ec4,0x3f6dbec4,0x3ec4bf6d,0xbef1bf62,0xbf7fbdc9,0xbf223f46,0x3e953f75
.long 0x3f0e3f55,0x3f7bbe48,0x3e48bf7b,0xbf55bf0e,0xbf22bf46,0xbf623ef1,0x3e953f75,0x3f7fbdc9
.long 0x3f353f35,0x3f35bf35,0xbf35bf35,0xbf353f35,0xbf46bf22,0xbef13f62,0x3f753e95,0x3dc9bf7f
.long 0x3f553f0e,0x3e48bf7b,0xbf7b3e48,0x3f0e3f55,0xbf62bef1,0x3dc93f7f,0x3f46bf22,0xbf75be95
.long 0x3f6d3ec4,0xbec4bf6d,0xbec43f6d,0x3f6dbec4,0xbf75be95,0x3f223f46,0xbdc9bf7f,0xbef13f62
.long 0x3f7b3e48,0xbf55bf0e,0x3f0e3f55,0xbe48bf7b,0xbf7fbdc9,0x3f753e95,0xbf62bef1,0x3f463f22
.long 0x3f800000,0xbf800000,0x3f800000,0xbf800000,0xbf7f3dc9,0x3f75be95,0xbf623ef1,0x3f46bf22
.long 0x3f7bbe48,0xbf553f0e,0x3f0ebf55,0xbe483f7b,0xbf753e95,0x3f22bf46,0xbdc93f7f,0xbef1bf62
.long 0x3f6dbec4,0xbec43f6d,0xbec4bf6d,0x3f6d3ec4,0xbf623ef1,0x3dc9bf7f,0x3f463f22,0xbf753e95
.long 0x3f55bf0e,0x3e483f7b,0xbf7bbe48,0x3f0ebf55,0xbf463f22,0xbef1bf62,0x3f75be95,0x3dc93f7f
.long 0x3f35bf35,0x3f353f35,0xbf353f35,0xbf35bf35,0xbf223f46,0xbf62bef1,0x3e95bf75,0x3f7f3dc9
.long 0x3f0ebf55,0x3f7b3e48,0x3e483f7b,0xbf553f0e,0xbef13f62,0xbf7f3dc9,0xbf22bf46,0x3e95bf75
.long 0x3ec4bf6d,0x3f6dbec4,0x3f6d3ec4,0x3ec43f6d,0xbe953f75,0xbf463f22,0xbf7f3dc9,0xbf62bef1
.long 0x3e48bf7b,0x3f0ebf55,0x3f55bf0e,0x3f7bbe48,0xbdc93f7f,0xbe953f75,0xbef13f62,0xbf223f46
.long 0x3f80,0x3f80,0x3f80,0x3f80,0xbf46bf22,0xbf62bef1,0xbf75be95,0xbf7fbdc9
.long 0x3f7bbe48,0x3f55bf0e,0x3f0ebf55,0x3e48bf7b,0xbef13f62,0x3dc93f7f,0x3f223f46,0x3f753e95
.long 0xbec4bf6d,0xbf6dbec4,0xbf6d3ec4,0xbec43f6d,0x3f753e95,0x3f46bf22,0xbdc9bf7f,0xbf62bef1
.long 0xbf553f0e,0x3e483f7b,0x3f7b3e48,0x3f0ebf55,0x3dc9bf7f,0xbf75be95,0xbef13f62,0x3f463f22
.long 0x3f353f35,0x3f35bf35,0xbf35bf35,0xbf353f35,0xbf7f3dc9,0x3e953f75,0x3f62bef1,0xbf22bf46
.long 0x3f0ebf55,0xbf7bbe48,0x3e483f7b,0x3f55bf0e,0x3e953f75,0x3f22bf46,0xbf7fbdc9,0x3ef13f62
.long 0xbf6dbec4,0x3ec43f6d,0x3ec4bf6d,0xbf6d3ec4,0x3f62bef1,0xbf7fbdc9,0x3f463f22,0xbe95bf75
.long 0xbe483f7b,0x3f0ebf55,0xbf553f0e,0x3f7bbe48,0xbf22bf46,0x3ef13f62,0xbe95bf75,0x3dc93f7f
.long 0x3f800000,0xbf800000,0x3f800000,0xbf800000,0xbf223f46,0x3ef1bf62,0xbe953f75,0x3dc9bf7f
.long 0xbe48bf7b,0x3f0e3f55,0xbf55bf0e,0x3f7b3e48,0x3f623ef1,0xbf7f3dc9,0x3f46bf22,0xbe953f75
.long 0xbf6d3ec4,0x3ec4bf6d,0x3ec43f6d,0xbf6dbec4,0x3e95bf75,0x3f223f46,0xbf7f3dc9,0x3ef1bf62
.long 0x3f0e3f55,0xbf7b3e48,0x3e48bf7b,0x3f553f0e,0xbf7fbdc9,0x3e95bf75,0x3f623ef1,0xbf223f46
.long 0x3f35bf35,0x3f353f35,0xbf353f35,0xbf35bf35,0x3dc93f7f,0xbf753e95,0xbef1bf62,0x3f46bf22
.long 0xbf55bf0e,0x3e48bf7b,0x3f7bbe48,0x3f0e3f55,0x3f75be95,0x3f463f22,0xbdc93f7f,0xbf623ef1
.long 0xbec43f6d,0xbf6d3ec4,0xbf6dbec4,0xbec4bf6d,0xbef1bf62,0x3dc9bf7f,0x3f22bf46,0x3f75be95
.long 0x3f7b3e48,0x3f553f0e,0x3f0e3f55,0x3e483f7b,0xbf463f22,0xbf623ef1,0xbf753e95,0xbf7f3dc9
.long 0x3f80,0x3f80,0x3f80,0x3f80,0xbf7f3dc9,0xbf753e95,0xbf623ef1,0xbf463f22
.long 0xbe48bf7b,0xbf0ebf55,0xbf55bf0e,0xbf7bbe48,0x3f75be95,0x3f22bf46,0x3dc9bf7f,0xbef1bf62
.long 0x3ec43f6d,0x3f6d3ec4,0x3f6dbec4,0x3ec4bf6d,0xbf623ef1,0xbdc93f7f,0x3f463f22,0x3f75be95
.long 0xbf0ebf55,0xbf7b3e48,0xbe483f7b,0x3f553f0e,0x3f46bf22,0xbef1bf62,0xbf753e95,0x3dc93f7f
.long 0x3f353f35,0x3f35bf35,0xbf35bf35,0xbf353f35,0xbf223f46,0x3f623ef1,0x3e95bf75,0xbf7fbdc9
.long 0xbf55bf0e,0xbe483f7b,0x3f7bbe48,0xbf0ebf55,0x3ef1bf62,0xbf7f3dc9,0x3f223f46,0x3e95bf75
.long 0x3f6d3ec4,0xbec4bf6d,0xbec43f6d,0x3f6dbec4,0xbe953f75,0x3f46bf22,0xbf7f3dc9,0x3f623ef1
.long 0xbf7bbe48,0x3f553f0e,0xbf0ebf55,0x3e483f7b,0x3dc9bf7f,0xbe953f75,0x3ef1bf62,0xbf223f46
.long 0x3f800000,0xbf800000,0x3f800000,0xbf800000,0x3dc93f7f,0xbe95bf75,0x3ef13f62,0xbf22bf46
.long 0xbf7b3e48,0x3f55bf0e,0xbf0e3f55,0x3e48bf7b,0xbe95bf75,0x3f463f22,0xbf7fbdc9,0x3f62bef1
.long 0x3f6dbec4,0xbec43f6d,0xbec4bf6d,0x3f6d3ec4,0x3ef13f62,0xbf7fbdc9,0x3f22bf46,0x3e953f75
.long 0xbf553f0e,0xbe48bf7b,0x3f7b3e48,0xbf0e3f55,0xbf22bf46,0x3f62bef1,0x3e953f75,0xbf7f3dc9
.long 0x3f35bf35,0x3f353f35,0xbf353f35,0xbf35bf35,0x3f463f22,0xbef13f62,0xbf75be95,0x3dc9bf7f
.long 0xbf0e3f55,0xbf7bbe48,0xbe48bf7b,0x3f55bf0e,0xbf62bef1,0xbdc9bf7f,0x3f46bf22,0x3f753e95
.long 0x3ec4bf6d,0x3f6dbec4,0x3f6d3ec4,0x3ec43f6d,0x3f753e95,0x3f223f46,0x3dc93f7f,0xbef13f62
.long 0xbe483f7b,0xbf0e3f55,0xbf553f0e,0xbf7b3e48,0xbf7fbdc9,0xbf75be95,0xbf62bef1,0xbf46bf22
.long 0x3f80,0x3f80,0x3f80,0x3f80,0xbf223f46,0xbef13f62,0xbe953f75,0xbdc93f7f
.long 0xbf7b3e48,0xbf553f0e,0xbf0e3f55,0xbe483f7b,0xbf62bef1,0xbf7f3dc9,0xbf463f22,0xbe953f75
.long 0xbec4bf6d,0xbf6dbec4,0xbf6d3ec4,0xbec43f6d,0x3e95bf75,0xbf22bf46,0xbf7f3dc9,0xbef13f62
.long 0x3f55bf0e,0xbe48bf7b,0xbf7bbe48,0xbf0e3f55,0x3f7f3dc9,0x3e95bf75,0xbf62bef1,0xbf223f46
.long 0x3f353f35,0x3f35bf35,0xbf35bf35,0xbf353f35,0x3dc93f7f,0x3f75be95,0xbef1bf62,0xbf463f22
.long 0xbf0e3f55,0x3f7b3e48,0xbe48bf7b,0xbf553f0e,0xbf753e95,0x3f463f22,0x3dc9bf7f,0xbf623ef1
.long 0xbf6dbec4,0x3ec43f6d,0x3ec4bf6d,0xbf6d3ec4,0xbef1bf62,0xbdc93f7f,0x3f22bf46,0xbf753e95
.long 0x3e48bf7b,0xbf0e3f55,0x3f55bf0e,0xbf7b3e48,0x3f46bf22,0xbf623ef1,0x3f75be95,0xbf7f3dc9
.long 0x3f800000,0xbf800000,0x3f800000,0xbf800000,0x3f463f22,0xbf62bef1,0x3f753e95,0xbf7fbdc9
.long 0x3e483f7b,0xbf0ebf55,0x3f553f0e,0xbf7bbe48,0xbef13f62,0xbdc9bf7f,0x3f223f46,0xbf75be95
.long 0xbf6d3ec4,0x3ec4bf6d,0x3ec43f6d,0xbf6dbec4,0xbf75be95,0x3f46bf22,0x3dc93f7f,0xbf62bef1
.long 0xbf0ebf55,0x3f7bbe48,0xbe483f7b,0xbf55bf0e,0x3dc9bf7f,0x3f753e95,0xbef13f62,0xbf46bf22
.long 0x3f35bf35,0x3f353f35,0xbf353f35,0xbf35bf35,0x3f7fbdc9,0x3e953f75,0xbf623ef1,0xbf22bf46
.long 0x3f553f0e,0xbe483f7b,0xbf7b3e48,0xbf0ebf55,0x3e953f75,0xbf223f46,0xbf7fbdc9,0xbef1bf62
.long 0xbec43f6d,0xbf6d3ec4,0xbf6dbec4,0xbec4bf6d,0xbf623ef1,0xbf7fbdc9,0xbf46bf22,0xbe95bf75
.long 0xbf7bbe48,0xbf55bf0e,0xbf0ebf55,0xbe48bf7b,0xbf22bf46,0xbef1bf62,0xbe95bf75,0xbdc9bf7f
.long 0x3f808000,0x3f808000,0x3f808000,0x3f808000,0x3f7fbdc9,0x3f75be95,0x3f62bef1,0x3f46bf22
.long 0x3f7bbe48,0x3f55bf0e,0x3f0ebf55,0x3e48bf7b,0x3f75be95,0x3f22bf46,0x3dc9bf7f,0xbef1bf62
.long 0x3f6dbec4,0x3ec4bf6d,0xbec4bf6d,0xbf6dbec4,0x3f62bef1,0x3dc9bf7f,0xbf46bf22,0xbf753e95
.long 0x3f55bf0e,0xbe48bf7b,0xbf7bbe48,0xbf0e3f55,0x3f46bf22,0xbef1bf62,0xbf753e95,0x3dc93f7f
.long 0x3f35bf35,0xbf35bf35,0xbf353f35,0x3f353f35,0x3f22bf46,0xbf62bef1,0xbe953f75,0x3f7f3dc9
.long 0x3f0ebf55,0xbf7bbe48,0x3e483f7b,0x3f55bf0e,0x3ef1bf62,0xbf7f3dc9,0x3f223f46,0x3e95bf75
.long 0x3ec4bf6d,0xbf6d3ec4,0x3f6d3ec4,0xbec4bf6d,0x3e95bf75,0xbf463f22,0x3f7fbdc9,0xbf62bef1
.long 0x3e48bf7b,0xbf0e3f55,0x3f55bf0e,0xbf7b3e48,0x3dc9bf7f,0xbe953f75,0x3ef1bf62,0xbf223f46
.long 0xbf80,0x3f80,0xbf80,0x3f80,0xbdc9bf7f,0x3e953f75,0xbef1bf62,0x3f223f46
.long 0xbe48bf7b,0x3f0e3f55,0xbf55bf0e,0x3f7b3e48,0xbe95bf75,0x3f463f22,0xbf7fbdc9,0x3f62bef1
.long 0xbec4bf6d,0x3f6d3ec4,0xbf6d3ec4,0x3ec4bf6d,0xbef1bf62,0x3f7f3dc9,0xbf223f46,0xbe95bf75
.long 0xbf0ebf55,0x3f7bbe48,0xbe483f7b,0xbf55bf0e,0xbf22bf46,0x3f62bef1,0x3e953f75,0xbf7f3dc9
.long 0xbf35bf35,0x3f35bf35,0x3f353f35,0xbf353f35,0xbf46bf22,0x3ef1bf62,0x3f753e95,0xbdc93f7f
.long 0xbf55bf0e,0x3e48bf7b,0x3f7bbe48,0x3f0e3f55,0xbf62bef1,0xbdc9bf7f,0x3f46bf22,0x3f753e95
.long 0xbf6dbec4,0xbec4bf6d,0x3ec4bf6d,0x3f6dbec4,0xbf75be95,0xbf22bf46,0xbdc9bf7f,0x3ef1bf62
.long 0xbf7bbe48,0xbf55bf0e,0xbf0ebf55,0xbe48bf7b,0xbf7fbdc9,0xbf75be95,0xbf62bef1,0xbf46bf22
.long 0x3f808000,0x3f808000,0x3f808000,0x3f808000,0x3f22bf46,0x3ef1bf62,0x3e95bf75,0x3dc9bf7f
.long 0xbe48bf7b,0xbf0ebf55,0xbf55bf0e,0xbf7bbe48,0xbf62bef1,0xbf7f3dc9,0xbf463f22,0xbe953f75
.long 0xbf6d3ec4,0xbec43f6d,0x3ec43f6d,0x3f6d3ec4,0xbe953f75,0x3f223f46,0x3f7fbdc9,0x3ef1bf62
.long 0x3f0e3f55,0x3f7bbe48,0x3e48bf7b,0xbf55bf0e,0x3f7f3dc9,0x3e95bf75,0xbf62bef1,0xbf223f46
.long 0x3f35bf35,0xbf35bf35,0xbf353f35,0x3f353f35,0xbdc9bf7f,0xbf753e95,0x3ef13f62,0x3f46bf22
.long 0xbf55bf0e,0xbe483f7b,0x3f7bbe48,0xbf0ebf55,0xbf753e95,0x3f463f22,0x3dc9bf7f,0xbf623ef1
.long 0xbec43f6d,0x3f6dbec4,0xbf6dbec4,0x3ec43f6d,0x3ef13f62,0x3dc9bf7f,0xbf223f46,0x3f75be95
.long 0x3f7b3e48,0xbf55bf0e,0x3f0e3f55,0xbe48bf7b,0x3f46bf22,0xbf623ef1,0x3f75be95,0xbf7f3dc9
.long 0xbf80,0x3f80,0xbf80,0x3f80,0xbf46bf22,0x3f623ef1,0xbf75be95,0x3f7f3dc9
.long 0xbf7b3e48,0x3f55bf0e,0xbf0e3f55,0x3e48bf7b,0xbef13f62,0xbdc9bf7f,0x3f223f46,0xbf75be95
.long 0x3ec43f6d,0xbf6dbec4,0x3f6dbec4,0xbec43f6d,0x3f753e95,0xbf463f22,0xbdc9bf7f,0x3f623ef1
.long 0x3f55bf0e,0x3e483f7b,0xbf7bbe48,0x3f0ebf55,0x3dc9bf7f,0x3f753e95,0xbef13f62,0xbf46bf22
.long 0xbf35bf35,0x3f35bf35,0x3f353f35,0xbf353f35,0xbf7f3dc9,0xbe95bf75,0x3f62bef1,0x3f223f46
.long 0xbf0e3f55,0xbf7bbe48,0xbe48bf7b,0x3f55bf0e,0x3e953f75,0xbf223f46,0xbf7fbdc9,0xbef1bf62
.long 0x3f6d3ec4,0x3ec43f6d,0xbec43f6d,0xbf6d3ec4,0x3f62bef1,0x3f7f3dc9,0x3f463f22,0x3e953f75
.long 0x3e48bf7b,0x3f0ebf55,0x3f55bf0e,0x3f7bbe48,0xbf22bf46,0xbef1bf62,0xbe95bf75,0xbdc9bf7f
.long 0x3f808000,0x3f808000,0x3f808000,0x3f808000,0xbdc9bf7f,0xbe95bf75,0xbef1bf62,0xbf22bf46
.long 0xbf7b3e48,0xbf553f0e,0xbf0e3f55,0xbe483f7b,0x3e953f75,0x3f463f22,0x3f7f3dc9,0x3f62bef1
.long 0x3f6dbec4,0x3ec4bf6d,0xbec4bf6d,0xbf6dbec4,0xbef1bf62,0xbf7fbdc9,0xbf223f46,0x3e953f75
.long 0xbf553f0e,0x3e483f7b,0x3f7b3e48,0x3f0ebf55,0x3f223f46,0x3f62bef1,0xbe95bf75,0xbf7f3dc9
.long 0x3f35bf35,0xbf35bf35,0xbf353f35,0x3f353f35,0xbf46bf22,0xbef13f62,0x3f753e95,0x3dc9bf7f
.long 0xbf0e3f55,0x3f7b3e48,0xbe48bf7b,0xbf553f0e,0x3f623ef1,0xbdc9bf7f,0xbf463f22,0x3f753e95
.long 0x3ec4bf6d,0xbf6d3ec4,0x3f6d3ec4,0xbec4bf6d,0xbf75be95,0x3f223f46,0xbdc9bf7f,0xbef13f62
.long 0xbe483f7b,0x3f0ebf55,0xbf553f0e,0x3f7bbe48,0x3f7f3dc9,0xbf75be95,0x3f623ef1,0xbf46bf22
.long 0xbf80,0x3f80,0xbf80,0x3f80,0xbf7f3dc9,0x3f75be95,0xbf623ef1,0x3f46bf22
.long 0x3e483f7b,0xbf0ebf55,0x3f553f0e,0xbf7bbe48,0x3f75be95,0xbf223f46,0x3dc9bf7f,0x3ef13f62
.long 0xbec4bf6d,0x3f6d3ec4,0xbf6d3ec4,0x3ec4bf6d,0xbf623ef1,0x3dc9bf7f,0x3f463f22,0xbf753e95
.long 0x3f0e3f55,0xbf7b3e48,0x3e48bf7b,0x3f553f0e,0x3f46bf22,0x3ef13f62,0xbf753e95,0xbdc9bf7f
.long 0xbf35bf35,0x3f35bf35,0x3f353f35,0xbf353f35,0xbf223f46,0xbf62bef1,0x3e95bf75,0x3f7f3dc9
.long 0x3f553f0e,0xbe483f7b,0xbf7b3e48,0xbf0ebf55,0x3ef1bf62,0x3f7fbdc9,0x3f223f46,0xbe953f75
.long 0xbf6dbec4,0xbec4bf6d,0x3ec4bf6d,0x3f6dbec4,0xbe953f75,0xbf463f22,0xbf7f3dc9,0xbf62bef1
.long 0x3f7b3e48,0x3f553f0e,0x3f0e3f55,0x3e483f7b,0x3dc9bf7f,0x3e95bf75,0x3ef1bf62,0x3f22bf46
.long 0x3f808000,0x3f808000,0x3f808000,0x3f808000,0xbf46bf22,0xbf62bef1,0xbf75be95,0xbf7fbdc9
.long 0x3e483f7b,0x3f0e3f55,0x3f553f0e,0x3f7b3e48,0x3ef1bf62,0xbdc9bf7f,0xbf22bf46,0xbf75be95
.long 0xbf6d3ec4,0xbec43f6d,0x3ec43f6d,0x3f6d3ec4,0x3f753e95,0x3f46bf22,0xbdc9bf7f,0xbf62bef1
.long 0xbf0ebf55,0xbf7b3e48,0xbe483f7b,0x3f553f0e,0xbdc93f7f,0x3f753e95,0x3ef1bf62,0xbf46bf22
.long 0x3f35bf35,0xbf35bf35,0xbf353f35,0x3f353f35,0xbf7f3dc9,0x3e953f75,0x3f62bef1,0xbf22bf46
.long 0x3f553f0e,0x3e48bf7b,0xbf7b3e48,0x3f0e3f55,0xbe95bf75,0xbf223f46,0x3f7f3dc9,0xbef1bf62
.long 0xbec43f6d,0x3f6dbec4,0xbf6dbec4,0x3ec43f6d,0x3f62bef1,0xbf7fbdc9,0x3f463f22,0xbe95bf75
.long 0xbf7bbe48,0x3f553f0e,0xbf0ebf55,0x3e483f7b,0x3f223f46,0xbef1bf62,0x3e953f75,0xbdc9bf7f
.long 0xbf80,0x3f80,0xbf80,0x3f80,0xbf223f46,0x3ef1bf62,0xbe953f75,0x3dc9bf7f
.long 0x3f7bbe48,0xbf553f0e,0x3f0ebf55,0xbe483f7b,0xbf62bef1,0x3f7fbdc9,0xbf463f22,0x3e95bf75
.long 0x3ec43f6d,0xbf6dbec4,0x3f6dbec4,0xbec43f6d,0x3e95bf75,0x3f223f46,0xbf7f3dc9,0x3ef1bf62
.long 0xbf553f0e,0xbe48bf7b,0x3f7b3e48,0xbf0e3f55,0x3f7f3dc9,0xbe953f75,0xbf62bef1,0x3f22bf46
.long 0xbf35bf35,0x3f35bf35,0x3f353f35,0xbf353f35,0x3dc93f7f,0xbf753e95,0xbef1bf62,0x3f46bf22
.long 0x3f0ebf55,0x3f7b3e48,0x3e483f7b,0xbf553f0e,0xbf753e95,0xbf46bf22,0x3dc9bf7f,0x3f62bef1
.long 0x3f6d3ec4,0x3ec43f6d,0xbec43f6d,0xbf6d3ec4,0xbef1bf62,0x3dc9bf7f,0x3f22bf46,0x3f75be95
.long 0xbe483f7b,0xbf0e3f55,0xbf553f0e,0xbf7b3e48,0x3f46bf22,0x3f62bef1,0x3f75be95,0x3f7fbdc9
.long 0x3f808000,0x3f808000,0x3f808000,0x3f808000,0xbf7f3dc9,0xbf753e95,0xbf623ef1,0xbf463f22
.long 0x3f7bbe48,0x3f55bf0e,0x3f0ebf55,0x3e48bf7b,0xbf753e95,0xbf223f46,0xbdc93f7f,0x3ef13f62
.long 0x3f6dbec4,0x3ec4bf6d,0xbec4bf6d,0xbf6dbec4,0xbf623ef1,0xbdc93f7f,0x3f463f22,0x3f75be95
.long 0x3f55bf0e,0xbe48bf7b,0xbf7bbe48,0xbf0e3f55,0xbf463f22,0x3ef13f62,0x3f75be95,0xbdc9bf7f
.long 0x3f35bf35,0xbf35bf35,0xbf353f35,0x3f353f35,0xbf223f46,0x3f623ef1,0x3e95bf75,0xbf7fbdc9
.long 0x3f0ebf55,0xbf7bbe48,0x3e483f7b,0x3f55bf0e,0xbef13f62,0x3f7fbdc9,0xbf22bf46,0xbe953f75
.long 0x3ec4bf6d,0xbf6d3ec4,0x3f6d3ec4,0xbec4bf6d,0xbe953f75,0x3f46bf22,0xbf7f3dc9,0x3f623ef1
.long 0x3e48bf7b,0xbf0e3f55,0x3f55bf0e,0xbf7b3e48,0xbdc93f7f,0x3e95bf75,0xbef13f62,0x3f22bf46
.long 0xbf80,0x3f80,0xbf80,0x3f80,0x3dc93f7f,0xbe95bf75,0x3ef13f62,0xbf22bf46
.long 0xbe48bf7b,0x3f0e3f55,0xbf55bf0e,0x3f7b3e48,0x3e953f75,0xbf46bf22,0x3f7f3dc9,0xbf623ef1
.long 0xbec4bf6d,0x3f6d3ec4,0xbf6d3ec4,0x3ec4bf6d,0x3ef13f62,0xbf7fbdc9,0x3f22bf46,0x3e953f75
.long 0xbf0ebf55,0x3f7bbe48,0xbe483f7b,0xbf55bf0e,0x3f223f46,0xbf623ef1,0xbe95bf75,0x3f7fbdc9
.long 0xbf35bf35,0x3f35bf35,0x3f353f35,0xbf353f35,0x3f463f22,0xbef13f62,0xbf75be95,0x3dc9bf7f
.long 0xbf55bf0e,0x3e48bf7b,0x3f7bbe48,0x3f0e3f55,0x3f623ef1,0x3dc93f7f,0xbf463f22,0xbf75be95
.long 0xbf6dbec4,0xbec4bf6d,0x3ec4bf6d,0x3f6dbec4,0x3f753e95,0x3f223f46,0x3dc93f7f,0xbef13f62
.long 0xbf7bbe48,0xbf55bf0e,0xbf0ebf55,0xbe48bf7b,0x3f7f3dc9,0x3f753e95,0x3f623ef1,0x3f463f22
.long 0x3f808000,0x3f808000,0x3f808000,0x3f808000,0xbf223f46,0xbef13f62,0xbe953f75,0xbdc93f7f
.long 0xbe48bf7b,0xbf0ebf55,0xbf55bf0e,0xbf7bbe48,0x3f623ef1,0x3f7fbdc9,0x3f46bf22,0x3e95bf75
.long 0xbf6d3ec4,0xbec43f6d,0x3ec43f6d,0x3f6d3ec4,0x3e95bf75,0xbf22bf46,0xbf7f3dc9,0xbef13f62
.long 0x3f0e3f55,0x3f7bbe48,0x3e48bf7b,0xbf55bf0e,0xbf7fbdc9,0xbe953f75,0x3f623ef1,0x3f22bf46
.long 0x3f35bf35,0xbf35bf35,0xbf353f35,0x3f353f35,0x3dc93f7f,0x3f75be95,0xbef1bf62,0xbf463f22
.long 0xbf55bf0e,0xbe483f7b,0x3f7bbe48,0xbf0ebf55,0x3f75be95,0xbf46bf22,0xbdc93f7f,0x3f62bef1
.long 0xbec43f6d,0x3f6dbec4,0xbf6dbec4,0x3ec43f6d,0xbef1bf62,0xbdc93f7f,0x3f22bf46,0xbf753e95
.long 0x3f7b3e48,0xbf55bf0e,0x3f0e3f55,0xbe48bf7b,0xbf463f22,0x3f62bef1,0xbf753e95,0x3f7fbdc9
.long 0xbf80,0x3f80,0xbf80,0x3f80,0x3f463f22,0xbf62bef1,0x3f753e95,0xbf7fbdc9
.long 0xbf7b3e48,0x3f55bf0e,0xbf0e3f55,0x3e48bf7b,0x3ef1bf62,0x3dc93f7f,0xbf22bf46,0x3f753e95
.long 0x3ec43f6d,0xbf6dbec4,0x3f6dbec4,0xbec43f6d,0xbf75be95,0x3f46bf22,0x3dc93f7f,0xbf62bef1
.long 0x3f55bf0e,0x3e483f7b,0xbf7bbe48,0x3f0ebf55,0xbdc93f7f,0xbf75be95,0x3ef1bf62,0x3f463f22
.long 0xbf35bf35,0x3f35bf35,0x3f353f35,0xbf353f35,0x3f7fbdc9,0x3e953f75,0xbf623ef1,0xbf22bf46
.long 0xbf0e3f55,0xbf7bbe48,0xbe48bf7b,0x3f55bf0e,0xbe95bf75,0x3f22bf46,0x3f7f3dc9,0x3ef13f62
.long 0x3f6d3ec4,0x3ec43f6d,0xbec43f6d,0xbf6d3ec4,0xbf623ef1,0xbf7fbdc9,0xbf46bf22,0xbe95bf75
.long 0x3e48bf7b,0x3f0ebf55,0x3f55bf0e,0x3f7bbe48,0x3f223f46,0x3ef13f62,0x3e953f75,0x3dc93f7f
.long 0x3f808000,0x3f808000,0x3f808000,0x3f808000,0x3dc93f7f,0x3e953f75,0x3ef13f62,0x3f223f46
.long 0xbf7b3e48,0xbf553f0e,0xbf0e3f55,0xbe483f7b,0xbe95bf75,0xbf46bf22,0xbf7fbdc9,0xbf623ef1
.long 0x3f6dbec4,0x3ec4bf6d,0xbec4bf6d,0xbf6dbec4,0x3ef13f62,0x3f7f3dc9,0x3f22bf46,0xbe95bf75
.long 0xbf553f0e,0x3e483f7b,0x3f7b3e48,0x3f0ebf55,0xbf22bf46,0xbf623ef1,0x3e953f75,0x3f7fbdc9
.long 0x3f35bf35,0xbf35bf35,0xbf353f35,0x3f353f35,0x3f463f22,0x3ef1bf62,0xbf75be95,0xbdc93f7f
.long 0xbf0e3f55,0x3f7b3e48,0xbe48bf7b,0xbf553f0e,0xbf62bef1,0x3dc93f7f,0x3f46bf22,0xbf75be95
.long 0x3ec4bf6d,0xbf6d3ec4,0x3f6d3ec4,0xbec4bf6d,0x3f753e95,0xbf22bf46,0x3dc93f7f,0x3ef1bf62
.long 0xbe483f7b,0x3f0ebf55,0xbf553f0e,0x3f7bbe48,0xbf7fbdc9,0x3f753e95,0xbf62bef1,0x3f463f22
.long 0xbf80,0x3f80,0xbf80,0x3f80,0x3f7fbdc9,0xbf753e95,0x3f62bef1,0xbf463f22
.long 0x3e483f7b,0xbf0ebf55,0x3f553f0e,0xbf7bbe48,0xbf753e95,0x3f22bf46,0xbdc93f7f,0xbef1bf62
.long 0xbec4bf6d,0x3f6d3ec4,0xbf6d3ec4,0x3ec4bf6d,0x3f62bef1,0xbdc93f7f,0xbf46bf22,0x3f75be95
.long 0x3f0e3f55,0xbf7b3e48,0x3e48bf7b,0x3f553f0e,0xbf463f22,0xbef1bf62,0x3f75be95,0x3dc93f7f
.long 0xbf35bf35,0x3f35bf35,0x3f353f35,0xbf353f35,0x3f22bf46,0x3f623ef1,0xbe953f75,0xbf7fbdc9
.long 0x3f553f0e,0xbe483f7b,0xbf7b3e48,0xbf0ebf55,0xbef13f62,0xbf7f3dc9,0xbf22bf46,0x3e95bf75
.long 0xbf6dbec4,0xbec4bf6d,0x3ec4bf6d,0x3f6dbec4,0x3e95bf75,0x3f46bf22,0x3f7fbdc9,0x3f623ef1
.long 0x3f7b3e48,0x3f553f0e,0x3f0e3f55,0x3e483f7b,0xbdc93f7f,0xbe953f75,0xbef13f62,0xbf223f46
.long 0x3f808000,0x3f808000,0x3f808000,0x3f808000,0x3f463f22,0x3f623ef1,0x3f753e95,0x3f7f3dc9
.long 0x3e483f7b,0x3f0e3f55,0x3f553f0e,0x3f7b3e48,0xbef13f62,0x3dc93f7f,0x3f223f46,0x3f753e95
.long 0xbf6d3ec4,0xbec43f6d,0x3ec43f6d,0x3f6d3ec4,0xbf75be95,0xbf463f22,0x3dc93f7f,0x3f623ef1
.long 0xbf0ebf55,0xbf7b3e48,0xbe483f7b,0x3f553f0e,0x3dc9bf7f,0xbf75be95,0xbef13f62,0x3f463f22
.long 0x3f35bf35,0xbf35bf35,0xbf353f35,0x3f353f35,0x3f7fbdc9,0xbe95bf75,0xbf623ef1,0x3f223f46
.long 0x3f553f0e,0x3e48bf7b,0xbf7b3e48,0x3f0e3f55,0x3e953f75,0x3f22bf46,0xbf7fbdc9,0x3ef13f62
.long 0xbec43f6d,0x3f6dbec4,0xbf6dbec4,0x3ec43f6d,0xbf623ef1,0x3f7f3dc9,0xbf46bf22,0x3e953f75
.long 0xbf7bbe48,0x3f553f0e,0xbf0ebf55,0x3e483f7b,0xbf22bf46,0x3ef13f62,0xbe95bf75,0x3dc93f7f
.long 0xbf80,0x3f80,0xbf80,0x3f80,0x3f22bf46,0xbef13f62,0x3e95bf75,0xbdc93f7f
.long 0x3f7bbe48,0xbf553f0e,0x3f0ebf55,0xbe483f7b,0x3f623ef1,0xbf7f3dc9,0x3f46bf22,0xbe953f75
.long 0x3ec43f6d,0xbf6dbec4,0x3f6dbec4,0xbec43f6d,0xbe953f75,0xbf22bf46,0x3f7fbdc9,0xbef13f62
.long 0xbf553f0e,0xbe48bf7b,0x3f7b3e48,0xbf0e3f55,0xbf7fbdc9,0x3e95bf75,0x3f623ef1,0xbf223f46
.long 0xbf35bf35,0x3f35bf35,0x3f353f35,0xbf353f35,0xbdc9bf7f,0x3f75be95,0x3ef13f62,0xbf463f22
.long 0x3f0ebf55,0x3f7b3e48,0x3e483f7b,0xbf553f0e,0x3f75be95,0x3f463f22,0xbdc93f7f,0xbf623ef1
.long 0x3f6d3ec4,0x3ec43f6d,0xbec43f6d,0xbf6d3ec4,0x3ef13f62,0xbdc93f7f,0xbf223f46,0xbf753e95
.long 0xbe483f7b,0xbf0e3f55,0xbf553f0e,0xbf7b3e48,0xbf463f22,0xbf623ef1,0xbf753e95,0xbf7f3dc9
.size fft_tab, 110592
```
